```python
import torch

def _softmax(x, axis=-1):
    return torch.softmax(x, dim=axis)
def _gelu(x):
    return torch.nn.functional.gelu(x, approximate="tanh")
def _silu(x):
    return torch.nn.functional.silu(x)
def _sigmoid(x):
    return torch.sigmoid(x)
def _layernorm(x, axis=-1, eps=1e-5):
    m = x.mean(dim=axis, keepdim=True)
    v = x.var(dim=axis, keepdim=True, unbiased=False)
    return (x - m) / torch.sqrt(v + eps)
def _scatter_add(tgt, idx, src, axis=0):
    return tgt.clone().index_add_(axis, idx, src)
def _segment_sum(src, seg, n):
    out = torch.zeros((n,) + src.shape[1:], dtype=src.dtype)
    return out.index_add_(0, seg, src)
def _pad(x, pw):
    flat = tuple(v for pair in reversed(pw) for v in pair)
    return torch.nn.functional.pad(x, flat)

kernel_name = 'concat_heads__mha_block_cached__gqa_block_cached__near_ridge'

def setup_inputs():

    _w = (lambda a: (lambda t: t.to(torch.bfloat16) if t.is_floating_point() else t)(torch.as_tensor(a)))
    def _A_setup():
        B, Sq, D = 16, 192, 512
        H, Sk, Dh = 32, 512, 128
        return {
            "x": _w((lambda *s: torch.randn(*s, dtype=torch.bfloat16) * 0.8)(B, Sq, D)),
            "k_cache": _w((lambda *s: torch.randn(*s, dtype=torch.bfloat16) * 0.8)(B, H, Sk, Dh)),
            "v_cache": _w((lambda *s: torch.randn(*s, dtype=torch.bfloat16) * 0.05)(B, H, Sk, Dh)),
            "wq": _w((lambda *s: torch.randn(*s, dtype=torch.bfloat16) * 0.8)(D, H * Dh) * (D ** -0.5)),
            "wo": _w((lambda *s: torch.randn(*s, dtype=torch.bfloat16) * 0.05)(H * Dh, D) * ((H * Dh) ** -0.5)),
        }
    _A_in = _A_setup()

    def _B_setup():
        B, Sq, D = 16, 192, 512
        Hq, Hkv, Sk, Dh = 32, 32, 512, 128
        assert Hq % Hkv == 0, (Hq, Hkv)
        return {
            "x": _w((lambda *s: torch.randn(*s, dtype=torch.bfloat16) * 0.8)(B, Sq, D)),
            "k_cache": _w((lambda *s: torch.randn(*s, dtype=torch.bfloat16) * 0.8)(B, Hkv, Sk, Dh)),
            "v_cache": _w((lambda *s: torch.randn(*s, dtype=torch.bfloat16) * 0.05)(B, Hkv, Sk, Dh)),
            "wq": _w((lambda *s: torch.randn(*s, dtype=torch.bfloat16) * 0.8)(D, Hq * Dh) * (D ** -0.5)),
            "wo": _w((lambda *s: torch.randn(*s, dtype=torch.bfloat16) * 0.05)(Hq * Dh, D) * ((Hq * Dh) ** -0.5)),
        }
    _B_in = _B_setup()

    return {
        "A_x": _A_in["x"],
        "A_k_cache": _A_in["k_cache"],
        "A_v_cache": _A_in["v_cache"],
        "A_wq": _A_in["wq"],
        "A_wo": _A_in["wo"],
        "B_x": _B_in["x"],
        "B_k_cache": _B_in["k_cache"],
        "B_v_cache": _B_in["v_cache"],
        "B_wq": _B_in["wq"],
        "B_wo": _B_in["wo"],
    }

def reference(A_x, A_k_cache, A_v_cache, A_wq, A_wo, B_x, B_k_cache, B_v_cache, B_wq, B_wo):
    def _A_ref(x, k_cache, v_cache, wq, wo):
        B, Sq, D = x.shape
        H, Dh = 32, 128
        q = (lambda x, *d: x.permute(*d))((x @ wq).reshape(B, Sq, H, Dh), 0, 2, 1, 3)
        scores = torch.einsum("bhqd,bhkd->bhqk", q, k_cache) * (Dh ** -0.5)
        p = _softmax(scores, axis=-1)
        o = torch.einsum("bhqk,bhkd->bhqd", p, v_cache)
        return (lambda x, *d: x.permute(*d))(o, 0, 2, 1, 3).reshape(B, Sq, H * Dh) @ wo

    def _B_ref(x, k_cache, v_cache, wq, wo):
        B, Sq, D = x.shape
        Hq, Dh = 32, 128
        Hkv = k_cache.shape[1]
        rep = Hq // Hkv
        q = (lambda x, *d: x.permute(*d))((x @ wq).reshape(B, Sq, Hq, Dh), 0, 2, 1, 3)
        k = (lambda x, n, axis: torch.repeat_interleave(x, n, dim=axis))(k_cache, rep, axis=1)
        v = (lambda x, n, axis: torch.repeat_interleave(x, n, dim=axis))(v_cache, rep, axis=1)
        scores = torch.einsum("bhqd,bhkd->bhqk", q, k) * (Dh ** -0.5)
        p = _softmax(scores, axis=-1)
        o = torch.einsum("bhqk,bhkd->bhqd", p, v)
        return (lambda x, *d: x.permute(*d))(o, 0, 2, 1, 3).reshape(B, Sq, Hq * Dh) @ wo

    a = _A_ref(A_x, A_k_cache, A_v_cache, A_wq, A_wo)
    b = _B_ref(B_x, B_k_cache, B_v_cache, B_wq, B_wo)
    return torch.concatenate([a, b], axis=-1)
```

```asm
; @launch grid=(256,1,1) block=(256,1,1) lds=163840
.amdgcn_target "amdgcn-amd-amdhsa--gfx950"
.text
.globl concat_heads__mha_block_cached__gqa_block_cached__near_ridge_kernel
.p2align 8
.type concat_heads__mha_block_cached__gqa_block_cached__near_ridge_kernel,@function
concat_heads__mha_block_cached__gqa_block_cached__near_ridge_kernel:
s_cmp_ge_u32 s2, 256
s_cbranch_scc1 K2_END
s_load_dwordx16 s[48:63], s[0:1], 0
s_load_dwordx8 s[64:71], s[0:1], 64
s_load_dwordx2 s[72:73], s[0:1], 96
v_lshrrev_b32 v1, 6, v0
v_and_b32 v0, 63, v0
v_readfirstlane_b32 s28, v1
s_and_b32 s86, s2, 7
s_lshr_b32 s87, s2, 3
s_lshr_b32 s31, s86, 2
s_and_b32 s88, s86, 1
s_lshl_b32 s88, s88, 3
s_and_b32 s82, s87, 7
s_add_u32 s32, s88, s82
s_lshr_b32 s88, s86, 1
s_and_b32 s88, s88, 1
s_lshl_b32 s88, s88, 2
s_lshr_b32 s83, s87, 3
s_add_u32 s33, s88, s83
s_and_b32 s29, s28, 1
s_lshr_b32 s30, s28, 1
s_waitcnt lgkmcnt(0)
s_cmp_eq_u32 s31, 0
s_cselect_b32 s4, s48, s58
s_cselect_b32 s5, s49, s59
s_cselect_b32 s8, s54, s64
s_cselect_b32 s9, s55, s65
s_cselect_b32 s20, s56, s66
s_cselect_b32 s21, s57, s67
s_cselect_b32 s90, s50, s60
s_cselect_b32 s91, s51, s61
s_cselect_b32 s92, s52, s62
s_cselect_b32 s93, s53, s63
s_cmp_eq_u32 s30, 0
s_cselect_b32 s12, s90, s92
s_cselect_b32 s13, s91, s93
s_cselect_b32 s94, 64, 128
s_cselect_b32 s95, 128, 0
s_mov_b32 s96, 128
s_cselect_b32 s96, 192, s96
s_cselect_b32 s97, 0, 1
s_cselect_b32 s35, 0, 32768
s_mov_b32 s6, 3145728
s_mov_b32 s7, 0x00020000
s_mov_b32 s10, 4194304
s_mov_b32 s11, 0x00020000
s_mov_b32 s22, 4194304
s_mov_b32 s23, 0x00020000
s_mov_b32 s14, 67108864
s_mov_b32 s15, 0x00020000
s_mov_b32 s16, s72
s_mov_b32 s17, s73
s_mov_b32 s18, 0
s_mov_b32 s19, 0x00020000
s_add_u32 s24, s72, 50331648
s_addc_u32 s25, s73, 0
s_mov_b32 s26, 8388608
s_mov_b32 s27, 0x00020000
s_lshl_b32 s88, s32, 5
s_lshl_b32 s89, s33, 2
s_add_u32 s88, s88, s89
s_lshl_b32 s89, s29, 1
s_add_u32 s88, s88, s89
s_lshl_b32 s34, s88, 17
s_lshl_b32 s89, s29, 14
s_add_u32 s35, s35, s89
s_lshl_b32 s88, s28, 16
s_lshl_b32 s89, s33, 10
s_add_u32 s36, s88, s89
s_lshl_b32 s37, s28, 12
s_lshl_b32 s88, s82, 19
s_add_u32 s78, s36, s88
s_mul_i32 s88, s32, 196608
s_mul_i32 s89, s28, 49152
s_add_u32 s38, s88, s89
s_mul_i32 s39, s28, 6144
s_lshl_b32 s88, s83, 8
s_add_u32 s79, s38, s88
s_lshl_b32 s88, s83, 1
s_add_u32 s88, s88, s82
s_and_b32 s88, s88, 7
s_lshl_b32 s78, s88, 19
s_lshl_b32 s79, s88, 7
s_mov_b32 s81, 196608
s_mul_i32 s88, s2, 5
s_lshr_b32 s89, s2, 4
s_add_u32 s88, s88, s89
s_and_b32 s88, s88, 15
s_lshl_b32 s85, s88, 13
s_lshl_b32 s88, s31, 4
s_add_u32 s88, s88, s32
s_lshl_b32 s88, s88, 1
s_add_u32 s88, s88, s30
s_lshl_b32 s88, s88, 7
s_lshl_b32 s89, s33, 4
s_add_u32 s88, s88, s89
s_lshl_b32 s89, s29, 3
s_add_u32 s88, s88, s89
s_mul_i32 s40, s88, 6144
s_and_b32 s88, s86, 3
s_lshl_b32 s88, s88, 5
s_add_u32 s88, s88, s87
s_lshl_b32 s89, s88, 15
s_lshl_b32 s98, s28, 13
s_add_u32 s44, s89, s98
s_lshl_b32 s89, s31, 2
s_add_u32 s89, s89, s28
s_lshl_b32 s89, s89, 7
s_add_u32 s89, s89, s88
s_lshl_b32 s45, s89, 13
s_mov_b32 s43, 0x3e0293ee
s_mov_b32 s46, 0
v_and_b32 v14, 15, v0
v_lshrrev_b32 v8, 4, v0
v_lshrrev_b32 v9, 2, v14
v_and_b32 v10, 3, v14
v_lshlrev_b32 v4, 4, v0
v_lshrrev_b32 v11, 5, v0
v_and_b32 v12, 15, v0
v_lshlrev_b32 v13, 2, v11
v_xor_b32 v12, v12, v13
v_lshlrev_b32 v12, 4, v12
v_lshl_add_u32 v12, v11, 13, v12
v_bfe_u32 v13, v0, 4, 1
v_lshl_add_u32 v60, v13, 9, v12
v_xor_b32 v61, 128, v60
v_add_u32 v2, 30720, v60
v_add_u32 v3, 46080, v61
v_add_u32 v61, 15360, v61
v_lshrrev_b32 v11, 3, v0
v_and_b32 v12, 7, v0
v_xor_b32 v12, v12, v8
v_lshlrev_b32 v12, 4, v12
v_lshl_add_u32 v62, v11, 10, v12
v_xor_b32 v63, 64, v62
v_add_u32 v6, 14336, v62
v_add_u32 v7, 21504, v63
v_add_u32 v63, 7168, v63
v_lshlrev_b32 v11, s97, v8
v_xor_b32 v11, v11, v14
v_lshlrev_b32 v11, 4, v11
v_lshl_add_u32 v50, v8, 8, v11
v_xor_b32 v51, s94, v50
v_xor_b32 v52, s95, v50
v_xor_b32 v53, s96, v50
s_mov_b32 s18, 0
s_add_u32 s42, s78, 0
s_and_b32 s42, s42, 0x3fffff
s_add_u32 s42, s42, s36
s_add_u32 m0, s37, 65536
s_nop 0
buffer_load_dwordx4 v60, s[8:11], s42 offen offset:0  lds
buffer_load_dwordx4 v61, s[8:11], s42 offen offset:1024  lds
buffer_load_dwordx4 v2, s[8:11], s42 offen offset:2048  lds
buffer_load_dwordx4 v3, s[8:11], s42 offen offset:3072  lds
s_add_u32 s42, s79, 0
s_and_b32 s42, s42, 1023
s_add_u32 s42, s42, s38
s_add_u32 m0, s39, 139264
s_nop 0
buffer_load_dwordx4 v62, s[4:7], s42 offen offset:0  lds
buffer_load_dwordx4 v63, s[4:7], s42 offen offset:1024  lds
buffer_load_dwordx4 v6, s[4:7], s42 offen offset:2048  lds
buffer_load_dwordx4 v7, s[4:7], s42 offen offset:3072  lds
s_add_u32 s42, s42, 32768
s_add_u32 m0, s39, 143360
s_nop 0
buffer_load_dwordx4 v62, s[4:7], s42 offen offset:0  lds
buffer_load_dwordx4 v63, s[4:7], s42 offen offset:1024  lds
s_add_u32 s42, s78, 262144
s_and_b32 s42, s42, 0x3fffff
s_add_u32 s42, s42, s36
s_add_u32 m0, s37, 81920
s_nop 0
buffer_load_dwordx4 v60, s[8:11], s42 offen offset:0  lds
buffer_load_dwordx4 v61, s[8:11], s42 offen offset:1024  lds
buffer_load_dwordx4 v2, s[8:11], s42 offen offset:2048  lds
buffer_load_dwordx4 v3, s[8:11], s42 offen offset:3072  lds
s_lshl_b32 s88, s29, 14
v_xor_b32 v11, v8, v14
v_lshlrev_b32 v11, 4, v11
v_lshl_add_u32 v11, v14, 8, v11
v_add_u32 v38, s88, v11
v_xor_b32 v39, 64, v38
v_xor_b32 v40, 128, v38
v_xor_b32 v41, 192, v38
v_and_b32 v11, 1, v8
v_lshlrev_b32 v11, 2, v11
v_add_u32 v11, v11, v9
v_lshlrev_b32 v11, 1, v11
v_lshrrev_b32 v12, 1, v10
v_xor_b32 v11, v11, v12
v_lshlrev_b32 v11, 4, v11
v_and_b32 v12, 1, v10
v_lshl_add_u32 v11, v12, 3, v11
v_lshl_add_u32 v12, v8, 2, v9
v_lshl_add_u32 v11, v12, 8, v11
s_add_u32 s89, s88, 32768
v_add_u32 v42, s89, v11
v_xor_b32 v43, 32, v42
v_xor_b32 v44, 64, v42
v_xor_b32 v45, 96, v42
v_xor_b32 v46, 128, v42
v_xor_b32 v47, 160, v42
v_xor_b32 v48, 192, v42
v_xor_b32 v49, 224, v42
s_lshl_b32 s88, s29, 4
v_add_u32 v11, s88, v10
v_lshlrev_b32 v12, 2, v9
v_xor_b32 v11, v11, v12
v_lshlrev_b32 v11, 4, v11
v_lshl_add_u32 v12, v8, 3, v9
v_lshl_add_u32 v11, v12, 9, v11
v_add_u32 v54, 65536, v11
v_xor_b32 v55, 64, v54
v_xor_b32 v56, 128, v54
v_xor_b32 v57, 192, v54
s_mul_i32 s88, s30, 12288
s_add_u32 s88, s88, 114688
v_lshrrev_b32 v11, 1, v14
v_xor_b32 v11, v11, v8
v_lshlrev_b32 v11, 4, v11
v_lshl_add_u32 v11, v14, 7, v11
v_add_u32 v58, s88, v11
v_xor_b32 v59, 64, v58
s_mov_b32 s86, s43
s_mov_b32 s87, s43
s_mov_b32 s92, s70
s_mov_b32 s93, s71
s_mov_b32 s94, 256
s_mov_b32 s95, 0x00020000
s_lshl_b32 s97, s31, 2
s_add_u32 s97, s97, 0
s_lshl_b32 s88, s31, 4
s_add_u32 s88, s88, s32
s_add_u32 s88, s88, 2
s_lshl_b32 s96, s88, 2
s_mov_b32 s97, s96
v_mov_b32 v11, 0x3f803f80
v_accvgpr_write_b32 a224, v11
v_accvgpr_write_b32 a225, v11
v_accvgpr_write_b32 a226, v11
v_accvgpr_write_b32 a227, v11
L_A:
s_lshl_b32 s84, s46, 17
s_waitcnt vmcnt(10)
s_waitcnt vmcnt(4)
s_barrier
ds_read_b64_tr_b16 a[96:97], v54 offset:0
ds_read_b64_tr_b16 a[98:99], v54 offset:2048
ds_read_b64_tr_b16 a[100:101], v54 offset:8
ds_read_b64_tr_b16 a[102:103], v54 offset:2056
ds_read_b64_tr_b16 a[104:105], v55 offset:0
ds_read_b64_tr_b16 a[106:107], v55 offset:2048
ds_read_b64_tr_b16 a[108:109], v55 offset:8
ds_read_b64_tr_b16 a[110:111], v55 offset:2056
ds_read_b64_tr_b16 a[112:113], v56 offset:0
ds_read_b64_tr_b16 a[114:115], v56 offset:2048
ds_read_b64_tr_b16 a[116:117], v56 offset:8
ds_read_b64_tr_b16 a[118:119], v56 offset:2056
ds_read_b64_tr_b16 a[120:121], v57 offset:0
ds_read_b64_tr_b16 a[122:123], v57 offset:2048
ds_read_b64_tr_b16 a[124:125], v57 offset:8
ds_read_b64_tr_b16 a[126:127], v57 offset:2056
ds_read_b128 a[128:131], v58 offset:24576
ds_read_b128 a[132:135], v58 offset:26624
ds_read_b128 a[136:139], v58 offset:28672
ds_read_b128 a[140:143], v58 offset:30720
ds_read_b128 a[144:147], v58 offset:32768
ds_read_b128 a[148:151], v58 offset:34816
s_waitcnt lgkmcnt(0)
v_mfma_f32_16x16x32_bf16 v[64:67], a[96:99], a[128:131], 0
s_add_u32 s42, s78, 524288
s_and_b32 s42, s42, 0x3fffff
s_add_u32 s42, s42, s36
s_add_u32 m0, s37, 98304
s_nop 0
buffer_load_dwordx4 v60, s[8:11], s42 offen offset:0  lds
v_mfma_f32_16x16x32_bf16 v[68:71], a[96:99], a[132:135], 0
v_mfma_f32_16x16x32_bf16 v[72:75], a[96:99], a[136:139], 0
v_mfma_f32_16x16x32_bf16 v[76:79], a[96:99], a[140:143], 0
buffer_load_dwordx4 v61, s[8:11], s42 offen offset:1024  lds
v_mfma_f32_16x16x32_bf16 v[80:83], a[96:99], a[144:147], 0
v_mfma_f32_16x16x32_bf16 v[84:87], a[96:99], a[148:151], 0
v_mfma_f32_16x16x32_bf16 v[88:91], a[100:103], a[128:131], 0
buffer_load_dwordx4 v2, s[8:11], s42 offen offset:2048  lds
v_mfma_f32_16x16x32_bf16 v[92:95], a[100:103], a[132:135], 0
v_mfma_f32_16x16x32_bf16 v[96:99], a[100:103], a[136:139], 0
v_mfma_f32_16x16x32_bf16 v[100:103], a[100:103], a[140:143], 0
v_mfma_f32_16x16x32_bf16 v[104:107], a[100:103], a[144:147], 0
s_waitcnt vmcnt(3)
v_mfma_f32_16x16x32_bf16 v[108:111], a[100:103], a[148:151], 0
s_waitcnt lgkmcnt(0)
s_barrier
buffer_load_dwordx4 v3, s[8:11], s42 offen offset:3072  lds
v_mfma_f32_16x16x32_bf16 v[112:115], a[104:107], a[128:131], 0
v_mfma_f32_16x16x32_bf16 v[116:119], a[104:107], a[132:135], 0
s_add_u32 s42, s79, 128
s_and_b32 s42, s42, 1023
s_add_u32 s42, s42, s38
s_add_u32 m0, s39, 114688
s_nop 0
buffer_load_dwordx4 v62, s[4:7], s42 offen offset:0  lds
v_mfma_f32_16x16x32_bf16 v[120:123], a[104:107], a[136:139], 0
v_mfma_f32_16x16x32_bf16 v[124:127], a[104:107], a[140:143], 0
ds_read_b64_tr_b16 a[96:97], v54 offset:16384
v_mfma_f32_16x16x32_bf16 v[128:131], a[104:107], a[144:147], 0
ds_read_b64_tr_b16 a[98:99], v54 offset:18432
v_mfma_f32_16x16x32_bf16 v[132:135], a[104:107], a[148:151], 0
buffer_load_dwordx4 v63, s[4:7], s42 offen offset:1024  lds
v_mfma_f32_16x16x32_bf16 v[136:139], a[108:111], a[128:131], 0
ds_read_b64_tr_b16 a[100:101], v54 offset:16392
v_mfma_f32_16x16x32_bf16 v[140:143], a[108:111], a[132:135], 0
ds_read_b64_tr_b16 a[102:103], v54 offset:18440
v_mfma_f32_16x16x32_bf16 v[144:147], a[108:111], a[136:139], 0
buffer_load_dwordx4 v6, s[4:7], s42 offen offset:2048  lds
v_mfma_f32_16x16x32_bf16 v[148:151], a[108:111], a[140:143], 0
ds_read_b64_tr_b16 a[104:105], v55 offset:16384
v_mfma_f32_16x16x32_bf16 v[152:155], a[108:111], a[144:147], 0
ds_read_b64_tr_b16 a[106:107], v55 offset:18432
v_mfma_f32_16x16x32_bf16 v[156:159], a[108:111], a[148:151], 0
ds_read_b64_tr_b16 a[108:109], v55 offset:16392
v_mfma_f32_16x16x32_bf16 v[160:163], a[112:115], a[128:131], 0
buffer_load_dwordx4 v7, s[4:7], s42 offen offset:3072  lds
v_mfma_f32_16x16x32_bf16 v[164:167], a[112:115], a[132:135], 0
ds_read_b64_tr_b16 a[110:111], v55 offset:18440
v_mfma_f32_16x16x32_bf16 v[168:171], a[112:115], a[136:139], 0
ds_read_b128 a[152:155], v59 offset:24576
v_mfma_f32_16x16x32_bf16 v[172:175], a[112:115], a[140:143], 0
s_add_u32 s42, s42, 32768
s_add_u32 m0, s39, 118784
s_nop 0
buffer_load_dwordx4 v62, s[4:7], s42 offen offset:0  lds
v_mfma_f32_16x16x32_bf16 v[176:179], a[112:115], a[144:147], 0
v_mfma_f32_16x16x32_bf16 v[180:183], a[112:115], a[148:151], 0
ds_read_b64_tr_b16 a[112:113], v56 offset:16384
v_mfma_f32_16x16x32_bf16 v[184:187], a[116:119], a[128:131], 0
buffer_load_dwordx4 v63, s[4:7], s42 offen offset:1024  lds
v_mfma_f32_16x16x32_bf16 v[188:191], a[116:119], a[132:135], 0
ds_read_b64_tr_b16 a[114:115], v56 offset:18432
v_mfma_f32_16x16x32_bf16 v[192:195], a[116:119], a[136:139], 0
ds_read_b128 a[156:159], v59 offset:26624
v_mfma_f32_16x16x32_bf16 v[196:199], a[116:119], a[140:143], 0
ds_read_b128 a[160:163], v59 offset:28672
v_mfma_f32_16x16x32_bf16 v[200:203], a[116:119], a[144:147], 0
s_add_u32 s42, s78, 786432
s_and_b32 s42, s42, 0x3fffff
s_add_u32 s42, s42, s36
s_add_u32 m0, s37, 65536
s_nop 0
buffer_load_dwordx4 v60, s[8:11], s42 offen offset:0  lds
v_mfma_f32_16x16x32_bf16 v[204:207], a[116:119], a[148:151], 0
v_mfma_f32_16x16x32_bf16 v[208:211], a[120:123], a[128:131], 0
s_add_u32 s83, s40, 4294942720
buffer_store_dwordx4 a[0:3], v4, s[16:19], s83 offen offset:0 sc1
v_mfma_f32_16x16x32_bf16 v[212:215], a[120:123], a[132:135], 0
v_mfma_f32_16x16x32_bf16 v[216:219], a[120:123], a[136:139], 0
buffer_load_dwordx4 v61, s[8:11], s42 offen offset:1024  lds
v_mfma_f32_16x16x32_bf16 v[220:223], a[120:123], a[140:143], 0
ds_read_b128 a[164:167], v59 offset:30720
v_mfma_f32_16x16x32_bf16 v[224:227], a[120:123], a[144:147], 0
ds_read_b128 a[168:171], v59 offset:32768
ds_read_b128 a[172:175], v59 offset:34816
v_mfma_f32_16x16x32_bf16 v[228:231], a[120:123], a[148:151], 0
buffer_store_dwordx4 a[4:7], v4, s[16:19], s83 offen offset:1024 sc1
v_mfma_f32_16x16x32_bf16 v[232:235], a[124:127], a[128:131], 0
buffer_load_dwordx4 v2, s[8:11], s42 offen offset:2048  lds
v_mfma_f32_16x16x32_bf16 v[236:239], a[124:127], a[132:135], 0
ds_read_b64_tr_b16 a[116:117], v56 offset:16392
v_mfma_f32_16x16x32_bf16 v[240:243], a[124:127], a[136:139], 0
ds_read_b64_tr_b16 a[118:119], v56 offset:18440
v_mfma_f32_16x16x32_bf16 v[244:247], a[124:127], a[140:143], 0
buffer_load_dwordx4 v3, s[8:11], s42 offen offset:3072  lds
buffer_store_dwordx4 a[8:11], v4, s[16:19], s83 offen offset:2048 sc1
v_mfma_f32_16x16x32_bf16 v[248:251], a[124:127], a[144:147], 0
v_mfma_f32_16x16x32_bf16 v[252:255], a[124:127], a[148:151], 0
ds_read_b64_tr_b16 a[120:121], v57 offset:16384
ds_read_b64_tr_b16 a[122:123], v57 offset:18432
ds_read_b64_tr_b16 a[124:125], v57 offset:16392
ds_read_b64_tr_b16 a[126:127], v57 offset:18440
s_waitcnt lgkmcnt(4)
v_mfma_f32_16x16x32_bf16 v[64:67], a[96:99], a[152:155], v[64:67]
v_mfma_f32_16x16x32_bf16 v[68:71], a[96:99], a[156:159], v[68:71]
v_mfma_f32_16x16x32_bf16 v[72:75], a[96:99], a[160:163], v[72:75]
v_mfma_f32_16x16x32_bf16 v[76:79], a[96:99], a[164:167], v[76:79]
v_mfma_f32_16x16x32_bf16 v[80:83], a[96:99], a[168:171], v[80:83]
v_mfma_f32_16x16x32_bf16 v[84:87], a[96:99], a[172:175], v[84:87]
v_mfma_f32_16x16x32_bf16 v[88:91], a[100:103], a[152:155], v[88:91]
v_mfma_f32_16x16x32_bf16 v[92:95], a[100:103], a[156:159], v[92:95]
v_mfma_f32_16x16x32_bf16 v[96:99], a[100:103], a[160:163], v[96:99]
v_mfma_f32_16x16x32_bf16 v[100:103], a[100:103], a[164:167], v[100:103]
v_mfma_f32_16x16x32_bf16 v[104:107], a[100:103], a[168:171], v[104:107]
s_waitcnt vmcnt(13)
s_waitcnt vmcnt(7)
v_mfma_f32_16x16x32_bf16 v[108:111], a[100:103], a[172:175], v[108:111]
s_waitcnt lgkmcnt(0)
s_barrier
v_mfma_f32_16x16x32_bf16 v[112:115], a[104:107], a[152:155], v[112:115]
ds_read_b64_tr_b16 a[96:97], v54 offset:32768
v_mfma_f32_16x16x32_bf16 v[116:119], a[104:107], a[156:159], v[116:119]
s_add_u32 s42, s78, 1048576
s_and_b32 s42, s42, 0x3fffff
s_add_u32 s42, s42, s36
s_add_u32 m0, s37, 81920
s_nop 0
buffer_load_dwordx4 v60, s[8:11], s42 offen offset:0  lds
v_mfma_f32_16x16x32_bf16 v[120:123], a[104:107], a[160:163], v[120:123]
v_mfma_f32_16x16x32_bf16 v[124:127], a[104:107], a[164:167], v[124:127]
ds_read_b64_tr_b16 a[98:99], v54 offset:34816
v_mfma_f32_16x16x32_bf16 v[128:131], a[104:107], a[168:171], v[128:131]
buffer_load_dwordx4 v61, s[8:11], s42 offen offset:1024  lds
v_mfma_f32_16x16x32_bf16 v[132:135], a[104:107], a[172:175], v[132:135]
ds_read_b64_tr_b16 a[100:101], v54 offset:32776
v_mfma_f32_16x16x32_bf16 v[136:139], a[108:111], a[152:155], v[136:139]
ds_read_b64_tr_b16 a[102:103], v54 offset:34824
v_mfma_f32_16x16x32_bf16 v[140:143], a[108:111], a[156:159], v[140:143]
ds_read_b64_tr_b16 a[104:105], v55 offset:32768
v_mfma_f32_16x16x32_bf16 v[144:147], a[108:111], a[160:163], v[144:147]
buffer_load_dwordx4 v2, s[8:11], s42 offen offset:2048  lds
v_mfma_f32_16x16x32_bf16 v[148:151], a[108:111], a[164:167], v[148:151]
ds_read_b64_tr_b16 a[106:107], v55 offset:34816
v_mfma_f32_16x16x32_bf16 v[152:155], a[108:111], a[168:171], v[152:155]
ds_read_b128 a[128:131], v58 offset:0
v_mfma_f32_16x16x32_bf16 v[156:159], a[108:111], a[172:175], v[156:159]
ds_read_b64_tr_b16 a[108:109], v55 offset:32776
v_mfma_f32_16x16x32_bf16 v[160:163], a[112:115], a[152:155], v[160:163]
buffer_load_dwordx4 v3, s[8:11], s42 offen offset:3072  lds
v_mfma_f32_16x16x32_bf16 v[164:167], a[112:115], a[156:159], v[164:167]
ds_read_b64_tr_b16 a[110:111], v55 offset:34824
v_mfma_f32_16x16x32_bf16 v[168:171], a[112:115], a[160:163], v[168:171]
ds_read_b128 a[132:135], v58 offset:2048
v_mfma_f32_16x16x32_bf16 v[172:175], a[112:115], a[164:167], v[172:175]
ds_read_b128 a[136:139], v58 offset:4096
v_mfma_f32_16x16x32_bf16 v[176:179], a[112:115], a[168:171], v[176:179]
s_add_u32 s42, s79, 256
s_and_b32 s42, s42, 1023
s_add_u32 s42, s42, s38
s_add_u32 m0, s39, 139264
s_nop 0
buffer_load_dwordx4 v62, s[4:7], s42 offen offset:0  lds
v_mfma_f32_16x16x32_bf16 v[180:183], a[112:115], a[172:175], v[180:183]
v_mfma_f32_16x16x32_bf16 v[184:187], a[116:119], a[152:155], v[184:187]
ds_read_b64_tr_b16 a[112:113], v56 offset:32768
v_mfma_f32_16x16x32_bf16 v[188:191], a[116:119], a[156:159], v[188:191]
ds_read_b64_tr_b16 a[114:115], v56 offset:34816
v_mfma_f32_16x16x32_bf16 v[192:195], a[116:119], a[160:163], v[192:195]
buffer_load_dwordx4 v63, s[4:7], s42 offen offset:1024  lds
v_mfma_f32_16x16x32_bf16 v[196:199], a[116:119], a[164:167], v[196:199]
ds_read_b128 a[140:143], v58 offset:6144
v_mfma_f32_16x16x32_bf16 v[200:203], a[116:119], a[168:171], v[200:203]
ds_read_b128 a[144:147], v58 offset:8192
v_mfma_f32_16x16x32_bf16 v[204:207], a[116:119], a[172:175], v[204:207]
ds_read_b128 a[148:151], v58 offset:10240
v_mfma_f32_16x16x32_bf16 v[208:211], a[120:123], a[152:155], v[208:211]
buffer_load_dwordx4 v6, s[4:7], s42 offen offset:2048  lds
v_mfma_f32_16x16x32_bf16 v[212:215], a[120:123], a[156:159], v[212:215]
s_add_u32 s83, s40, 4294942720
buffer_store_dwordx4 a[12:15], v4, s[16:19], s83 offen offset:3072 sc1
v_mfma_f32_16x16x32_bf16 v[216:219], a[120:123], a[160:163], v[216:219]
v_mfma_f32_16x16x32_bf16 v[220:223], a[120:123], a[164:167], v[220:223]
ds_read_b64_tr_b16 a[116:117], v56 offset:32776
v_mfma_f32_16x16x32_bf16 v[224:227], a[120:123], a[168:171], v[224:227]
s_add_u32 s83, s40, 4294946816
buffer_store_dwordx4 a[16:19], v4, s[16:19], s83 offen offset:0 sc1
v_mfma_f32_16x16x32_bf16 v[228:231], a[120:123], a[172:175], v[228:231]
v_mfma_f32_16x16x32_bf16 v[232:235], a[124:127], a[152:155], v[232:235]
ds_read_b64_tr_b16 a[118:119], v56 offset:34824
v_mfma_f32_16x16x32_bf16 v[236:239], a[124:127], a[156:159], v[236:239]
ds_read_b64_tr_b16 a[120:121], v57 offset:32768
v_mfma_f32_16x16x32_bf16 v[240:243], a[124:127], a[160:163], v[240:243]
buffer_store_dwordx4 a[20:23], v4, s[16:19], s83 offen offset:1024 sc1
v_mfma_f32_16x16x32_bf16 v[244:247], a[124:127], a[164:167], v[244:247]
ds_read_b64_tr_b16 a[122:123], v57 offset:34816
v_mfma_f32_16x16x32_bf16 v[248:251], a[124:127], a[168:171], v[248:251]
v_mfma_f32_16x16x32_bf16 v[252:255], a[124:127], a[172:175], v[252:255]
ds_read_b64_tr_b16 a[124:125], v57 offset:32776
ds_read_b64_tr_b16 a[126:127], v57 offset:34824
s_waitcnt lgkmcnt(4)
v_mfma_f32_16x16x32_bf16 v[64:67], a[96:99], a[128:131], v[64:67]
s_add_u32 s42, s79, 256
s_and_b32 s42, s42, 1023
s_add_u32 s42, s42, s38
s_add_u32 m0, s39, 139264
s_nop 0
buffer_load_dwordx4 v7, s[4:7], s42 offen offset:3072  lds
v_mfma_f32_16x16x32_bf16 v[68:71], a[96:99], a[132:135], v[68:71]
v_mfma_f32_16x16x32_bf16 v[72:75], a[96:99], a[136:139], v[72:75]
v_mfma_f32_16x16x32_bf16 v[76:79], a[96:99], a[140:143], v[76:79]
s_add_u32 s42, s42, 32768
s_add_u32 m0, s39, 143360
s_nop 0
buffer_load_dwordx4 v62, s[4:7], s42 offen offset:0  lds
v_mfma_f32_16x16x32_bf16 v[80:83], a[96:99], a[144:147], v[80:83]
v_mfma_f32_16x16x32_bf16 v[84:87], a[96:99], a[148:151], v[84:87]
v_mfma_f32_16x16x32_bf16 v[88:91], a[100:103], a[128:131], v[88:91]
buffer_load_dwordx4 v63, s[4:7], s42 offen offset:1024  lds
v_mfma_f32_16x16x32_bf16 v[92:95], a[100:103], a[132:135], v[92:95]
v_mfma_f32_16x16x32_bf16 v[96:99], a[100:103], a[136:139], v[96:99]
v_mfma_f32_16x16x32_bf16 v[100:103], a[100:103], a[140:143], v[100:103]
v_mfma_f32_16x16x32_bf16 v[104:107], a[100:103], a[144:147], v[104:107]
s_waitcnt vmcnt(14)
v_mfma_f32_16x16x32_bf16 v[108:111], a[100:103], a[148:151], v[108:111]
s_waitcnt lgkmcnt(0)
s_barrier
v_mfma_f32_16x16x32_bf16 v[112:115], a[104:107], a[128:131], v[112:115]
ds_read_b64_tr_b16 a[96:97], v54 offset:0
v_mfma_f32_16x16x32_bf16 v[116:119], a[104:107], a[132:135], v[116:119]
s_add_u32 s42, s78, 1310720
s_and_b32 s42, s42, 0x3fffff
s_add_u32 s42, s42, s36
s_add_u32 m0, s37, 98304
s_nop 0
buffer_load_dwordx4 v60, s[8:11], s42 offen offset:0  lds
v_mfma_f32_16x16x32_bf16 v[120:123], a[104:107], a[136:139], v[120:123]
v_mfma_f32_16x16x32_bf16 v[124:127], a[104:107], a[140:143], v[124:127]
ds_read_b64_tr_b16 a[98:99], v54 offset:2048
v_mfma_f32_16x16x32_bf16 v[128:131], a[104:107], a[144:147], v[128:131]
ds_read_b64_tr_b16 a[100:101], v54 offset:8
v_mfma_f32_16x16x32_bf16 v[132:135], a[104:107], a[148:151], v[132:135]
ds_read_b64_tr_b16 a[102:103], v54 offset:2056
v_mfma_f32_16x16x32_bf16 v[136:139], a[108:111], a[128:131], v[136:139]
ds_read_b64_tr_b16 a[104:105], v55 offset:0
v_mfma_f32_16x16x32_bf16 v[140:143], a[108:111], a[132:135], v[140:143]
buffer_load_dwordx4 v61, s[8:11], s42 offen offset:1024  lds
v_mfma_f32_16x16x32_bf16 v[144:147], a[108:111], a[136:139], v[144:147]
ds_read_b64_tr_b16 a[106:107], v55 offset:2048
v_mfma_f32_16x16x32_bf16 v[148:151], a[108:111], a[140:143], v[148:151]
ds_read_b128 a[152:155], v59 offset:0
v_mfma_f32_16x16x32_bf16 v[152:155], a[108:111], a[144:147], v[152:155]
ds_read_b128 a[156:159], v59 offset:2048
v_mfma_f32_16x16x32_bf16 v[156:159], a[108:111], a[148:151], v[156:159]
ds_read_b64_tr_b16 a[108:109], v55 offset:8
v_mfma_f32_16x16x32_bf16 v[160:163], a[112:115], a[128:131], v[160:163]
ds_read_b64_tr_b16 a[110:111], v55 offset:2056
v_mfma_f32_16x16x32_bf16 v[164:167], a[112:115], a[132:135], v[164:167]
ds_read_b128 a[160:163], v59 offset:4096
v_mfma_f32_16x16x32_bf16 v[168:171], a[112:115], a[136:139], v[168:171]
buffer_load_dwordx4 v2, s[8:11], s42 offen offset:2048  lds
v_mfma_f32_16x16x32_bf16 v[172:175], a[112:115], a[140:143], v[172:175]
ds_read_b128 a[164:167], v59 offset:6144
v_mfma_f32_16x16x32_bf16 v[176:179], a[112:115], a[144:147], v[176:179]
ds_read_b128 a[168:171], v59 offset:8192
v_mfma_f32_16x16x32_bf16 v[180:183], a[112:115], a[148:151], v[180:183]
ds_read_b64_tr_b16 a[112:113], v56 offset:0
v_mfma_f32_16x16x32_bf16 v[184:187], a[116:119], a[128:131], v[184:187]
ds_read_b64_tr_b16 a[114:115], v56 offset:2048
v_mfma_f32_16x16x32_bf16 v[188:191], a[116:119], a[132:135], v[188:191]
ds_read_b128 a[172:175], v59 offset:10240
v_mfma_f32_16x16x32_bf16 v[192:195], a[116:119], a[136:139], v[192:195]
v_mfma_f32_16x16x32_bf16 v[196:199], a[116:119], a[140:143], v[196:199]
buffer_load_dwordx4 v3, s[8:11], s42 offen offset:3072  lds
v_mfma_f32_16x16x32_bf16 v[200:203], a[116:119], a[144:147], v[200:203]
v_mfma_f32_16x16x32_bf16 v[204:207], a[116:119], a[148:151], v[204:207]
ds_read_b64_tr_b16 a[116:117], v56 offset:8
v_mfma_f32_16x16x32_bf16 v[208:211], a[120:123], a[128:131], v[208:211]
s_add_u32 s83, s40, 4294946816
buffer_store_dwordx4 a[24:27], v4, s[16:19], s83 offen offset:2048 sc1
v_mfma_f32_16x16x32_bf16 v[212:215], a[120:123], a[132:135], v[212:215]
v_mfma_f32_16x16x32_bf16 v[216:219], a[120:123], a[136:139], v[216:219]
ds_read_b64_tr_b16 a[118:119], v56 offset:2056
v_mfma_f32_16x16x32_bf16 v[220:223], a[120:123], a[140:143], v[220:223]
v_mfma_f32_16x16x32_bf16 v[224:227], a[120:123], a[144:147], v[224:227]
buffer_store_dwordx4 a[28:31], v4, s[16:19], s83 offen offset:3072 sc1
v_mfma_f32_16x16x32_bf16 v[228:231], a[120:123], a[148:151], v[228:231]
ds_read_b64_tr_b16 a[120:121], v57 offset:0
v_mfma_f32_16x16x32_bf16 v[232:235], a[124:127], a[128:131], v[232:235]
ds_read_b64_tr_b16 a[122:123], v57 offset:2048
v_mfma_f32_16x16x32_bf16 v[236:239], a[124:127], a[132:135], v[236:239]
v_mfma_f32_16x16x32_bf16 v[240:243], a[124:127], a[136:139], v[240:243]
s_add_u32 s83, s40, 4294950912
buffer_store_dwordx4 a[32:35], v4, s[16:19], s83 offen offset:0 sc1
v_mfma_f32_16x16x32_bf16 v[244:247], a[124:127], a[140:143], v[244:247]
v_mfma_f32_16x16x32_bf16 v[248:251], a[124:127], a[144:147], v[248:251]
v_mfma_f32_16x16x32_bf16 v[252:255], a[124:127], a[148:151], v[252:255]
ds_read_b64_tr_b16 a[124:125], v57 offset:8
ds_read_b64_tr_b16 a[126:127], v57 offset:2056
s_waitcnt lgkmcnt(4)
v_mfma_f32_16x16x32_bf16 v[64:67], a[96:99], a[152:155], v[64:67]
v_mfma_f32_16x16x32_bf16 v[68:71], a[96:99], a[156:159], v[68:71]
v_mfma_f32_16x16x32_bf16 v[72:75], a[96:99], a[160:163], v[72:75]
v_mfma_f32_16x16x32_bf16 v[76:79], a[96:99], a[164:167], v[76:79]
v_mfma_f32_16x16x32_bf16 v[80:83], a[96:99], a[168:171], v[80:83]
v_mfma_f32_16x16x32_bf16 v[84:87], a[96:99], a[172:175], v[84:87]
v_mfma_f32_16x16x32_bf16 v[88:91], a[100:103], a[152:155], v[88:91]
v_mfma_f32_16x16x32_bf16 v[92:95], a[100:103], a[156:159], v[92:95]
v_mfma_f32_16x16x32_bf16 v[96:99], a[100:103], a[160:163], v[96:99]
v_mfma_f32_16x16x32_bf16 v[100:103], a[100:103], a[164:167], v[100:103]
v_mfma_f32_16x16x32_bf16 v[104:107], a[100:103], a[168:171], v[104:107]
s_waitcnt vmcnt(16)
s_waitcnt vmcnt(7)
v_mfma_f32_16x16x32_bf16 v[108:111], a[100:103], a[172:175], v[108:111]
s_waitcnt lgkmcnt(0)
s_barrier
v_mfma_f32_16x16x32_bf16 v[112:115], a[104:107], a[152:155], v[112:115]
ds_read_b64_tr_b16 a[96:97], v54 offset:16384
v_mfma_f32_16x16x32_bf16 v[116:119], a[104:107], a[156:159], v[116:119]
s_add_u32 s42, s78, 1572864
s_and_b32 s42, s42, 0x3fffff
s_add_u32 s42, s42, s36
s_add_u32 m0, s37, 65536
s_nop 0
buffer_load_dwordx4 v60, s[8:11], s42 offen offset:0  lds
v_mfma_f32_16x16x32_bf16 v[120:123], a[104:107], a[160:163], v[120:123]
v_mfma_f32_16x16x32_bf16 v[124:127], a[104:107], a[164:167], v[124:127]
ds_read_b64_tr_b16 a[98:99], v54 offset:18432
v_mfma_f32_16x16x32_bf16 v[128:131], a[104:107], a[168:171], v[128:131]
buffer_load_dwordx4 v61, s[8:11], s42 offen offset:1024  lds
v_mfma_f32_16x16x32_bf16 v[132:135], a[104:107], a[172:175], v[132:135]
ds_read_b64_tr_b16 a[100:101], v54 offset:16392
v_mfma_f32_16x16x32_bf16 v[136:139], a[108:111], a[152:155], v[136:139]
ds_read_b64_tr_b16 a[102:103], v54 offset:18440
v_mfma_f32_16x16x32_bf16 v[140:143], a[108:111], a[156:159], v[140:143]
ds_read_b64_tr_b16 a[104:105], v55 offset:16384
v_mfma_f32_16x16x32_bf16 v[144:147], a[108:111], a[160:163], v[144:147]
buffer_load_dwordx4 v2, s[8:11], s42 offen offset:2048  lds
v_mfma_f32_16x16x32_bf16 v[148:151], a[108:111], a[164:167], v[148:151]
ds_read_b64_tr_b16 a[106:107], v55 offset:18432
v_mfma_f32_16x16x32_bf16 v[152:155], a[108:111], a[168:171], v[152:155]
ds_read_b128 a[128:131], v58 offset:24576
v_mfma_f32_16x16x32_bf16 v[156:159], a[108:111], a[172:175], v[156:159]
ds_read_b64_tr_b16 a[108:109], v55 offset:16392
v_mfma_f32_16x16x32_bf16 v[160:163], a[112:115], a[152:155], v[160:163]
buffer_load_dwordx4 v3, s[8:11], s42 offen offset:3072  lds
v_mfma_f32_16x16x32_bf16 v[164:167], a[112:115], a[156:159], v[164:167]
ds_read_b64_tr_b16 a[110:111], v55 offset:18440
v_mfma_f32_16x16x32_bf16 v[168:171], a[112:115], a[160:163], v[168:171]
ds_read_b128 a[132:135], v58 offset:26624
v_mfma_f32_16x16x32_bf16 v[172:175], a[112:115], a[164:167], v[172:175]
ds_read_b128 a[136:139], v58 offset:28672
v_mfma_f32_16x16x32_bf16 v[176:179], a[112:115], a[168:171], v[176:179]
s_add_u32 s42, s79, 384
s_and_b32 s42, s42, 1023
s_add_u32 s42, s42, s38
s_add_u32 m0, s39, 114688
s_nop 0
buffer_load_dwordx4 v62, s[4:7], s42 offen offset:0  lds
v_mfma_f32_16x16x32_bf16 v[180:183], a[112:115], a[172:175], v[180:183]
v_mfma_f32_16x16x32_bf16 v[184:187], a[116:119], a[152:155], v[184:187]
ds_read_b64_tr_b16 a[112:113], v56 offset:16384
v_mfma_f32_16x16x32_bf16 v[188:191], a[116:119], a[156:159], v[188:191]
ds_read_b64_tr_b16 a[114:115], v56 offset:18432
v_mfma_f32_16x16x32_bf16 v[192:195], a[116:119], a[160:163], v[192:195]
buffer_load_dwordx4 v63, s[4:7], s42 offen offset:1024  lds
v_mfma_f32_16x16x32_bf16 v[196:199], a[116:119], a[164:167], v[196:199]
ds_read_b128 a[140:143], v58 offset:30720
v_mfma_f32_16x16x32_bf16 v[200:203], a[116:119], a[168:171], v[200:203]
ds_read_b128 a[144:147], v58 offset:32768
v_mfma_f32_16x16x32_bf16 v[204:207], a[116:119], a[172:175], v[204:207]
ds_read_b128 a[148:151], v58 offset:34816
v_mfma_f32_16x16x32_bf16 v[208:211], a[120:123], a[152:155], v[208:211]
buffer_load_dwordx4 v6, s[4:7], s42 offen offset:2048  lds
v_mfma_f32_16x16x32_bf16 v[212:215], a[120:123], a[156:159], v[212:215]
s_add_u32 s83, s40, 4294950912
buffer_store_dwordx4 a[36:39], v4, s[16:19], s83 offen offset:1024 sc1
v_mfma_f32_16x16x32_bf16 v[216:219], a[120:123], a[160:163], v[216:219]
v_mfma_f32_16x16x32_bf16 v[220:223], a[120:123], a[164:167], v[220:223]
ds_read_b64_tr_b16 a[116:117], v56 offset:16392
v_mfma_f32_16x16x32_bf16 v[224:227], a[120:123], a[168:171], v[224:227]
buffer_store_dwordx4 a[40:43], v4, s[16:19], s83 offen offset:2048 sc1
v_mfma_f32_16x16x32_bf16 v[228:231], a[120:123], a[172:175], v[228:231]
ds_read_b64_tr_b16 a[118:119], v56 offset:18440
v_mfma_f32_16x16x32_bf16 v[232:235], a[124:127], a[152:155], v[232:235]
ds_read_b64_tr_b16 a[120:121], v57 offset:16384
v_mfma_f32_16x16x32_bf16 v[236:239], a[124:127], a[156:159], v[236:239]
ds_read_b64_tr_b16 a[122:123], v57 offset:18432
v_mfma_f32_16x16x32_bf16 v[240:243], a[124:127], a[160:163], v[240:243]
buffer_store_dwordx4 a[44:47], v4, s[16:19], s83 offen offset:3072 sc1
v_mfma_f32_16x16x32_bf16 v[244:247], a[124:127], a[164:167], v[244:247]
v_mfma_f32_16x16x32_bf16 v[248:251], a[124:127], a[168:171], v[248:251]
v_mfma_f32_16x16x32_bf16 v[252:255], a[124:127], a[172:175], v[252:255]
ds_read_b64_tr_b16 a[124:125], v57 offset:16392
ds_read_b64_tr_b16 a[126:127], v57 offset:18440
s_waitcnt lgkmcnt(4)
v_mfma_f32_16x16x32_bf16 v[64:67], a[96:99], a[128:131], v[64:67]
s_add_u32 s42, s79, 384
s_and_b32 s42, s42, 1023
s_add_u32 s42, s42, s38
s_add_u32 m0, s39, 114688
s_nop 0
buffer_load_dwordx4 v7, s[4:7], s42 offen offset:3072  lds
v_mfma_f32_16x16x32_bf16 v[68:71], a[96:99], a[132:135], v[68:71]
v_mfma_f32_16x16x32_bf16 v[72:75], a[96:99], a[136:139], v[72:75]
v_mfma_f32_16x16x32_bf16 v[76:79], a[96:99], a[140:143], v[76:79]
s_add_u32 s42, s42, 32768
s_add_u32 m0, s39, 118784
s_nop 0
buffer_load_dwordx4 v62, s[4:7], s42 offen offset:0  lds
v_mfma_f32_16x16x32_bf16 v[80:83], a[96:99], a[144:147], v[80:83]
v_mfma_f32_16x16x32_bf16 v[84:87], a[96:99], a[148:151], v[84:87]
v_mfma_f32_16x16x32_bf16 v[88:91], a[100:103], a[128:131], v[88:91]
buffer_load_dwordx4 v63, s[4:7], s42 offen offset:1024  lds
v_mfma_f32_16x16x32_bf16 v[92:95], a[100:103], a[132:135], v[92:95]
v_mfma_f32_16x16x32_bf16 v[96:99], a[100:103], a[136:139], v[96:99]
v_mfma_f32_16x16x32_bf16 v[100:103], a[100:103], a[140:143], v[100:103]
v_mfma_f32_16x16x32_bf16 v[104:107], a[100:103], a[144:147], v[104:107]
s_waitcnt vmcnt(16)
v_mfma_f32_16x16x32_bf16 v[108:111], a[100:103], a[148:151], v[108:111]
s_waitcnt lgkmcnt(0)
s_barrier
v_mfma_f32_16x16x32_bf16 v[112:115], a[104:107], a[128:131], v[112:115]
ds_read_b64_tr_b16 a[96:97], v54 offset:32768
v_mfma_f32_16x16x32_bf16 v[116:119], a[104:107], a[132:135], v[116:119]
s_add_u32 s42, s78, 1835008
s_and_b32 s42, s42, 0x3fffff
s_add_u32 s42, s42, s36
s_add_u32 m0, s37, 81920
s_nop 0
buffer_load_dwordx4 v60, s[8:11], s42 offen offset:0  lds
v_mfma_f32_16x16x32_bf16 v[120:123], a[104:107], a[136:139], v[120:123]
v_mfma_f32_16x16x32_bf16 v[124:127], a[104:107], a[140:143], v[124:127]
ds_read_b64_tr_b16 a[98:99], v54 offset:34816
v_mfma_f32_16x16x32_bf16 v[128:131], a[104:107], a[144:147], v[128:131]
ds_read_b64_tr_b16 a[100:101], v54 offset:32776
v_mfma_f32_16x16x32_bf16 v[132:135], a[104:107], a[148:151], v[132:135]
ds_read_b64_tr_b16 a[102:103], v54 offset:34824
v_mfma_f32_16x16x32_bf16 v[136:139], a[108:111], a[128:131], v[136:139]
ds_read_b64_tr_b16 a[104:105], v55 offset:32768
v_mfma_f32_16x16x32_bf16 v[140:143], a[108:111], a[132:135], v[140:143]
buffer_load_dwordx4 v61, s[8:11], s42 offen offset:1024  lds
v_mfma_f32_16x16x32_bf16 v[144:147], a[108:111], a[136:139], v[144:147]
ds_read_b64_tr_b16 a[106:107], v55 offset:34816
v_mfma_f32_16x16x32_bf16 v[148:151], a[108:111], a[140:143], v[148:151]
ds_read_b128 a[152:155], v59 offset:24576
v_mfma_f32_16x16x32_bf16 v[152:155], a[108:111], a[144:147], v[152:155]
ds_read_b128 a[156:159], v59 offset:26624
v_mfma_f32_16x16x32_bf16 v[156:159], a[108:111], a[148:151], v[156:159]
ds_read_b64_tr_b16 a[108:109], v55 offset:32776
v_mfma_f32_16x16x32_bf16 v[160:163], a[112:115], a[128:131], v[160:163]
ds_read_b64_tr_b16 a[110:111], v55 offset:34824
v_mfma_f32_16x16x32_bf16 v[164:167], a[112:115], a[132:135], v[164:167]
ds_read_b128 a[160:163], v59 offset:28672
v_mfma_f32_16x16x32_bf16 v[168:171], a[112:115], a[136:139], v[168:171]
buffer_load_dwordx4 v2, s[8:11], s42 offen offset:2048  lds
v_mfma_f32_16x16x32_bf16 v[172:175], a[112:115], a[140:143], v[172:175]
ds_read_b128 a[164:167], v59 offset:30720
v_mfma_f32_16x16x32_bf16 v[176:179], a[112:115], a[144:147], v[176:179]
ds_read_b128 a[168:171], v59 offset:32768
v_mfma_f32_16x16x32_bf16 v[180:183], a[112:115], a[148:151], v[180:183]
ds_read_b64_tr_b16 a[112:113], v56 offset:32768
v_mfma_f32_16x16x32_bf16 v[184:187], a[116:119], a[128:131], v[184:187]
ds_read_b64_tr_b16 a[114:115], v56 offset:34816
v_mfma_f32_16x16x32_bf16 v[188:191], a[116:119], a[132:135], v[188:191]
ds_read_b128 a[172:175], v59 offset:34816
v_mfma_f32_16x16x32_bf16 v[192:195], a[116:119], a[136:139], v[192:195]
v_mfma_f32_16x16x32_bf16 v[196:199], a[116:119], a[140:143], v[196:199]
buffer_load_dwordx4 v3, s[8:11], s42 offen offset:3072  lds
v_mfma_f32_16x16x32_bf16 v[200:203], a[116:119], a[144:147], v[200:203]
v_mfma_f32_16x16x32_bf16 v[204:207], a[116:119], a[148:151], v[204:207]
ds_read_b64_tr_b16 a[116:117], v56 offset:32776
v_mfma_f32_16x16x32_bf16 v[208:211], a[120:123], a[128:131], v[208:211]
s_add_u32 s83, s40, 4294955008
buffer_store_dwordx4 a[48:51], v4, s[16:19], s83 offen offset:0 sc1
v_mfma_f32_16x16x32_bf16 v[212:215], a[120:123], a[132:135], v[212:215]
v_mfma_f32_16x16x32_bf16 v[216:219], a[120:123], a[136:139], v[216:219]
ds_read_b64_tr_b16 a[118:119], v56 offset:34824
v_mfma_f32_16x16x32_bf16 v[220:223], a[120:123], a[140:143], v[220:223]
v_mfma_f32_16x16x32_bf16 v[224:227], a[120:123], a[144:147], v[224:227]
buffer_store_dwordx4 a[52:55], v4, s[16:19], s83 offen offset:1024 sc1
v_mfma_f32_16x16x32_bf16 v[228:231], a[120:123], a[148:151], v[228:231]
ds_read_b64_tr_b16 a[120:121], v57 offset:32768
v_mfma_f32_16x16x32_bf16 v[232:235], a[124:127], a[128:131], v[232:235]
ds_read_b64_tr_b16 a[122:123], v57 offset:34816
v_mfma_f32_16x16x32_bf16 v[236:239], a[124:127], a[132:135], v[236:239]
v_mfma_f32_16x16x32_bf16 v[240:243], a[124:127], a[136:139], v[240:243]
buffer_store_dwordx4 a[56:59], v4, s[16:19], s83 offen offset:2048 sc1
v_mfma_f32_16x16x32_bf16 v[244:247], a[124:127], a[140:143], v[244:247]
v_mfma_f32_16x16x32_bf16 v[248:251], a[124:127], a[144:147], v[248:251]
v_mfma_f32_16x16x32_bf16 v[252:255], a[124:127], a[148:151], v[252:255]
ds_read_b64_tr_b16 a[124:125], v57 offset:32776
ds_read_b64_tr_b16 a[126:127], v57 offset:34824
s_waitcnt lgkmcnt(4)
v_mfma_f32_16x16x32_bf16 v[64:67], a[96:99], a[152:155], v[64:67]
v_mfma_f32_16x16x32_bf16 v[68:71], a[96:99], a[156:159], v[68:71]
v_mfma_f32_16x16x32_bf16 v[72:75], a[96:99], a[160:163], v[72:75]
v_mfma_f32_16x16x32_bf16 v[76:79], a[96:99], a[164:167], v[76:79]
v_mfma_f32_16x16x32_bf16 v[80:83], a[96:99], a[168:171], v[80:83]
v_mfma_f32_16x16x32_bf16 v[84:87], a[96:99], a[172:175], v[84:87]
v_mfma_f32_16x16x32_bf16 v[88:91], a[100:103], a[152:155], v[88:91]
v_mfma_f32_16x16x32_bf16 v[92:95], a[100:103], a[156:159], v[92:95]
v_mfma_f32_16x16x32_bf16 v[96:99], a[100:103], a[160:163], v[96:99]
v_mfma_f32_16x16x32_bf16 v[100:103], a[100:103], a[164:167], v[100:103]
v_mfma_f32_16x16x32_bf16 v[104:107], a[100:103], a[168:171], v[104:107]
s_waitcnt vmcnt(16)
s_waitcnt vmcnt(7)
v_mfma_f32_16x16x32_bf16 v[108:111], a[100:103], a[172:175], v[108:111]
s_waitcnt lgkmcnt(0)
s_barrier
v_mfma_f32_16x16x32_bf16 v[112:115], a[104:107], a[152:155], v[112:115]
ds_read_b64_tr_b16 a[96:97], v54 offset:0
v_mfma_f32_16x16x32_bf16 v[116:119], a[104:107], a[156:159], v[116:119]
s_add_u32 s42, s78, 2097152
s_and_b32 s42, s42, 0x3fffff
s_add_u32 s42, s42, s36
s_add_u32 m0, s37, 98304
s_nop 0
buffer_load_dwordx4 v60, s[8:11], s42 offen offset:0  lds
v_mfma_f32_16x16x32_bf16 v[120:123], a[104:107], a[160:163], v[120:123]
v_mfma_f32_16x16x32_bf16 v[124:127], a[104:107], a[164:167], v[124:127]
ds_read_b64_tr_b16 a[98:99], v54 offset:2048
v_mfma_f32_16x16x32_bf16 v[128:131], a[104:107], a[168:171], v[128:131]
buffer_load_dwordx4 v61, s[8:11], s42 offen offset:1024  lds
v_mfma_f32_16x16x32_bf16 v[132:135], a[104:107], a[172:175], v[132:135]
ds_read_b64_tr_b16 a[100:101], v54 offset:8
v_mfma_f32_16x16x32_bf16 v[136:139], a[108:111], a[152:155], v[136:139]
ds_read_b64_tr_b16 a[102:103], v54 offset:2056
v_mfma_f32_16x16x32_bf16 v[140:143], a[108:111], a[156:159], v[140:143]
ds_read_b64_tr_b16 a[104:105], v55 offset:0
v_mfma_f32_16x16x32_bf16 v[144:147], a[108:111], a[160:163], v[144:147]
buffer_load_dwordx4 v2, s[8:11], s42 offen offset:2048  lds
v_mfma_f32_16x16x32_bf16 v[148:151], a[108:111], a[164:167], v[148:151]
ds_read_b64_tr_b16 a[106:107], v55 offset:2048
v_mfma_f32_16x16x32_bf16 v[152:155], a[108:111], a[168:171], v[152:155]
ds_read_b128 a[128:131], v58 offset:0
v_mfma_f32_16x16x32_bf16 v[156:159], a[108:111], a[172:175], v[156:159]
ds_read_b64_tr_b16 a[108:109], v55 offset:8
v_mfma_f32_16x16x32_bf16 v[160:163], a[112:115], a[152:155], v[160:163]
buffer_load_dwordx4 v3, s[8:11], s42 offen offset:3072  lds
v_mfma_f32_16x16x32_bf16 v[164:167], a[112:115], a[156:159], v[164:167]
ds_read_b64_tr_b16 a[110:111], v55 offset:2056
v_mfma_f32_16x16x32_bf16 v[168:171], a[112:115], a[160:163], v[168:171]
ds_read_b128 a[132:135], v58 offset:2048
v_mfma_f32_16x16x32_bf16 v[172:175], a[112:115], a[164:167], v[172:175]
ds_read_b128 a[136:139], v58 offset:4096
v_mfma_f32_16x16x32_bf16 v[176:179], a[112:115], a[168:171], v[176:179]
s_add_u32 s42, s79, 512
s_and_b32 s42, s42, 1023
s_add_u32 s42, s42, s38
s_add_u32 m0, s39, 139264
s_nop 0
buffer_load_dwordx4 v62, s[4:7], s42 offen offset:0  lds
v_mfma_f32_16x16x32_bf16 v[180:183], a[112:115], a[172:175], v[180:183]
v_mfma_f32_16x16x32_bf16 v[184:187], a[116:119], a[152:155], v[184:187]
ds_read_b64_tr_b16 a[112:113], v56 offset:0
v_mfma_f32_16x16x32_bf16 v[188:191], a[116:119], a[156:159], v[188:191]
ds_read_b64_tr_b16 a[114:115], v56 offset:2048
v_mfma_f32_16x16x32_bf16 v[192:195], a[116:119], a[160:163], v[192:195]
buffer_load_dwordx4 v63, s[4:7], s42 offen offset:1024  lds
v_mfma_f32_16x16x32_bf16 v[196:199], a[116:119], a[164:167], v[196:199]
ds_read_b128 a[140:143], v58 offset:6144
v_mfma_f32_16x16x32_bf16 v[200:203], a[116:119], a[168:171], v[200:203]
ds_read_b128 a[144:147], v58 offset:8192
v_mfma_f32_16x16x32_bf16 v[204:207], a[116:119], a[172:175], v[204:207]
ds_read_b128 a[148:151], v58 offset:10240
v_mfma_f32_16x16x32_bf16 v[208:211], a[120:123], a[152:155], v[208:211]
buffer_load_dwordx4 v6, s[4:7], s42 offen offset:2048  lds
v_mfma_f32_16x16x32_bf16 v[212:215], a[120:123], a[156:159], v[212:215]
s_add_u32 s83, s40, 4294955008
buffer_store_dwordx4 a[60:63], v4, s[16:19], s83 offen offset:3072 sc1
v_mfma_f32_16x16x32_bf16 v[216:219], a[120:123], a[160:163], v[216:219]
v_mfma_f32_16x16x32_bf16 v[220:223], a[120:123], a[164:167], v[220:223]
ds_read_b64_tr_b16 a[116:117], v56 offset:8
v_mfma_f32_16x16x32_bf16 v[224:227], a[120:123], a[168:171], v[224:227]
s_add_u32 s83, s40, 4294959104
buffer_store_dwordx4 a[64:67], v4, s[16:19], s83 offen offset:0 sc1
v_mfma_f32_16x16x32_bf16 v[228:231], a[120:123], a[172:175], v[228:231]
v_mfma_f32_16x16x32_bf16 v[232:235], a[124:127], a[152:155], v[232:235]
ds_read_b64_tr_b16 a[118:119], v56 offset:2056
v_mfma_f32_16x16x32_bf16 v[236:239], a[124:127], a[156:159], v[236:239]
ds_read_b64_tr_b16 a[120:121], v57 offset:0
v_mfma_f32_16x16x32_bf16 v[240:243], a[124:127], a[160:163], v[240:243]
buffer_store_dwordx4 a[68:71], v4, s[16:19], s83 offen offset:1024 sc1
v_mfma_f32_16x16x32_bf16 v[244:247], a[124:127], a[164:167], v[244:247]
ds_read_b64_tr_b16 a[122:123], v57 offset:2048
v_mfma_f32_16x16x32_bf16 v[248:251], a[124:127], a[168:171], v[248:251]
v_mfma_f32_16x16x32_bf16 v[252:255], a[124:127], a[172:175], v[252:255]
ds_read_b64_tr_b16 a[124:125], v57 offset:8
ds_read_b64_tr_b16 a[126:127], v57 offset:2056
s_waitcnt lgkmcnt(4)
v_mfma_f32_16x16x32_bf16 v[64:67], a[96:99], a[128:131], v[64:67]
s_add_u32 s42, s79, 512
s_and_b32 s42, s42, 1023
s_add_u32 s42, s42, s38
s_add_u32 m0, s39, 139264
s_nop 0
buffer_load_dwordx4 v7, s[4:7], s42 offen offset:3072  lds
v_mfma_f32_16x16x32_bf16 v[68:71], a[96:99], a[132:135], v[68:71]
v_mfma_f32_16x16x32_bf16 v[72:75], a[96:99], a[136:139], v[72:75]
v_mfma_f32_16x16x32_bf16 v[76:79], a[96:99], a[140:143], v[76:79]
s_add_u32 s42, s42, 32768
s_add_u32 m0, s39, 143360
s_nop 0
buffer_load_dwordx4 v62, s[4:7], s42 offen offset:0  lds
v_mfma_f32_16x16x32_bf16 v[80:83], a[96:99], a[144:147], v[80:83]
v_mfma_f32_16x16x32_bf16 v[84:87], a[96:99], a[148:151], v[84:87]
v_mfma_f32_16x16x32_bf16 v[88:91], a[100:103], a[128:131], v[88:91]
buffer_load_dwordx4 v63, s[4:7], s42 offen offset:1024  lds
v_mfma_f32_16x16x32_bf16 v[92:95], a[100:103], a[132:135], v[92:95]
v_mfma_f32_16x16x32_bf16 v[96:99], a[100:103], a[136:139], v[96:99]
v_mfma_f32_16x16x32_bf16 v[100:103], a[100:103], a[140:143], v[100:103]
v_mfma_f32_16x16x32_bf16 v[104:107], a[100:103], a[144:147], v[104:107]
s_waitcnt vmcnt(16)
v_mfma_f32_16x16x32_bf16 v[108:111], a[100:103], a[148:151], v[108:111]
s_waitcnt lgkmcnt(0)
s_barrier
v_mfma_f32_16x16x32_bf16 v[112:115], a[104:107], a[128:131], v[112:115]
ds_read_b64_tr_b16 a[96:97], v54 offset:16384
v_mfma_f32_16x16x32_bf16 v[116:119], a[104:107], a[132:135], v[116:119]
s_add_u32 s42, s78, 2359296
s_and_b32 s42, s42, 0x3fffff
s_add_u32 s42, s42, s36
s_add_u32 m0, s37, 65536
s_nop 0
buffer_load_dwordx4 v60, s[8:11], s42 offen offset:0  lds
v_mfma_f32_16x16x32_bf16 v[120:123], a[104:107], a[136:139], v[120:123]
v_mfma_f32_16x16x32_bf16 v[124:127], a[104:107], a[140:143], v[124:127]
ds_read_b64_tr_b16 a[98:99], v54 offset:18432
v_mfma_f32_16x16x32_bf16 v[128:131], a[104:107], a[144:147], v[128:131]
ds_read_b64_tr_b16 a[100:101], v54 offset:16392
v_mfma_f32_16x16x32_bf16 v[132:135], a[104:107], a[148:151], v[132:135]
ds_read_b64_tr_b16 a[102:103], v54 offset:18440
v_mfma_f32_16x16x32_bf16 v[136:139], a[108:111], a[128:131], v[136:139]
ds_read_b64_tr_b16 a[104:105], v55 offset:16384
v_mfma_f32_16x16x32_bf16 v[140:143], a[108:111], a[132:135], v[140:143]
buffer_load_dwordx4 v61, s[8:11], s42 offen offset:1024  lds
v_mfma_f32_16x16x32_bf16 v[144:147], a[108:111], a[136:139], v[144:147]
ds_read_b64_tr_b16 a[106:107], v55 offset:18432
v_mfma_f32_16x16x32_bf16 v[148:151], a[108:111], a[140:143], v[148:151]
ds_read_b128 a[152:155], v59 offset:0
v_mfma_f32_16x16x32_bf16 v[152:155], a[108:111], a[144:147], v[152:155]
ds_read_b128 a[156:159], v59 offset:2048
v_mfma_f32_16x16x32_bf16 v[156:159], a[108:111], a[148:151], v[156:159]
ds_read_b64_tr_b16 a[108:109], v55 offset:16392
v_mfma_f32_16x16x32_bf16 v[160:163], a[112:115], a[128:131], v[160:163]
ds_read_b64_tr_b16 a[110:111], v55 offset:18440
v_mfma_f32_16x16x32_bf16 v[164:167], a[112:115], a[132:135], v[164:167]
ds_read_b128 a[160:163], v59 offset:4096
v_mfma_f32_16x16x32_bf16 v[168:171], a[112:115], a[136:139], v[168:171]
buffer_load_dwordx4 v2, s[8:11], s42 offen offset:2048  lds
v_mfma_f32_16x16x32_bf16 v[172:175], a[112:115], a[140:143], v[172:175]
ds_read_b128 a[164:167], v59 offset:6144
v_mfma_f32_16x16x32_bf16 v[176:179], a[112:115], a[144:147], v[176:179]
ds_read_b128 a[168:171], v59 offset:8192
v_mfma_f32_16x16x32_bf16 v[180:183], a[112:115], a[148:151], v[180:183]
ds_read_b64_tr_b16 a[112:113], v56 offset:16384
v_mfma_f32_16x16x32_bf16 v[184:187], a[116:119], a[128:131], v[184:187]
ds_read_b64_tr_b16 a[114:115], v56 offset:18432
v_mfma_f32_16x16x32_bf16 v[188:191], a[116:119], a[132:135], v[188:191]
ds_read_b128 a[172:175], v59 offset:10240
v_mfma_f32_16x16x32_bf16 v[192:195], a[116:119], a[136:139], v[192:195]
v_mfma_f32_16x16x32_bf16 v[196:199], a[116:119], a[140:143], v[196:199]
buffer_load_dwordx4 v3, s[8:11], s42 offen offset:3072  lds
v_mfma_f32_16x16x32_bf16 v[200:203], a[116:119], a[144:147], v[200:203]
v_mfma_f32_16x16x32_bf16 v[204:207], a[116:119], a[148:151], v[204:207]
ds_read_b64_tr_b16 a[116:117], v56 offset:16392
v_mfma_f32_16x16x32_bf16 v[208:211], a[120:123], a[128:131], v[208:211]
s_add_u32 s83, s40, 4294959104
buffer_store_dwordx4 a[72:75], v4, s[16:19], s83 offen offset:2048 sc1
v_mfma_f32_16x16x32_bf16 v[212:215], a[120:123], a[132:135], v[212:215]
v_mfma_f32_16x16x32_bf16 v[216:219], a[120:123], a[136:139], v[216:219]
ds_read_b64_tr_b16 a[118:119], v56 offset:18440
v_mfma_f32_16x16x32_bf16 v[220:223], a[120:123], a[140:143], v[220:223]
v_mfma_f32_16x16x32_bf16 v[224:227], a[120:123], a[144:147], v[224:227]
buffer_store_dwordx4 a[76:79], v4, s[16:19], s83 offen offset:3072 sc1
v_mfma_f32_16x16x32_bf16 v[228:231], a[120:123], a[148:151], v[228:231]
ds_read_b64_tr_b16 a[120:121], v57 offset:16384
v_mfma_f32_16x16x32_bf16 v[232:235], a[124:127], a[128:131], v[232:235]
ds_read_b64_tr_b16 a[122:123], v57 offset:18432
v_mfma_f32_16x16x32_bf16 v[236:239], a[124:127], a[132:135], v[236:239]
v_mfma_f32_16x16x32_bf16 v[240:243], a[124:127], a[136:139], v[240:243]
s_add_u32 s83, s40, 4294963200
buffer_store_dwordx4 a[80:83], v4, s[16:19], s83 offen offset:0 sc1
v_mfma_f32_16x16x32_bf16 v[244:247], a[124:127], a[140:143], v[244:247]
v_mfma_f32_16x16x32_bf16 v[248:251], a[124:127], a[144:147], v[248:251]
v_mfma_f32_16x16x32_bf16 v[252:255], a[124:127], a[148:151], v[252:255]
ds_read_b64_tr_b16 a[124:125], v57 offset:16392
ds_read_b64_tr_b16 a[126:127], v57 offset:18440
s_waitcnt lgkmcnt(4)
v_mfma_f32_16x16x32_bf16 v[64:67], a[96:99], a[152:155], v[64:67]
v_mfma_f32_16x16x32_bf16 v[68:71], a[96:99], a[156:159], v[68:71]
v_mfma_f32_16x16x32_bf16 v[72:75], a[96:99], a[160:163], v[72:75]
v_mfma_f32_16x16x32_bf16 v[76:79], a[96:99], a[164:167], v[76:79]
v_mfma_f32_16x16x32_bf16 v[80:83], a[96:99], a[168:171], v[80:83]
v_mfma_f32_16x16x32_bf16 v[84:87], a[96:99], a[172:175], v[84:87]
v_mfma_f32_16x16x32_bf16 v[88:91], a[100:103], a[152:155], v[88:91]
v_mfma_f32_16x16x32_bf16 v[92:95], a[100:103], a[156:159], v[92:95]
v_mfma_f32_16x16x32_bf16 v[96:99], a[100:103], a[160:163], v[96:99]
v_mfma_f32_16x16x32_bf16 v[100:103], a[100:103], a[164:167], v[100:103]
v_mfma_f32_16x16x32_bf16 v[104:107], a[100:103], a[168:171], v[104:107]
s_waitcnt vmcnt(16)
s_waitcnt vmcnt(7)
v_mfma_f32_16x16x32_bf16 v[108:111], a[100:103], a[172:175], v[108:111]
s_waitcnt lgkmcnt(0)
s_barrier
v_mfma_f32_16x16x32_bf16 v[112:115], a[104:107], a[152:155], v[112:115]
ds_read_b64_tr_b16 a[96:97], v54 offset:32768
v_mfma_f32_16x16x32_bf16 v[116:119], a[104:107], a[156:159], v[116:119]
s_add_u32 s42, s78, 2621440
s_and_b32 s42, s42, 0x3fffff
s_add_u32 s42, s42, s36
s_add_u32 m0, s37, 81920
s_nop 0
buffer_load_dwordx4 v60, s[8:11], s42 offen offset:0  lds
v_mfma_f32_16x16x32_bf16 v[120:123], a[104:107], a[160:163], v[120:123]
v_mfma_f32_16x16x32_bf16 v[124:127], a[104:107], a[164:167], v[124:127]
ds_read_b64_tr_b16 a[98:99], v54 offset:34816
v_mfma_f32_16x16x32_bf16 v[128:131], a[104:107], a[168:171], v[128:131]
buffer_load_dwordx4 v61, s[8:11], s42 offen offset:1024  lds
v_mfma_f32_16x16x32_bf16 v[132:135], a[104:107], a[172:175], v[132:135]
ds_read_b64_tr_b16 a[100:101], v54 offset:32776
v_mfma_f32_16x16x32_bf16 v[136:139], a[108:111], a[152:155], v[136:139]
ds_read_b64_tr_b16 a[102:103], v54 offset:34824
v_mfma_f32_16x16x32_bf16 v[140:143], a[108:111], a[156:159], v[140:143]
ds_read_b64_tr_b16 a[104:105], v55 offset:32768
v_mfma_f32_16x16x32_bf16 v[144:147], a[108:111], a[160:163], v[144:147]
buffer_load_dwordx4 v2, s[8:11], s42 offen offset:2048  lds
v_mfma_f32_16x16x32_bf16 v[148:151], a[108:111], a[164:167], v[148:151]
ds_read_b64_tr_b16 a[106:107], v55 offset:34816
v_mfma_f32_16x16x32_bf16 v[152:155], a[108:111], a[168:171], v[152:155]
ds_read_b128 a[128:131], v58 offset:24576
v_mfma_f32_16x16x32_bf16 v[156:159], a[108:111], a[172:175], v[156:159]
ds_read_b64_tr_b16 a[108:109], v55 offset:32776
v_mfma_f32_16x16x32_bf16 v[160:163], a[112:115], a[152:155], v[160:163]
buffer_load_dwordx4 v3, s[8:11], s42 offen offset:3072  lds
v_mfma_f32_16x16x32_bf16 v[164:167], a[112:115], a[156:159], v[164:167]
ds_read_b64_tr_b16 a[110:111], v55 offset:34824
v_mfma_f32_16x16x32_bf16 v[168:171], a[112:115], a[160:163], v[168:171]
ds_read_b128 a[132:135], v58 offset:26624
v_mfma_f32_16x16x32_bf16 v[172:175], a[112:115], a[164:167], v[172:175]
ds_read_b128 a[136:139], v58 offset:28672
v_mfma_f32_16x16x32_bf16 v[176:179], a[112:115], a[168:171], v[176:179]
s_add_u32 s42, s79, 640
s_and_b32 s42, s42, 1023
s_add_u32 s42, s42, s38
s_add_u32 m0, s39, 114688
s_nop 0
buffer_load_dwordx4 v62, s[4:7], s42 offen offset:0  lds
v_mfma_f32_16x16x32_bf16 v[180:183], a[112:115], a[172:175], v[180:183]
v_mfma_f32_16x16x32_bf16 v[184:187], a[116:119], a[152:155], v[184:187]
ds_read_b64_tr_b16 a[112:113], v56 offset:32768
v_mfma_f32_16x16x32_bf16 v[188:191], a[116:119], a[156:159], v[188:191]
ds_read_b64_tr_b16 a[114:115], v56 offset:34816
v_mfma_f32_16x16x32_bf16 v[192:195], a[116:119], a[160:163], v[192:195]
buffer_load_dwordx4 v63, s[4:7], s42 offen offset:1024  lds
v_mfma_f32_16x16x32_bf16 v[196:199], a[116:119], a[164:167], v[196:199]
ds_read_b128 a[140:143], v58 offset:30720
v_mfma_f32_16x16x32_bf16 v[200:203], a[116:119], a[168:171], v[200:203]
ds_read_b128 a[144:147], v58 offset:32768
v_mfma_f32_16x16x32_bf16 v[204:207], a[116:119], a[172:175], v[204:207]
ds_read_b128 a[148:151], v58 offset:34816
v_mfma_f32_16x16x32_bf16 v[208:211], a[120:123], a[152:155], v[208:211]
buffer_load_dwordx4 v6, s[4:7], s42 offen offset:2048  lds
v_mfma_f32_16x16x32_bf16 v[212:215], a[120:123], a[156:159], v[212:215]
s_add_u32 s83, s40, 4294963200
buffer_store_dwordx4 a[84:87], v4, s[16:19], s83 offen offset:1024 sc1
v_mfma_f32_16x16x32_bf16 v[216:219], a[120:123], a[160:163], v[216:219]
v_mfma_f32_16x16x32_bf16 v[220:223], a[120:123], a[164:167], v[220:223]
ds_read_b64_tr_b16 a[116:117], v56 offset:32776
v_mfma_f32_16x16x32_bf16 v[224:227], a[120:123], a[168:171], v[224:227]
buffer_store_dwordx4 a[88:91], v4, s[16:19], s83 offen offset:2048 sc1
v_mfma_f32_16x16x32_bf16 v[228:231], a[120:123], a[172:175], v[228:231]
ds_read_b64_tr_b16 a[118:119], v56 offset:34824
v_mfma_f32_16x16x32_bf16 v[232:235], a[124:127], a[152:155], v[232:235]
ds_read_b64_tr_b16 a[120:121], v57 offset:32768
v_mfma_f32_16x16x32_bf16 v[236:239], a[124:127], a[156:159], v[236:239]
ds_read_b64_tr_b16 a[122:123], v57 offset:34816
v_mfma_f32_16x16x32_bf16 v[240:243], a[124:127], a[160:163], v[240:243]
buffer_store_dwordx4 a[92:95], v4, s[16:19], s83 offen offset:3072 sc1
v_mfma_f32_16x16x32_bf16 v[244:247], a[124:127], a[164:167], v[244:247]
v_mfma_f32_16x16x32_bf16 v[248:251], a[124:127], a[168:171], v[248:251]
v_mfma_f32_16x16x32_bf16 v[252:255], a[124:127], a[172:175], v[252:255]
ds_read_b64_tr_b16 a[124:125], v57 offset:32776
ds_read_b64_tr_b16 a[126:127], v57 offset:34824
s_waitcnt lgkmcnt(4)
v_mfma_f32_16x16x32_bf16 v[64:67], a[96:99], a[128:131], v[64:67]
s_add_u32 s42, s79, 640
s_and_b32 s42, s42, 1023
s_add_u32 s42, s42, s38
s_add_u32 m0, s39, 114688
s_nop 0
buffer_load_dwordx4 v7, s[4:7], s42 offen offset:3072  lds
v_mfma_f32_16x16x32_bf16 v[68:71], a[96:99], a[132:135], v[68:71]
v_mfma_f32_16x16x32_bf16 v[72:75], a[96:99], a[136:139], v[72:75]
v_mfma_f32_16x16x32_bf16 v[76:79], a[96:99], a[140:143], v[76:79]
s_add_u32 s42, s42, 32768
s_add_u32 m0, s39, 118784
s_nop 0
buffer_load_dwordx4 v62, s[4:7], s42 offen offset:0  lds
v_mfma_f32_16x16x32_bf16 v[80:83], a[96:99], a[144:147], v[80:83]
v_mfma_f32_16x16x32_bf16 v[84:87], a[96:99], a[148:151], v[84:87]
v_mfma_f32_16x16x32_bf16 v[88:91], a[100:103], a[128:131], v[88:91]
buffer_load_dwordx4 v63, s[4:7], s42 offen offset:1024  lds
v_mfma_f32_16x16x32_bf16 v[92:95], a[100:103], a[132:135], v[92:95]
v_mfma_f32_16x16x32_bf16 v[96:99], a[100:103], a[136:139], v[96:99]
v_mfma_f32_16x16x32_bf16 v[100:103], a[100:103], a[140:143], v[100:103]
v_mfma_f32_16x16x32_bf16 v[104:107], a[100:103], a[144:147], v[104:107]
s_waitcnt vmcnt(16)
v_mfma_f32_16x16x32_bf16 v[108:111], a[100:103], a[148:151], v[108:111]
s_waitcnt lgkmcnt(0)
s_barrier
v_mfma_f32_16x16x32_bf16 v[112:115], a[104:107], a[128:131], v[112:115]
ds_read_b64_tr_b16 a[96:97], v54 offset:0
v_mfma_f32_16x16x32_bf16 v[116:119], a[104:107], a[132:135], v[116:119]
s_add_u32 s42, s78, 2883584
s_and_b32 s42, s42, 0x3fffff
s_add_u32 s42, s42, s36
s_add_u32 m0, s37, 98304
s_nop 0
buffer_load_dwordx4 v60, s[8:11], s42 offen offset:0  lds
v_mfma_f32_16x16x32_bf16 v[120:123], a[104:107], a[136:139], v[120:123]
v_mfma_f32_16x16x32_bf16 v[124:127], a[104:107], a[140:143], v[124:127]
ds_read_b64_tr_b16 a[98:99], v54 offset:2048
v_mfma_f32_16x16x32_bf16 v[128:131], a[104:107], a[144:147], v[128:131]
ds_read_b64_tr_b16 a[100:101], v54 offset:8
v_mfma_f32_16x16x32_bf16 v[132:135], a[104:107], a[148:151], v[132:135]
ds_read_b64_tr_b16 a[102:103], v54 offset:2056
v_mfma_f32_16x16x32_bf16 v[136:139], a[108:111], a[128:131], v[136:139]
ds_read_b64_tr_b16 a[104:105], v55 offset:0
v_mfma_f32_16x16x32_bf16 v[140:143], a[108:111], a[132:135], v[140:143]
ds_read_b64_tr_b16 a[106:107], v55 offset:2048
v_mfma_f32_16x16x32_bf16 v[144:147], a[108:111], a[136:139], v[144:147]
ds_read_b128 a[152:155], v59 offset:24576
v_mfma_f32_16x16x32_bf16 v[148:151], a[108:111], a[140:143], v[148:151]
buffer_load_dwordx4 v61, s[8:11], s42 offen offset:1024  lds
v_mfma_f32_16x16x32_bf16 v[152:155], a[108:111], a[144:147], v[152:155]
ds_read_b128 a[156:159], v59 offset:26624
v_mfma_f32_16x16x32_bf16 v[156:159], a[108:111], a[148:151], v[156:159]
ds_read_b64_tr_b16 a[108:109], v55 offset:8
v_mfma_f32_16x16x32_bf16 v[160:163], a[112:115], a[128:131], v[160:163]
ds_read_b64_tr_b16 a[110:111], v55 offset:2056
v_mfma_f32_16x16x32_bf16 v[164:167], a[112:115], a[132:135], v[164:167]
ds_read_b128 a[160:163], v59 offset:28672
v_mfma_f32_16x16x32_bf16 v[168:171], a[112:115], a[136:139], v[168:171]
ds_read_b128 a[164:167], v59 offset:30720
v_mfma_f32_16x16x32_bf16 v[172:175], a[112:115], a[140:143], v[172:175]
ds_read_b128 a[168:171], v59 offset:32768
v_mfma_f32_16x16x32_bf16 v[176:179], a[112:115], a[144:147], v[176:179]
ds_read_b128 a[172:175], v59 offset:34816
v_mfma_f32_16x16x32_bf16 v[180:183], a[112:115], a[148:151], v[180:183]
ds_read_b64_tr_b16 a[112:113], v56 offset:0
v_mfma_f32_16x16x32_bf16 v[184:187], a[116:119], a[128:131], v[184:187]
buffer_load_dwordx4 v2, s[8:11], s42 offen offset:2048  lds
v_mfma_f32_16x16x32_bf16 v[188:191], a[116:119], a[132:135], v[188:191]
ds_read_b64_tr_b16 a[114:115], v56 offset:2048
v_mfma_f32_16x16x32_bf16 v[192:195], a[116:119], a[136:139], v[192:195]
v_mfma_f32_16x16x32_bf16 v[196:199], a[116:119], a[140:143], v[196:199]
v_mfma_f32_16x16x32_bf16 v[200:203], a[116:119], a[144:147], v[200:203]
v_mfma_f32_16x16x32_bf16 v[204:207], a[116:119], a[148:151], v[204:207]
ds_read_b64_tr_b16 a[116:117], v56 offset:8
v_mfma_f32_16x16x32_bf16 v[208:211], a[120:123], a[128:131], v[208:211]
ds_read_b64_tr_b16 a[118:119], v56 offset:2056
v_mfma_f32_16x16x32_bf16 v[212:215], a[120:123], a[132:135], v[212:215]
v_mfma_f32_16x16x32_bf16 v[216:219], a[120:123], a[136:139], v[216:219]
v_mfma_f32_16x16x32_bf16 v[220:223], a[120:123], a[140:143], v[220:223]
buffer_load_dwordx4 v3, s[8:11], s42 offen offset:3072  lds
v_mfma_f32_16x16x32_bf16 v[224:227], a[120:123], a[144:147], v[224:227]
v_mfma_f32_16x16x32_bf16 v[228:231], a[120:123], a[148:151], v[228:231]
ds_read_b64_tr_b16 a[120:121], v57 offset:0
v_mfma_f32_16x16x32_bf16 v[232:235], a[124:127], a[128:131], v[232:235]
ds_read_b64_tr_b16 a[122:123], v57 offset:2048
v_mfma_f32_16x16x32_bf16 v[236:239], a[124:127], a[132:135], v[236:239]
v_mfma_f32_16x16x32_bf16 v[240:243], a[124:127], a[136:139], v[240:243]
v_mfma_f32_16x16x32_bf16 v[244:247], a[124:127], a[140:143], v[244:247]
v_mfma_f32_16x16x32_bf16 v[248:251], a[124:127], a[144:147], v[248:251]
v_mfma_f32_16x16x32_bf16 v[252:255], a[124:127], a[148:151], v[252:255]
ds_read_b64_tr_b16 a[124:125], v57 offset:8
ds_read_b64_tr_b16 a[126:127], v57 offset:2056
s_waitcnt lgkmcnt(4)
v_mfma_f32_16x16x32_bf16 v[64:67], a[96:99], a[152:155], v[64:67]
v_mfma_f32_16x16x32_bf16 v[68:71], a[96:99], a[156:159], v[68:71]
v_mfma_f32_16x16x32_bf16 v[72:75], a[96:99], a[160:163], v[72:75]
v_mfma_f32_16x16x32_bf16 v[76:79], a[96:99], a[164:167], v[76:79]
v_mfma_f32_16x16x32_bf16 v[80:83], a[96:99], a[168:171], v[80:83]
v_mfma_f32_16x16x32_bf16 v[84:87], a[96:99], a[172:175], v[84:87]
v_mfma_f32_16x16x32_bf16 v[88:91], a[100:103], a[152:155], v[88:91]
v_mfma_f32_16x16x32_bf16 v[92:95], a[100:103], a[156:159], v[92:95]
v_mfma_f32_16x16x32_bf16 v[96:99], a[100:103], a[160:163], v[96:99]
v_mfma_f32_16x16x32_bf16 v[100:103], a[100:103], a[164:167], v[100:103]
v_mfma_f32_16x16x32_bf16 v[104:107], a[100:103], a[168:171], v[104:107]
s_waitcnt vmcnt(13)
s_waitcnt vmcnt(4)
v_mfma_f32_16x16x32_bf16 v[108:111], a[100:103], a[172:175], v[108:111]
s_waitcnt lgkmcnt(0)
s_barrier
v_mfma_f32_16x16x32_bf16 v[112:115], a[104:107], a[152:155], v[112:115]
ds_read_b64_tr_b16 a[96:97], v54 offset:16384
v_mfma_f32_16x16x32_bf16 v[116:119], a[104:107], a[156:159], v[116:119]
s_add_u32 s42, s78, 3145728
s_and_b32 s42, s42, 0x3fffff
s_add_u32 s42, s42, s36
s_add_u32 m0, s37, 65536
s_nop 0
buffer_load_dwordx4 v60, s[8:11], s42 offen offset:0  lds
v_mfma_f32_16x16x32_bf16 v[120:123], a[104:107], a[160:163], v[120:123]
v_mfma_f32_16x16x32_bf16 v[124:127], a[104:107], a[164:167], v[124:127]
ds_read_b64_tr_b16 a[98:99], v54 offset:18432
v_mfma_f32_16x16x32_bf16 v[128:131], a[104:107], a[168:171], v[128:131]
ds_read_b64_tr_b16 a[100:101], v54 offset:16392
v_mfma_f32_16x16x32_bf16 v[132:135], a[104:107], a[172:175], v[132:135]
ds_read_b64_tr_b16 a[102:103], v54 offset:18440
v_mfma_f32_16x16x32_bf16 v[136:139], a[108:111], a[152:155], v[136:139]
buffer_load_dwordx4 v61, s[8:11], s42 offen offset:1024  lds
v_mfma_f32_16x16x32_bf16 v[140:143], a[108:111], a[156:159], v[140:143]
ds_read_b64_tr_b16 a[104:105], v55 offset:16384
v_mfma_f32_16x16x32_bf16 v[144:147], a[108:111], a[160:163], v[144:147]
ds_read_b64_tr_b16 a[106:107], v55 offset:18432
v_mfma_f32_16x16x32_bf16 v[148:151], a[108:111], a[164:167], v[148:151]
ds_read_b128 a[128:131], v58 offset:0
v_mfma_f32_16x16x32_bf16 v[152:155], a[108:111], a[168:171], v[152:155]
ds_read_b128 a[132:135], v58 offset:2048
v_mfma_f32_16x16x32_bf16 v[156:159], a[108:111], a[172:175], v[156:159]
buffer_load_dwordx4 v2, s[8:11], s42 offen offset:2048  lds
v_mfma_f32_16x16x32_bf16 v[160:163], a[112:115], a[152:155], v[160:163]
ds_read_b64_tr_b16 a[108:109], v55 offset:16392
v_mfma_f32_16x16x32_bf16 v[164:167], a[112:115], a[156:159], v[164:167]
ds_read_b64_tr_b16 a[110:111], v55 offset:18440
v_mfma_f32_16x16x32_bf16 v[168:171], a[112:115], a[160:163], v[168:171]
ds_read_b128 a[136:139], v58 offset:4096
v_mfma_f32_16x16x32_bf16 v[172:175], a[112:115], a[164:167], v[172:175]
ds_read_b128 a[140:143], v58 offset:6144
v_mfma_f32_16x16x32_bf16 v[176:179], a[112:115], a[168:171], v[176:179]
buffer_load_dwordx4 v3, s[8:11], s42 offen offset:3072  lds
v_mfma_f32_16x16x32_bf16 v[180:183], a[112:115], a[172:175], v[180:183]
ds_read_b64_tr_b16 a[112:113], v56 offset:16384
v_mfma_f32_16x16x32_bf16 v[184:187], a[116:119], a[152:155], v[184:187]
ds_read_b64_tr_b16 a[114:115], v56 offset:18432
v_mfma_f32_16x16x32_bf16 v[188:191], a[116:119], a[156:159], v[188:191]
ds_read_b128 a[144:147], v58 offset:8192
v_mfma_f32_16x16x32_bf16 v[192:195], a[116:119], a[160:163], v[192:195]
ds_read_b128 a[148:151], v58 offset:10240
v_mfma_f32_16x16x32_bf16 v[196:199], a[116:119], a[164:167], v[196:199]
s_add_u32 s42, s79, 768
s_and_b32 s42, s42, 1023
s_add_u32 s42, s42, s38
s_add_u32 m0, s39, 139264
s_nop 0
buffer_load_dwordx4 v62, s[4:7], s42 offen offset:0  lds
v_mfma_f32_16x16x32_bf16 v[200:203], a[116:119], a[168:171], v[200:203]
v_mfma_f32_16x16x32_bf16 v[204:207], a[116:119], a[172:175], v[204:207]
ds_read_b64_tr_b16 a[116:117], v56 offset:16392
v_mfma_f32_16x16x32_bf16 v[208:211], a[120:123], a[152:155], v[208:211]
ds_read_b64_tr_b16 a[118:119], v56 offset:18440
v_mfma_f32_16x16x32_bf16 v[212:215], a[120:123], a[156:159], v[212:215]
v_mfma_f32_16x16x32_bf16 v[216:219], a[120:123], a[160:163], v[216:219]
buffer_load_dwordx4 v63, s[4:7], s42 offen offset:1024  lds
v_mfma_f32_16x16x32_bf16 v[220:223], a[120:123], a[164:167], v[220:223]
v_mfma_f32_16x16x32_bf16 v[224:227], a[120:123], a[168:171], v[224:227]
v_mfma_f32_16x16x32_bf16 v[228:231], a[120:123], a[172:175], v[228:231]
ds_read_b64_tr_b16 a[120:121], v57 offset:16384
v_mfma_f32_16x16x32_bf16 v[232:235], a[124:127], a[152:155], v[232:235]
ds_read_b64_tr_b16 a[122:123], v57 offset:18432
v_mfma_f32_16x16x32_bf16 v[236:239], a[124:127], a[156:159], v[236:239]
buffer_load_dwordx4 v6, s[4:7], s42 offen offset:2048  lds
v_mfma_f32_16x16x32_bf16 v[240:243], a[124:127], a[160:163], v[240:243]
v_mfma_f32_16x16x32_bf16 v[244:247], a[124:127], a[164:167], v[244:247]
v_mfma_f32_16x16x32_bf16 v[248:251], a[124:127], a[168:171], v[248:251]
v_mfma_f32_16x16x32_bf16 v[252:255], a[124:127], a[172:175], v[252:255]
ds_read_b64_tr_b16 a[124:125], v57 offset:16392
ds_read_b64_tr_b16 a[126:127], v57 offset:18440
s_waitcnt lgkmcnt(4)
v_mfma_f32_16x16x32_bf16 v[64:67], a[96:99], a[128:131], v[64:67]
s_add_u32 s42, s79, 768
s_and_b32 s42, s42, 1023
s_add_u32 s42, s42, s38
s_add_u32 m0, s39, 139264
s_nop 0
buffer_load_dwordx4 v7, s[4:7], s42 offen offset:3072  lds
v_mfma_f32_16x16x32_bf16 v[68:71], a[96:99], a[132:135], v[68:71]
v_mfma_f32_16x16x32_bf16 v[72:75], a[96:99], a[136:139], v[72:75]
v_mfma_f32_16x16x32_bf16 v[76:79], a[96:99], a[140:143], v[76:79]
s_add_u32 s42, s42, 32768
s_add_u32 m0, s39, 143360
s_nop 0
buffer_load_dwordx4 v62, s[4:7], s42 offen offset:0  lds
v_mfma_f32_16x16x32_bf16 v[80:83], a[96:99], a[144:147], v[80:83]
v_mfma_f32_16x16x32_bf16 v[84:87], a[96:99], a[148:151], v[84:87]
v_mfma_f32_16x16x32_bf16 v[88:91], a[100:103], a[128:131], v[88:91]
buffer_load_dwordx4 v63, s[4:7], s42 offen offset:1024  lds
v_mfma_f32_16x16x32_bf16 v[92:95], a[100:103], a[132:135], v[92:95]
v_mfma_f32_16x16x32_bf16 v[96:99], a[100:103], a[136:139], v[96:99]
v_mfma_f32_16x16x32_bf16 v[100:103], a[100:103], a[140:143], v[100:103]
v_mfma_f32_16x16x32_bf16 v[104:107], a[100:103], a[144:147], v[104:107]
s_waitcnt vmcnt(10)
v_mfma_f32_16x16x32_bf16 v[108:111], a[100:103], a[148:151], v[108:111]
s_waitcnt lgkmcnt(0)
s_barrier
v_mfma_f32_16x16x32_bf16 v[112:115], a[104:107], a[128:131], v[112:115]
ds_read_b64_tr_b16 a[96:97], v54 offset:32768
v_mfma_f32_16x16x32_bf16 v[116:119], a[104:107], a[132:135], v[116:119]
s_add_u32 s42, s78, 3407872
s_and_b32 s42, s42, 0x3fffff
s_add_u32 s42, s42, s36
s_add_u32 m0, s37, 81920
s_nop 0
buffer_load_dwordx4 v60, s[8:11], s42 offen offset:0  lds
v_mfma_f32_16x16x32_bf16 v[120:123], a[104:107], a[136:139], v[120:123]
v_mfma_f32_16x16x32_bf16 v[124:127], a[104:107], a[140:143], v[124:127]
ds_read_b64_tr_b16 a[98:99], v54 offset:34816
v_mfma_f32_16x16x32_bf16 v[128:131], a[104:107], a[144:147], v[128:131]
ds_read_b64_tr_b16 a[100:101], v54 offset:32776
v_mfma_f32_16x16x32_bf16 v[132:135], a[104:107], a[148:151], v[132:135]
ds_read_b64_tr_b16 a[102:103], v54 offset:34824
v_mfma_f32_16x16x32_bf16 v[136:139], a[108:111], a[128:131], v[136:139]
buffer_load_dwordx4 v61, s[8:11], s42 offen offset:1024  lds
v_mfma_f32_16x16x32_bf16 v[140:143], a[108:111], a[132:135], v[140:143]
ds_read_b64_tr_b16 a[104:105], v55 offset:32768
v_mfma_f32_16x16x32_bf16 v[144:147], a[108:111], a[136:139], v[144:147]
ds_read_b64_tr_b16 a[106:107], v55 offset:34816
v_mfma_f32_16x16x32_bf16 v[148:151], a[108:111], a[140:143], v[148:151]
ds_read_b128 a[152:155], v59 offset:0
v_mfma_f32_16x16x32_bf16 v[152:155], a[108:111], a[144:147], v[152:155]
ds_read_b128 a[156:159], v59 offset:2048
v_mfma_f32_16x16x32_bf16 v[156:159], a[108:111], a[148:151], v[156:159]
buffer_load_dwordx4 v2, s[8:11], s42 offen offset:2048  lds
v_mfma_f32_16x16x32_bf16 v[160:163], a[112:115], a[128:131], v[160:163]
ds_read_b64_tr_b16 a[108:109], v55 offset:32776
v_mfma_f32_16x16x32_bf16 v[164:167], a[112:115], a[132:135], v[164:167]
ds_read_b64_tr_b16 a[110:111], v55 offset:34824
v_mfma_f32_16x16x32_bf16 v[168:171], a[112:115], a[136:139], v[168:171]
ds_read_b128 a[160:163], v59 offset:4096
v_mfma_f32_16x16x32_bf16 v[172:175], a[112:115], a[140:143], v[172:175]
ds_read_b128 a[164:167], v59 offset:6144
v_mfma_f32_16x16x32_bf16 v[176:179], a[112:115], a[144:147], v[176:179]
buffer_load_dwordx4 v3, s[8:11], s42 offen offset:3072  lds
v_mfma_f32_16x16x32_bf16 v[180:183], a[112:115], a[148:151], v[180:183]
ds_read_b64_tr_b16 a[112:113], v56 offset:32768
v_mfma_f32_16x16x32_bf16 v[184:187], a[116:119], a[128:131], v[184:187]
ds_read_b64_tr_b16 a[114:115], v56 offset:34816
v_mfma_f32_16x16x32_bf16 v[188:191], a[116:119], a[132:135], v[188:191]
ds_read_b128 a[168:171], v59 offset:8192
v_mfma_f32_16x16x32_bf16 v[192:195], a[116:119], a[136:139], v[192:195]
ds_read_b128 a[172:175], v59 offset:10240
v_mfma_f32_16x16x32_bf16 v[196:199], a[116:119], a[140:143], v[196:199]
v_mfma_f32_16x16x32_bf16 v[200:203], a[116:119], a[144:147], v[200:203]
s_add_u32 s74, s34, s84
s_add_u32 s84, s84, 8192
s_add_u32 m0, s35, 0
s_nop 0
buffer_load_dwordx4 v50, s[12:15], s74 offen offset:0 nt lds
v_mfma_f32_16x16x32_bf16 v[204:207], a[116:119], a[148:151], v[204:207]
v_mfma_f32_16x16x32_bf16 v[208:211], a[120:123], a[128:131], v[208:211]
ds_read_b64_tr_b16 a[116:117], v56 offset:32776
v_mfma_f32_16x16x32_bf16 v[212:215], a[120:123], a[132:135], v[212:215]
buffer_load_dwordx4 v51, s[12:15], s74 offen offset:1024 nt lds
v_mfma_f32_16x16x32_bf16 v[216:219], a[120:123], a[136:139], v[216:219]
ds_read_b64_tr_b16 a[118:119], v56 offset:34824
v_mfma_f32_16x16x32_bf16 v[220:223], a[120:123], a[140:143], v[220:223]
v_mfma_f32_16x16x32_bf16 v[224:227], a[120:123], a[144:147], v[224:227]
v_mfma_f32_16x16x32_bf16 v[228:231], a[120:123], a[148:151], v[228:231]
buffer_load_dwordx4 v52, s[12:15], s74 offen offset:2048 nt lds
v_mfma_f32_16x16x32_bf16 v[232:235], a[124:127], a[128:131], v[232:235]
ds_read_b64_tr_b16 a[120:121], v57 offset:32768
v_mfma_f32_16x16x32_bf16 v[236:239], a[124:127], a[132:135], v[236:239]
ds_read_b64_tr_b16 a[122:123], v57 offset:34816
v_mfma_f32_16x16x32_bf16 v[240:243], a[124:127], a[136:139], v[240:243]
buffer_load_dwordx4 v53, s[12:15], s74 offen offset:3072 nt lds
v_mfma_f32_16x16x32_bf16 v[244:247], a[124:127], a[140:143], v[244:247]
v_mfma_f32_16x16x32_bf16 v[248:251], a[124:127], a[144:147], v[248:251]
v_mfma_f32_16x16x32_bf16 v[252:255], a[124:127], a[148:151], v[252:255]
ds_read_b64_tr_b16 a[124:125], v57 offset:32776
ds_read_b64_tr_b16 a[126:127], v57 offset:34824
s_waitcnt lgkmcnt(4)
v_mfma_f32_16x16x32_bf16 v[64:67], a[96:99], a[152:155], v[64:67]
v_mfma_f32_16x16x32_bf16 v[68:71], a[96:99], a[156:159], v[68:71]
v_mfma_f32_16x16x32_bf16 v[72:75], a[96:99], a[160:163], v[72:75]
v_mfma_f32_16x16x32_bf16 v[76:79], a[96:99], a[164:167], v[76:79]
v_mfma_f32_16x16x32_bf16 v[80:83], a[96:99], a[168:171], v[80:83]
v_mfma_f32_16x16x32_bf16 v[84:87], a[96:99], a[172:175], v[84:87]
v_mfma_f32_16x16x32_bf16 v[88:91], a[100:103], a[152:155], v[88:91]
v_mfma_f32_16x16x32_bf16 v[92:95], a[100:103], a[156:159], v[92:95]
v_mfma_f32_16x16x32_bf16 v[96:99], a[100:103], a[160:163], v[96:99]
v_mfma_f32_16x16x32_bf16 v[100:103], a[100:103], a[164:167], v[100:103]
v_mfma_f32_16x16x32_bf16 v[104:107], a[100:103], a[168:171], v[104:107]
s_waitcnt vmcnt(14)
s_waitcnt vmcnt(8)
v_mfma_f32_16x16x32_bf16 v[108:111], a[100:103], a[172:175], v[108:111]
s_waitcnt lgkmcnt(0)
s_barrier
v_mfma_f32_16x16x32_bf16 v[112:115], a[104:107], a[152:155], v[112:115]
ds_read_b64_tr_b16 a[96:97], v54 offset:0
v_mfma_f32_16x16x32_bf16 v[116:119], a[104:107], a[156:159], v[116:119]
s_add_u32 s42, s78, 3670016
s_and_b32 s42, s42, 0x3fffff
s_add_u32 s42, s42, s36
s_add_u32 m0, s37, 98304
s_nop 0
buffer_load_dwordx4 v60, s[8:11], s42 offen offset:0  lds
v_mfma_f32_16x16x32_bf16 v[120:123], a[104:107], a[160:163], v[120:123]
v_mfma_f32_16x16x32_bf16 v[124:127], a[104:107], a[164:167], v[124:127]
buffer_load_dwordx4 v61, s[8:11], s42 offen offset:1024  lds
v_mfma_f32_16x16x32_bf16 v[128:131], a[104:107], a[168:171], v[128:131]
ds_read_b64_tr_b16 a[98:99], v54 offset:2048
v_mfma_f32_16x16x32_bf16 v[132:135], a[104:107], a[172:175], v[132:135]
ds_read_b64_tr_b16 a[100:101], v54 offset:8
v_mfma_f32_16x16x32_bf16 v[136:139], a[108:111], a[152:155], v[136:139]
buffer_load_dwordx4 v2, s[8:11], s42 offen offset:2048  lds
v_mfma_f32_16x16x32_bf16 v[140:143], a[108:111], a[156:159], v[140:143]
ds_read_b64_tr_b16 a[102:103], v54 offset:2056
v_mfma_f32_16x16x32_bf16 v[144:147], a[108:111], a[160:163], v[144:147]
ds_read_b64_tr_b16 a[104:105], v55 offset:0
v_mfma_f32_16x16x32_bf16 v[148:151], a[108:111], a[164:167], v[148:151]
buffer_load_dwordx4 v3, s[8:11], s42 offen offset:3072  lds
v_mfma_f32_16x16x32_bf16 v[152:155], a[108:111], a[168:171], v[152:155]
ds_read_b64_tr_b16 a[106:107], v55 offset:2048
v_mfma_f32_16x16x32_bf16 v[156:159], a[108:111], a[172:175], v[156:159]
ds_read_b64_tr_b16 a[108:109], v55 offset:8
v_mfma_f32_16x16x32_bf16 v[160:163], a[112:115], a[152:155], v[160:163]
s_add_u32 s42, s79, 896
s_and_b32 s42, s42, 1023
s_add_u32 s42, s42, s38
s_add_u32 m0, s39, 114688
s_nop 0
buffer_load_dwordx4 v62, s[4:7], s42 offen offset:0  lds
v_mfma_f32_16x16x32_bf16 v[164:167], a[112:115], a[156:159], v[164:167]
v_mfma_f32_16x16x32_bf16 v[168:171], a[112:115], a[160:163], v[168:171]
ds_read_b64_tr_b16 a[110:111], v55 offset:2056
v_mfma_f32_16x16x32_bf16 v[172:175], a[112:115], a[164:167], v[172:175]
buffer_load_dwordx4 v63, s[4:7], s42 offen offset:1024  lds
v_mfma_f32_16x16x32_bf16 v[176:179], a[112:115], a[168:171], v[176:179]
ds_read_b128 a[128:131], v58 offset:24576
v_mfma_f32_16x16x32_bf16 v[180:183], a[112:115], a[172:175], v[180:183]
ds_read_b64_tr_b16 a[112:113], v56 offset:0
v_mfma_f32_16x16x32_bf16 v[184:187], a[116:119], a[152:155], v[184:187]
buffer_load_dwordx4 v6, s[4:7], s42 offen offset:2048  lds
v_mfma_f32_16x16x32_bf16 v[188:191], a[116:119], a[156:159], v[188:191]
ds_read_b64_tr_b16 a[114:115], v56 offset:2048
v_mfma_f32_16x16x32_bf16 v[192:195], a[116:119], a[160:163], v[192:195]
ds_read_b128 a[132:135], v58 offset:26624
v_mfma_f32_16x16x32_bf16 v[196:199], a[116:119], a[164:167], v[196:199]
ds_read_b128 a[136:139], v58 offset:28672
v_mfma_f32_16x16x32_bf16 v[200:203], a[116:119], a[168:171], v[200:203]
s_add_u32 s41, s74, 4096
s_add_u32 m0, s35, 4096
s_nop 0
buffer_load_dwordx4 v50, s[12:15], s41 offen offset:0 nt lds
v_mfma_f32_16x16x32_bf16 v[204:207], a[116:119], a[172:175], v[204:207]
v_mfma_f32_16x16x32_bf16 v[208:211], a[120:123], a[152:155], v[208:211]
ds_read_b128 a[140:143], v58 offset:30720
v_mfma_f32_16x16x32_bf16 v[212:215], a[120:123], a[156:159], v[212:215]
buffer_load_dwordx4 v51, s[12:15], s41 offen offset:1024 nt lds
v_mfma_f32_16x16x32_bf16 v[216:219], a[120:123], a[160:163], v[216:219]
ds_read_b128 a[144:147], v58 offset:32768
v_mfma_f32_16x16x32_bf16 v[220:223], a[120:123], a[164:167], v[220:223]
ds_read_b128 a[148:151], v58 offset:34816
v_mfma_f32_16x16x32_bf16 v[224:227], a[120:123], a[168:171], v[224:227]
ds_read_b64_tr_b16 a[116:117], v56 offset:8
v_mfma_f32_16x16x32_bf16 v[228:231], a[120:123], a[172:175], v[228:231]
buffer_load_dwordx4 v52, s[12:15], s41 offen offset:2048 nt lds
v_mfma_f32_16x16x32_bf16 v[232:235], a[124:127], a[152:155], v[232:235]
ds_read_b64_tr_b16 a[118:119], v56 offset:2056
v_mfma_f32_16x16x32_bf16 v[236:239], a[124:127], a[156:159], v[236:239]
ds_read_b64_tr_b16 a[120:121], v57 offset:0
v_mfma_f32_16x16x32_bf16 v[240:243], a[124:127], a[160:163], v[240:243]
buffer_load_dwordx4 v53, s[12:15], s41 offen offset:3072 nt lds
v_mfma_f32_16x16x32_bf16 v[244:247], a[124:127], a[164:167], v[244:247]
ds_read_b64_tr_b16 a[122:123], v57 offset:2048
v_mfma_f32_16x16x32_bf16 v[248:251], a[124:127], a[168:171], v[248:251]
v_mfma_f32_16x16x32_bf16 v[252:255], a[124:127], a[172:175], v[252:255]
ds_read_b64_tr_b16 a[124:125], v57 offset:8
ds_read_b64_tr_b16 a[126:127], v57 offset:2056
s_cmp_eq_u32 s46, 1
s_cbranch_scc1 L_B1
s_waitcnt lgkmcnt(4)
v_mfma_f32_16x16x32_bf16 v[64:67], a[96:99], a[128:131], v[64:67]
s_add_u32 s42, s79, 896
s_and_b32 s42, s42, 1023
s_add_u32 s42, s42, s38
s_add_u32 m0, s39, 114688
s_nop 0
buffer_load_dwordx4 v7, s[4:7], s42 offen offset:3072  lds
v_mfma_f32_16x16x32_bf16 v[68:71], a[96:99], a[132:135], v[68:71]
v_mfma_f32_16x16x32_bf16 v[72:75], a[96:99], a[136:139], v[72:75]
v_mfma_f32_16x16x32_bf16 v[76:79], a[96:99], a[140:143], v[76:79]
s_add_u32 s42, s42, 32768
s_add_u32 m0, s39, 118784
s_nop 0
buffer_load_dwordx4 v62, s[4:7], s42 offen offset:0  lds
v_mfma_f32_16x16x32_bf16 v[80:83], a[96:99], a[144:147], v[80:83]
v_mfma_f32_16x16x32_bf16 v[84:87], a[96:99], a[148:151], v[84:87]
v_mfma_f32_16x16x32_bf16 v[88:91], a[100:103], a[128:131], v[88:91]
buffer_load_dwordx4 v63, s[4:7], s42 offen offset:1024  lds
v_mfma_f32_16x16x32_bf16 v[92:95], a[100:103], a[132:135], v[92:95]
v_mfma_f32_16x16x32_bf16 v[96:99], a[100:103], a[136:139], v[96:99]
v_mfma_f32_16x16x32_bf16 v[100:103], a[100:103], a[140:143], v[100:103]
v_mfma_f32_16x16x32_bf16 v[104:107], a[100:103], a[144:147], v[104:107]
s_waitcnt vmcnt(18)
v_mfma_f32_16x16x32_bf16 v[108:111], a[100:103], a[148:151], v[108:111]
s_waitcnt lgkmcnt(0)
s_barrier
v_mfma_f32_16x16x32_bf16 v[112:115], a[104:107], a[128:131], v[112:115]
ds_read_b64_tr_b16 a[96:97], v54 offset:16384
v_mfma_f32_16x16x32_bf16 v[116:119], a[104:107], a[132:135], v[116:119]
s_add_u32 s42, s78, 3932160
s_and_b32 s42, s42, 0x3fffff
s_add_u32 s42, s42, s36
s_add_u32 m0, s37, 65536
s_nop 0
buffer_load_dwordx4 v60, s[8:11], s42 offen offset:0  lds
v_mfma_f32_16x16x32_bf16 v[120:123], a[104:107], a[136:139], v[120:123]
v_mfma_f32_16x16x32_bf16 v[124:127], a[104:107], a[140:143], v[124:127]
ds_read_b64_tr_b16 a[98:99], v54 offset:18432
v_mfma_f32_16x16x32_bf16 v[128:131], a[104:107], a[144:147], v[128:131]
ds_read_b64_tr_b16 a[100:101], v54 offset:16392
v_mfma_f32_16x16x32_bf16 v[132:135], a[104:107], a[148:151], v[132:135]
ds_read_b64_tr_b16 a[102:103], v54 offset:18440
v_mfma_f32_16x16x32_bf16 v[136:139], a[108:111], a[128:131], v[136:139]
buffer_load_dwordx4 v61, s[8:11], s42 offen offset:1024  lds
v_mfma_f32_16x16x32_bf16 v[140:143], a[108:111], a[132:135], v[140:143]
ds_read_b64_tr_b16 a[104:105], v55 offset:16384
v_mfma_f32_16x16x32_bf16 v[144:147], a[108:111], a[136:139], v[144:147]
ds_read_b64_tr_b16 a[106:107], v55 offset:18432
v_mfma_f32_16x16x32_bf16 v[148:151], a[108:111], a[140:143], v[148:151]
ds_read_b128 a[152:155], v59 offset:24576
v_mfma_f32_16x16x32_bf16 v[152:155], a[108:111], a[144:147], v[152:155]
ds_read_b128 a[156:159], v59 offset:26624
v_mfma_f32_16x16x32_bf16 v[156:159], a[108:111], a[148:151], v[156:159]
buffer_load_dwordx4 v2, s[8:11], s42 offen offset:2048  lds
v_mfma_f32_16x16x32_bf16 v[160:163], a[112:115], a[128:131], v[160:163]
ds_read_b64_tr_b16 a[108:109], v55 offset:16392
v_mfma_f32_16x16x32_bf16 v[164:167], a[112:115], a[132:135], v[164:167]
ds_read_b64_tr_b16 a[110:111], v55 offset:18440
v_mfma_f32_16x16x32_bf16 v[168:171], a[112:115], a[136:139], v[168:171]
ds_read_b128 a[160:163], v59 offset:28672
v_mfma_f32_16x16x32_bf16 v[172:175], a[112:115], a[140:143], v[172:175]
ds_read_b128 a[164:167], v59 offset:30720
v_mfma_f32_16x16x32_bf16 v[176:179], a[112:115], a[144:147], v[176:179]
buffer_load_dwordx4 v3, s[8:11], s42 offen offset:3072  lds
v_mfma_f32_16x16x32_bf16 v[180:183], a[112:115], a[148:151], v[180:183]
ds_read_b64_tr_b16 a[112:113], v56 offset:16384
v_mfma_f32_16x16x32_bf16 v[184:187], a[116:119], a[128:131], v[184:187]
ds_read_b64_tr_b16 a[114:115], v56 offset:18432
v_mfma_f32_16x16x32_bf16 v[188:191], a[116:119], a[132:135], v[188:191]
ds_read_b128 a[168:171], v59 offset:32768
v_mfma_f32_16x16x32_bf16 v[192:195], a[116:119], a[136:139], v[192:195]
ds_read_b128 a[172:175], v59 offset:34816
v_mfma_f32_16x16x32_bf16 v[196:199], a[116:119], a[140:143], v[196:199]
v_mfma_f32_16x16x32_bf16 v[200:203], a[116:119], a[144:147], v[200:203]
s_add_u32 s74, s34, s84
s_add_u32 s84, s84, 8192
s_add_u32 m0, s35, 8192
s_nop 0
buffer_load_dwordx4 v50, s[12:15], s74 offen offset:0 nt lds
v_mfma_f32_16x16x32_bf16 v[204:207], a[116:119], a[148:151], v[204:207]
v_mfma_f32_16x16x32_bf16 v[208:211], a[120:123], a[128:131], v[208:211]
ds_read_b64_tr_b16 a[116:117], v56 offset:16392
v_mfma_f32_16x16x32_bf16 v[212:215], a[120:123], a[132:135], v[212:215]
buffer_load_dwordx4 v51, s[12:15], s74 offen offset:1024 nt lds
v_mfma_f32_16x16x32_bf16 v[216:219], a[120:123], a[136:139], v[216:219]
ds_read_b64_tr_b16 a[118:119], v56 offset:18440
v_mfma_f32_16x16x32_bf16 v[220:223], a[120:123], a[140:143], v[220:223]
v_mfma_f32_16x16x32_bf16 v[224:227], a[120:123], a[144:147], v[224:227]
v_mfma_f32_16x16x32_bf16 v[228:231], a[120:123], a[148:151], v[228:231]
buffer_load_dwordx4 v52, s[12:15], s74 offen offset:2048 nt lds
v_mfma_f32_16x16x32_bf16 v[232:235], a[124:127], a[128:131], v[232:235]
ds_read_b64_tr_b16 a[120:121], v57 offset:16384
v_mfma_f32_16x16x32_bf16 v[236:239], a[124:127], a[132:135], v[236:239]
ds_read_b64_tr_b16 a[122:123], v57 offset:18432
v_mfma_f32_16x16x32_bf16 v[240:243], a[124:127], a[136:139], v[240:243]
buffer_load_dwordx4 v53, s[12:15], s74 offen offset:3072 nt lds
v_mfma_f32_16x16x32_bf16 v[244:247], a[124:127], a[140:143], v[244:247]
v_mfma_f32_16x16x32_bf16 v[248:251], a[124:127], a[144:147], v[248:251]
v_mfma_f32_16x16x32_bf16 v[252:255], a[124:127], a[148:151], v[252:255]
ds_read_b64_tr_b16 a[124:125], v57 offset:16392
ds_read_b64_tr_b16 a[126:127], v57 offset:18440
s_waitcnt lgkmcnt(4)
v_mfma_f32_16x16x32_bf16 v[64:67], a[96:99], a[152:155], v[64:67]
v_mfma_f32_16x16x32_bf16 v[68:71], a[96:99], a[156:159], v[68:71]
v_mfma_f32_16x16x32_bf16 v[72:75], a[96:99], a[160:163], v[72:75]
v_mfma_f32_16x16x32_bf16 v[76:79], a[96:99], a[164:167], v[76:79]
v_mfma_f32_16x16x32_bf16 v[80:83], a[96:99], a[168:171], v[80:83]
v_mfma_f32_16x16x32_bf16 v[84:87], a[96:99], a[172:175], v[84:87]
v_mfma_f32_16x16x32_bf16 v[88:91], a[100:103], a[152:155], v[88:91]
v_mfma_f32_16x16x32_bf16 v[92:95], a[100:103], a[156:159], v[92:95]
v_mfma_f32_16x16x32_bf16 v[96:99], a[100:103], a[160:163], v[96:99]
v_mfma_f32_16x16x32_bf16 v[100:103], a[100:103], a[164:167], v[100:103]
v_mfma_f32_16x16x32_bf16 v[104:107], a[100:103], a[168:171], v[104:107]
s_waitcnt vmcnt(18)
s_waitcnt vmcnt(8)
v_mfma_f32_16x16x32_bf16 v[108:111], a[100:103], a[172:175], v[108:111]
s_waitcnt lgkmcnt(0)
s_barrier
v_mfma_f32_16x16x32_bf16 v[112:115], a[104:107], a[152:155], v[112:115]
ds_read_b64_tr_b16 a[96:97], v54 offset:32768
v_mfma_f32_16x16x32_bf16 v[116:119], a[104:107], a[156:159], v[116:119]
s_add_u32 s41, s74, 4096
s_add_u32 m0, s35, 12288
s_nop 0
buffer_load_dwordx4 v50, s[12:15], s41 offen offset:0 nt lds
v_mfma_f32_16x16x32_bf16 v[120:123], a[104:107], a[160:163], v[120:123]
v_mfma_f32_16x16x32_bf16 v[124:127], a[104:107], a[164:167], v[124:127]
ds_read_b64_tr_b16 a[98:99], v54 offset:34816
v_mfma_f32_16x16x32_bf16 v[128:131], a[104:107], a[168:171], v[128:131]
ds_read_b64_tr_b16 a[100:101], v54 offset:32776
v_mfma_f32_16x16x32_bf16 v[132:135], a[104:107], a[172:175], v[132:135]
ds_read_b64_tr_b16 a[102:103], v54 offset:34824
v_mfma_f32_16x16x32_bf16 v[136:139], a[108:111], a[152:155], v[136:139]
ds_read_b64_tr_b16 a[104:105], v55 offset:32768
v_mfma_f32_16x16x32_bf16 v[140:143], a[108:111], a[156:159], v[140:143]
ds_read_b64_tr_b16 a[106:107], v55 offset:34816
v_mfma_f32_16x16x32_bf16 v[144:147], a[108:111], a[160:163], v[144:147]
ds_read_b128 a[128:131], v58 offset:0
v_mfma_f32_16x16x32_bf16 v[148:151], a[108:111], a[164:167], v[148:151]
buffer_load_dwordx4 v51, s[12:15], s41 offen offset:1024 nt lds
v_mfma_f32_16x16x32_bf16 v[152:155], a[108:111], a[168:171], v[152:155]
ds_read_b128 a[132:135], v58 offset:2048
v_mfma_f32_16x16x32_bf16 v[156:159], a[108:111], a[172:175], v[156:159]
ds_read_b64_tr_b16 a[108:109], v55 offset:32776
v_mfma_f32_16x16x32_bf16 v[160:163], a[112:115], a[152:155], v[160:163]
ds_read_b64_tr_b16 a[110:111], v55 offset:34824
v_mfma_f32_16x16x32_bf16 v[164:167], a[112:115], a[156:159], v[164:167]
ds_read_b128 a[136:139], v58 offset:4096
v_mfma_f32_16x16x32_bf16 v[168:171], a[112:115], a[160:163], v[168:171]
ds_read_b128 a[140:143], v58 offset:6144
v_mfma_f32_16x16x32_bf16 v[172:175], a[112:115], a[164:167], v[172:175]
ds_read_b128 a[144:147], v58 offset:8192
v_mfma_f32_16x16x32_bf16 v[176:179], a[112:115], a[168:171], v[176:179]
ds_read_b128 a[148:151], v58 offset:10240
v_mfma_f32_16x16x32_bf16 v[180:183], a[112:115], a[172:175], v[180:183]
ds_read_b64_tr_b16 a[112:113], v56 offset:32768
v_mfma_f32_16x16x32_bf16 v[184:187], a[116:119], a[152:155], v[184:187]
buffer_load_dwordx4 v52, s[12:15], s41 offen offset:2048 nt lds
v_mfma_f32_16x16x32_bf16 v[188:191], a[116:119], a[156:159], v[188:191]
ds_read_b64_tr_b16 a[114:115], v56 offset:34816
v_mfma_f32_16x16x32_bf16 v[192:195], a[116:119], a[160:163], v[192:195]
v_mfma_f32_16x16x32_bf16 v[196:199], a[116:119], a[164:167], v[196:199]
v_mfma_f32_16x16x32_bf16 v[200:203], a[116:119], a[168:171], v[200:203]
v_mfma_f32_16x16x32_bf16 v[204:207], a[116:119], a[172:175], v[204:207]
ds_read_b64_tr_b16 a[116:117], v56 offset:32776
v_mfma_f32_16x16x32_bf16 v[208:211], a[120:123], a[152:155], v[208:211]
ds_read_b64_tr_b16 a[118:119], v56 offset:34824
v_mfma_f32_16x16x32_bf16 v[212:215], a[120:123], a[156:159], v[212:215]
v_mfma_f32_16x16x32_bf16 v[216:219], a[120:123], a[160:163], v[216:219]
v_mfma_f32_16x16x32_bf16 v[220:223], a[120:123], a[164:167], v[220:223]
buffer_load_dwordx4 v53, s[12:15], s41 offen offset:3072 nt lds
v_mfma_f32_16x16x32_bf16 v[224:227], a[120:123], a[168:171], v[224:227]
v_mfma_f32_16x16x32_bf16 v[228:231], a[120:123], a[172:175], v[228:231]
ds_read_b64_tr_b16 a[120:121], v57 offset:32768
v_mfma_f32_16x16x32_bf16 v[232:235], a[124:127], a[152:155], v[232:235]
ds_read_b64_tr_b16 a[122:123], v57 offset:34816
v_mfma_f32_16x16x32_bf16 v[236:239], a[124:127], a[156:159], v[236:239]
v_mfma_f32_16x16x32_bf16 v[240:243], a[124:127], a[160:163], v[240:243]
v_mfma_f32_16x16x32_bf16 v[244:247], a[124:127], a[164:167], v[244:247]
v_mfma_f32_16x16x32_bf16 v[248:251], a[124:127], a[168:171], v[248:251]
v_mfma_f32_16x16x32_bf16 v[252:255], a[124:127], a[172:175], v[252:255]
ds_read_b64_tr_b16 a[124:125], v57 offset:32776
ds_read_b64_tr_b16 a[126:127], v57 offset:34824
s_waitcnt lgkmcnt(4)
v_mfma_f32_16x16x32_bf16 v[64:67], a[96:99], a[128:131], v[64:67]
v_mfma_f32_16x16x32_bf16 v[68:71], a[96:99], a[132:135], v[68:71]
v_mfma_f32_16x16x32_bf16 v[72:75], a[96:99], a[136:139], v[72:75]
v_mfma_f32_16x16x32_bf16 v[76:79], a[96:99], a[140:143], v[76:79]
v_mfma_f32_16x16x32_bf16 v[80:83], a[96:99], a[144:147], v[80:83]
v_mfma_f32_16x16x32_bf16 v[84:87], a[96:99], a[148:151], v[84:87]
v_mfma_f32_16x16x32_bf16 v[88:91], a[100:103], a[128:131], v[88:91]
v_mfma_f32_16x16x32_bf16 v[92:95], a[100:103], a[132:135], v[92:95]
v_mfma_f32_16x16x32_bf16 v[96:99], a[100:103], a[136:139], v[96:99]
v_mfma_f32_16x16x32_bf16 v[100:103], a[100:103], a[140:143], v[100:103]
v_mfma_f32_16x16x32_bf16 v[104:107], a[100:103], a[144:147], v[104:107]
s_waitcnt vmcnt(8)
v_mfma_f32_16x16x32_bf16 v[108:111], a[100:103], a[148:151], v[108:111]
s_waitcnt lgkmcnt(0)
s_barrier
v_mfma_f32_16x16x32_bf16 v[112:115], a[104:107], a[128:131], v[112:115]
ds_read_b64_tr_b16 a[96:97], v54 offset:0
v_mfma_f32_16x16x32_bf16 v[116:119], a[104:107], a[132:135], v[116:119]
ds_read_b64_tr_b16 a[98:99], v54 offset:2048
v_mfma_f32_16x16x32_bf16 v[120:123], a[104:107], a[136:139], v[120:123]
ds_read_b64_tr_b16 a[100:101], v54 offset:8
v_mfma_f32_16x16x32_bf16 v[124:127], a[104:107], a[140:143], v[124:127]
ds_read_b64_tr_b16 a[102:103], v54 offset:2056
v_mfma_f32_16x16x32_bf16 v[128:131], a[104:107], a[144:147], v[128:131]
ds_read_b128 a[152:155], v59 offset:0
v_mfma_f32_16x16x32_bf16 v[132:135], a[104:107], a[148:151], v[132:135]
ds_read_b64_tr_b16 a[104:105], v55 offset:0
v_mfma_f32_16x16x32_bf16 v[136:139], a[108:111], a[128:131], v[136:139]
ds_read_b64_tr_b16 a[106:107], v55 offset:2048
v_mfma_f32_16x16x32_bf16 v[140:143], a[108:111], a[132:135], v[140:143]
ds_read_b128 a[156:159], v59 offset:2048
v_mfma_f32_16x16x32_bf16 v[144:147], a[108:111], a[136:139], v[144:147]
ds_read_b128 a[160:163], v59 offset:4096
v_mfma_f32_16x16x32_bf16 v[148:151], a[108:111], a[140:143], v[148:151]
ds_read_b128 a[164:167], v59 offset:6144
v_mfma_f32_16x16x32_bf16 v[152:155], a[108:111], a[144:147], v[152:155]
ds_read_b128 a[168:171], v59 offset:8192
v_mfma_f32_16x16x32_bf16 v[156:159], a[108:111], a[148:151], v[156:159]
ds_read_b64_tr_b16 a[108:109], v55 offset:8
v_mfma_f32_16x16x32_bf16 v[160:163], a[112:115], a[128:131], v[160:163]
ds_read_b64_tr_b16 a[110:111], v55 offset:2056
v_mfma_f32_16x16x32_bf16 v[164:167], a[112:115], a[132:135], v[164:167]
ds_read_b128 a[172:175], v59 offset:10240
v_mfma_f32_16x16x32_bf16 v[168:171], a[112:115], a[136:139], v[168:171]
v_mfma_f32_16x16x32_bf16 v[172:175], a[112:115], a[140:143], v[172:175]
v_mfma_f32_16x16x32_bf16 v[176:179], a[112:115], a[144:147], v[176:179]
v_mfma_f32_16x16x32_bf16 v[180:183], a[112:115], a[148:151], v[180:183]
ds_read_b64_tr_b16 a[112:113], v56 offset:0
v_mfma_f32_16x16x32_bf16 v[184:187], a[116:119], a[128:131], v[184:187]
ds_read_b64_tr_b16 a[114:115], v56 offset:2048
v_mfma_f32_16x16x32_bf16 v[188:191], a[116:119], a[132:135], v[188:191]
v_mfma_f32_16x16x32_bf16 v[192:195], a[116:119], a[136:139], v[192:195]
v_mfma_f32_16x16x32_bf16 v[196:199], a[116:119], a[140:143], v[196:199]
v_mfma_f32_16x16x32_bf16 v[200:203], a[116:119], a[144:147], v[200:203]
v_mfma_f32_16x16x32_bf16 v[204:207], a[116:119], a[148:151], v[204:207]
ds_read_b64_tr_b16 a[116:117], v56 offset:8
v_mfma_f32_16x16x32_bf16 v[208:211], a[120:123], a[128:131], v[208:211]
ds_read_b64_tr_b16 a[118:119], v56 offset:2056
v_mfma_f32_16x16x32_bf16 v[212:215], a[120:123], a[132:135], v[212:215]
v_mfma_f32_16x16x32_bf16 v[216:219], a[120:123], a[136:139], v[216:219]
v_mfma_f32_16x16x32_bf16 v[220:223], a[120:123], a[140:143], v[220:223]
v_mfma_f32_16x16x32_bf16 v[224:227], a[120:123], a[144:147], v[224:227]
v_mfma_f32_16x16x32_bf16 v[228:231], a[120:123], a[148:151], v[228:231]
ds_read_b64_tr_b16 a[120:121], v57 offset:0
v_mfma_f32_16x16x32_bf16 v[232:235], a[124:127], a[128:131], v[232:235]
ds_read_b64_tr_b16 a[122:123], v57 offset:2048
v_mfma_f32_16x16x32_bf16 v[236:239], a[124:127], a[132:135], v[236:239]
v_mfma_f32_16x16x32_bf16 v[240:243], a[124:127], a[136:139], v[240:243]
v_mfma_f32_16x16x32_bf16 v[244:247], a[124:127], a[140:143], v[244:247]
v_mfma_f32_16x16x32_bf16 v[248:251], a[124:127], a[144:147], v[248:251]
v_mfma_f32_16x16x32_bf16 v[252:255], a[124:127], a[148:151], v[252:255]
ds_read_b64_tr_b16 a[124:125], v57 offset:8
ds_read_b64_tr_b16 a[126:127], v57 offset:2056
s_waitcnt lgkmcnt(4)
v_mfma_f32_16x16x32_bf16 v[64:67], a[96:99], a[152:155], v[64:67]
v_mfma_f32_16x16x32_bf16 v[68:71], a[96:99], a[156:159], v[68:71]
v_mfma_f32_16x16x32_bf16 v[72:75], a[96:99], a[160:163], v[72:75]
v_mfma_f32_16x16x32_bf16 v[76:79], a[96:99], a[164:167], v[76:79]
v_mfma_f32_16x16x32_bf16 v[80:83], a[96:99], a[168:171], v[80:83]
v_mfma_f32_16x16x32_bf16 v[84:87], a[96:99], a[172:175], v[84:87]
v_mfma_f32_16x16x32_bf16 v[88:91], a[100:103], a[152:155], v[88:91]
v_mfma_f32_16x16x32_bf16 v[92:95], a[100:103], a[156:159], v[92:95]
v_mfma_f32_16x16x32_bf16 v[96:99], a[100:103], a[160:163], v[96:99]
v_mfma_f32_16x16x32_bf16 v[100:103], a[100:103], a[164:167], v[100:103]
v_mfma_f32_16x16x32_bf16 v[104:107], a[100:103], a[168:171], v[104:107]
s_waitcnt vmcnt(8)
v_mfma_f32_16x16x32_bf16 v[108:111], a[100:103], a[172:175], v[108:111]
s_waitcnt lgkmcnt(0)
s_barrier
v_mfma_f32_16x16x32_bf16 v[112:115], a[104:107], a[152:155], v[112:115]
s_add_u32 s74, s34, s84
s_add_u32 s84, s84, 8192
s_add_u32 m0, s35, 65536
s_nop 0
buffer_load_dwordx4 v50, s[12:15], s74 offen offset:0 nt lds
v_mfma_f32_16x16x32_bf16 v[116:119], a[104:107], a[156:159], v[116:119]
v_mfma_f32_16x16x32_bf16 v[120:123], a[104:107], a[160:163], v[120:123]
v_mfma_f32_16x16x32_bf16 v[124:127], a[104:107], a[164:167], v[124:127]
v_mfma_f32_16x16x32_bf16 v[128:131], a[104:107], a[168:171], v[128:131]
v_mfma_f32_16x16x32_bf16 v[132:135], a[104:107], a[172:175], v[132:135]
v_mfma_f32_16x16x32_bf16 v[136:139], a[108:111], a[152:155], v[136:139]
v_mfma_f32_16x16x32_bf16 v[140:143], a[108:111], a[156:159], v[140:143]
v_mfma_f32_16x16x32_bf16 v[144:147], a[108:111], a[160:163], v[144:147]
v_mfma_f32_16x16x32_bf16 v[148:151], a[108:111], a[164:167], v[148:151]
buffer_load_dwordx4 v51, s[12:15], s74 offen offset:1024 nt lds
v_mfma_f32_16x16x32_bf16 v[152:155], a[108:111], a[168:171], v[152:155]
v_mfma_f32_16x16x32_bf16 v[156:159], a[108:111], a[172:175], v[156:159]
v_mfma_f32_16x16x32_bf16 v[160:163], a[112:115], a[152:155], v[160:163]
v_mfma_f32_16x16x32_bf16 v[164:167], a[112:115], a[156:159], v[164:167]
v_mfma_f32_16x16x32_bf16 v[168:171], a[112:115], a[160:163], v[168:171]
v_mfma_f32_16x16x32_bf16 v[172:175], a[112:115], a[164:167], v[172:175]
v_mfma_f32_16x16x32_bf16 v[176:179], a[112:115], a[168:171], v[176:179]
v_mfma_f32_16x16x32_bf16 v[180:183], a[112:115], a[172:175], v[180:183]
v_mfma_f32_16x16x32_bf16 v[184:187], a[116:119], a[152:155], v[184:187]
buffer_load_dwordx4 v52, s[12:15], s74 offen offset:2048 nt lds
v_mfma_f32_16x16x32_bf16 v[188:191], a[116:119], a[156:159], v[188:191]
v_mfma_f32_16x16x32_bf16 v[192:195], a[116:119], a[160:163], v[192:195]
v_mfma_f32_16x16x32_bf16 v[196:199], a[116:119], a[164:167], v[196:199]
v_mfma_f32_16x16x32_bf16 v[200:203], a[116:119], a[168:171], v[200:203]
v_mfma_f32_16x16x32_bf16 v[204:207], a[116:119], a[172:175], v[204:207]
v_mfma_f32_16x16x32_bf16 v[208:211], a[120:123], a[152:155], v[208:211]
v_mfma_f32_16x16x32_bf16 v[212:215], a[120:123], a[156:159], v[212:215]
v_mfma_f32_16x16x32_bf16 v[216:219], a[120:123], a[160:163], v[216:219]
v_mfma_f32_16x16x32_bf16 v[220:223], a[120:123], a[164:167], v[220:223]
buffer_load_dwordx4 v53, s[12:15], s74 offen offset:3072 nt lds
v_mfma_f32_16x16x32_bf16 v[224:227], a[120:123], a[168:171], v[224:227]
v_mfma_f32_16x16x32_bf16 v[228:231], a[120:123], a[172:175], v[228:231]
v_mfma_f32_16x16x32_bf16 v[232:235], a[124:127], a[152:155], v[232:235]
v_mfma_f32_16x16x32_bf16 v[236:239], a[124:127], a[156:159], v[236:239]
v_mfma_f32_16x16x32_bf16 v[240:243], a[124:127], a[160:163], v[240:243]
v_mfma_f32_16x16x32_bf16 v[244:247], a[124:127], a[164:167], v[244:247]
v_mfma_f32_16x16x32_bf16 v[248:251], a[124:127], a[168:171], v[248:251]
v_mfma_f32_16x16x32_bf16 v[252:255], a[124:127], a[172:175], v[252:255]
ds_read_b128 a[96:99], v38 offset:0
ds_read_b128 a[100:103], v39 offset:0
ds_read_b128 a[104:107], v40 offset:0
ds_read_b128 a[108:111], v41 offset:0
ds_read_b128 a[112:115], v38 offset:4096
ds_read_b128 a[116:119], v39 offset:4096
ds_read_b128 a[120:123], v40 offset:4096
ds_read_b128 a[124:127], v41 offset:4096
v_pk_mul_f32 v[64:65], v[64:65], s[86:87]
v_pk_mul_f32 v[66:67], v[66:67], s[86:87]
v_pk_mul_f32 v[88:89], v[88:89], s[86:87]
v_pk_mul_f32 v[90:91], v[90:91], s[86:87]
v_cvt_pk_bf16_f32 v8, v64, v65
v_cvt_pk_bf16_f32 v9, v66, v67
v_cvt_pk_bf16_f32 v10, v88, v89
v_cvt_pk_bf16_f32 v11, v90, v91
v_accvgpr_write_b32 a0, v8
v_accvgpr_write_b32 a1, v9
v_accvgpr_write_b32 a2, v10
v_accvgpr_write_b32 a3, v11
v_pk_mul_f32 v[112:113], v[112:113], s[86:87]
v_pk_mul_f32 v[114:115], v[114:115], s[86:87]
v_pk_mul_f32 v[136:137], v[136:137], s[86:87]
v_pk_mul_f32 v[138:139], v[138:139], s[86:87]
v_cvt_pk_bf16_f32 v12, v112, v113
v_cvt_pk_bf16_f32 v13, v114, v115
v_cvt_pk_bf16_f32 v14, v136, v137
v_cvt_pk_bf16_f32 v15, v138, v139
v_accvgpr_write_b32 a4, v12
v_accvgpr_write_b32 a5, v13
v_accvgpr_write_b32 a6, v14
v_accvgpr_write_b32 a7, v15
v_pk_mul_f32 v[160:161], v[160:161], s[86:87]
v_pk_mul_f32 v[162:163], v[162:163], s[86:87]
v_pk_mul_f32 v[184:185], v[184:185], s[86:87]
v_pk_mul_f32 v[186:187], v[186:187], s[86:87]
v_cvt_pk_bf16_f32 v16, v160, v161
v_cvt_pk_bf16_f32 v17, v162, v163
v_cvt_pk_bf16_f32 v18, v184, v185
v_cvt_pk_bf16_f32 v19, v186, v187
v_accvgpr_write_b32 a8, v16
v_accvgpr_write_b32 a9, v17
v_accvgpr_write_b32 a10, v18
v_accvgpr_write_b32 a11, v19
v_pk_mul_f32 v[208:209], v[208:209], s[86:87]
v_pk_mul_f32 v[210:211], v[210:211], s[86:87]
v_pk_mul_f32 v[232:233], v[232:233], s[86:87]
v_pk_mul_f32 v[234:235], v[234:235], s[86:87]
v_cvt_pk_bf16_f32 v20, v208, v209
v_cvt_pk_bf16_f32 v21, v210, v211
v_cvt_pk_bf16_f32 v22, v232, v233
v_cvt_pk_bf16_f32 v23, v234, v235
v_accvgpr_write_b32 a12, v20
v_accvgpr_write_b32 a13, v21
v_accvgpr_write_b32 a14, v22
v_accvgpr_write_b32 a15, v23
ds_read_b64_tr_b16 a[160:161], v42 offset:0
ds_read_b64_tr_b16 a[162:163], v42 offset:4096
ds_read_b64_tr_b16 a[164:165], v43 offset:0
ds_read_b64_tr_b16 a[166:167], v43 offset:4096
v_pk_mul_f32 v[68:69], v[68:69], s[86:87]
v_pk_mul_f32 v[70:71], v[70:71], s[86:87]
v_pk_mul_f32 v[92:93], v[92:93], s[86:87]
v_pk_mul_f32 v[94:95], v[94:95], s[86:87]
v_cvt_pk_bf16_f32 v8, v68, v69
v_cvt_pk_bf16_f32 v9, v70, v71
v_cvt_pk_bf16_f32 v10, v92, v93
v_cvt_pk_bf16_f32 v11, v94, v95
v_accvgpr_write_b32 a16, v8
v_accvgpr_write_b32 a17, v9
v_accvgpr_write_b32 a18, v10
v_accvgpr_write_b32 a19, v11
v_pk_mul_f32 v[116:117], v[116:117], s[86:87]
v_pk_mul_f32 v[118:119], v[118:119], s[86:87]
v_pk_mul_f32 v[140:141], v[140:141], s[86:87]
v_pk_mul_f32 v[142:143], v[142:143], s[86:87]
v_cvt_pk_bf16_f32 v12, v116, v117
v_cvt_pk_bf16_f32 v13, v118, v119
v_cvt_pk_bf16_f32 v14, v140, v141
v_cvt_pk_bf16_f32 v15, v142, v143
v_accvgpr_write_b32 a20, v12
v_accvgpr_write_b32 a21, v13
v_accvgpr_write_b32 a22, v14
v_accvgpr_write_b32 a23, v15
v_pk_mul_f32 v[164:165], v[164:165], s[86:87]
v_pk_mul_f32 v[166:167], v[166:167], s[86:87]
v_pk_mul_f32 v[188:189], v[188:189], s[86:87]
v_pk_mul_f32 v[190:191], v[190:191], s[86:87]
v_cvt_pk_bf16_f32 v16, v164, v165
v_cvt_pk_bf16_f32 v17, v166, v167
v_cvt_pk_bf16_f32 v18, v188, v189
v_cvt_pk_bf16_f32 v19, v190, v191
v_accvgpr_write_b32 a24, v16
v_accvgpr_write_b32 a25, v17
v_accvgpr_write_b32 a26, v18
v_accvgpr_write_b32 a27, v19
v_pk_mul_f32 v[212:213], v[212:213], s[86:87]
v_pk_mul_f32 v[214:215], v[214:215], s[86:87]
v_pk_mul_f32 v[236:237], v[236:237], s[86:87]
v_pk_mul_f32 v[238:239], v[238:239], s[86:87]
v_cvt_pk_bf16_f32 v20, v212, v213
v_cvt_pk_bf16_f32 v21, v214, v215
v_cvt_pk_bf16_f32 v22, v236, v237
v_cvt_pk_bf16_f32 v23, v238, v239
v_accvgpr_write_b32 a28, v20
v_accvgpr_write_b32 a29, v21
v_accvgpr_write_b32 a30, v22
v_accvgpr_write_b32 a31, v23
s_add_u32 s41, s74, 4096
s_add_u32 m0, s35, 69632
s_nop 0
buffer_load_dwordx4 v50, s[12:15], s41 offen offset:0 nt lds
ds_read_b64_tr_b16 a[168:169], v44 offset:0
ds_read_b64_tr_b16 a[170:171], v44 offset:4096
ds_read_b64_tr_b16 a[172:173], v45 offset:0
ds_read_b64_tr_b16 a[174:175], v45 offset:4096
v_pk_mul_f32 v[72:73], v[72:73], s[86:87]
v_pk_mul_f32 v[74:75], v[74:75], s[86:87]
v_pk_mul_f32 v[96:97], v[96:97], s[86:87]
v_pk_mul_f32 v[98:99], v[98:99], s[86:87]
v_cvt_pk_bf16_f32 v8, v72, v73
v_cvt_pk_bf16_f32 v9, v74, v75
v_cvt_pk_bf16_f32 v10, v96, v97
v_cvt_pk_bf16_f32 v11, v98, v99
v_accvgpr_write_b32 a32, v8
v_accvgpr_write_b32 a33, v9
v_accvgpr_write_b32 a34, v10
v_accvgpr_write_b32 a35, v11
v_pk_mul_f32 v[120:121], v[120:121], s[86:87]
v_pk_mul_f32 v[122:123], v[122:123], s[86:87]
v_pk_mul_f32 v[144:145], v[144:145], s[86:87]
v_pk_mul_f32 v[146:147], v[146:147], s[86:87]
v_cvt_pk_bf16_f32 v12, v120, v121
v_cvt_pk_bf16_f32 v13, v122, v123
v_cvt_pk_bf16_f32 v14, v144, v145
v_cvt_pk_bf16_f32 v15, v146, v147
v_accvgpr_write_b32 a36, v12
v_accvgpr_write_b32 a37, v13
v_accvgpr_write_b32 a38, v14
v_accvgpr_write_b32 a39, v15
v_pk_mul_f32 v[168:169], v[168:169], s[86:87]
v_pk_mul_f32 v[170:171], v[170:171], s[86:87]
v_pk_mul_f32 v[192:193], v[192:193], s[86:87]
v_pk_mul_f32 v[194:195], v[194:195], s[86:87]
v_cvt_pk_bf16_f32 v16, v168, v169
v_cvt_pk_bf16_f32 v17, v170, v171
v_cvt_pk_bf16_f32 v18, v192, v193
v_cvt_pk_bf16_f32 v19, v194, v195
v_accvgpr_write_b32 a40, v16
v_accvgpr_write_b32 a41, v17
v_accvgpr_write_b32 a42, v18
v_accvgpr_write_b32 a43, v19
v_pk_mul_f32 v[216:217], v[216:217], s[86:87]
v_pk_mul_f32 v[218:219], v[218:219], s[86:87]
v_pk_mul_f32 v[240:241], v[240:241], s[86:87]
v_pk_mul_f32 v[242:243], v[242:243], s[86:87]
v_cvt_pk_bf16_f32 v20, v216, v217
v_cvt_pk_bf16_f32 v21, v218, v219
v_cvt_pk_bf16_f32 v22, v240, v241
v_cvt_pk_bf16_f32 v23, v242, v243
v_accvgpr_write_b32 a44, v20
v_accvgpr_write_b32 a45, v21
v_accvgpr_write_b32 a46, v22
v_accvgpr_write_b32 a47, v23
buffer_load_dwordx4 v51, s[12:15], s41 offen offset:1024 nt lds
ds_read_b64_tr_b16 a[176:177], v46 offset:0
ds_read_b64_tr_b16 a[178:179], v46 offset:4096
ds_read_b64_tr_b16 a[180:181], v47 offset:0
ds_read_b64_tr_b16 a[182:183], v47 offset:4096
v_pk_mul_f32 v[76:77], v[76:77], s[86:87]
v_pk_mul_f32 v[78:79], v[78:79], s[86:87]
v_pk_mul_f32 v[100:101], v[100:101], s[86:87]
v_pk_mul_f32 v[102:103], v[102:103], s[86:87]
v_cvt_pk_bf16_f32 v8, v76, v77
v_cvt_pk_bf16_f32 v9, v78, v79
v_cvt_pk_bf16_f32 v10, v100, v101
v_cvt_pk_bf16_f32 v11, v102, v103
v_accvgpr_write_b32 a48, v8
v_accvgpr_write_b32 a49, v9
v_accvgpr_write_b32 a50, v10
v_accvgpr_write_b32 a51, v11
v_pk_mul_f32 v[124:125], v[124:125], s[86:87]
v_pk_mul_f32 v[126:127], v[126:127], s[86:87]
v_pk_mul_f32 v[148:149], v[148:149], s[86:87]
v_pk_mul_f32 v[150:151], v[150:151], s[86:87]
v_cvt_pk_bf16_f32 v12, v124, v125
v_cvt_pk_bf16_f32 v13, v126, v127
v_cvt_pk_bf16_f32 v14, v148, v149
v_cvt_pk_bf16_f32 v15, v150, v151
v_accvgpr_write_b32 a52, v12
v_accvgpr_write_b32 a53, v13
v_accvgpr_write_b32 a54, v14
v_accvgpr_write_b32 a55, v15
v_pk_mul_f32 v[172:173], v[172:173], s[86:87]
v_pk_mul_f32 v[174:175], v[174:175], s[86:87]
v_pk_mul_f32 v[196:197], v[196:197], s[86:87]
v_pk_mul_f32 v[198:199], v[198:199], s[86:87]
v_cvt_pk_bf16_f32 v16, v172, v173
v_cvt_pk_bf16_f32 v17, v174, v175
v_cvt_pk_bf16_f32 v18, v196, v197
v_cvt_pk_bf16_f32 v19, v198, v199
v_accvgpr_write_b32 a56, v16
v_accvgpr_write_b32 a57, v17
v_accvgpr_write_b32 a58, v18
v_accvgpr_write_b32 a59, v19
v_pk_mul_f32 v[220:221], v[220:221], s[86:87]
v_pk_mul_f32 v[222:223], v[222:223], s[86:87]
v_pk_mul_f32 v[244:245], v[244:245], s[86:87]
v_pk_mul_f32 v[246:247], v[246:247], s[86:87]
v_cvt_pk_bf16_f32 v20, v220, v221
v_cvt_pk_bf16_f32 v21, v222, v223
v_cvt_pk_bf16_f32 v22, v244, v245
v_cvt_pk_bf16_f32 v23, v246, v247
v_accvgpr_write_b32 a60, v20
v_accvgpr_write_b32 a61, v21
v_accvgpr_write_b32 a62, v22
v_accvgpr_write_b32 a63, v23
buffer_load_dwordx4 v52, s[12:15], s41 offen offset:2048 nt lds
ds_read_b64_tr_b16 a[184:185], v48 offset:0
ds_read_b64_tr_b16 a[186:187], v48 offset:4096
ds_read_b64_tr_b16 a[188:189], v49 offset:0
ds_read_b64_tr_b16 a[190:191], v49 offset:4096
v_pk_mul_f32 v[80:81], v[80:81], s[86:87]
v_pk_mul_f32 v[82:83], v[82:83], s[86:87]
v_pk_mul_f32 v[104:105], v[104:105], s[86:87]
v_pk_mul_f32 v[106:107], v[106:107], s[86:87]
v_cvt_pk_bf16_f32 v8, v80, v81
v_cvt_pk_bf16_f32 v9, v82, v83
v_cvt_pk_bf16_f32 v10, v104, v105
v_cvt_pk_bf16_f32 v11, v106, v107
v_accvgpr_write_b32 a64, v8
v_accvgpr_write_b32 a65, v9
v_accvgpr_write_b32 a66, v10
v_accvgpr_write_b32 a67, v11
v_pk_mul_f32 v[128:129], v[128:129], s[86:87]
v_pk_mul_f32 v[130:131], v[130:131], s[86:87]
v_pk_mul_f32 v[152:153], v[152:153], s[86:87]
v_pk_mul_f32 v[154:155], v[154:155], s[86:87]
v_cvt_pk_bf16_f32 v12, v128, v129
v_cvt_pk_bf16_f32 v13, v130, v131
v_cvt_pk_bf16_f32 v14, v152, v153
v_cvt_pk_bf16_f32 v15, v154, v155
v_accvgpr_write_b32 a68, v12
v_accvgpr_write_b32 a69, v13
v_accvgpr_write_b32 a70, v14
v_accvgpr_write_b32 a71, v15
v_pk_mul_f32 v[176:177], v[176:177], s[86:87]
v_pk_mul_f32 v[178:179], v[178:179], s[86:87]
v_pk_mul_f32 v[200:201], v[200:201], s[86:87]
v_pk_mul_f32 v[202:203], v[202:203], s[86:87]
v_cvt_pk_bf16_f32 v16, v176, v177
v_cvt_pk_bf16_f32 v17, v178, v179
v_cvt_pk_bf16_f32 v18, v200, v201
v_cvt_pk_bf16_f32 v19, v202, v203
v_accvgpr_write_b32 a72, v16
v_accvgpr_write_b32 a73, v17
v_accvgpr_write_b32 a74, v18
v_accvgpr_write_b32 a75, v19
v_pk_mul_f32 v[224:225], v[224:225], s[86:87]
v_pk_mul_f32 v[226:227], v[226:227], s[86:87]
v_pk_mul_f32 v[248:249], v[248:249], s[86:87]
v_pk_mul_f32 v[250:251], v[250:251], s[86:87]
v_cvt_pk_bf16_f32 v20, v224, v225
v_cvt_pk_bf16_f32 v21, v226, v227
v_cvt_pk_bf16_f32 v22, v248, v249
v_cvt_pk_bf16_f32 v23, v250, v251
v_accvgpr_write_b32 a76, v20
v_accvgpr_write_b32 a77, v21
v_accvgpr_write_b32 a78, v22
v_accvgpr_write_b32 a79, v23
buffer_load_dwordx4 v53, s[12:15], s41 offen offset:3072 nt lds
v_pk_mul_f32 v[84:85], v[84:85], s[86:87]
v_pk_mul_f32 v[86:87], v[86:87], s[86:87]
v_pk_mul_f32 v[108:109], v[108:109], s[86:87]
v_pk_mul_f32 v[110:111], v[110:111], s[86:87]
v_cvt_pk_bf16_f32 v8, v84, v85
v_cvt_pk_bf16_f32 v9, v86, v87
v_cvt_pk_bf16_f32 v10, v108, v109
v_cvt_pk_bf16_f32 v11, v110, v111
v_accvgpr_write_b32 a80, v8
v_accvgpr_write_b32 a81, v9
v_accvgpr_write_b32 a82, v10
v_accvgpr_write_b32 a83, v11
v_pk_mul_f32 v[132:133], v[132:133], s[86:87]
v_pk_mul_f32 v[134:135], v[134:135], s[86:87]
v_pk_mul_f32 v[156:157], v[156:157], s[86:87]
v_pk_mul_f32 v[158:159], v[158:159], s[86:87]
v_cvt_pk_bf16_f32 v12, v132, v133
v_cvt_pk_bf16_f32 v13, v134, v135
v_cvt_pk_bf16_f32 v14, v156, v157
v_cvt_pk_bf16_f32 v15, v158, v159
v_accvgpr_write_b32 a84, v12
v_accvgpr_write_b32 a85, v13
v_accvgpr_write_b32 a86, v14
v_accvgpr_write_b32 a87, v15
v_pk_mul_f32 v[180:181], v[180:181], s[86:87]
v_pk_mul_f32 v[182:183], v[182:183], s[86:87]
v_pk_mul_f32 v[204:205], v[204:205], s[86:87]
v_pk_mul_f32 v[206:207], v[206:207], s[86:87]
v_cvt_pk_bf16_f32 v16, v180, v181
v_cvt_pk_bf16_f32 v17, v182, v183
v_cvt_pk_bf16_f32 v18, v204, v205
v_cvt_pk_bf16_f32 v19, v206, v207
v_accvgpr_write_b32 a88, v16
v_accvgpr_write_b32 a89, v17
v_accvgpr_write_b32 a90, v18
v_accvgpr_write_b32 a91, v19
v_pk_mul_f32 v[228:229], v[228:229], s[86:87]
v_pk_mul_f32 v[230:231], v[230:231], s[86:87]
v_pk_mul_f32 v[252:253], v[252:253], s[86:87]
v_pk_mul_f32 v[254:255], v[254:255], s[86:87]
v_cvt_pk_bf16_f32 v20, v228, v229
v_cvt_pk_bf16_f32 v21, v230, v231
v_cvt_pk_bf16_f32 v22, v252, v253
v_cvt_pk_bf16_f32 v23, v254, v255
v_accvgpr_write_b32 a92, v20
v_accvgpr_write_b32 a93, v21
v_accvgpr_write_b32 a94, v22
v_accvgpr_write_b32 a95, v23
L_C:
s_waitcnt lgkmcnt(15)
v_mfma_f32_16x16x32_bf16 v[8:11], a[96:99], a[0:3], 0
v_mfma_f32_16x16x32_bf16 v[8:11], a[100:103], a[4:7], v[8:11]
v_mfma_f32_16x16x32_bf16 v[8:11], a[104:107], a[8:11], v[8:11]
v_mfma_f32_16x16x32_bf16 v[8:11], a[108:111], a[12:15], v[8:11]
v_mfma_f32_16x16x32_bf16 v[12:15], a[112:115], a[0:3], 0
v_mfma_f32_16x16x32_bf16 v[12:15], a[116:119], a[4:7], v[12:15]
v_mfma_f32_16x16x32_bf16 v[12:15], a[120:123], a[8:11], v[12:15]
v_mfma_f32_16x16x32_bf16 v[12:15], a[124:127], a[12:15], v[12:15]
v_mfma_f32_16x16x32_bf16 v[16:19], a[96:99], a[16:19], 0
s_nop 2
v_exp_f32 v8, v8
v_exp_f32 v9, v9
v_mfma_f32_16x16x32_bf16 v[16:19], a[100:103], a[20:23], v[16:19]
v_exp_f32 v10, v10
v_cvt_pk_bf16_f32 v24, v8, v9
v_mfma_f32_16x16x32_bf16 v[16:19], a[104:107], a[24:27], v[16:19]
v_exp_f32 v11, v11
v_mfma_f32_16x16x32_bf16 v[16:19], a[108:111], a[28:31], v[16:19]
v_exp_f32 v12, v12
v_cvt_pk_bf16_f32 v25, v10, v11
v_mfma_f32_16x16x32_bf16 v[20:23], a[112:115], a[16:19], 0
v_exp_f32 v13, v13
v_mfma_f32_16x16x32_bf16 v[20:23], a[116:119], a[20:23], v[20:23]
v_exp_f32 v14, v14
v_cvt_pk_bf16_f32 v26, v12, v13
v_mfma_f32_16x16x32_bf16 v[20:23], a[120:123], a[24:27], v[20:23]
v_exp_f32 v15, v15
v_mfma_f32_16x16x32_bf16 v[20:23], a[124:127], a[28:31], v[20:23]
v_cvt_pk_bf16_f32 v27, v14, v15
s_waitcnt vmcnt(8)
s_waitcnt lgkmcnt(0)
s_barrier
v_mfma_f32_16x16x32_bf16 v[8:11], a[96:99], a[32:35], 0
v_exp_f32 v16, v16
v_mfma_f32_16x16x32_bf16 v[64:67], a[160:163], v[24:27], 0
ds_read_b128 a[128:131], v38 offset:8192
v_mfma_f32_16x16x32_bf16 v[8:11], a[100:103], a[36:39], v[8:11]
v_exp_f32 v17, v17
v_mfma_f32_16x16x32_bf16 v[88:91], a[164:167], v[24:27], 0
v_cvt_pk_bf16_f32 v28, v16, v17
s_add_u32 s74, s34, s84
v_mfma_f32_16x16x32_bf16 v[8:11], a[104:107], a[40:43], v[8:11]
v_exp_f32 v18, v18
v_mfma_f32_16x16x32_bf16 v[112:115], a[168:171], v[24:27], 0
ds_read_b128 a[132:135], v39 offset:8192
v_mfma_f32_16x16x32_bf16 v[8:11], a[108:111], a[44:47], v[8:11]
v_exp_f32 v19, v19
v_mfma_f32_16x16x32_bf16 v[136:139], a[172:175], v[24:27], 0
v_cvt_pk_bf16_f32 v29, v18, v19
s_add_u32 s84, s84, 8192
v_mfma_f32_16x16x32_bf16 v[12:15], a[112:115], a[32:35], 0
v_exp_f32 v20, v20
v_mfma_f32_16x16x32_bf16 v[160:163], a[176:179], v[24:27], 0
ds_read_b128 a[136:139], v40 offset:8192
v_mfma_f32_16x16x32_bf16 v[12:15], a[116:119], a[36:39], v[12:15]
v_exp_f32 v21, v21
v_mfma_f32_16x16x32_bf16 v[184:187], a[180:183], v[24:27], 0
v_cvt_pk_bf16_f32 v30, v20, v21
s_add_u32 m0, s35, 73728
v_mfma_f32_16x16x32_bf16 v[12:15], a[120:123], a[40:43], v[12:15]
v_exp_f32 v22, v22
v_mfma_f32_16x16x32_bf16 v[208:211], a[184:187], v[24:27], 0
ds_read_b128 a[140:143], v41 offset:8192
v_mfma_f32_16x16x32_bf16 v[12:15], a[124:127], a[44:47], v[12:15]
v_exp_f32 v23, v23
v_mfma_f32_16x16x32_bf16 v[232:235], a[188:191], v[24:27], 0
v_cvt_pk_bf16_f32 v31, v22, v23
v_mfma_f32_16x16x32_bf16 a[228:231], a[224:227], v[24:27], 0
s_waitcnt vmcnt(4)
buffer_load_dwordx4 v50, s[12:15], s74 offen offset:0 nt lds
v_mfma_f32_16x16x32_bf16 v[16:19], a[96:99], a[48:51], 0
v_exp_f32 v8, v8
v_mfma_f32_16x16x32_bf16 v[68:71], a[160:163], v[28:31], 0
ds_read_b128 a[144:147], v38 offset:12288
v_mfma_f32_16x16x32_bf16 v[16:19], a[100:103], a[52:55], v[16:19]
v_exp_f32 v9, v9
v_mfma_f32_16x16x32_bf16 v[92:95], a[164:167], v[28:31], 0
v_cvt_pk_bf16_f32 v24, v8, v9
v_mfma_f32_16x16x32_bf16 v[16:19], a[104:107], a[56:59], v[16:19]
v_exp_f32 v10, v10
v_mfma_f32_16x16x32_bf16 v[116:119], a[168:171], v[28:31], 0
ds_read_b128 a[148:151], v39 offset:12288
v_mfma_f32_16x16x32_bf16 v[16:19], a[108:111], a[60:63], v[16:19]
v_exp_f32 v11, v11
v_mfma_f32_16x16x32_bf16 v[140:143], a[172:175], v[28:31], 0
v_cvt_pk_bf16_f32 v25, v10, v11
v_mfma_f32_16x16x32_bf16 v[20:23], a[112:115], a[48:51], 0
v_exp_f32 v12, v12
v_mfma_f32_16x16x32_bf16 v[164:167], a[176:179], v[28:31], 0
ds_read_b128 a[152:155], v40 offset:12288
v_mfma_f32_16x16x32_bf16 v[20:23], a[116:119], a[52:55], v[20:23]
v_exp_f32 v13, v13
v_mfma_f32_16x16x32_bf16 v[188:191], a[180:183], v[28:31], 0
v_cvt_pk_bf16_f32 v26, v12, v13
v_mfma_f32_16x16x32_bf16 v[20:23], a[120:123], a[56:59], v[20:23]
v_exp_f32 v14, v14
v_mfma_f32_16x16x32_bf16 v[212:215], a[184:187], v[28:31], 0
ds_read_b128 a[156:159], v41 offset:12288
v_mfma_f32_16x16x32_bf16 v[20:23], a[124:127], a[60:63], v[20:23]
v_exp_f32 v15, v15
v_mfma_f32_16x16x32_bf16 v[236:239], a[188:191], v[28:31], 0
v_cvt_pk_bf16_f32 v27, v14, v15
v_mfma_f32_16x16x32_bf16 a[232:235], a[224:227], v[28:31], 0
s_waitcnt vmcnt(4)
buffer_load_dwordx4 v51, s[12:15], s74 offen offset:1024 nt lds
v_mfma_f32_16x16x32_bf16 v[8:11], a[96:99], a[64:67], 0
v_exp_f32 v16, v16
v_mfma_f32_16x16x32_bf16 v[72:75], a[160:163], v[24:27], 0
ds_read_b64_tr_b16 a[192:193], v42 offset:8192
v_mfma_f32_16x16x32_bf16 v[8:11], a[100:103], a[68:71], v[8:11]
v_exp_f32 v17, v17
v_mfma_f32_16x16x32_bf16 v[96:99], a[164:167], v[24:27], 0
v_cvt_pk_bf16_f32 v28, v16, v17
v_mfma_f32_16x16x32_bf16 v[8:11], a[104:107], a[72:75], v[8:11]
v_exp_f32 v18, v18
v_mfma_f32_16x16x32_bf16 v[120:123], a[168:171], v[24:27], 0
ds_read_b64_tr_b16 a[194:195], v42 offset:12288
v_mfma_f32_16x16x32_bf16 v[8:11], a[108:111], a[76:79], v[8:11]
v_exp_f32 v19, v19
v_mfma_f32_16x16x32_bf16 v[144:147], a[172:175], v[24:27], 0
v_cvt_pk_bf16_f32 v29, v18, v19
v_mfma_f32_16x16x32_bf16 v[12:15], a[112:115], a[64:67], 0
v_exp_f32 v20, v20
v_mfma_f32_16x16x32_bf16 v[168:171], a[176:179], v[24:27], 0
ds_read_b64_tr_b16 a[196:197], v43 offset:8192
v_mfma_f32_16x16x32_bf16 v[12:15], a[116:119], a[68:71], v[12:15]
v_exp_f32 v21, v21
v_mfma_f32_16x16x32_bf16 v[192:195], a[180:183], v[24:27], 0
v_cvt_pk_bf16_f32 v30, v20, v21
s_waitcnt vmcnt(4)
buffer_load_dwordx4 v52, s[12:15], s74 offen offset:2048 nt lds
v_mfma_f32_16x16x32_bf16 v[12:15], a[120:123], a[72:75], v[12:15]
v_exp_f32 v22, v22
v_mfma_f32_16x16x32_bf16 v[216:219], a[184:187], v[24:27], 0
ds_read_b64_tr_b16 a[198:199], v43 offset:12288
v_mfma_f32_16x16x32_bf16 v[12:15], a[124:127], a[76:79], v[12:15]
v_exp_f32 v23, v23
v_mfma_f32_16x16x32_bf16 v[240:243], a[188:191], v[24:27], 0
v_cvt_pk_bf16_f32 v31, v22, v23
v_mfma_f32_16x16x32_bf16 a[236:239], a[224:227], v[24:27], 0
s_waitcnt vmcnt(4)
buffer_load_dwordx4 v53, s[12:15], s74 offen offset:3072 nt lds
v_mfma_f32_16x16x32_bf16 v[16:19], a[96:99], a[80:83], 0
v_exp_f32 v8, v8
v_mfma_f32_16x16x32_bf16 v[76:79], a[160:163], v[28:31], 0
ds_read_b64_tr_b16 a[200:201], v44 offset:8192
v_mfma_f32_16x16x32_bf16 v[16:19], a[100:103], a[84:87], v[16:19]
v_exp_f32 v9, v9
v_mfma_f32_16x16x32_bf16 v[100:103], a[164:167], v[28:31], 0
v_cvt_pk_bf16_f32 v24, v8, v9
s_add_u32 s41, s74, 4096
v_mfma_f32_16x16x32_bf16 v[16:19], a[104:107], a[88:91], v[16:19]
v_exp_f32 v10, v10
v_mfma_f32_16x16x32_bf16 v[124:127], a[168:171], v[28:31], 0
ds_read_b64_tr_b16 a[202:203], v44 offset:12288
v_mfma_f32_16x16x32_bf16 v[16:19], a[108:111], a[92:95], v[16:19]
v_exp_f32 v11, v11
v_mfma_f32_16x16x32_bf16 v[148:151], a[172:175], v[28:31], 0
v_cvt_pk_bf16_f32 v25, v10, v11
s_add_u32 m0, s35, 77824
v_mfma_f32_16x16x32_bf16 v[20:23], a[112:115], a[80:83], 0
v_exp_f32 v12, v12
v_mfma_f32_16x16x32_bf16 v[172:175], a[176:179], v[28:31], 0
ds_read_b64_tr_b16 a[204:205], v45 offset:8192
v_mfma_f32_16x16x32_bf16 v[20:23], a[116:119], a[84:87], v[20:23]
v_exp_f32 v13, v13
v_mfma_f32_16x16x32_bf16 v[196:199], a[180:183], v[28:31], 0
v_cvt_pk_bf16_f32 v26, v12, v13
v_mfma_f32_16x16x32_bf16 v[20:23], a[120:123], a[88:91], v[20:23]
v_exp_f32 v14, v14
v_mfma_f32_16x16x32_bf16 v[220:223], a[184:187], v[28:31], 0
ds_read_b64_tr_b16 a[206:207], v45 offset:12288
v_mfma_f32_16x16x32_bf16 v[20:23], a[124:127], a[92:95], v[20:23]
v_exp_f32 v15, v15
v_mfma_f32_16x16x32_bf16 v[244:247], a[188:191], v[28:31], 0
v_cvt_pk_bf16_f32 v27, v14, v15
v_mfma_f32_16x16x32_bf16 a[240:243], a[224:227], v[28:31], 0
s_waitcnt vmcnt(4)
buffer_load_dwordx4 v50, s[12:15], s41 offen offset:0 nt lds
s_waitcnt lgkmcnt(15)
v_mfma_f32_16x16x32_bf16 v[8:11], a[128:131], a[0:3], 0
v_exp_f32 v16, v16
v_mfma_f32_16x16x32_bf16 v[80:83], a[160:163], v[24:27], 0
ds_read_b64_tr_b16 a[208:209], v46 offset:8192
s_waitcnt lgkmcnt(15)
v_mfma_f32_16x16x32_bf16 v[8:11], a[132:135], a[4:7], v[8:11]
v_exp_f32 v17, v17
v_mfma_f32_16x16x32_bf16 v[104:107], a[164:167], v[24:27], 0
v_cvt_pk_bf16_f32 v28, v16, v17
s_waitcnt lgkmcnt(14)
v_mfma_f32_16x16x32_bf16 v[8:11], a[136:139], a[8:11], v[8:11]
v_exp_f32 v18, v18
v_mfma_f32_16x16x32_bf16 v[128:131], a[168:171], v[24:27], 0
ds_read_b64_tr_b16 a[210:211], v46 offset:12288
s_waitcnt lgkmcnt(14)
v_mfma_f32_16x16x32_bf16 v[8:11], a[140:143], a[12:15], v[8:11]
v_exp_f32 v19, v19
v_mfma_f32_16x16x32_bf16 v[152:155], a[172:175], v[24:27], 0
v_cvt_pk_bf16_f32 v29, v18, v19
s_waitcnt lgkmcnt(13)
v_mfma_f32_16x16x32_bf16 v[12:15], a[144:147], a[0:3], 0
v_exp_f32 v20, v20
v_mfma_f32_16x16x32_bf16 v[176:179], a[176:179], v[24:27], 0
ds_read_b64_tr_b16 a[212:213], v47 offset:8192
s_waitcnt lgkmcnt(13)
v_mfma_f32_16x16x32_bf16 v[12:15], a[148:151], a[4:7], v[12:15]
v_exp_f32 v21, v21
v_mfma_f32_16x16x32_bf16 v[200:203], a[180:183], v[24:27], 0
v_cvt_pk_bf16_f32 v30, v20, v21
s_waitcnt lgkmcnt(12)
v_mfma_f32_16x16x32_bf16 v[12:15], a[152:155], a[8:11], v[12:15]
v_exp_f32 v22, v22
v_mfma_f32_16x16x32_bf16 v[224:227], a[184:187], v[24:27], 0
ds_read_b64_tr_b16 a[214:215], v47 offset:12288
s_waitcnt lgkmcnt(12)
v_mfma_f32_16x16x32_bf16 v[12:15], a[156:159], a[12:15], v[12:15]
v_exp_f32 v23, v23
v_mfma_f32_16x16x32_bf16 v[248:251], a[188:191], v[24:27], 0
v_cvt_pk_bf16_f32 v31, v22, v23
v_mfma_f32_16x16x32_bf16 a[244:247], a[224:227], v[24:27], 0
s_waitcnt vmcnt(4)
buffer_load_dwordx4 v51, s[12:15], s41 offen offset:1024 nt lds
v_mfma_f32_16x16x32_bf16 v[16:19], a[128:131], a[16:19], 0
v_exp_f32 v8, v8
v_mfma_f32_16x16x32_bf16 v[84:87], a[160:163], v[28:31], 0
ds_read_b64_tr_b16 a[216:217], v48 offset:8192
v_mfma_f32_16x16x32_bf16 v[16:19], a[132:135], a[20:23], v[16:19]
v_exp_f32 v9, v9
v_mfma_f32_16x16x32_bf16 v[108:111], a[164:167], v[28:31], 0
v_cvt_pk_bf16_f32 v24, v8, v9
v_mfma_f32_16x16x32_bf16 v[16:19], a[136:139], a[24:27], v[16:19]
v_exp_f32 v10, v10
v_mfma_f32_16x16x32_bf16 v[132:135], a[168:171], v[28:31], 0
ds_read_b64_tr_b16 a[218:219], v48 offset:12288
v_mfma_f32_16x16x32_bf16 v[16:19], a[140:143], a[28:31], v[16:19]
v_exp_f32 v11, v11
v_mfma_f32_16x16x32_bf16 v[156:159], a[172:175], v[28:31], 0
v_cvt_pk_bf16_f32 v25, v10, v11
v_mfma_f32_16x16x32_bf16 v[20:23], a[144:147], a[16:19], 0
v_exp_f32 v12, v12
v_mfma_f32_16x16x32_bf16 v[180:183], a[176:179], v[28:31], 0
ds_read_b64_tr_b16 a[220:221], v49 offset:8192
v_mfma_f32_16x16x32_bf16 v[20:23], a[148:151], a[20:23], v[20:23]
v_exp_f32 v13, v13
ds_read_b64_tr_b16 a[222:223], v49 offset:12288
v_mfma_f32_16x16x32_bf16 v[204:207], a[180:183], v[28:31], 0
v_cvt_pk_bf16_f32 v26, v12, v13
s_waitcnt vmcnt(4)
buffer_load_dwordx4 v52, s[12:15], s41 offen offset:2048 nt lds
v_mfma_f32_16x16x32_bf16 v[20:23], a[152:155], a[24:27], v[20:23]
v_exp_f32 v14, v14
v_mfma_f32_16x16x32_bf16 v[228:231], a[184:187], v[28:31], 0
v_mfma_f32_16x16x32_bf16 v[20:23], a[156:159], a[28:31], v[20:23]
v_exp_f32 v15, v15
v_mfma_f32_16x16x32_bf16 v[252:255], a[188:191], v[28:31], 0
v_cvt_pk_bf16_f32 v27, v14, v15
v_mfma_f32_16x16x32_bf16 a[248:251], a[224:227], v[28:31], 0
s_waitcnt vmcnt(4)
buffer_load_dwordx4 v53, s[12:15], s41 offen offset:3072 nt lds
s_mov_b32 s75, s35
s_mov_b32 s47, 5
L_at:
s_waitcnt vmcnt(5)
s_waitcnt lgkmcnt(0)
s_barrier
v_xor_b32 v38, 65536, v38
v_xor_b32 v39, 65536, v39
v_xor_b32 v40, 65536, v40
v_xor_b32 v41, 65536, v41
v_mfma_f32_16x16x32_bf16 v[8:11], a[128:131], a[32:35], 0
v_exp_f32 v16, v16
v_mfma_f32_16x16x32_bf16 v[64:67], a[192:195], v[24:27], v[64:67]
ds_read_b128 a[96:99], v38 offset:0
v_mfma_f32_16x16x32_bf16 v[8:11], a[132:135], a[36:39], v[8:11]
v_exp_f32 v17, v17
v_mfma_f32_16x16x32_bf16 v[88:91], a[196:199], v[24:27], v[88:91]
v_cvt_pk_bf16_f32 v28, v16, v17
s_add_u32 s74, s34, s84
v_mfma_f32_16x16x32_bf16 v[8:11], a[136:139], a[40:43], v[8:11]
v_exp_f32 v18, v18
v_mfma_f32_16x16x32_bf16 v[112:115], a[200:203], v[24:27], v[112:115]
ds_read_b128 a[100:103], v39 offset:0
v_mfma_f32_16x16x32_bf16 v[8:11], a[140:143], a[44:47], v[8:11]
v_exp_f32 v19, v19
v_mfma_f32_16x16x32_bf16 v[136:139], a[204:207], v[24:27], v[136:139]
v_cvt_pk_bf16_f32 v29, v18, v19
s_add_u32 s84, s84, 8192
v_mfma_f32_16x16x32_bf16 v[12:15], a[144:147], a[32:35], 0
v_exp_f32 v20, v20
v_mfma_f32_16x16x32_bf16 v[160:163], a[208:211], v[24:27], v[160:163]
ds_read_b128 a[104:107], v40 offset:0
v_mfma_f32_16x16x32_bf16 v[12:15], a[148:151], a[36:39], v[12:15]
v_exp_f32 v21, v21
v_mfma_f32_16x16x32_bf16 v[184:187], a[212:215], v[24:27], v[184:187]
v_cvt_pk_bf16_f32 v30, v20, v21
s_add_u32 m0, s75, 0
v_mfma_f32_16x16x32_bf16 v[12:15], a[152:155], a[40:43], v[12:15]
v_exp_f32 v22, v22
v_mfma_f32_16x16x32_bf16 v[208:211], a[216:219], v[24:27], v[208:211]
ds_read_b128 a[108:111], v41 offset:0
v_mfma_f32_16x16x32_bf16 v[12:15], a[156:159], a[44:47], v[12:15]
v_exp_f32 v23, v23
v_mfma_f32_16x16x32_bf16 v[232:235], a[220:223], v[24:27], v[232:235]
v_cvt_pk_bf16_f32 v31, v22, v23
v_xor_b32 v42, 65536, v42
v_mfma_f32_16x16x32_bf16 a[228:231], a[224:227], v[24:27], a[228:231]
s_waitcnt vmcnt(4)
buffer_load_dwordx4 v50, s[12:15], s74 offen offset:0 nt lds
v_xor_b32 v43, 65536, v43
v_xor_b32 v44, 65536, v44
v_xor_b32 v45, 65536, v45
v_mfma_f32_16x16x32_bf16 v[16:19], a[128:131], a[48:51], 0
v_exp_f32 v8, v8
v_mfma_f32_16x16x32_bf16 v[68:71], a[192:195], v[28:31], v[68:71]
ds_read_b128 a[112:115], v38 offset:4096
v_mfma_f32_16x16x32_bf16 v[16:19], a[132:135], a[52:55], v[16:19]
v_exp_f32 v9, v9
v_mfma_f32_16x16x32_bf16 v[92:95], a[196:199], v[28:31], v[92:95]
v_cvt_pk_bf16_f32 v24, v8, v9
v_xor_b32 v46, 65536, v46
v_mfma_f32_16x16x32_bf16 v[16:19], a[136:139], a[56:59], v[16:19]
v_exp_f32 v10, v10
v_mfma_f32_16x16x32_bf16 v[116:119], a[200:203], v[28:31], v[116:119]
ds_read_b128 a[116:119], v39 offset:4096
v_mfma_f32_16x16x32_bf16 v[16:19], a[140:143], a[60:63], v[16:19]
v_exp_f32 v11, v11
v_mfma_f32_16x16x32_bf16 v[140:143], a[204:207], v[28:31], v[140:143]
v_cvt_pk_bf16_f32 v25, v10, v11
v_xor_b32 v47, 65536, v47
v_mfma_f32_16x16x32_bf16 v[20:23], a[144:147], a[48:51], 0
v_exp_f32 v12, v12
v_mfma_f32_16x16x32_bf16 v[164:167], a[208:211], v[28:31], v[164:167]
ds_read_b128 a[120:123], v40 offset:4096
v_mfma_f32_16x16x32_bf16 v[20:23], a[148:151], a[52:55], v[20:23]
v_exp_f32 v13, v13
v_mfma_f32_16x16x32_bf16 v[188:191], a[212:215], v[28:31], v[188:191]
v_cvt_pk_bf16_f32 v26, v12, v13
v_xor_b32 v48, 65536, v48
v_mfma_f32_16x16x32_bf16 v[20:23], a[152:155], a[56:59], v[20:23]
v_exp_f32 v14, v14
v_mfma_f32_16x16x32_bf16 v[212:215], a[216:219], v[28:31], v[212:215]
ds_read_b128 a[124:127], v41 offset:4096
v_mfma_f32_16x16x32_bf16 v[20:23], a[156:159], a[60:63], v[20:23]
v_exp_f32 v15, v15
v_mfma_f32_16x16x32_bf16 v[236:239], a[220:223], v[28:31], v[236:239]
v_cvt_pk_bf16_f32 v27, v14, v15
v_xor_b32 v49, 65536, v49
v_mfma_f32_16x16x32_bf16 a[232:235], a[224:227], v[28:31], a[232:235]
s_waitcnt vmcnt(4)
buffer_load_dwordx4 v51, s[12:15], s74 offen offset:1024 nt lds
v_mfma_f32_16x16x32_bf16 v[8:11], a[128:131], a[64:67], 0
v_exp_f32 v16, v16
v_mfma_f32_16x16x32_bf16 v[72:75], a[192:195], v[24:27], v[72:75]
ds_read_b64_tr_b16 a[160:161], v42 offset:0
v_mfma_f32_16x16x32_bf16 v[8:11], a[132:135], a[68:71], v[8:11]
v_exp_f32 v17, v17
v_mfma_f32_16x16x32_bf16 v[96:99], a[196:199], v[24:27], v[96:99]
v_cvt_pk_bf16_f32 v28, v16, v17
v_mfma_f32_16x16x32_bf16 v[8:11], a[136:139], a[72:75], v[8:11]
v_exp_f32 v18, v18
v_mfma_f32_16x16x32_bf16 v[120:123], a[200:203], v[24:27], v[120:123]
ds_read_b64_tr_b16 a[162:163], v42 offset:4096
v_mfma_f32_16x16x32_bf16 v[8:11], a[140:143], a[76:79], v[8:11]
v_exp_f32 v19, v19
v_mfma_f32_16x16x32_bf16 v[144:147], a[204:207], v[24:27], v[144:147]
v_cvt_pk_bf16_f32 v29, v18, v19
v_mfma_f32_16x16x32_bf16 v[12:15], a[144:147], a[64:67], 0
v_exp_f32 v20, v20
v_mfma_f32_16x16x32_bf16 v[168:171], a[208:211], v[24:27], v[168:171]
ds_read_b64_tr_b16 a[164:165], v43 offset:0
v_mfma_f32_16x16x32_bf16 v[12:15], a[148:151], a[68:71], v[12:15]
v_exp_f32 v21, v21
v_mfma_f32_16x16x32_bf16 v[192:195], a[212:215], v[24:27], v[192:195]
v_cvt_pk_bf16_f32 v30, v20, v21
s_waitcnt vmcnt(4)
buffer_load_dwordx4 v52, s[12:15], s74 offen offset:2048 nt lds
v_mfma_f32_16x16x32_bf16 v[12:15], a[152:155], a[72:75], v[12:15]
v_exp_f32 v22, v22
v_mfma_f32_16x16x32_bf16 v[216:219], a[216:219], v[24:27], v[216:219]
ds_read_b64_tr_b16 a[166:167], v43 offset:4096
v_mfma_f32_16x16x32_bf16 v[12:15], a[156:159], a[76:79], v[12:15]
v_exp_f32 v23, v23
v_mfma_f32_16x16x32_bf16 v[240:243], a[220:223], v[24:27], v[240:243]
v_cvt_pk_bf16_f32 v31, v22, v23
v_mfma_f32_16x16x32_bf16 a[236:239], a[224:227], v[24:27], a[236:239]
s_waitcnt vmcnt(4)
buffer_load_dwordx4 v53, s[12:15], s74 offen offset:3072 nt lds
v_mfma_f32_16x16x32_bf16 v[16:19], a[128:131], a[80:83], 0
v_exp_f32 v8, v8
v_mfma_f32_16x16x32_bf16 v[76:79], a[192:195], v[28:31], v[76:79]
ds_read_b64_tr_b16 a[168:169], v44 offset:0
v_mfma_f32_16x16x32_bf16 v[16:19], a[132:135], a[84:87], v[16:19]
v_exp_f32 v9, v9
v_mfma_f32_16x16x32_bf16 v[100:103], a[196:199], v[28:31], v[100:103]
v_cvt_pk_bf16_f32 v24, v8, v9
s_add_u32 s41, s74, 4096
v_mfma_f32_16x16x32_bf16 v[16:19], a[136:139], a[88:91], v[16:19]
v_exp_f32 v10, v10
v_mfma_f32_16x16x32_bf16 v[124:127], a[200:203], v[28:31], v[124:127]
ds_read_b64_tr_b16 a[170:171], v44 offset:4096
v_mfma_f32_16x16x32_bf16 v[16:19], a[140:143], a[92:95], v[16:19]
v_exp_f32 v11, v11
v_mfma_f32_16x16x32_bf16 v[148:151], a[204:207], v[28:31], v[148:151]
v_cvt_pk_bf16_f32 v25, v10, v11
s_add_u32 m0, s75, 4096
v_mfma_f32_16x16x32_bf16 v[20:23], a[144:147], a[80:83], 0
v_exp_f32 v12, v12
v_mfma_f32_16x16x32_bf16 v[172:175], a[208:211], v[28:31], v[172:175]
ds_read_b64_tr_b16 a[172:173], v45 offset:0
v_mfma_f32_16x16x32_bf16 v[20:23], a[148:151], a[84:87], v[20:23]
v_exp_f32 v13, v13
v_mfma_f32_16x16x32_bf16 v[196:199], a[212:215], v[28:31], v[196:199]
v_cvt_pk_bf16_f32 v26, v12, v13
v_mfma_f32_16x16x32_bf16 v[20:23], a[152:155], a[88:91], v[20:23]
v_exp_f32 v14, v14
v_mfma_f32_16x16x32_bf16 v[220:223], a[216:219], v[28:31], v[220:223]
ds_read_b64_tr_b16 a[174:175], v45 offset:4096
v_mfma_f32_16x16x32_bf16 v[20:23], a[156:159], a[92:95], v[20:23]
v_exp_f32 v15, v15
v_mfma_f32_16x16x32_bf16 v[244:247], a[220:223], v[28:31], v[244:247]
v_cvt_pk_bf16_f32 v27, v14, v15
v_mfma_f32_16x16x32_bf16 a[240:243], a[224:227], v[28:31], a[240:243]
s_waitcnt vmcnt(4)
buffer_load_dwordx4 v50, s[12:15], s41 offen offset:0 nt lds
s_waitcnt lgkmcnt(15)
v_mfma_f32_16x16x32_bf16 v[8:11], a[96:99], a[0:3], 0
v_exp_f32 v16, v16
v_mfma_f32_16x16x32_bf16 v[80:83], a[192:195], v[24:27], v[80:83]
ds_read_b64_tr_b16 a[176:177], v46 offset:0
s_waitcnt lgkmcnt(15)
v_mfma_f32_16x16x32_bf16 v[8:11], a[100:103], a[4:7], v[8:11]
v_exp_f32 v17, v17
v_mfma_f32_16x16x32_bf16 v[104:107], a[196:199], v[24:27], v[104:107]
v_cvt_pk_bf16_f32 v28, v16, v17
s_waitcnt lgkmcnt(14)
v_mfma_f32_16x16x32_bf16 v[8:11], a[104:107], a[8:11], v[8:11]
v_exp_f32 v18, v18
v_mfma_f32_16x16x32_bf16 v[128:131], a[200:203], v[24:27], v[128:131]
ds_read_b64_tr_b16 a[178:179], v46 offset:4096
s_waitcnt lgkmcnt(14)
v_mfma_f32_16x16x32_bf16 v[8:11], a[108:111], a[12:15], v[8:11]
v_exp_f32 v19, v19
v_mfma_f32_16x16x32_bf16 v[152:155], a[204:207], v[24:27], v[152:155]
v_cvt_pk_bf16_f32 v29, v18, v19
s_waitcnt lgkmcnt(13)
v_mfma_f32_16x16x32_bf16 v[12:15], a[112:115], a[0:3], 0
v_exp_f32 v20, v20
v_mfma_f32_16x16x32_bf16 v[176:179], a[208:211], v[24:27], v[176:179]
ds_read_b64_tr_b16 a[180:181], v47 offset:0
s_waitcnt lgkmcnt(13)
v_mfma_f32_16x16x32_bf16 v[12:15], a[116:119], a[4:7], v[12:15]
v_exp_f32 v21, v21
v_mfma_f32_16x16x32_bf16 v[200:203], a[212:215], v[24:27], v[200:203]
v_cvt_pk_bf16_f32 v30, v20, v21
s_waitcnt lgkmcnt(12)
v_mfma_f32_16x16x32_bf16 v[12:15], a[120:123], a[8:11], v[12:15]
v_exp_f32 v22, v22
v_mfma_f32_16x16x32_bf16 v[224:227], a[216:219], v[24:27], v[224:227]
ds_read_b64_tr_b16 a[182:183], v47 offset:4096
s_waitcnt lgkmcnt(12)
v_mfma_f32_16x16x32_bf16 v[12:15], a[124:127], a[12:15], v[12:15]
v_exp_f32 v23, v23
v_mfma_f32_16x16x32_bf16 v[248:251], a[220:223], v[24:27], v[248:251]
v_cvt_pk_bf16_f32 v31, v22, v23
v_mfma_f32_16x16x32_bf16 a[244:247], a[224:227], v[24:27], a[244:247]
s_waitcnt vmcnt(4)
buffer_load_dwordx4 v51, s[12:15], s41 offen offset:1024 nt lds
v_mfma_f32_16x16x32_bf16 v[16:19], a[96:99], a[16:19], 0
v_exp_f32 v8, v8
v_mfma_f32_16x16x32_bf16 v[84:87], a[192:195], v[28:31], v[84:87]
ds_read_b64_tr_b16 a[184:185], v48 offset:0
v_mfma_f32_16x16x32_bf16 v[16:19], a[100:103], a[20:23], v[16:19]
v_exp_f32 v9, v9
v_mfma_f32_16x16x32_bf16 v[108:111], a[196:199], v[28:31], v[108:111]
v_cvt_pk_bf16_f32 v24, v8, v9
v_mfma_f32_16x16x32_bf16 v[16:19], a[104:107], a[24:27], v[16:19]
v_exp_f32 v10, v10
v_mfma_f32_16x16x32_bf16 v[132:135], a[200:203], v[28:31], v[132:135]
ds_read_b64_tr_b16 a[186:187], v48 offset:4096
v_mfma_f32_16x16x32_bf16 v[16:19], a[108:111], a[28:31], v[16:19]
v_exp_f32 v11, v11
v_mfma_f32_16x16x32_bf16 v[156:159], a[204:207], v[28:31], v[156:159]
v_cvt_pk_bf16_f32 v25, v10, v11
v_mfma_f32_16x16x32_bf16 v[20:23], a[112:115], a[16:19], 0
v_exp_f32 v12, v12
v_mfma_f32_16x16x32_bf16 v[180:183], a[208:211], v[28:31], v[180:183]
ds_read_b64_tr_b16 a[188:189], v49 offset:0
v_mfma_f32_16x16x32_bf16 v[20:23], a[116:119], a[20:23], v[20:23]
v_exp_f32 v13, v13
ds_read_b64_tr_b16 a[190:191], v49 offset:4096
v_mfma_f32_16x16x32_bf16 v[204:207], a[212:215], v[28:31], v[204:207]
v_cvt_pk_bf16_f32 v26, v12, v13
s_waitcnt vmcnt(4)
buffer_load_dwordx4 v52, s[12:15], s41 offen offset:2048 nt lds
v_mfma_f32_16x16x32_bf16 v[20:23], a[120:123], a[24:27], v[20:23]
v_exp_f32 v14, v14
v_mfma_f32_16x16x32_bf16 v[228:231], a[216:219], v[28:31], v[228:231]
v_mfma_f32_16x16x32_bf16 v[20:23], a[124:127], a[28:31], v[20:23]
v_exp_f32 v15, v15
v_mfma_f32_16x16x32_bf16 v[252:255], a[220:223], v[28:31], v[252:255]
v_cvt_pk_bf16_f32 v27, v14, v15
v_mfma_f32_16x16x32_bf16 a[248:251], a[224:227], v[28:31], a[248:251]
s_waitcnt vmcnt(4)
buffer_load_dwordx4 v53, s[12:15], s41 offen offset:3072 nt lds
s_waitcnt vmcnt(5)
s_waitcnt lgkmcnt(0)
s_barrier
v_mfma_f32_16x16x32_bf16 v[8:11], a[96:99], a[32:35], 0
v_exp_f32 v16, v16
v_mfma_f32_16x16x32_bf16 v[64:67], a[160:163], v[24:27], v[64:67]
ds_read_b128 a[128:131], v38 offset:8192
v_mfma_f32_16x16x32_bf16 v[8:11], a[100:103], a[36:39], v[8:11]
v_exp_f32 v17, v17
v_mfma_f32_16x16x32_bf16 v[88:91], a[164:167], v[24:27], v[88:91]
v_cvt_pk_bf16_f32 v28, v16, v17
s_add_u32 s74, s34, s84
v_mfma_f32_16x16x32_bf16 v[8:11], a[104:107], a[40:43], v[8:11]
v_exp_f32 v18, v18
v_mfma_f32_16x16x32_bf16 v[112:115], a[168:171], v[24:27], v[112:115]
ds_read_b128 a[132:135], v39 offset:8192
v_mfma_f32_16x16x32_bf16 v[8:11], a[108:111], a[44:47], v[8:11]
v_exp_f32 v19, v19
v_mfma_f32_16x16x32_bf16 v[136:139], a[172:175], v[24:27], v[136:139]
v_cvt_pk_bf16_f32 v29, v18, v19
s_add_u32 s84, s84, 8192
v_mfma_f32_16x16x32_bf16 v[12:15], a[112:115], a[32:35], 0
v_exp_f32 v20, v20
v_mfma_f32_16x16x32_bf16 v[160:163], a[176:179], v[24:27], v[160:163]
ds_read_b128 a[136:139], v40 offset:8192
v_mfma_f32_16x16x32_bf16 v[12:15], a[116:119], a[36:39], v[12:15]
v_exp_f32 v21, v21
v_mfma_f32_16x16x32_bf16 v[184:187], a[180:183], v[24:27], v[184:187]
v_cvt_pk_bf16_f32 v30, v20, v21
s_add_u32 m0, s75, 8192
v_mfma_f32_16x16x32_bf16 v[12:15], a[120:123], a[40:43], v[12:15]
v_exp_f32 v22, v22
v_mfma_f32_16x16x32_bf16 v[208:211], a[184:187], v[24:27], v[208:211]
ds_read_b128 a[140:143], v41 offset:8192
v_mfma_f32_16x16x32_bf16 v[12:15], a[124:127], a[44:47], v[12:15]
v_exp_f32 v23, v23
v_mfma_f32_16x16x32_bf16 v[232:235], a[188:191], v[24:27], v[232:235]
v_cvt_pk_bf16_f32 v31, v22, v23
v_mfma_f32_16x16x32_bf16 a[228:231], a[224:227], v[24:27], a[228:231]
s_waitcnt vmcnt(4)
buffer_load_dwordx4 v50, s[12:15], s74 offen offset:0 nt lds
v_mfma_f32_16x16x32_bf16 v[16:19], a[96:99], a[48:51], 0
v_exp_f32 v8, v8
v_mfma_f32_16x16x32_bf16 v[68:71], a[160:163], v[28:31], v[68:71]
ds_read_b128 a[144:147], v38 offset:12288
v_mfma_f32_16x16x32_bf16 v[16:19], a[100:103], a[52:55], v[16:19]
v_exp_f32 v9, v9
v_mfma_f32_16x16x32_bf16 v[92:95], a[164:167], v[28:31], v[92:95]
v_cvt_pk_bf16_f32 v24, v8, v9
v_mfma_f32_16x16x32_bf16 v[16:19], a[104:107], a[56:59], v[16:19]
v_exp_f32 v10, v10
v_mfma_f32_16x16x32_bf16 v[116:119], a[168:171], v[28:31], v[116:119]
ds_read_b128 a[148:151], v39 offset:12288
v_mfma_f32_16x16x32_bf16 v[16:19], a[108:111], a[60:63], v[16:19]
v_exp_f32 v11, v11
v_mfma_f32_16x16x32_bf16 v[140:143], a[172:175], v[28:31], v[140:143]
v_cvt_pk_bf16_f32 v25, v10, v11
v_mfma_f32_16x16x32_bf16 v[20:23], a[112:115], a[48:51], 0
v_exp_f32 v12, v12
v_mfma_f32_16x16x32_bf16 v[164:167], a[176:179], v[28:31], v[164:167]
ds_read_b128 a[152:155], v40 offset:12288
v_mfma_f32_16x16x32_bf16 v[20:23], a[116:119], a[52:55], v[20:23]
v_exp_f32 v13, v13
v_mfma_f32_16x16x32_bf16 v[188:191], a[180:183], v[28:31], v[188:191]
v_cvt_pk_bf16_f32 v26, v12, v13
v_mfma_f32_16x16x32_bf16 v[20:23], a[120:123], a[56:59], v[20:23]
v_exp_f32 v14, v14
v_mfma_f32_16x16x32_bf16 v[212:215], a[184:187], v[28:31], v[212:215]
ds_read_b128 a[156:159], v41 offset:12288
v_mfma_f32_16x16x32_bf16 v[20:23], a[124:127], a[60:63], v[20:23]
v_exp_f32 v15, v15
v_mfma_f32_16x16x32_bf16 v[236:239], a[188:191], v[28:31], v[236:239]
v_cvt_pk_bf16_f32 v27, v14, v15
v_mfma_f32_16x16x32_bf16 a[232:235], a[224:227], v[28:31], a[232:235]
s_waitcnt vmcnt(4)
buffer_load_dwordx4 v51, s[12:15], s74 offen offset:1024 nt lds
v_mfma_f32_16x16x32_bf16 v[8:11], a[96:99], a[64:67], 0
v_exp_f32 v16, v16
v_mfma_f32_16x16x32_bf16 v[72:75], a[160:163], v[24:27], v[72:75]
ds_read_b64_tr_b16 a[192:193], v42 offset:8192
v_mfma_f32_16x16x32_bf16 v[8:11], a[100:103], a[68:71], v[8:11]
v_exp_f32 v17, v17
v_mfma_f32_16x16x32_bf16 v[96:99], a[164:167], v[24:27], v[96:99]
v_cvt_pk_bf16_f32 v28, v16, v17
v_mfma_f32_16x16x32_bf16 v[8:11], a[104:107], a[72:75], v[8:11]
v_exp_f32 v18, v18
v_mfma_f32_16x16x32_bf16 v[120:123], a[168:171], v[24:27], v[120:123]
ds_read_b64_tr_b16 a[194:195], v42 offset:12288
v_mfma_f32_16x16x32_bf16 v[8:11], a[108:111], a[76:79], v[8:11]
v_exp_f32 v19, v19
v_mfma_f32_16x16x32_bf16 v[144:147], a[172:175], v[24:27], v[144:147]
v_cvt_pk_bf16_f32 v29, v18, v19
v_mfma_f32_16x16x32_bf16 v[12:15], a[112:115], a[64:67], 0
v_exp_f32 v20, v20
v_mfma_f32_16x16x32_bf16 v[168:171], a[176:179], v[24:27], v[168:171]
ds_read_b64_tr_b16 a[196:197], v43 offset:8192
v_mfma_f32_16x16x32_bf16 v[12:15], a[116:119], a[68:71], v[12:15]
v_exp_f32 v21, v21
v_mfma_f32_16x16x32_bf16 v[192:195], a[180:183], v[24:27], v[192:195]
v_cvt_pk_bf16_f32 v30, v20, v21
s_waitcnt vmcnt(4)
buffer_load_dwordx4 v52, s[12:15], s74 offen offset:2048 nt lds
v_mfma_f32_16x16x32_bf16 v[12:15], a[120:123], a[72:75], v[12:15]
v_exp_f32 v22, v22
v_mfma_f32_16x16x32_bf16 v[216:219], a[184:187], v[24:27], v[216:219]
ds_read_b64_tr_b16 a[198:199], v43 offset:12288
v_mfma_f32_16x16x32_bf16 v[12:15], a[124:127], a[76:79], v[12:15]
v_exp_f32 v23, v23
v_mfma_f32_16x16x32_bf16 v[240:243], a[188:191], v[24:27], v[240:243]
v_cvt_pk_bf16_f32 v31, v22, v23
v_mfma_f32_16x16x32_bf16 a[236:239], a[224:227], v[24:27], a[236:239]
s_waitcnt vmcnt(4)
buffer_load_dwordx4 v53, s[12:15], s74 offen offset:3072 nt lds
v_mfma_f32_16x16x32_bf16 v[16:19], a[96:99], a[80:83], 0
v_exp_f32 v8, v8
v_mfma_f32_16x16x32_bf16 v[76:79], a[160:163], v[28:31], v[76:79]
ds_read_b64_tr_b16 a[200:201], v44 offset:8192
v_mfma_f32_16x16x32_bf16 v[16:19], a[100:103], a[84:87], v[16:19]
v_exp_f32 v9, v9
v_mfma_f32_16x16x32_bf16 v[100:103], a[164:167], v[28:31], v[100:103]
v_cvt_pk_bf16_f32 v24, v8, v9
s_add_u32 s41, s74, 4096
v_mfma_f32_16x16x32_bf16 v[16:19], a[104:107], a[88:91], v[16:19]
v_exp_f32 v10, v10
v_mfma_f32_16x16x32_bf16 v[124:127], a[168:171], v[28:31], v[124:127]
ds_read_b64_tr_b16 a[202:203], v44 offset:12288
v_mfma_f32_16x16x32_bf16 v[16:19], a[108:111], a[92:95], v[16:19]
v_exp_f32 v11, v11
v_mfma_f32_16x16x32_bf16 v[148:151], a[172:175], v[28:31], v[148:151]
v_cvt_pk_bf16_f32 v25, v10, v11
s_add_u32 m0, s75, 12288
v_mfma_f32_16x16x32_bf16 v[20:23], a[112:115], a[80:83], 0
v_exp_f32 v12, v12
v_mfma_f32_16x16x32_bf16 v[172:175], a[176:179], v[28:31], v[172:175]
ds_read_b64_tr_b16 a[204:205], v45 offset:8192
v_mfma_f32_16x16x32_bf16 v[20:23], a[116:119], a[84:87], v[20:23]
v_exp_f32 v13, v13
v_mfma_f32_16x16x32_bf16 v[196:199], a[180:183], v[28:31], v[196:199]
v_cvt_pk_bf16_f32 v26, v12, v13
v_mfma_f32_16x16x32_bf16 v[20:23], a[120:123], a[88:91], v[20:23]
v_exp_f32 v14, v14
v_mfma_f32_16x16x32_bf16 v[220:223], a[184:187], v[28:31], v[220:223]
ds_read_b64_tr_b16 a[206:207], v45 offset:12288
v_mfma_f32_16x16x32_bf16 v[20:23], a[124:127], a[92:95], v[20:23]
v_exp_f32 v15, v15
v_mfma_f32_16x16x32_bf16 v[244:247], a[188:191], v[28:31], v[244:247]
v_cvt_pk_bf16_f32 v27, v14, v15
v_mfma_f32_16x16x32_bf16 a[240:243], a[224:227], v[28:31], a[240:243]
s_waitcnt vmcnt(4)
buffer_load_dwordx4 v50, s[12:15], s41 offen offset:0 nt lds
s_waitcnt lgkmcnt(15)
v_mfma_f32_16x16x32_bf16 v[8:11], a[128:131], a[0:3], 0
v_exp_f32 v16, v16
v_mfma_f32_16x16x32_bf16 v[80:83], a[160:163], v[24:27], v[80:83]
ds_read_b64_tr_b16 a[208:209], v46 offset:8192
s_waitcnt lgkmcnt(15)
v_mfma_f32_16x16x32_bf16 v[8:11], a[132:135], a[4:7], v[8:11]
v_exp_f32 v17, v17
v_mfma_f32_16x16x32_bf16 v[104:107], a[164:167], v[24:27], v[104:107]
v_cvt_pk_bf16_f32 v28, v16, v17
s_waitcnt lgkmcnt(14)
v_mfma_f32_16x16x32_bf16 v[8:11], a[136:139], a[8:11], v[8:11]
v_exp_f32 v18, v18
v_mfma_f32_16x16x32_bf16 v[128:131], a[168:171], v[24:27], v[128:131]
ds_read_b64_tr_b16 a[210:211], v46 offset:12288
s_waitcnt lgkmcnt(14)
v_mfma_f32_16x16x32_bf16 v[8:11], a[140:143], a[12:15], v[8:11]
v_exp_f32 v19, v19
v_mfma_f32_16x16x32_bf16 v[152:155], a[172:175], v[24:27], v[152:155]
v_cvt_pk_bf16_f32 v29, v18, v19
s_waitcnt lgkmcnt(13)
v_mfma_f32_16x16x32_bf16 v[12:15], a[144:147], a[0:3], 0
v_exp_f32 v20, v20
v_mfma_f32_16x16x32_bf16 v[176:179], a[176:179], v[24:27], v[176:179]
ds_read_b64_tr_b16 a[212:213], v47 offset:8192
s_waitcnt lgkmcnt(13)
v_mfma_f32_16x16x32_bf16 v[12:15], a[148:151], a[4:7], v[12:15]
v_exp_f32 v21, v21
v_mfma_f32_16x16x32_bf16 v[200:203], a[180:183], v[24:27], v[200:203]
v_cvt_pk_bf16_f32 v30, v20, v21
s_waitcnt lgkmcnt(12)
v_mfma_f32_16x16x32_bf16 v[12:15], a[152:155], a[8:11], v[12:15]
v_exp_f32 v22, v22
v_mfma_f32_16x16x32_bf16 v[224:227], a[184:187], v[24:27], v[224:227]
ds_read_b64_tr_b16 a[214:215], v47 offset:12288
s_waitcnt lgkmcnt(12)
v_mfma_f32_16x16x32_bf16 v[12:15], a[156:159], a[12:15], v[12:15]
v_exp_f32 v23, v23
v_mfma_f32_16x16x32_bf16 v[248:251], a[188:191], v[24:27], v[248:251]
v_cvt_pk_bf16_f32 v31, v22, v23
v_mfma_f32_16x16x32_bf16 a[244:247], a[224:227], v[24:27], a[244:247]
s_waitcnt vmcnt(4)
buffer_load_dwordx4 v51, s[12:15], s41 offen offset:1024 nt lds
v_mfma_f32_16x16x32_bf16 v[16:19], a[128:131], a[16:19], 0
v_exp_f32 v8, v8
v_mfma_f32_16x16x32_bf16 v[84:87], a[160:163], v[28:31], v[84:87]
ds_read_b64_tr_b16 a[216:217], v48 offset:8192
v_mfma_f32_16x16x32_bf16 v[16:19], a[132:135], a[20:23], v[16:19]
v_exp_f32 v9, v9
v_mfma_f32_16x16x32_bf16 v[108:111], a[164:167], v[28:31], v[108:111]
v_cvt_pk_bf16_f32 v24, v8, v9
v_mfma_f32_16x16x32_bf16 v[16:19], a[136:139], a[24:27], v[16:19]
v_exp_f32 v10, v10
v_mfma_f32_16x16x32_bf16 v[132:135], a[168:171], v[28:31], v[132:135]
ds_read_b64_tr_b16 a[218:219], v48 offset:12288
v_mfma_f32_16x16x32_bf16 v[16:19], a[140:143], a[28:31], v[16:19]
v_exp_f32 v11, v11
v_mfma_f32_16x16x32_bf16 v[156:159], a[172:175], v[28:31], v[156:159]
v_cvt_pk_bf16_f32 v25, v10, v11
v_mfma_f32_16x16x32_bf16 v[20:23], a[144:147], a[16:19], 0
v_exp_f32 v12, v12
v_mfma_f32_16x16x32_bf16 v[180:183], a[176:179], v[28:31], v[180:183]
ds_read_b64_tr_b16 a[220:221], v49 offset:8192
v_mfma_f32_16x16x32_bf16 v[20:23], a[148:151], a[20:23], v[20:23]
v_exp_f32 v13, v13
ds_read_b64_tr_b16 a[222:223], v49 offset:12288
v_mfma_f32_16x16x32_bf16 v[204:207], a[180:183], v[28:31], v[204:207]
v_cvt_pk_bf16_f32 v26, v12, v13
s_waitcnt vmcnt(4)
buffer_load_dwordx4 v52, s[12:15], s41 offen offset:2048 nt lds
v_mfma_f32_16x16x32_bf16 v[20:23], a[152:155], a[24:27], v[20:23]
v_exp_f32 v14, v14
v_mfma_f32_16x16x32_bf16 v[228:231], a[184:187], v[28:31], v[228:231]
v_mfma_f32_16x16x32_bf16 v[20:23], a[156:159], a[28:31], v[20:23]
v_exp_f32 v15, v15
v_mfma_f32_16x16x32_bf16 v[252:255], a[188:191], v[28:31], v[252:255]
v_cvt_pk_bf16_f32 v27, v14, v15
v_mfma_f32_16x16x32_bf16 a[248:251], a[224:227], v[28:31], a[248:251]
s_waitcnt vmcnt(4)
buffer_load_dwordx4 v53, s[12:15], s41 offen offset:3072 nt lds
s_xor_b32 s75, s75, 65536
s_sub_u32 s47, s47, 1
s_cmp_lg_u32 s47, 0
s_cbranch_scc1 L_at
s_waitcnt vmcnt(5)
s_waitcnt lgkmcnt(0)
s_barrier
v_xor_b32 v38, 65536, v38
v_xor_b32 v39, 65536, v39
v_xor_b32 v40, 65536, v40
v_xor_b32 v41, 65536, v41
v_mfma_f32_16x16x32_bf16 v[8:11], a[128:131], a[32:35], 0
v_exp_f32 v16, v16
v_mfma_f32_16x16x32_bf16 v[64:67], a[192:195], v[24:27], v[64:67]
ds_read_b128 a[96:99], v38 offset:0
v_mfma_f32_16x16x32_bf16 v[8:11], a[132:135], a[36:39], v[8:11]
v_exp_f32 v17, v17
v_mfma_f32_16x16x32_bf16 v[88:91], a[196:199], v[24:27], v[88:91]
v_cvt_pk_bf16_f32 v28, v16, v17
s_add_u32 s74, s34, s84
v_mfma_f32_16x16x32_bf16 v[8:11], a[136:139], a[40:43], v[8:11]
v_exp_f32 v18, v18
v_mfma_f32_16x16x32_bf16 v[112:115], a[200:203], v[24:27], v[112:115]
ds_read_b128 a[100:103], v39 offset:0
v_mfma_f32_16x16x32_bf16 v[8:11], a[140:143], a[44:47], v[8:11]
v_exp_f32 v19, v19
v_mfma_f32_16x16x32_bf16 v[136:139], a[204:207], v[24:27], v[136:139]
v_cvt_pk_bf16_f32 v29, v18, v19
s_add_u32 s84, s84, 8192
v_mfma_f32_16x16x32_bf16 v[12:15], a[144:147], a[32:35], 0
v_exp_f32 v20, v20
v_mfma_f32_16x16x32_bf16 v[160:163], a[208:211], v[24:27], v[160:163]
ds_read_b128 a[104:107], v40 offset:0
v_mfma_f32_16x16x32_bf16 v[12:15], a[148:151], a[36:39], v[12:15]
v_exp_f32 v21, v21
v_mfma_f32_16x16x32_bf16 v[184:187], a[212:215], v[24:27], v[184:187]
v_cvt_pk_bf16_f32 v30, v20, v21
s_add_u32 m0, s35, 65536
v_mfma_f32_16x16x32_bf16 v[12:15], a[152:155], a[40:43], v[12:15]
v_exp_f32 v22, v22
v_mfma_f32_16x16x32_bf16 v[208:211], a[216:219], v[24:27], v[208:211]
ds_read_b128 a[108:111], v41 offset:0
v_mfma_f32_16x16x32_bf16 v[12:15], a[156:159], a[44:47], v[12:15]
v_exp_f32 v23, v23
v_mfma_f32_16x16x32_bf16 v[232:235], a[220:223], v[24:27], v[232:235]
v_cvt_pk_bf16_f32 v31, v22, v23
v_xor_b32 v42, 65536, v42
v_mfma_f32_16x16x32_bf16 a[228:231], a[224:227], v[24:27], a[228:231]
s_waitcnt vmcnt(4)
buffer_load_dwordx4 v50, s[12:15], s74 offen offset:0 nt lds
v_xor_b32 v43, 65536, v43
v_xor_b32 v44, 65536, v44
v_xor_b32 v45, 65536, v45
v_mfma_f32_16x16x32_bf16 v[16:19], a[128:131], a[48:51], 0
v_exp_f32 v8, v8
v_mfma_f32_16x16x32_bf16 v[68:71], a[192:195], v[28:31], v[68:71]
ds_read_b128 a[112:115], v38 offset:4096
v_mfma_f32_16x16x32_bf16 v[16:19], a[132:135], a[52:55], v[16:19]
v_exp_f32 v9, v9
v_mfma_f32_16x16x32_bf16 v[92:95], a[196:199], v[28:31], v[92:95]
v_cvt_pk_bf16_f32 v24, v8, v9
v_xor_b32 v46, 65536, v46
v_mfma_f32_16x16x32_bf16 v[16:19], a[136:139], a[56:59], v[16:19]
v_exp_f32 v10, v10
v_mfma_f32_16x16x32_bf16 v[116:119], a[200:203], v[28:31], v[116:119]
ds_read_b128 a[116:119], v39 offset:4096
v_mfma_f32_16x16x32_bf16 v[16:19], a[140:143], a[60:63], v[16:19]
v_exp_f32 v11, v11
v_mfma_f32_16x16x32_bf16 v[140:143], a[204:207], v[28:31], v[140:143]
v_cvt_pk_bf16_f32 v25, v10, v11
v_xor_b32 v47, 65536, v47
v_mfma_f32_16x16x32_bf16 v[20:23], a[144:147], a[48:51], 0
v_exp_f32 v12, v12
v_mfma_f32_16x16x32_bf16 v[164:167], a[208:211], v[28:31], v[164:167]
ds_read_b128 a[120:123], v40 offset:4096
v_mfma_f32_16x16x32_bf16 v[20:23], a[148:151], a[52:55], v[20:23]
v_exp_f32 v13, v13
v_mfma_f32_16x16x32_bf16 v[188:191], a[212:215], v[28:31], v[188:191]
v_cvt_pk_bf16_f32 v26, v12, v13
v_xor_b32 v48, 65536, v48
v_mfma_f32_16x16x32_bf16 v[20:23], a[152:155], a[56:59], v[20:23]
v_exp_f32 v14, v14
v_mfma_f32_16x16x32_bf16 v[212:215], a[216:219], v[28:31], v[212:215]
ds_read_b128 a[124:127], v41 offset:4096
v_mfma_f32_16x16x32_bf16 v[20:23], a[156:159], a[60:63], v[20:23]
v_exp_f32 v15, v15
v_mfma_f32_16x16x32_bf16 v[236:239], a[220:223], v[28:31], v[236:239]
v_cvt_pk_bf16_f32 v27, v14, v15
v_xor_b32 v49, 65536, v49
v_mfma_f32_16x16x32_bf16 a[232:235], a[224:227], v[28:31], a[232:235]
s_waitcnt vmcnt(4)
buffer_load_dwordx4 v51, s[12:15], s74 offen offset:1024 nt lds
v_mfma_f32_16x16x32_bf16 v[8:11], a[128:131], a[64:67], 0
v_exp_f32 v16, v16
v_mfma_f32_16x16x32_bf16 v[72:75], a[192:195], v[24:27], v[72:75]
ds_read_b64_tr_b16 a[160:161], v42 offset:0
v_mfma_f32_16x16x32_bf16 v[8:11], a[132:135], a[68:71], v[8:11]
v_exp_f32 v17, v17
v_mfma_f32_16x16x32_bf16 v[96:99], a[196:199], v[24:27], v[96:99]
v_cvt_pk_bf16_f32 v28, v16, v17
v_mfma_f32_16x16x32_bf16 v[8:11], a[136:139], a[72:75], v[8:11]
v_exp_f32 v18, v18
v_mfma_f32_16x16x32_bf16 v[120:123], a[200:203], v[24:27], v[120:123]
ds_read_b64_tr_b16 a[162:163], v42 offset:4096
v_mfma_f32_16x16x32_bf16 v[8:11], a[140:143], a[76:79], v[8:11]
v_exp_f32 v19, v19
v_mfma_f32_16x16x32_bf16 v[144:147], a[204:207], v[24:27], v[144:147]
v_cvt_pk_bf16_f32 v29, v18, v19
v_mfma_f32_16x16x32_bf16 v[12:15], a[144:147], a[64:67], 0
v_exp_f32 v20, v20
v_mfma_f32_16x16x32_bf16 v[168:171], a[208:211], v[24:27], v[168:171]
ds_read_b64_tr_b16 a[164:165], v43 offset:0
v_mfma_f32_16x16x32_bf16 v[12:15], a[148:151], a[68:71], v[12:15]
v_exp_f32 v21, v21
v_mfma_f32_16x16x32_bf16 v[192:195], a[212:215], v[24:27], v[192:195]
v_cvt_pk_bf16_f32 v30, v20, v21
s_waitcnt vmcnt(4)
buffer_load_dwordx4 v52, s[12:15], s74 offen offset:2048 nt lds
v_mfma_f32_16x16x32_bf16 v[12:15], a[152:155], a[72:75], v[12:15]
v_exp_f32 v22, v22
v_mfma_f32_16x16x32_bf16 v[216:219], a[216:219], v[24:27], v[216:219]
ds_read_b64_tr_b16 a[166:167], v43 offset:4096
v_mfma_f32_16x16x32_bf16 v[12:15], a[156:159], a[76:79], v[12:15]
v_exp_f32 v23, v23
v_mfma_f32_16x16x32_bf16 v[240:243], a[220:223], v[24:27], v[240:243]
v_cvt_pk_bf16_f32 v31, v22, v23
v_mfma_f32_16x16x32_bf16 a[236:239], a[224:227], v[24:27], a[236:239]
s_waitcnt vmcnt(4)
buffer_load_dwordx4 v53, s[12:15], s74 offen offset:3072 nt lds
v_mfma_f32_16x16x32_bf16 v[16:19], a[128:131], a[80:83], 0
v_exp_f32 v8, v8
v_mfma_f32_16x16x32_bf16 v[76:79], a[192:195], v[28:31], v[76:79]
ds_read_b64_tr_b16 a[168:169], v44 offset:0
v_mfma_f32_16x16x32_bf16 v[16:19], a[132:135], a[84:87], v[16:19]
v_exp_f32 v9, v9
v_mfma_f32_16x16x32_bf16 v[100:103], a[196:199], v[28:31], v[100:103]
v_cvt_pk_bf16_f32 v24, v8, v9
s_add_u32 s41, s74, 4096
v_mfma_f32_16x16x32_bf16 v[16:19], a[136:139], a[88:91], v[16:19]
v_exp_f32 v10, v10
v_mfma_f32_16x16x32_bf16 v[124:127], a[200:203], v[28:31], v[124:127]
ds_read_b64_tr_b16 a[170:171], v44 offset:4096
v_mfma_f32_16x16x32_bf16 v[16:19], a[140:143], a[92:95], v[16:19]
v_exp_f32 v11, v11
v_mfma_f32_16x16x32_bf16 v[148:151], a[204:207], v[28:31], v[148:151]
v_cvt_pk_bf16_f32 v25, v10, v11
s_add_u32 m0, s35, 69632
v_mfma_f32_16x16x32_bf16 v[20:23], a[144:147], a[80:83], 0
v_exp_f32 v12, v12
v_mfma_f32_16x16x32_bf16 v[172:175], a[208:211], v[28:31], v[172:175]
ds_read_b64_tr_b16 a[172:173], v45 offset:0
v_mfma_f32_16x16x32_bf16 v[20:23], a[148:151], a[84:87], v[20:23]
v_exp_f32 v13, v13
v_mfma_f32_16x16x32_bf16 v[196:199], a[212:215], v[28:31], v[196:199]
v_cvt_pk_bf16_f32 v26, v12, v13
v_mfma_f32_16x16x32_bf16 v[20:23], a[152:155], a[88:91], v[20:23]
v_exp_f32 v14, v14
v_mfma_f32_16x16x32_bf16 v[220:223], a[216:219], v[28:31], v[220:223]
ds_read_b64_tr_b16 a[174:175], v45 offset:4096
v_mfma_f32_16x16x32_bf16 v[20:23], a[156:159], a[92:95], v[20:23]
v_exp_f32 v15, v15
v_mfma_f32_16x16x32_bf16 v[244:247], a[220:223], v[28:31], v[244:247]
v_cvt_pk_bf16_f32 v27, v14, v15
v_mfma_f32_16x16x32_bf16 a[240:243], a[224:227], v[28:31], a[240:243]
s_waitcnt vmcnt(4)
buffer_load_dwordx4 v50, s[12:15], s41 offen offset:0 nt lds
s_waitcnt lgkmcnt(15)
v_mfma_f32_16x16x32_bf16 v[8:11], a[96:99], a[0:3], 0
v_exp_f32 v16, v16
v_mfma_f32_16x16x32_bf16 v[80:83], a[192:195], v[24:27], v[80:83]
ds_read_b64_tr_b16 a[176:177], v46 offset:0
s_waitcnt lgkmcnt(15)
v_mfma_f32_16x16x32_bf16 v[8:11], a[100:103], a[4:7], v[8:11]
v_exp_f32 v17, v17
v_mfma_f32_16x16x32_bf16 v[104:107], a[196:199], v[24:27], v[104:107]
v_cvt_pk_bf16_f32 v28, v16, v17
s_waitcnt lgkmcnt(14)
v_mfma_f32_16x16x32_bf16 v[8:11], a[104:107], a[8:11], v[8:11]
v_exp_f32 v18, v18
v_mfma_f32_16x16x32_bf16 v[128:131], a[200:203], v[24:27], v[128:131]
ds_read_b64_tr_b16 a[178:179], v46 offset:4096
s_waitcnt lgkmcnt(14)
v_mfma_f32_16x16x32_bf16 v[8:11], a[108:111], a[12:15], v[8:11]
v_exp_f32 v19, v19
v_mfma_f32_16x16x32_bf16 v[152:155], a[204:207], v[24:27], v[152:155]
v_cvt_pk_bf16_f32 v29, v18, v19
s_waitcnt lgkmcnt(13)
v_mfma_f32_16x16x32_bf16 v[12:15], a[112:115], a[0:3], 0
v_exp_f32 v20, v20
v_mfma_f32_16x16x32_bf16 v[176:179], a[208:211], v[24:27], v[176:179]
ds_read_b64_tr_b16 a[180:181], v47 offset:0
s_waitcnt lgkmcnt(13)
v_mfma_f32_16x16x32_bf16 v[12:15], a[116:119], a[4:7], v[12:15]
v_exp_f32 v21, v21
v_mfma_f32_16x16x32_bf16 v[200:203], a[212:215], v[24:27], v[200:203]
v_cvt_pk_bf16_f32 v30, v20, v21
s_waitcnt lgkmcnt(12)
v_mfma_f32_16x16x32_bf16 v[12:15], a[120:123], a[8:11], v[12:15]
v_exp_f32 v22, v22
v_mfma_f32_16x16x32_bf16 v[224:227], a[216:219], v[24:27], v[224:227]
ds_read_b64_tr_b16 a[182:183], v47 offset:4096
s_waitcnt lgkmcnt(12)
v_mfma_f32_16x16x32_bf16 v[12:15], a[124:127], a[12:15], v[12:15]
v_exp_f32 v23, v23
v_mfma_f32_16x16x32_bf16 v[248:251], a[220:223], v[24:27], v[248:251]
v_cvt_pk_bf16_f32 v31, v22, v23
v_mfma_f32_16x16x32_bf16 a[244:247], a[224:227], v[24:27], a[244:247]
s_waitcnt vmcnt(4)
buffer_load_dwordx4 v51, s[12:15], s41 offen offset:1024 nt lds
v_mfma_f32_16x16x32_bf16 v[16:19], a[96:99], a[16:19], 0
v_exp_f32 v8, v8
v_mfma_f32_16x16x32_bf16 v[84:87], a[192:195], v[28:31], v[84:87]
ds_read_b64_tr_b16 a[184:185], v48 offset:0
v_mfma_f32_16x16x32_bf16 v[16:19], a[100:103], a[20:23], v[16:19]
v_exp_f32 v9, v9
v_mfma_f32_16x16x32_bf16 v[108:111], a[196:199], v[28:31], v[108:111]
v_cvt_pk_bf16_f32 v24, v8, v9
v_mfma_f32_16x16x32_bf16 v[16:19], a[104:107], a[24:27], v[16:19]
v_exp_f32 v10, v10
v_mfma_f32_16x16x32_bf16 v[132:135], a[200:203], v[28:31], v[132:135]
ds_read_b64_tr_b16 a[186:187], v48 offset:4096
v_mfma_f32_16x16x32_bf16 v[16:19], a[108:111], a[28:31], v[16:19]
v_exp_f32 v11, v11
v_mfma_f32_16x16x32_bf16 v[156:159], a[204:207], v[28:31], v[156:159]
v_cvt_pk_bf16_f32 v25, v10, v11
v_mfma_f32_16x16x32_bf16 v[20:23], a[112:115], a[16:19], 0
v_exp_f32 v12, v12
v_mfma_f32_16x16x32_bf16 v[180:183], a[208:211], v[28:31], v[180:183]
ds_read_b64_tr_b16 a[188:189], v49 offset:0
v_mfma_f32_16x16x32_bf16 v[20:23], a[116:119], a[20:23], v[20:23]
v_exp_f32 v13, v13
ds_read_b64_tr_b16 a[190:191], v49 offset:4096
v_mfma_f32_16x16x32_bf16 v[204:207], a[212:215], v[28:31], v[204:207]
v_cvt_pk_bf16_f32 v26, v12, v13
s_waitcnt vmcnt(4)
buffer_load_dwordx4 v52, s[12:15], s41 offen offset:2048 nt lds
v_mfma_f32_16x16x32_bf16 v[20:23], a[120:123], a[24:27], v[20:23]
v_exp_f32 v14, v14
v_mfma_f32_16x16x32_bf16 v[228:231], a[216:219], v[28:31], v[228:231]
v_mfma_f32_16x16x32_bf16 v[20:23], a[124:127], a[28:31], v[20:23]
v_exp_f32 v15, v15
v_mfma_f32_16x16x32_bf16 v[252:255], a[220:223], v[28:31], v[252:255]
v_cvt_pk_bf16_f32 v27, v14, v15
v_mfma_f32_16x16x32_bf16 a[248:251], a[224:227], v[28:31], a[248:251]
s_waitcnt vmcnt(4)
buffer_load_dwordx4 v53, s[12:15], s41 offen offset:3072 nt lds
s_waitcnt vmcnt(5)
s_waitcnt lgkmcnt(0)
s_barrier
v_mfma_f32_16x16x32_bf16 v[8:11], a[96:99], a[32:35], 0
v_exp_f32 v16, v16
v_mfma_f32_16x16x32_bf16 v[64:67], a[160:163], v[24:27], v[64:67]
ds_read_b128 a[128:131], v38 offset:8192
v_mfma_f32_16x16x32_bf16 v[8:11], a[100:103], a[36:39], v[8:11]
v_exp_f32 v17, v17
v_mfma_f32_16x16x32_bf16 v[88:91], a[164:167], v[24:27], v[88:91]
v_cvt_pk_bf16_f32 v28, v16, v17
s_add_u32 s74, s34, s84
v_mfma_f32_16x16x32_bf16 v[8:11], a[104:107], a[40:43], v[8:11]
v_exp_f32 v18, v18
v_mfma_f32_16x16x32_bf16 v[112:115], a[168:171], v[24:27], v[112:115]
ds_read_b128 a[132:135], v39 offset:8192
v_mfma_f32_16x16x32_bf16 v[8:11], a[108:111], a[44:47], v[8:11]
v_exp_f32 v19, v19
v_mfma_f32_16x16x32_bf16 v[136:139], a[172:175], v[24:27], v[136:139]
v_cvt_pk_bf16_f32 v29, v18, v19
s_add_u32 s84, s84, 8192
v_mfma_f32_16x16x32_bf16 v[12:15], a[112:115], a[32:35], 0
v_exp_f32 v20, v20
v_mfma_f32_16x16x32_bf16 v[160:163], a[176:179], v[24:27], v[160:163]
ds_read_b128 a[136:139], v40 offset:8192
v_mfma_f32_16x16x32_bf16 v[12:15], a[116:119], a[36:39], v[12:15]
v_exp_f32 v21, v21
v_mfma_f32_16x16x32_bf16 v[184:187], a[180:183], v[24:27], v[184:187]
v_cvt_pk_bf16_f32 v30, v20, v21
s_add_u32 m0, s35, 73728
v_mfma_f32_16x16x32_bf16 v[12:15], a[120:123], a[40:43], v[12:15]
v_exp_f32 v22, v22
v_mfma_f32_16x16x32_bf16 v[208:211], a[184:187], v[24:27], v[208:211]
ds_read_b128 a[140:143], v41 offset:8192
v_mfma_f32_16x16x32_bf16 v[12:15], a[124:127], a[44:47], v[12:15]
v_exp_f32 v23, v23
v_mfma_f32_16x16x32_bf16 v[232:235], a[188:191], v[24:27], v[232:235]
v_cvt_pk_bf16_f32 v31, v22, v23
v_mfma_f32_16x16x32_bf16 a[228:231], a[224:227], v[24:27], a[228:231]
s_waitcnt vmcnt(4)
buffer_load_dwordx4 v50, s[12:15], s74 offen offset:0 nt lds
v_mfma_f32_16x16x32_bf16 v[16:19], a[96:99], a[48:51], 0
v_exp_f32 v8, v8
v_mfma_f32_16x16x32_bf16 v[68:71], a[160:163], v[28:31], v[68:71]
ds_read_b128 a[144:147], v38 offset:12288
v_mfma_f32_16x16x32_bf16 v[16:19], a[100:103], a[52:55], v[16:19]
v_exp_f32 v9, v9
v_mfma_f32_16x16x32_bf16 v[92:95], a[164:167], v[28:31], v[92:95]
v_cvt_pk_bf16_f32 v24, v8, v9
v_mfma_f32_16x16x32_bf16 v[16:19], a[104:107], a[56:59], v[16:19]
v_exp_f32 v10, v10
v_mfma_f32_16x16x32_bf16 v[116:119], a[168:171], v[28:31], v[116:119]
ds_read_b128 a[148:151], v39 offset:12288
v_mfma_f32_16x16x32_bf16 v[16:19], a[108:111], a[60:63], v[16:19]
v_exp_f32 v11, v11
v_mfma_f32_16x16x32_bf16 v[140:143], a[172:175], v[28:31], v[140:143]
v_cvt_pk_bf16_f32 v25, v10, v11
v_mfma_f32_16x16x32_bf16 v[20:23], a[112:115], a[48:51], 0
v_exp_f32 v12, v12
v_mfma_f32_16x16x32_bf16 v[164:167], a[176:179], v[28:31], v[164:167]
ds_read_b128 a[152:155], v40 offset:12288
v_mfma_f32_16x16x32_bf16 v[20:23], a[116:119], a[52:55], v[20:23]
v_exp_f32 v13, v13
v_mfma_f32_16x16x32_bf16 v[188:191], a[180:183], v[28:31], v[188:191]
v_cvt_pk_bf16_f32 v26, v12, v13
v_mfma_f32_16x16x32_bf16 v[20:23], a[120:123], a[56:59], v[20:23]
v_exp_f32 v14, v14
v_mfma_f32_16x16x32_bf16 v[212:215], a[184:187], v[28:31], v[212:215]
ds_read_b128 a[156:159], v41 offset:12288
v_mfma_f32_16x16x32_bf16 v[20:23], a[124:127], a[60:63], v[20:23]
v_exp_f32 v15, v15
v_mfma_f32_16x16x32_bf16 v[236:239], a[188:191], v[28:31], v[236:239]
v_cvt_pk_bf16_f32 v27, v14, v15
v_mfma_f32_16x16x32_bf16 a[232:235], a[224:227], v[28:31], a[232:235]
s_waitcnt vmcnt(4)
buffer_load_dwordx4 v51, s[12:15], s74 offen offset:1024 nt lds
v_mfma_f32_16x16x32_bf16 v[8:11], a[96:99], a[64:67], 0
v_exp_f32 v16, v16
v_mfma_f32_16x16x32_bf16 v[72:75], a[160:163], v[24:27], v[72:75]
ds_read_b64_tr_b16 a[192:193], v42 offset:8192
v_mfma_f32_16x16x32_bf16 v[8:11], a[100:103], a[68:71], v[8:11]
v_exp_f32 v17, v17
v_mfma_f32_16x16x32_bf16 v[96:99], a[164:167], v[24:27], v[96:99]
v_cvt_pk_bf16_f32 v28, v16, v17
v_mfma_f32_16x16x32_bf16 v[8:11], a[104:107], a[72:75], v[8:11]
v_exp_f32 v18, v18
v_mfma_f32_16x16x32_bf16 v[120:123], a[168:171], v[24:27], v[120:123]
ds_read_b64_tr_b16 a[194:195], v42 offset:12288
v_mfma_f32_16x16x32_bf16 v[8:11], a[108:111], a[76:79], v[8:11]
v_exp_f32 v19, v19
v_mfma_f32_16x16x32_bf16 v[144:147], a[172:175], v[24:27], v[144:147]
v_cvt_pk_bf16_f32 v29, v18, v19
v_mfma_f32_16x16x32_bf16 v[12:15], a[112:115], a[64:67], 0
v_exp_f32 v20, v20
v_mfma_f32_16x16x32_bf16 v[168:171], a[176:179], v[24:27], v[168:171]
ds_read_b64_tr_b16 a[196:197], v43 offset:8192
v_mfma_f32_16x16x32_bf16 v[12:15], a[116:119], a[68:71], v[12:15]
v_exp_f32 v21, v21
v_mfma_f32_16x16x32_bf16 v[192:195], a[180:183], v[24:27], v[192:195]
v_cvt_pk_bf16_f32 v30, v20, v21
s_waitcnt vmcnt(4)
buffer_load_dwordx4 v52, s[12:15], s74 offen offset:2048 nt lds
v_mfma_f32_16x16x32_bf16 v[12:15], a[120:123], a[72:75], v[12:15]
v_exp_f32 v22, v22
v_mfma_f32_16x16x32_bf16 v[216:219], a[184:187], v[24:27], v[216:219]
ds_read_b64_tr_b16 a[198:199], v43 offset:12288
v_mfma_f32_16x16x32_bf16 v[12:15], a[124:127], a[76:79], v[12:15]
v_exp_f32 v23, v23
v_mfma_f32_16x16x32_bf16 v[240:243], a[188:191], v[24:27], v[240:243]
v_cvt_pk_bf16_f32 v31, v22, v23
v_mfma_f32_16x16x32_bf16 a[236:239], a[224:227], v[24:27], a[236:239]
s_waitcnt vmcnt(4)
buffer_load_dwordx4 v53, s[12:15], s74 offen offset:3072 nt lds
v_mfma_f32_16x16x32_bf16 v[16:19], a[96:99], a[80:83], 0
v_exp_f32 v8, v8
v_mfma_f32_16x16x32_bf16 v[76:79], a[160:163], v[28:31], v[76:79]
ds_read_b64_tr_b16 a[200:201], v44 offset:8192
v_mfma_f32_16x16x32_bf16 v[16:19], a[100:103], a[84:87], v[16:19]
v_exp_f32 v9, v9
v_mfma_f32_16x16x32_bf16 v[100:103], a[164:167], v[28:31], v[100:103]
v_cvt_pk_bf16_f32 v24, v8, v9
s_add_u32 s41, s74, 4096
v_mfma_f32_16x16x32_bf16 v[16:19], a[104:107], a[88:91], v[16:19]
v_exp_f32 v10, v10
v_mfma_f32_16x16x32_bf16 v[124:127], a[168:171], v[28:31], v[124:127]
ds_read_b64_tr_b16 a[202:203], v44 offset:12288
v_mfma_f32_16x16x32_bf16 v[16:19], a[108:111], a[92:95], v[16:19]
v_exp_f32 v11, v11
v_mfma_f32_16x16x32_bf16 v[148:151], a[172:175], v[28:31], v[148:151]
v_cvt_pk_bf16_f32 v25, v10, v11
s_add_u32 m0, s35, 77824
v_mfma_f32_16x16x32_bf16 v[20:23], a[112:115], a[80:83], 0
v_exp_f32 v12, v12
v_mfma_f32_16x16x32_bf16 v[172:175], a[176:179], v[28:31], v[172:175]
ds_read_b64_tr_b16 a[204:205], v45 offset:8192
v_mfma_f32_16x16x32_bf16 v[20:23], a[116:119], a[84:87], v[20:23]
v_exp_f32 v13, v13
v_mfma_f32_16x16x32_bf16 v[196:199], a[180:183], v[28:31], v[196:199]
v_cvt_pk_bf16_f32 v26, v12, v13
v_mfma_f32_16x16x32_bf16 v[20:23], a[120:123], a[88:91], v[20:23]
v_exp_f32 v14, v14
v_mfma_f32_16x16x32_bf16 v[220:223], a[184:187], v[28:31], v[220:223]
ds_read_b64_tr_b16 a[206:207], v45 offset:12288
v_mfma_f32_16x16x32_bf16 v[20:23], a[124:127], a[92:95], v[20:23]
v_exp_f32 v15, v15
v_mfma_f32_16x16x32_bf16 v[244:247], a[188:191], v[28:31], v[244:247]
v_cvt_pk_bf16_f32 v27, v14, v15
v_mfma_f32_16x16x32_bf16 a[240:243], a[224:227], v[28:31], a[240:243]
s_waitcnt vmcnt(4)
buffer_load_dwordx4 v50, s[12:15], s41 offen offset:0 nt lds
s_waitcnt lgkmcnt(15)
v_mfma_f32_16x16x32_bf16 v[8:11], a[128:131], a[0:3], 0
v_exp_f32 v16, v16
v_mfma_f32_16x16x32_bf16 v[80:83], a[160:163], v[24:27], v[80:83]
ds_read_b64_tr_b16 a[208:209], v46 offset:8192
s_waitcnt lgkmcnt(15)
v_mfma_f32_16x16x32_bf16 v[8:11], a[132:135], a[4:7], v[8:11]
v_exp_f32 v17, v17
v_mfma_f32_16x16x32_bf16 v[104:107], a[164:167], v[24:27], v[104:107]
v_cvt_pk_bf16_f32 v28, v16, v17
s_waitcnt lgkmcnt(14)
v_mfma_f32_16x16x32_bf16 v[8:11], a[136:139], a[8:11], v[8:11]
v_exp_f32 v18, v18
v_mfma_f32_16x16x32_bf16 v[128:131], a[168:171], v[24:27], v[128:131]
ds_read_b64_tr_b16 a[210:211], v46 offset:12288
s_waitcnt lgkmcnt(14)
v_mfma_f32_16x16x32_bf16 v[8:11], a[140:143], a[12:15], v[8:11]
v_exp_f32 v19, v19
v_mfma_f32_16x16x32_bf16 v[152:155], a[172:175], v[24:27], v[152:155]
v_cvt_pk_bf16_f32 v29, v18, v19
s_waitcnt lgkmcnt(13)
v_mfma_f32_16x16x32_bf16 v[12:15], a[144:147], a[0:3], 0
v_exp_f32 v20, v20
v_mfma_f32_16x16x32_bf16 v[176:179], a[176:179], v[24:27], v[176:179]
ds_read_b64_tr_b16 a[212:213], v47 offset:8192
s_waitcnt lgkmcnt(13)
v_mfma_f32_16x16x32_bf16 v[12:15], a[148:151], a[4:7], v[12:15]
v_exp_f32 v21, v21
v_mfma_f32_16x16x32_bf16 v[200:203], a[180:183], v[24:27], v[200:203]
v_cvt_pk_bf16_f32 v30, v20, v21
s_waitcnt lgkmcnt(12)
v_mfma_f32_16x16x32_bf16 v[12:15], a[152:155], a[8:11], v[12:15]
v_exp_f32 v22, v22
v_mfma_f32_16x16x32_bf16 v[224:227], a[184:187], v[24:27], v[224:227]
ds_read_b64_tr_b16 a[214:215], v47 offset:12288
s_waitcnt lgkmcnt(12)
v_mfma_f32_16x16x32_bf16 v[12:15], a[156:159], a[12:15], v[12:15]
v_exp_f32 v23, v23
v_mfma_f32_16x16x32_bf16 v[248:251], a[188:191], v[24:27], v[248:251]
v_cvt_pk_bf16_f32 v31, v22, v23
v_mfma_f32_16x16x32_bf16 a[244:247], a[224:227], v[24:27], a[244:247]
s_waitcnt vmcnt(4)
buffer_load_dwordx4 v51, s[12:15], s41 offen offset:1024 nt lds
v_mfma_f32_16x16x32_bf16 v[16:19], a[128:131], a[16:19], 0
v_exp_f32 v8, v8
v_mfma_f32_16x16x32_bf16 v[84:87], a[160:163], v[28:31], v[84:87]
ds_read_b64_tr_b16 a[216:217], v48 offset:8192
v_mfma_f32_16x16x32_bf16 v[16:19], a[132:135], a[20:23], v[16:19]
v_exp_f32 v9, v9
v_mfma_f32_16x16x32_bf16 v[108:111], a[164:167], v[28:31], v[108:111]
v_cvt_pk_bf16_f32 v24, v8, v9
v_mfma_f32_16x16x32_bf16 v[16:19], a[136:139], a[24:27], v[16:19]
v_exp_f32 v10, v10
v_mfma_f32_16x16x32_bf16 v[132:135], a[168:171], v[28:31], v[132:135]
ds_read_b64_tr_b16 a[218:219], v48 offset:12288
v_mfma_f32_16x16x32_bf16 v[16:19], a[140:143], a[28:31], v[16:19]
v_exp_f32 v11, v11
v_mfma_f32_16x16x32_bf16 v[156:159], a[172:175], v[28:31], v[156:159]
v_cvt_pk_bf16_f32 v25, v10, v11
v_mfma_f32_16x16x32_bf16 v[20:23], a[144:147], a[16:19], 0
v_exp_f32 v12, v12
v_mfma_f32_16x16x32_bf16 v[180:183], a[176:179], v[28:31], v[180:183]
ds_read_b64_tr_b16 a[220:221], v49 offset:8192
v_mfma_f32_16x16x32_bf16 v[20:23], a[148:151], a[20:23], v[20:23]
v_exp_f32 v13, v13
ds_read_b64_tr_b16 a[222:223], v49 offset:12288
v_mfma_f32_16x16x32_bf16 v[204:207], a[180:183], v[28:31], v[204:207]
v_cvt_pk_bf16_f32 v26, v12, v13
s_waitcnt vmcnt(4)
buffer_load_dwordx4 v52, s[12:15], s41 offen offset:2048 nt lds
v_mfma_f32_16x16x32_bf16 v[20:23], a[152:155], a[24:27], v[20:23]
v_exp_f32 v14, v14
v_mfma_f32_16x16x32_bf16 v[228:231], a[184:187], v[28:31], v[228:231]
v_mfma_f32_16x16x32_bf16 v[20:23], a[156:159], a[28:31], v[20:23]
v_exp_f32 v15, v15
v_mfma_f32_16x16x32_bf16 v[252:255], a[188:191], v[28:31], v[252:255]
v_cvt_pk_bf16_f32 v27, v14, v15
v_mfma_f32_16x16x32_bf16 a[248:251], a[224:227], v[28:31], a[248:251]
s_waitcnt vmcnt(4)
buffer_load_dwordx4 v53, s[12:15], s41 offen offset:3072 nt lds
s_cmp_eq_u32 s46, 1
s_cbranch_scc1 L_D1
s_waitcnt vmcnt(5)
s_waitcnt lgkmcnt(0)
s_barrier
v_xor_b32 v38, 65536, v38
v_xor_b32 v39, 65536, v39
v_xor_b32 v40, 65536, v40
v_xor_b32 v41, 65536, v41
v_mfma_f32_16x16x32_bf16 v[8:11], a[128:131], a[32:35], 0
v_exp_f32 v16, v16
v_mfma_f32_16x16x32_bf16 v[64:67], a[192:195], v[24:27], v[64:67]
ds_read_b128 a[96:99], v38 offset:0
v_mfma_f32_16x16x32_bf16 v[8:11], a[132:135], a[36:39], v[8:11]
v_exp_f32 v17, v17
v_mfma_f32_16x16x32_bf16 v[88:91], a[196:199], v[24:27], v[88:91]
v_cvt_pk_bf16_f32 v28, v16, v17
s_add_u32 s42, s44, 0
v_mfma_f32_16x16x32_bf16 v[8:11], a[136:139], a[40:43], v[8:11]
v_exp_f32 v18, v18
v_mfma_f32_16x16x32_bf16 v[112:115], a[200:203], v[24:27], v[112:115]
ds_read_b128 a[100:103], v39 offset:0
v_mfma_f32_16x16x32_bf16 v[8:11], a[140:143], a[44:47], v[8:11]
v_exp_f32 v19, v19
v_mfma_f32_16x16x32_bf16 v[136:139], a[204:207], v[24:27], v[136:139]
v_cvt_pk_bf16_f32 v29, v18, v19
v_xor_b32 v42, 65536, v42
v_mfma_f32_16x16x32_bf16 v[12:15], a[144:147], a[32:35], 0
v_exp_f32 v20, v20
v_mfma_f32_16x16x32_bf16 v[160:163], a[208:211], v[24:27], v[160:163]
ds_read_b128 a[104:107], v40 offset:0
v_mfma_f32_16x16x32_bf16 v[12:15], a[148:151], a[36:39], v[12:15]
v_exp_f32 v21, v21
v_mfma_f32_16x16x32_bf16 v[184:187], a[212:215], v[24:27], v[184:187]
v_cvt_pk_bf16_f32 v30, v20, v21
v_xor_b32 v43, 65536, v43
v_mfma_f32_16x16x32_bf16 v[12:15], a[152:155], a[40:43], v[12:15]
v_exp_f32 v22, v22
v_mfma_f32_16x16x32_bf16 v[208:211], a[216:219], v[24:27], v[208:211]
ds_read_b128 a[108:111], v41 offset:0
v_mfma_f32_16x16x32_bf16 v[12:15], a[156:159], a[44:47], v[12:15]
v_exp_f32 v23, v23
v_mfma_f32_16x16x32_bf16 v[232:235], a[220:223], v[24:27], v[232:235]
v_cvt_pk_bf16_f32 v31, v22, v23
v_xor_b32 v44, 65536, v44
v_mfma_f32_16x16x32_bf16 a[228:231], a[224:227], v[24:27], a[228:231]
buffer_load_dwordx4 a[252:255], v4, s[20:23], s42 offen offset:0
v_xor_b32 v45, 65536, v45
v_mfma_f32_16x16x32_bf16 v[16:19], a[128:131], a[48:51], 0
v_exp_f32 v8, v8
v_mfma_f32_16x16x32_bf16 v[68:71], a[192:195], v[28:31], v[68:71]
ds_read_b128 a[112:115], v38 offset:4096
v_mfma_f32_16x16x32_bf16 v[16:19], a[132:135], a[52:55], v[16:19]
v_exp_f32 v9, v9
v_mfma_f32_16x16x32_bf16 v[92:95], a[196:199], v[28:31], v[92:95]
v_cvt_pk_bf16_f32 v24, v8, v9
v_xor_b32 v46, 65536, v46
v_mfma_f32_16x16x32_bf16 v[16:19], a[136:139], a[56:59], v[16:19]
v_exp_f32 v10, v10
v_mfma_f32_16x16x32_bf16 v[116:119], a[200:203], v[28:31], v[116:119]
ds_read_b128 a[116:119], v39 offset:4096
v_mfma_f32_16x16x32_bf16 v[16:19], a[140:143], a[60:63], v[16:19]
v_exp_f32 v11, v11
v_mfma_f32_16x16x32_bf16 v[140:143], a[204:207], v[28:31], v[140:143]
v_cvt_pk_bf16_f32 v25, v10, v11
v_xor_b32 v47, 65536, v47
v_mfma_f32_16x16x32_bf16 v[20:23], a[144:147], a[48:51], 0
v_exp_f32 v12, v12
v_mfma_f32_16x16x32_bf16 v[164:167], a[208:211], v[28:31], v[164:167]
ds_read_b128 a[120:123], v40 offset:4096
v_mfma_f32_16x16x32_bf16 v[20:23], a[148:151], a[52:55], v[20:23]
v_exp_f32 v13, v13
v_mfma_f32_16x16x32_bf16 v[188:191], a[212:215], v[28:31], v[188:191]
v_cvt_pk_bf16_f32 v26, v12, v13
v_xor_b32 v48, 65536, v48
v_mfma_f32_16x16x32_bf16 v[20:23], a[152:155], a[56:59], v[20:23]
v_exp_f32 v14, v14
v_mfma_f32_16x16x32_bf16 v[212:215], a[216:219], v[28:31], v[212:215]
ds_read_b128 a[124:127], v41 offset:4096
v_mfma_f32_16x16x32_bf16 v[20:23], a[156:159], a[60:63], v[20:23]
v_exp_f32 v15, v15
v_mfma_f32_16x16x32_bf16 v[236:239], a[220:223], v[28:31], v[236:239]
v_cvt_pk_bf16_f32 v27, v14, v15
v_xor_b32 v49, 65536, v49
v_mfma_f32_16x16x32_bf16 a[232:235], a[224:227], v[28:31], a[232:235]
buffer_load_dwordx4 a[252:255], v4, s[20:23], s42 offen offset:1024
v_mfma_f32_16x16x32_bf16 v[8:11], a[128:131], a[64:67], 0
v_exp_f32 v16, v16
v_mfma_f32_16x16x32_bf16 v[72:75], a[192:195], v[24:27], v[72:75]
ds_read_b64_tr_b16 a[160:161], v42 offset:0
v_mfma_f32_16x16x32_bf16 v[8:11], a[132:135], a[68:71], v[8:11]
v_exp_f32 v17, v17
v_mfma_f32_16x16x32_bf16 v[96:99], a[196:199], v[24:27], v[96:99]
v_cvt_pk_bf16_f32 v28, v16, v17
v_mfma_f32_16x16x32_bf16 v[8:11], a[136:139], a[72:75], v[8:11]
v_exp_f32 v18, v18
v_mfma_f32_16x16x32_bf16 v[120:123], a[200:203], v[24:27], v[120:123]
ds_read_b64_tr_b16 a[162:163], v42 offset:4096
v_mfma_f32_16x16x32_bf16 v[8:11], a[140:143], a[76:79], v[8:11]
v_exp_f32 v19, v19
v_mfma_f32_16x16x32_bf16 v[144:147], a[204:207], v[24:27], v[144:147]
v_cvt_pk_bf16_f32 v29, v18, v19
v_mfma_f32_16x16x32_bf16 v[12:15], a[144:147], a[64:67], 0
v_exp_f32 v20, v20
v_mfma_f32_16x16x32_bf16 v[168:171], a[208:211], v[24:27], v[168:171]
ds_read_b64_tr_b16 a[164:165], v43 offset:0
v_mfma_f32_16x16x32_bf16 v[12:15], a[148:151], a[68:71], v[12:15]
v_exp_f32 v21, v21
v_mfma_f32_16x16x32_bf16 v[192:195], a[212:215], v[24:27], v[192:195]
v_cvt_pk_bf16_f32 v30, v20, v21
buffer_load_dwordx4 a[252:255], v4, s[20:23], s42 offen offset:2048
v_mfma_f32_16x16x32_bf16 v[12:15], a[152:155], a[72:75], v[12:15]
v_exp_f32 v22, v22
v_mfma_f32_16x16x32_bf16 v[216:219], a[216:219], v[24:27], v[216:219]
ds_read_b64_tr_b16 a[166:167], v43 offset:4096
v_mfma_f32_16x16x32_bf16 v[12:15], a[156:159], a[76:79], v[12:15]
v_exp_f32 v23, v23
v_mfma_f32_16x16x32_bf16 v[240:243], a[220:223], v[24:27], v[240:243]
v_cvt_pk_bf16_f32 v31, v22, v23
v_mfma_f32_16x16x32_bf16 a[236:239], a[224:227], v[24:27], a[236:239]
buffer_load_dwordx4 a[252:255], v4, s[20:23], s42 offen offset:3072
v_mfma_f32_16x16x32_bf16 v[16:19], a[128:131], a[80:83], 0
v_exp_f32 v8, v8
v_mfma_f32_16x16x32_bf16 v[76:79], a[192:195], v[28:31], v[76:79]
ds_read_b64_tr_b16 a[168:169], v44 offset:0
v_mfma_f32_16x16x32_bf16 v[16:19], a[132:135], a[84:87], v[16:19]
v_exp_f32 v9, v9
v_mfma_f32_16x16x32_bf16 v[100:103], a[196:199], v[28:31], v[100:103]
v_cvt_pk_bf16_f32 v24, v8, v9
s_add_u32 s42, s44, 4096
v_mfma_f32_16x16x32_bf16 v[16:19], a[136:139], a[88:91], v[16:19]
v_exp_f32 v10, v10
v_mfma_f32_16x16x32_bf16 v[124:127], a[200:203], v[28:31], v[124:127]
ds_read_b64_tr_b16 a[170:171], v44 offset:4096
v_mfma_f32_16x16x32_bf16 v[16:19], a[140:143], a[92:95], v[16:19]
v_exp_f32 v11, v11
v_mfma_f32_16x16x32_bf16 v[148:151], a[204:207], v[28:31], v[148:151]
v_cvt_pk_bf16_f32 v25, v10, v11
v_mfma_f32_16x16x32_bf16 v[20:23], a[144:147], a[80:83], 0
v_exp_f32 v12, v12
v_mfma_f32_16x16x32_bf16 v[172:175], a[208:211], v[28:31], v[172:175]
ds_read_b64_tr_b16 a[172:173], v45 offset:0
v_mfma_f32_16x16x32_bf16 v[20:23], a[148:151], a[84:87], v[20:23]
v_exp_f32 v13, v13
v_mfma_f32_16x16x32_bf16 v[196:199], a[212:215], v[28:31], v[196:199]
v_cvt_pk_bf16_f32 v26, v12, v13
v_mfma_f32_16x16x32_bf16 v[20:23], a[152:155], a[88:91], v[20:23]
v_exp_f32 v14, v14
v_mfma_f32_16x16x32_bf16 v[220:223], a[216:219], v[28:31], v[220:223]
ds_read_b64_tr_b16 a[174:175], v45 offset:4096
v_mfma_f32_16x16x32_bf16 v[20:23], a[156:159], a[92:95], v[20:23]
v_exp_f32 v15, v15
v_mfma_f32_16x16x32_bf16 v[244:247], a[220:223], v[28:31], v[244:247]
v_cvt_pk_bf16_f32 v27, v14, v15
v_mfma_f32_16x16x32_bf16 a[240:243], a[224:227], v[28:31], a[240:243]
buffer_load_dwordx4 a[252:255], v4, s[20:23], s42 offen offset:0
s_waitcnt lgkmcnt(15)
v_mfma_f32_16x16x32_bf16 v[8:11], a[96:99], a[0:3], 0
v_exp_f32 v16, v16
v_mfma_f32_16x16x32_bf16 v[80:83], a[192:195], v[24:27], v[80:83]
ds_read_b64_tr_b16 a[176:177], v46 offset:0
s_waitcnt lgkmcnt(15)
v_mfma_f32_16x16x32_bf16 v[8:11], a[100:103], a[4:7], v[8:11]
v_exp_f32 v17, v17
v_mfma_f32_16x16x32_bf16 v[104:107], a[196:199], v[24:27], v[104:107]
v_cvt_pk_bf16_f32 v28, v16, v17
s_waitcnt lgkmcnt(14)
v_mfma_f32_16x16x32_bf16 v[8:11], a[104:107], a[8:11], v[8:11]
v_exp_f32 v18, v18
v_mfma_f32_16x16x32_bf16 v[128:131], a[200:203], v[24:27], v[128:131]
ds_read_b64_tr_b16 a[178:179], v46 offset:4096
s_waitcnt lgkmcnt(14)
v_mfma_f32_16x16x32_bf16 v[8:11], a[108:111], a[12:15], v[8:11]
v_exp_f32 v19, v19
v_mfma_f32_16x16x32_bf16 v[152:155], a[204:207], v[24:27], v[152:155]
v_cvt_pk_bf16_f32 v29, v18, v19
s_waitcnt lgkmcnt(13)
v_mfma_f32_16x16x32_bf16 v[12:15], a[112:115], a[0:3], 0
v_exp_f32 v20, v20
v_mfma_f32_16x16x32_bf16 v[176:179], a[208:211], v[24:27], v[176:179]
ds_read_b64_tr_b16 a[180:181], v47 offset:0
s_waitcnt lgkmcnt(13)
v_mfma_f32_16x16x32_bf16 v[12:15], a[116:119], a[4:7], v[12:15]
v_exp_f32 v21, v21
v_mfma_f32_16x16x32_bf16 v[200:203], a[212:215], v[24:27], v[200:203]
v_cvt_pk_bf16_f32 v30, v20, v21
s_waitcnt lgkmcnt(12)
v_mfma_f32_16x16x32_bf16 v[12:15], a[120:123], a[8:11], v[12:15]
v_exp_f32 v22, v22
v_mfma_f32_16x16x32_bf16 v[224:227], a[216:219], v[24:27], v[224:227]
ds_read_b64_tr_b16 a[182:183], v47 offset:4096
s_waitcnt lgkmcnt(12)
v_mfma_f32_16x16x32_bf16 v[12:15], a[124:127], a[12:15], v[12:15]
v_exp_f32 v23, v23
v_mfma_f32_16x16x32_bf16 v[248:251], a[220:223], v[24:27], v[248:251]
v_cvt_pk_bf16_f32 v31, v22, v23
v_mfma_f32_16x16x32_bf16 a[244:247], a[224:227], v[24:27], a[244:247]
buffer_load_dwordx4 a[252:255], v4, s[20:23], s42 offen offset:1024
v_mfma_f32_16x16x32_bf16 v[16:19], a[96:99], a[16:19], 0
v_exp_f32 v8, v8
v_mfma_f32_16x16x32_bf16 v[84:87], a[192:195], v[28:31], v[84:87]
ds_read_b64_tr_b16 a[184:185], v48 offset:0
v_mfma_f32_16x16x32_bf16 v[16:19], a[100:103], a[20:23], v[16:19]
v_exp_f32 v9, v9
v_mfma_f32_16x16x32_bf16 v[108:111], a[196:199], v[28:31], v[108:111]
v_cvt_pk_bf16_f32 v24, v8, v9
v_mfma_f32_16x16x32_bf16 v[16:19], a[104:107], a[24:27], v[16:19]
v_exp_f32 v10, v10
v_mfma_f32_16x16x32_bf16 v[132:135], a[200:203], v[28:31], v[132:135]
ds_read_b64_tr_b16 a[186:187], v48 offset:4096
v_mfma_f32_16x16x32_bf16 v[16:19], a[108:111], a[28:31], v[16:19]
v_exp_f32 v11, v11
v_mfma_f32_16x16x32_bf16 v[156:159], a[204:207], v[28:31], v[156:159]
v_cvt_pk_bf16_f32 v25, v10, v11
v_mfma_f32_16x16x32_bf16 v[20:23], a[112:115], a[16:19], 0
v_exp_f32 v12, v12
v_mfma_f32_16x16x32_bf16 v[180:183], a[208:211], v[28:31], v[180:183]
ds_read_b64_tr_b16 a[188:189], v49 offset:0
v_mfma_f32_16x16x32_bf16 v[20:23], a[116:119], a[20:23], v[20:23]
v_exp_f32 v13, v13
ds_read_b64_tr_b16 a[190:191], v49 offset:4096
v_mfma_f32_16x16x32_bf16 v[204:207], a[212:215], v[28:31], v[204:207]
v_cvt_pk_bf16_f32 v26, v12, v13
buffer_load_dwordx4 a[252:255], v4, s[20:23], s42 offen offset:2048
v_mfma_f32_16x16x32_bf16 v[20:23], a[120:123], a[24:27], v[20:23]
v_exp_f32 v14, v14
v_mfma_f32_16x16x32_bf16 v[228:231], a[216:219], v[28:31], v[228:231]
v_mfma_f32_16x16x32_bf16 v[20:23], a[124:127], a[28:31], v[20:23]
v_exp_f32 v15, v15
v_mfma_f32_16x16x32_bf16 v[252:255], a[220:223], v[28:31], v[252:255]
v_cvt_pk_bf16_f32 v27, v14, v15
v_mfma_f32_16x16x32_bf16 a[248:251], a[224:227], v[28:31], a[248:251]
buffer_load_dwordx4 a[252:255], v4, s[20:23], s42 offen offset:3072
s_waitcnt vmcnt(8)
s_waitcnt lgkmcnt(0)
s_barrier
v_mfma_f32_16x16x32_bf16 v[8:11], a[96:99], a[32:35], 0
v_exp_f32 v16, v16
v_mfma_f32_16x16x32_bf16 v[64:67], a[160:163], v[24:27], v[64:67]
ds_read_b128 a[128:131], v38 offset:8192
v_mfma_f32_16x16x32_bf16 v[8:11], a[100:103], a[36:39], v[8:11]
v_exp_f32 v17, v17
v_mfma_f32_16x16x32_bf16 v[88:91], a[164:167], v[24:27], v[88:91]
v_cvt_pk_bf16_f32 v28, v16, v17
v_mfma_f32_16x16x32_bf16 v[8:11], a[104:107], a[40:43], v[8:11]
v_exp_f32 v18, v18
v_mfma_f32_16x16x32_bf16 v[112:115], a[168:171], v[24:27], v[112:115]
ds_read_b128 a[132:135], v39 offset:8192
v_mfma_f32_16x16x32_bf16 v[8:11], a[108:111], a[44:47], v[8:11]
v_exp_f32 v19, v19
v_mfma_f32_16x16x32_bf16 v[136:139], a[172:175], v[24:27], v[136:139]
v_cvt_pk_bf16_f32 v29, v18, v19
v_mfma_f32_16x16x32_bf16 v[12:15], a[112:115], a[32:35], 0
v_exp_f32 v20, v20
v_mfma_f32_16x16x32_bf16 v[160:163], a[176:179], v[24:27], v[160:163]
ds_read_b128 a[136:139], v40 offset:8192
v_mfma_f32_16x16x32_bf16 v[12:15], a[116:119], a[36:39], v[12:15]
v_exp_f32 v21, v21
v_mfma_f32_16x16x32_bf16 v[184:187], a[180:183], v[24:27], v[184:187]
v_cvt_pk_bf16_f32 v30, v20, v21
v_mfma_f32_16x16x32_bf16 v[12:15], a[120:123], a[40:43], v[12:15]
v_exp_f32 v22, v22
v_mfma_f32_16x16x32_bf16 v[208:211], a[184:187], v[24:27], v[208:211]
ds_read_b128 a[140:143], v41 offset:8192
v_mfma_f32_16x16x32_bf16 v[12:15], a[124:127], a[44:47], v[12:15]
v_exp_f32 v23, v23
v_mfma_f32_16x16x32_bf16 v[232:235], a[188:191], v[24:27], v[232:235]
v_cvt_pk_bf16_f32 v31, v22, v23
v_mfma_f32_16x16x32_bf16 a[228:231], a[224:227], v[24:27], a[228:231]
v_mfma_f32_16x16x32_bf16 v[16:19], a[96:99], a[48:51], 0
v_exp_f32 v8, v8
v_mfma_f32_16x16x32_bf16 v[68:71], a[160:163], v[28:31], v[68:71]
ds_read_b128 a[144:147], v38 offset:12288
v_mfma_f32_16x16x32_bf16 v[16:19], a[100:103], a[52:55], v[16:19]
v_exp_f32 v9, v9
v_mfma_f32_16x16x32_bf16 v[92:95], a[164:167], v[28:31], v[92:95]
v_cvt_pk_bf16_f32 v24, v8, v9
v_mfma_f32_16x16x32_bf16 v[16:19], a[104:107], a[56:59], v[16:19]
v_exp_f32 v10, v10
v_mfma_f32_16x16x32_bf16 v[116:119], a[168:171], v[28:31], v[116:119]
ds_read_b128 a[148:151], v39 offset:12288
v_mfma_f32_16x16x32_bf16 v[16:19], a[108:111], a[60:63], v[16:19]
v_exp_f32 v11, v11
v_mfma_f32_16x16x32_bf16 v[140:143], a[172:175], v[28:31], v[140:143]
v_cvt_pk_bf16_f32 v25, v10, v11
v_mfma_f32_16x16x32_bf16 v[20:23], a[112:115], a[48:51], 0
v_exp_f32 v12, v12
v_mfma_f32_16x16x32_bf16 v[164:167], a[176:179], v[28:31], v[164:167]
ds_read_b128 a[152:155], v40 offset:12288
v_mfma_f32_16x16x32_bf16 v[20:23], a[116:119], a[52:55], v[20:23]
v_exp_f32 v13, v13
v_mfma_f32_16x16x32_bf16 v[188:191], a[180:183], v[28:31], v[188:191]
v_cvt_pk_bf16_f32 v26, v12, v13
v_mfma_f32_16x16x32_bf16 v[20:23], a[120:123], a[56:59], v[20:23]
v_exp_f32 v14, v14
v_mfma_f32_16x16x32_bf16 v[212:215], a[184:187], v[28:31], v[212:215]
ds_read_b128 a[156:159], v41 offset:12288
v_mfma_f32_16x16x32_bf16 v[20:23], a[124:127], a[60:63], v[20:23]
v_exp_f32 v15, v15
v_mfma_f32_16x16x32_bf16 v[236:239], a[188:191], v[28:31], v[236:239]
v_cvt_pk_bf16_f32 v27, v14, v15
v_mfma_f32_16x16x32_bf16 a[232:235], a[224:227], v[28:31], a[232:235]
v_mfma_f32_16x16x32_bf16 v[8:11], a[96:99], a[64:67], 0
v_exp_f32 v16, v16
v_mfma_f32_16x16x32_bf16 v[72:75], a[160:163], v[24:27], v[72:75]
ds_read_b64_tr_b16 a[192:193], v42 offset:8192
v_mfma_f32_16x16x32_bf16 v[8:11], a[100:103], a[68:71], v[8:11]
v_exp_f32 v17, v17
v_mfma_f32_16x16x32_bf16 v[96:99], a[164:167], v[24:27], v[96:99]
v_cvt_pk_bf16_f32 v28, v16, v17
v_mfma_f32_16x16x32_bf16 v[8:11], a[104:107], a[72:75], v[8:11]
v_exp_f32 v18, v18
v_mfma_f32_16x16x32_bf16 v[120:123], a[168:171], v[24:27], v[120:123]
ds_read_b64_tr_b16 a[194:195], v42 offset:12288
v_mfma_f32_16x16x32_bf16 v[8:11], a[108:111], a[76:79], v[8:11]
v_exp_f32 v19, v19
v_mfma_f32_16x16x32_bf16 v[144:147], a[172:175], v[24:27], v[144:147]
v_cvt_pk_bf16_f32 v29, v18, v19
v_mfma_f32_16x16x32_bf16 v[12:15], a[112:115], a[64:67], 0
v_exp_f32 v20, v20
v_mfma_f32_16x16x32_bf16 v[168:171], a[176:179], v[24:27], v[168:171]
ds_read_b64_tr_b16 a[196:197], v43 offset:8192
v_mfma_f32_16x16x32_bf16 v[12:15], a[116:119], a[68:71], v[12:15]
v_exp_f32 v21, v21
v_mfma_f32_16x16x32_bf16 v[192:195], a[180:183], v[24:27], v[192:195]
v_cvt_pk_bf16_f32 v30, v20, v21
v_mfma_f32_16x16x32_bf16 v[12:15], a[120:123], a[72:75], v[12:15]
v_exp_f32 v22, v22
v_mfma_f32_16x16x32_bf16 v[216:219], a[184:187], v[24:27], v[216:219]
ds_read_b64_tr_b16 a[198:199], v43 offset:12288
v_mfma_f32_16x16x32_bf16 v[12:15], a[124:127], a[76:79], v[12:15]
v_exp_f32 v23, v23
v_mfma_f32_16x16x32_bf16 v[240:243], a[188:191], v[24:27], v[240:243]
v_cvt_pk_bf16_f32 v31, v22, v23
v_mfma_f32_16x16x32_bf16 a[236:239], a[224:227], v[24:27], a[236:239]
v_mfma_f32_16x16x32_bf16 v[16:19], a[96:99], a[80:83], 0
v_exp_f32 v8, v8
v_mfma_f32_16x16x32_bf16 v[76:79], a[160:163], v[28:31], v[76:79]
ds_read_b64_tr_b16 a[200:201], v44 offset:8192
v_mfma_f32_16x16x32_bf16 v[16:19], a[100:103], a[84:87], v[16:19]
v_exp_f32 v9, v9
v_mfma_f32_16x16x32_bf16 v[100:103], a[164:167], v[28:31], v[100:103]
v_cvt_pk_bf16_f32 v24, v8, v9
v_mfma_f32_16x16x32_bf16 v[16:19], a[104:107], a[88:91], v[16:19]
v_exp_f32 v10, v10
v_mfma_f32_16x16x32_bf16 v[124:127], a[168:171], v[28:31], v[124:127]
ds_read_b64_tr_b16 a[202:203], v44 offset:12288
v_mfma_f32_16x16x32_bf16 v[16:19], a[108:111], a[92:95], v[16:19]
v_exp_f32 v11, v11
v_mfma_f32_16x16x32_bf16 v[148:151], a[172:175], v[28:31], v[148:151]
v_cvt_pk_bf16_f32 v25, v10, v11
v_mfma_f32_16x16x32_bf16 v[20:23], a[112:115], a[80:83], 0
v_exp_f32 v12, v12
v_mfma_f32_16x16x32_bf16 v[172:175], a[176:179], v[28:31], v[172:175]
ds_read_b64_tr_b16 a[204:205], v45 offset:8192
v_mfma_f32_16x16x32_bf16 v[20:23], a[116:119], a[84:87], v[20:23]
v_exp_f32 v13, v13
v_mfma_f32_16x16x32_bf16 v[196:199], a[180:183], v[28:31], v[196:199]
v_cvt_pk_bf16_f32 v26, v12, v13
v_mfma_f32_16x16x32_bf16 v[20:23], a[120:123], a[88:91], v[20:23]
v_exp_f32 v14, v14
v_mfma_f32_16x16x32_bf16 v[220:223], a[184:187], v[28:31], v[220:223]
ds_read_b64_tr_b16 a[206:207], v45 offset:12288
v_mfma_f32_16x16x32_bf16 v[20:23], a[124:127], a[92:95], v[20:23]
v_exp_f32 v15, v15
v_mfma_f32_16x16x32_bf16 v[244:247], a[188:191], v[28:31], v[244:247]
v_cvt_pk_bf16_f32 v27, v14, v15
v_mfma_f32_16x16x32_bf16 a[240:243], a[224:227], v[28:31], a[240:243]
s_waitcnt lgkmcnt(15)
v_mfma_f32_16x16x32_bf16 v[8:11], a[128:131], a[0:3], 0
v_exp_f32 v16, v16
v_mfma_f32_16x16x32_bf16 v[80:83], a[160:163], v[24:27], v[80:83]
ds_read_b64_tr_b16 a[208:209], v46 offset:8192
s_waitcnt lgkmcnt(15)
v_mfma_f32_16x16x32_bf16 v[8:11], a[132:135], a[4:7], v[8:11]
v_exp_f32 v17, v17
v_mfma_f32_16x16x32_bf16 v[104:107], a[164:167], v[24:27], v[104:107]
v_cvt_pk_bf16_f32 v28, v16, v17
s_waitcnt lgkmcnt(14)
v_mfma_f32_16x16x32_bf16 v[8:11], a[136:139], a[8:11], v[8:11]
v_exp_f32 v18, v18
v_mfma_f32_16x16x32_bf16 v[128:131], a[168:171], v[24:27], v[128:131]
ds_read_b64_tr_b16 a[210:211], v46 offset:12288
s_waitcnt lgkmcnt(14)
v_mfma_f32_16x16x32_bf16 v[8:11], a[140:143], a[12:15], v[8:11]
v_exp_f32 v19, v19
v_mfma_f32_16x16x32_bf16 v[152:155], a[172:175], v[24:27], v[152:155]
v_cvt_pk_bf16_f32 v29, v18, v19
s_waitcnt lgkmcnt(13)
v_mfma_f32_16x16x32_bf16 v[12:15], a[144:147], a[0:3], 0
v_exp_f32 v20, v20
v_mfma_f32_16x16x32_bf16 v[176:179], a[176:179], v[24:27], v[176:179]
ds_read_b64_tr_b16 a[212:213], v47 offset:8192
s_waitcnt lgkmcnt(13)
v_mfma_f32_16x16x32_bf16 v[12:15], a[148:151], a[4:7], v[12:15]
v_exp_f32 v21, v21
v_mfma_f32_16x16x32_bf16 v[200:203], a[180:183], v[24:27], v[200:203]
v_cvt_pk_bf16_f32 v30, v20, v21
s_waitcnt lgkmcnt(12)
v_mfma_f32_16x16x32_bf16 v[12:15], a[152:155], a[8:11], v[12:15]
v_exp_f32 v22, v22
v_mfma_f32_16x16x32_bf16 v[224:227], a[184:187], v[24:27], v[224:227]
ds_read_b64_tr_b16 a[214:215], v47 offset:12288
s_waitcnt lgkmcnt(12)
v_mfma_f32_16x16x32_bf16 v[12:15], a[156:159], a[12:15], v[12:15]
v_exp_f32 v23, v23
v_mfma_f32_16x16x32_bf16 v[248:251], a[188:191], v[24:27], v[248:251]
v_cvt_pk_bf16_f32 v31, v22, v23
v_mfma_f32_16x16x32_bf16 a[244:247], a[224:227], v[24:27], a[244:247]
v_mfma_f32_16x16x32_bf16 v[16:19], a[128:131], a[16:19], 0
v_exp_f32 v8, v8
v_mfma_f32_16x16x32_bf16 v[84:87], a[160:163], v[28:31], v[84:87]
ds_read_b64_tr_b16 a[216:217], v48 offset:8192
v_mfma_f32_16x16x32_bf16 v[16:19], a[132:135], a[20:23], v[16:19]
v_exp_f32 v9, v9
v_mfma_f32_16x16x32_bf16 v[108:111], a[164:167], v[28:31], v[108:111]
v_cvt_pk_bf16_f32 v24, v8, v9
v_mfma_f32_16x16x32_bf16 v[16:19], a[136:139], a[24:27], v[16:19]
v_exp_f32 v10, v10
v_mfma_f32_16x16x32_bf16 v[132:135], a[168:171], v[28:31], v[132:135]
ds_read_b64_tr_b16 a[218:219], v48 offset:12288
v_mfma_f32_16x16x32_bf16 v[16:19], a[140:143], a[28:31], v[16:19]
v_exp_f32 v11, v11
v_mfma_f32_16x16x32_bf16 v[156:159], a[172:175], v[28:31], v[156:159]
v_cvt_pk_bf16_f32 v25, v10, v11
v_mfma_f32_16x16x32_bf16 v[20:23], a[144:147], a[16:19], 0
v_exp_f32 v12, v12
v_mfma_f32_16x16x32_bf16 v[180:183], a[176:179], v[28:31], v[180:183]
ds_read_b64_tr_b16 a[220:221], v49 offset:8192
v_mfma_f32_16x16x32_bf16 v[20:23], a[148:151], a[20:23], v[20:23]
v_exp_f32 v13, v13
ds_read_b64_tr_b16 a[222:223], v49 offset:12288
v_mfma_f32_16x16x32_bf16 v[204:207], a[180:183], v[28:31], v[204:207]
v_cvt_pk_bf16_f32 v26, v12, v13
v_mfma_f32_16x16x32_bf16 v[20:23], a[152:155], a[24:27], v[20:23]
v_exp_f32 v14, v14
v_mfma_f32_16x16x32_bf16 v[228:231], a[184:187], v[28:31], v[228:231]
v_mfma_f32_16x16x32_bf16 v[20:23], a[156:159], a[28:31], v[20:23]
v_exp_f32 v15, v15
v_mfma_f32_16x16x32_bf16 v[252:255], a[188:191], v[28:31], v[252:255]
v_cvt_pk_bf16_f32 v27, v14, v15
v_mfma_f32_16x16x32_bf16 a[248:251], a[224:227], v[28:31], a[248:251]
s_waitcnt lgkmcnt(0)
s_barrier
v_xor_b32 v38, 65536, v38
v_xor_b32 v39, 65536, v39
v_xor_b32 v40, 65536, v40
v_xor_b32 v41, 65536, v41
v_mfma_f32_16x16x32_bf16 v[8:11], a[128:131], a[32:35], 0
v_exp_f32 v16, v16
v_mfma_f32_16x16x32_bf16 v[64:67], a[192:195], v[24:27], v[64:67]
s_add_u32 s42, s78, 0
s_and_b32 s42, s42, 0x3fffff
v_mfma_f32_16x16x32_bf16 v[8:11], a[132:135], a[36:39], v[8:11]
v_exp_f32 v17, v17
s_add_u32 s42, s42, s36
s_add_u32 s42, s42, 256
s_add_u32 m0, s37, 65536
v_mfma_f32_16x16x32_bf16 v[88:91], a[196:199], v[24:27], v[88:91]
v_cvt_pk_bf16_f32 v28, v16, v17
buffer_load_dwordx4 v60, s[8:11], s42 offen offset:0  lds
v_mfma_f32_16x16x32_bf16 v[8:11], a[136:139], a[40:43], v[8:11]
v_exp_f32 v18, v18
v_mfma_f32_16x16x32_bf16 v[112:115], a[200:203], v[24:27], v[112:115]
v_mfma_f32_16x16x32_bf16 v[8:11], a[140:143], a[44:47], v[8:11]
v_exp_f32 v19, v19
v_mfma_f32_16x16x32_bf16 v[136:139], a[204:207], v[24:27], v[136:139]
v_cvt_pk_bf16_f32 v29, v18, v19
v_xor_b32 v42, 65536, v42
v_mfma_f32_16x16x32_bf16 v[12:15], a[144:147], a[32:35], 0
v_exp_f32 v20, v20
v_mfma_f32_16x16x32_bf16 v[160:163], a[208:211], v[24:27], v[160:163]
buffer_load_dwordx4 v61, s[8:11], s42 offen offset:1024  lds
v_mfma_f32_16x16x32_bf16 v[12:15], a[148:151], a[36:39], v[12:15]
v_exp_f32 v21, v21
v_mfma_f32_16x16x32_bf16 v[184:187], a[212:215], v[24:27], v[184:187]
v_cvt_pk_bf16_f32 v30, v20, v21
v_xor_b32 v43, 65536, v43
v_mfma_f32_16x16x32_bf16 v[12:15], a[152:155], a[40:43], v[12:15]
v_exp_f32 v22, v22
v_mfma_f32_16x16x32_bf16 v[208:211], a[216:219], v[24:27], v[208:211]
v_xor_b32 v44, 65536, v44
v_xor_b32 v45, 65536, v45
v_mfma_f32_16x16x32_bf16 v[12:15], a[156:159], a[44:47], v[12:15]
v_exp_f32 v23, v23
v_mfma_f32_16x16x32_bf16 v[232:235], a[220:223], v[24:27], v[232:235]
v_cvt_pk_bf16_f32 v31, v22, v23
v_mfma_f32_16x16x32_bf16 a[228:231], a[224:227], v[24:27], a[228:231]
buffer_load_dwordx4 v2, s[8:11], s42 offen offset:2048  lds
v_mfma_f32_16x16x32_bf16 v[16:19], a[128:131], a[48:51], 0
v_exp_f32 v8, v8
v_mfma_f32_16x16x32_bf16 v[68:71], a[192:195], v[28:31], v[68:71]
v_xor_b32 v46, 65536, v46
v_xor_b32 v47, 65536, v47
v_mfma_f32_16x16x32_bf16 v[16:19], a[132:135], a[52:55], v[16:19]
v_exp_f32 v9, v9
v_mfma_f32_16x16x32_bf16 v[92:95], a[196:199], v[28:31], v[92:95]
v_cvt_pk_bf16_f32 v24, v8, v9
buffer_load_dwordx4 v3, s[8:11], s42 offen offset:3072  lds
v_mfma_f32_16x16x32_bf16 v[16:19], a[136:139], a[56:59], v[16:19]
v_exp_f32 v10, v10
v_mfma_f32_16x16x32_bf16 v[116:119], a[200:203], v[28:31], v[116:119]
s_add_u32 s42, s79, 0
v_mfma_f32_16x16x32_bf16 v[16:19], a[140:143], a[60:63], v[16:19]
v_exp_f32 v11, v11
v_mfma_f32_16x16x32_bf16 v[140:143], a[204:207], v[28:31], v[140:143]
v_cvt_pk_bf16_f32 v25, v10, v11
s_and_b32 s42, s42, 1023
v_mfma_f32_16x16x32_bf16 v[20:23], a[144:147], a[48:51], 0
v_exp_f32 v12, v12
s_add_u32 s42, s42, s38
s_add_u32 m0, s39, 139264
v_mfma_f32_16x16x32_bf16 v[164:167], a[208:211], v[28:31], v[164:167]
buffer_load_dwordx4 v62, s[4:7], s42 offen offset:0  lds
v_mfma_f32_16x16x32_bf16 v[20:23], a[148:151], a[52:55], v[20:23]
v_exp_f32 v13, v13
v_mfma_f32_16x16x32_bf16 v[188:191], a[212:215], v[28:31], v[188:191]
v_cvt_pk_bf16_f32 v26, v12, v13
v_mfma_f32_16x16x32_bf16 v[20:23], a[152:155], a[56:59], v[20:23]
v_exp_f32 v14, v14
v_mfma_f32_16x16x32_bf16 v[212:215], a[216:219], v[28:31], v[212:215]
v_xor_b32 v48, 65536, v48
v_mfma_f32_16x16x32_bf16 v[20:23], a[156:159], a[60:63], v[20:23]
v_exp_f32 v15, v15
v_mfma_f32_16x16x32_bf16 v[236:239], a[220:223], v[28:31], v[236:239]
v_cvt_pk_bf16_f32 v27, v14, v15
v_xor_b32 v49, 65536, v49
v_mfma_f32_16x16x32_bf16 a[232:235], a[224:227], v[28:31], a[232:235]
buffer_load_dwordx4 v63, s[4:7], s42 offen offset:1024  lds
v_mfma_f32_16x16x32_bf16 v[8:11], a[128:131], a[64:67], 0
v_exp_f32 v16, v16
v_mfma_f32_16x16x32_bf16 v[72:75], a[192:195], v[24:27], v[72:75]
v_mfma_f32_16x16x32_bf16 v[8:11], a[132:135], a[68:71], v[8:11]
v_exp_f32 v17, v17
v_mfma_f32_16x16x32_bf16 v[96:99], a[196:199], v[24:27], v[96:99]
v_cvt_pk_bf16_f32 v28, v16, v17
v_mfma_f32_16x16x32_bf16 v[8:11], a[136:139], a[72:75], v[8:11]
v_exp_f32 v18, v18
v_mfma_f32_16x16x32_bf16 v[120:123], a[200:203], v[24:27], v[120:123]
v_mfma_f32_16x16x32_bf16 v[8:11], a[140:143], a[76:79], v[8:11]
v_exp_f32 v19, v19
v_mfma_f32_16x16x32_bf16 v[144:147], a[204:207], v[24:27], v[144:147]
v_cvt_pk_bf16_f32 v29, v18, v19
v_mfma_f32_16x16x32_bf16 v[12:15], a[144:147], a[64:67], 0
v_exp_f32 v20, v20
v_mfma_f32_16x16x32_bf16 v[168:171], a[208:211], v[24:27], v[168:171]
v_mfma_f32_16x16x32_bf16 v[12:15], a[148:151], a[68:71], v[12:15]
v_exp_f32 v21, v21
v_mfma_f32_16x16x32_bf16 v[192:195], a[212:215], v[24:27], v[192:195]
v_cvt_pk_bf16_f32 v30, v20, v21
buffer_load_dwordx4 v6, s[4:7], s42 offen offset:2048  lds
v_mfma_f32_16x16x32_bf16 v[12:15], a[152:155], a[72:75], v[12:15]
v_exp_f32 v22, v22
v_mfma_f32_16x16x32_bf16 v[216:219], a[216:219], v[24:27], v[216:219]
v_mfma_f32_16x16x32_bf16 v[12:15], a[156:159], a[76:79], v[12:15]
v_exp_f32 v23, v23
v_mfma_f32_16x16x32_bf16 v[240:243], a[220:223], v[24:27], v[240:243]
v_cvt_pk_bf16_f32 v31, v22, v23
v_mfma_f32_16x16x32_bf16 a[236:239], a[224:227], v[24:27], a[236:239]
buffer_load_dwordx4 v7, s[4:7], s42 offen offset:3072  lds
v_mfma_f32_16x16x32_bf16 v[16:19], a[128:131], a[80:83], 0
v_exp_f32 v8, v8
v_mfma_f32_16x16x32_bf16 v[76:79], a[192:195], v[28:31], v[76:79]
s_add_u32 s42, s42, 32768
s_add_u32 m0, s39, 143360
v_mfma_f32_16x16x32_bf16 v[16:19], a[132:135], a[84:87], v[16:19]
v_exp_f32 v9, v9
v_mfma_f32_16x16x32_bf16 v[100:103], a[196:199], v[28:31], v[100:103]
v_cvt_pk_bf16_f32 v24, v8, v9
v_mfma_f32_16x16x32_bf16 v[16:19], a[136:139], a[88:91], v[16:19]
v_exp_f32 v10, v10
v_mfma_f32_16x16x32_bf16 v[124:127], a[200:203], v[28:31], v[124:127]
v_mfma_f32_16x16x32_bf16 v[16:19], a[140:143], a[92:95], v[16:19]
v_exp_f32 v11, v11
v_mfma_f32_16x16x32_bf16 v[148:151], a[204:207], v[28:31], v[148:151]
v_cvt_pk_bf16_f32 v25, v10, v11
v_mfma_f32_16x16x32_bf16 v[20:23], a[144:147], a[80:83], 0
v_exp_f32 v12, v12
v_mfma_f32_16x16x32_bf16 v[172:175], a[208:211], v[28:31], v[172:175]
v_mfma_f32_16x16x32_bf16 v[20:23], a[148:151], a[84:87], v[20:23]
v_exp_f32 v13, v13
v_mfma_f32_16x16x32_bf16 v[196:199], a[212:215], v[28:31], v[196:199]
v_cvt_pk_bf16_f32 v26, v12, v13
buffer_load_dwordx4 v62, s[4:7], s42 offen offset:0  lds
v_mfma_f32_16x16x32_bf16 v[20:23], a[152:155], a[88:91], v[20:23]
v_exp_f32 v14, v14
v_mfma_f32_16x16x32_bf16 v[220:223], a[216:219], v[28:31], v[220:223]
v_mfma_f32_16x16x32_bf16 v[20:23], a[156:159], a[92:95], v[20:23]
v_exp_f32 v15, v15
v_mfma_f32_16x16x32_bf16 v[244:247], a[220:223], v[28:31], v[244:247]
v_cvt_pk_bf16_f32 v27, v14, v15
v_mfma_f32_16x16x32_bf16 a[240:243], a[224:227], v[28:31], a[240:243]
buffer_load_dwordx4 v63, s[4:7], s42 offen offset:1024  lds
v_mfma_f32_16x16x32_bf16 v[80:83], a[192:195], v[24:27], v[80:83]
v_exp_f32 v16, v16
v_mfma_f32_16x16x32_bf16 v[104:107], a[196:199], v[24:27], v[104:107]
v_exp_f32 v17, v17
s_nop 0
v_cvt_pk_bf16_f32 v28, v16, v17
v_mfma_f32_16x16x32_bf16 v[128:131], a[200:203], v[24:27], v[128:131]
v_exp_f32 v18, v18
v_mfma_f32_16x16x32_bf16 v[152:155], a[204:207], v[24:27], v[152:155]
v_exp_f32 v19, v19
s_nop 0
v_cvt_pk_bf16_f32 v29, v18, v19
v_mfma_f32_16x16x32_bf16 v[176:179], a[208:211], v[24:27], v[176:179]
v_exp_f32 v20, v20
s_add_u32 s42, s78, 262144
s_and_b32 s42, s42, 0x3fffff
s_add_u32 s42, s42, s36
s_add_u32 s42, s42, 256
s_add_u32 m0, s37, 81920
v_mfma_f32_16x16x32_bf16 v[200:203], a[212:215], v[24:27], v[200:203]
v_exp_f32 v21, v21
s_nop 0
v_cvt_pk_bf16_f32 v30, v20, v21
buffer_load_dwordx4 v60, s[8:11], s42 offen offset:0  lds
v_mfma_f32_16x16x32_bf16 v[224:227], a[216:219], v[24:27], v[224:227]
v_exp_f32 v22, v22
v_mfma_f32_16x16x32_bf16 v[248:251], a[220:223], v[24:27], v[248:251]
v_exp_f32 v23, v23
s_nop 0
v_cvt_pk_bf16_f32 v31, v22, v23
v_mfma_f32_16x16x32_bf16 a[244:247], a[224:227], v[24:27], a[244:247]
buffer_load_dwordx4 v61, s[8:11], s42 offen offset:1024  lds
v_mfma_f32_16x16x32_bf16 v[84:87], a[192:195], v[28:31], v[84:87]
v_mfma_f32_16x16x32_bf16 v[108:111], a[196:199], v[28:31], v[108:111]
v_mfma_f32_16x16x32_bf16 v[132:135], a[200:203], v[28:31], v[132:135]
v_mfma_f32_16x16x32_bf16 v[156:159], a[204:207], v[28:31], v[156:159]
v_mfma_f32_16x16x32_bf16 v[180:183], a[208:211], v[28:31], v[180:183]
v_mfma_f32_16x16x32_bf16 v[204:207], a[212:215], v[28:31], v[204:207]
buffer_load_dwordx4 v2, s[8:11], s42 offen offset:2048  lds
v_mfma_f32_16x16x32_bf16 v[228:231], a[216:219], v[28:31], v[228:231]
v_mfma_f32_16x16x32_bf16 v[252:255], a[220:223], v[28:31], v[252:255]
v_mfma_f32_16x16x32_bf16 a[248:251], a[224:227], v[28:31], a[248:251]
buffer_load_dwordx4 v3, s[8:11], s42 offen offset:3072  lds
v_accvgpr_read_b32 v8, a228
v_accvgpr_read_b32 v9, a232
v_accvgpr_read_b32 v10, a236
v_accvgpr_read_b32 v11, a240
v_accvgpr_read_b32 v12, a244
s_nop 1
v_accvgpr_read_b32 v13, a248
v_max3_f32 v14, v8, v9, v10
v_min3_f32 v15, v8, v9, v10
v_max3_f32 v14, v14, v11, v12
v_min3_f32 v15, v15, v11, v12
v_max_f32 v14, v14, v13
v_min_f32 v15, v15, v13
v_cmp_nge_f32 vcc, 0x49800000, v14
s_nop 3
s_mov_b64 s[88:89], vcc
v_cmp_nle_f32 vcc, 0x39800000, v15
s_nop 3
s_or_b64 s[88:89], s[88:89], vcc
s_cmp_lg_u64 s[88:89], 0
s_cselect_b32 s88, 1, 0
v_mov_b32 v8, s88
s_lshl_b32 s89, s28, 2
s_add_u32 s89, s89, 131072
v_mov_b32 v9, s89
ds_write_b32 v9, v8
s_waitcnt lgkmcnt(0)
s_barrier
v_mov_b32 v9, 131072
ds_read_b128 v[12:15], v9
s_waitcnt lgkmcnt(0)
v_or_b32 v12, v12, v13
v_or_b32 v14, v14, v15
v_or_b32 v12, v12, v14
s_nop 0
v_readfirstlane_b32 s88, v12
s_nop 3
s_cmp_lg_u32 s88, 0
s_cbranch_scc1 L_FB
L_OE0:
v_accvgpr_read_b32 v32, a228
v_accvgpr_read_b32 v33, a232
v_accvgpr_read_b32 v34, a236
v_accvgpr_read_b32 v35, a240
v_accvgpr_read_b32 v36, a244
v_accvgpr_read_b32 v37, a248
v_rcp_f32 v32, v32
v_rcp_f32 v33, v33
v_rcp_f32 v34, v34
v_rcp_f32 v35, v35
v_rcp_f32 v36, v36
v_rcp_f32 v37, v37
v_pk_mul_f32 v[64:65], v[64:65], v[32:33] op_sel_hi:[1,0]
v_pk_mul_f32 v[66:67], v[66:67], v[32:33] op_sel_hi:[1,0]
v_pk_mul_f32 v[88:89], v[88:89], v[32:33] op_sel_hi:[1,0]
v_pk_mul_f32 v[90:91], v[90:91], v[32:33] op_sel_hi:[1,0]
v_cvt_pk_bf16_f32 v8, v64, v65
v_cvt_pk_bf16_f32 v9, v66, v67
v_cvt_pk_bf16_f32 v10, v88, v89
v_cvt_pk_bf16_f32 v11, v90, v91
v_accvgpr_write_b32 a0, v8
v_accvgpr_write_b32 a1, v9
v_accvgpr_write_b32 a2, v10
v_accvgpr_write_b32 a3, v11
v_pk_mul_f32 v[112:113], v[112:113], v[32:33] op_sel_hi:[1,0]
v_pk_mul_f32 v[114:115], v[114:115], v[32:33] op_sel_hi:[1,0]
v_pk_mul_f32 v[136:137], v[136:137], v[32:33] op_sel_hi:[1,0]
v_pk_mul_f32 v[138:139], v[138:139], v[32:33] op_sel_hi:[1,0]
v_cvt_pk_bf16_f32 v12, v112, v113
v_cvt_pk_bf16_f32 v13, v114, v115
v_cvt_pk_bf16_f32 v14, v136, v137
v_cvt_pk_bf16_f32 v15, v138, v139
v_accvgpr_write_b32 a24, v12
v_accvgpr_write_b32 a25, v13
v_accvgpr_write_b32 a26, v14
v_accvgpr_write_b32 a27, v15
v_pk_mul_f32 v[160:161], v[160:161], v[32:33] op_sel_hi:[1,0]
v_pk_mul_f32 v[162:163], v[162:163], v[32:33] op_sel_hi:[1,0]
v_pk_mul_f32 v[184:185], v[184:185], v[32:33] op_sel_hi:[1,0]
v_pk_mul_f32 v[186:187], v[186:187], v[32:33] op_sel_hi:[1,0]
v_cvt_pk_bf16_f32 v16, v160, v161
v_cvt_pk_bf16_f32 v17, v162, v163
v_cvt_pk_bf16_f32 v18, v184, v185
v_cvt_pk_bf16_f32 v19, v186, v187
v_accvgpr_write_b32 a48, v16
v_accvgpr_write_b32 a49, v17
v_accvgpr_write_b32 a50, v18
v_accvgpr_write_b32 a51, v19
v_pk_mul_f32 v[208:209], v[208:209], v[32:33] op_sel_hi:[1,0]
v_pk_mul_f32 v[210:211], v[210:211], v[32:33] op_sel_hi:[1,0]
v_pk_mul_f32 v[232:233], v[232:233], v[32:33] op_sel_hi:[1,0]
v_pk_mul_f32 v[234:235], v[234:235], v[32:33] op_sel_hi:[1,0]
v_cvt_pk_bf16_f32 v20, v208, v209
v_cvt_pk_bf16_f32 v21, v210, v211
v_cvt_pk_bf16_f32 v22, v232, v233
v_cvt_pk_bf16_f32 v23, v234, v235
v_accvgpr_write_b32 a72, v20
v_accvgpr_write_b32 a73, v21
v_accvgpr_write_b32 a74, v22
v_accvgpr_write_b32 a75, v23
v_pk_mul_f32 v[68:69], v[68:69], v[32:33] op_sel:[0,1] op_sel_hi:[1,1]
v_pk_mul_f32 v[70:71], v[70:71], v[32:33] op_sel:[0,1] op_sel_hi:[1,1]
v_pk_mul_f32 v[92:93], v[92:93], v[32:33] op_sel:[0,1] op_sel_hi:[1,1]
v_pk_mul_f32 v[94:95], v[94:95], v[32:33] op_sel:[0,1] op_sel_hi:[1,1]
v_cvt_pk_bf16_f32 v24, v68, v69
v_cvt_pk_bf16_f32 v25, v70, v71
v_cvt_pk_bf16_f32 v26, v92, v93
v_cvt_pk_bf16_f32 v27, v94, v95
v_accvgpr_write_b32 a4, v24
v_accvgpr_write_b32 a5, v25
v_accvgpr_write_b32 a6, v26
v_accvgpr_write_b32 a7, v27
v_pk_mul_f32 v[116:117], v[116:117], v[32:33] op_sel:[0,1] op_sel_hi:[1,1]
v_pk_mul_f32 v[118:119], v[118:119], v[32:33] op_sel:[0,1] op_sel_hi:[1,1]
v_pk_mul_f32 v[140:141], v[140:141], v[32:33] op_sel:[0,1] op_sel_hi:[1,1]
v_pk_mul_f32 v[142:143], v[142:143], v[32:33] op_sel:[0,1] op_sel_hi:[1,1]
v_cvt_pk_bf16_f32 v28, v116, v117
v_cvt_pk_bf16_f32 v29, v118, v119
v_cvt_pk_bf16_f32 v30, v140, v141
v_cvt_pk_bf16_f32 v31, v142, v143
v_accvgpr_write_b32 a28, v28
v_accvgpr_write_b32 a29, v29
v_accvgpr_write_b32 a30, v30
v_accvgpr_write_b32 a31, v31
v_pk_mul_f32 v[164:165], v[164:165], v[32:33] op_sel:[0,1] op_sel_hi:[1,1]
v_pk_mul_f32 v[166:167], v[166:167], v[32:33] op_sel:[0,1] op_sel_hi:[1,1]
v_pk_mul_f32 v[188:189], v[188:189], v[32:33] op_sel:[0,1] op_sel_hi:[1,1]
v_pk_mul_f32 v[190:191], v[190:191], v[32:33] op_sel:[0,1] op_sel_hi:[1,1]
v_cvt_pk_bf16_f32 v8, v164, v165
v_cvt_pk_bf16_f32 v9, v166, v167
v_cvt_pk_bf16_f32 v10, v188, v189
v_cvt_pk_bf16_f32 v11, v190, v191
v_accvgpr_write_b32 a52, v8
v_accvgpr_write_b32 a53, v9
v_accvgpr_write_b32 a54, v10
v_accvgpr_write_b32 a55, v11
v_pk_mul_f32 v[212:213], v[212:213], v[32:33] op_sel:[0,1] op_sel_hi:[1,1]
v_pk_mul_f32 v[214:215], v[214:215], v[32:33] op_sel:[0,1] op_sel_hi:[1,1]
v_pk_mul_f32 v[236:237], v[236:237], v[32:33] op_sel:[0,1] op_sel_hi:[1,1]
v_pk_mul_f32 v[238:239], v[238:239], v[32:33] op_sel:[0,1] op_sel_hi:[1,1]
v_cvt_pk_bf16_f32 v12, v212, v213
v_cvt_pk_bf16_f32 v13, v214, v215
v_cvt_pk_bf16_f32 v14, v236, v237
v_cvt_pk_bf16_f32 v15, v238, v239
v_accvgpr_write_b32 a76, v12
v_accvgpr_write_b32 a77, v13
v_accvgpr_write_b32 a78, v14
v_accvgpr_write_b32 a79, v15
v_pk_mul_f32 v[72:73], v[72:73], v[34:35] op_sel_hi:[1,0]
v_pk_mul_f32 v[74:75], v[74:75], v[34:35] op_sel_hi:[1,0]
v_pk_mul_f32 v[96:97], v[96:97], v[34:35] op_sel_hi:[1,0]
v_pk_mul_f32 v[98:99], v[98:99], v[34:35] op_sel_hi:[1,0]
v_cvt_pk_bf16_f32 v16, v72, v73
v_cvt_pk_bf16_f32 v17, v74, v75
v_cvt_pk_bf16_f32 v18, v96, v97
v_cvt_pk_bf16_f32 v19, v98, v99
v_accvgpr_write_b32 a8, v16
v_accvgpr_write_b32 a9, v17
v_accvgpr_write_b32 a10, v18
v_accvgpr_write_b32 a11, v19
v_pk_mul_f32 v[120:121], v[120:121], v[34:35] op_sel_hi:[1,0]
v_pk_mul_f32 v[122:123], v[122:123], v[34:35] op_sel_hi:[1,0]
v_pk_mul_f32 v[144:145], v[144:145], v[34:35] op_sel_hi:[1,0]
v_pk_mul_f32 v[146:147], v[146:147], v[34:35] op_sel_hi:[1,0]
v_cvt_pk_bf16_f32 v20, v120, v121
v_cvt_pk_bf16_f32 v21, v122, v123
v_cvt_pk_bf16_f32 v22, v144, v145
v_cvt_pk_bf16_f32 v23, v146, v147
v_accvgpr_write_b32 a32, v20
v_accvgpr_write_b32 a33, v21
v_accvgpr_write_b32 a34, v22
v_accvgpr_write_b32 a35, v23
v_pk_mul_f32 v[168:169], v[168:169], v[34:35] op_sel_hi:[1,0]
v_pk_mul_f32 v[170:171], v[170:171], v[34:35] op_sel_hi:[1,0]
v_pk_mul_f32 v[192:193], v[192:193], v[34:35] op_sel_hi:[1,0]
v_pk_mul_f32 v[194:195], v[194:195], v[34:35] op_sel_hi:[1,0]
v_cvt_pk_bf16_f32 v24, v168, v169
v_cvt_pk_bf16_f32 v25, v170, v171
v_cvt_pk_bf16_f32 v26, v192, v193
v_cvt_pk_bf16_f32 v27, v194, v195
v_accvgpr_write_b32 a56, v24
v_accvgpr_write_b32 a57, v25
v_accvgpr_write_b32 a58, v26
v_accvgpr_write_b32 a59, v27
v_pk_mul_f32 v[216:217], v[216:217], v[34:35] op_sel_hi:[1,0]
v_pk_mul_f32 v[218:219], v[218:219], v[34:35] op_sel_hi:[1,0]
v_pk_mul_f32 v[240:241], v[240:241], v[34:35] op_sel_hi:[1,0]
v_pk_mul_f32 v[242:243], v[242:243], v[34:35] op_sel_hi:[1,0]
v_cvt_pk_bf16_f32 v28, v216, v217
v_cvt_pk_bf16_f32 v29, v218, v219
v_cvt_pk_bf16_f32 v30, v240, v241
v_cvt_pk_bf16_f32 v31, v242, v243
v_accvgpr_write_b32 a80, v28
v_accvgpr_write_b32 a81, v29
v_accvgpr_write_b32 a82, v30
v_accvgpr_write_b32 a83, v31
v_pk_mul_f32 v[76:77], v[76:77], v[34:35] op_sel:[0,1] op_sel_hi:[1,1]
v_pk_mul_f32 v[78:79], v[78:79], v[34:35] op_sel:[0,1] op_sel_hi:[1,1]
v_pk_mul_f32 v[100:101], v[100:101], v[34:35] op_sel:[0,1] op_sel_hi:[1,1]
v_pk_mul_f32 v[102:103], v[102:103], v[34:35] op_sel:[0,1] op_sel_hi:[1,1]
v_cvt_pk_bf16_f32 v8, v76, v77
v_cvt_pk_bf16_f32 v9, v78, v79
v_cvt_pk_bf16_f32 v10, v100, v101
v_cvt_pk_bf16_f32 v11, v102, v103
v_accvgpr_write_b32 a12, v8
v_accvgpr_write_b32 a13, v9
v_accvgpr_write_b32 a14, v10
v_accvgpr_write_b32 a15, v11
v_pk_mul_f32 v[124:125], v[124:125], v[34:35] op_sel:[0,1] op_sel_hi:[1,1]
v_pk_mul_f32 v[126:127], v[126:127], v[34:35] op_sel:[0,1] op_sel_hi:[1,1]
v_pk_mul_f32 v[148:149], v[148:149], v[34:35] op_sel:[0,1] op_sel_hi:[1,1]
v_pk_mul_f32 v[150:151], v[150:151], v[34:35] op_sel:[0,1] op_sel_hi:[1,1]
v_cvt_pk_bf16_f32 v12, v124, v125
v_cvt_pk_bf16_f32 v13, v126, v127
v_cvt_pk_bf16_f32 v14, v148, v149
v_cvt_pk_bf16_f32 v15, v150, v151
v_accvgpr_write_b32 a36, v12
v_accvgpr_write_b32 a37, v13
v_accvgpr_write_b32 a38, v14
v_accvgpr_write_b32 a39, v15
v_pk_mul_f32 v[172:173], v[172:173], v[34:35] op_sel:[0,1] op_sel_hi:[1,1]
v_pk_mul_f32 v[174:175], v[174:175], v[34:35] op_sel:[0,1] op_sel_hi:[1,1]
v_pk_mul_f32 v[196:197], v[196:197], v[34:35] op_sel:[0,1] op_sel_hi:[1,1]
v_pk_mul_f32 v[198:199], v[198:199], v[34:35] op_sel:[0,1] op_sel_hi:[1,1]
v_cvt_pk_bf16_f32 v16, v172, v173
v_cvt_pk_bf16_f32 v17, v174, v175
v_cvt_pk_bf16_f32 v18, v196, v197
v_cvt_pk_bf16_f32 v19, v198, v199
v_accvgpr_write_b32 a60, v16
v_accvgpr_write_b32 a61, v17
v_accvgpr_write_b32 a62, v18
v_accvgpr_write_b32 a63, v19
v_pk_mul_f32 v[220:221], v[220:221], v[34:35] op_sel:[0,1] op_sel_hi:[1,1]
v_pk_mul_f32 v[222:223], v[222:223], v[34:35] op_sel:[0,1] op_sel_hi:[1,1]
v_pk_mul_f32 v[244:245], v[244:245], v[34:35] op_sel:[0,1] op_sel_hi:[1,1]
v_pk_mul_f32 v[246:247], v[246:247], v[34:35] op_sel:[0,1] op_sel_hi:[1,1]
v_cvt_pk_bf16_f32 v20, v220, v221
v_cvt_pk_bf16_f32 v21, v222, v223
v_cvt_pk_bf16_f32 v22, v244, v245
v_cvt_pk_bf16_f32 v23, v246, v247
v_accvgpr_write_b32 a84, v20
v_accvgpr_write_b32 a85, v21
v_accvgpr_write_b32 a86, v22
v_accvgpr_write_b32 a87, v23
v_pk_mul_f32 v[80:81], v[80:81], v[36:37] op_sel_hi:[1,0]
v_pk_mul_f32 v[82:83], v[82:83], v[36:37] op_sel_hi:[1,0]
v_pk_mul_f32 v[104:105], v[104:105], v[36:37] op_sel_hi:[1,0]
v_pk_mul_f32 v[106:107], v[106:107], v[36:37] op_sel_hi:[1,0]
v_cvt_pk_bf16_f32 v24, v80, v81
v_cvt_pk_bf16_f32 v25, v82, v83
v_cvt_pk_bf16_f32 v26, v104, v105
v_cvt_pk_bf16_f32 v27, v106, v107
v_accvgpr_write_b32 a16, v24
v_accvgpr_write_b32 a17, v25
v_accvgpr_write_b32 a18, v26
v_accvgpr_write_b32 a19, v27
v_pk_mul_f32 v[128:129], v[128:129], v[36:37] op_sel_hi:[1,0]
v_pk_mul_f32 v[130:131], v[130:131], v[36:37] op_sel_hi:[1,0]
v_pk_mul_f32 v[152:153], v[152:153], v[36:37] op_sel_hi:[1,0]
v_pk_mul_f32 v[154:155], v[154:155], v[36:37] op_sel_hi:[1,0]
v_cvt_pk_bf16_f32 v28, v128, v129
v_cvt_pk_bf16_f32 v29, v130, v131
v_cvt_pk_bf16_f32 v30, v152, v153
v_cvt_pk_bf16_f32 v31, v154, v155
v_accvgpr_write_b32 a40, v28
v_accvgpr_write_b32 a41, v29
v_accvgpr_write_b32 a42, v30
v_accvgpr_write_b32 a43, v31
v_pk_mul_f32 v[176:177], v[176:177], v[36:37] op_sel_hi:[1,0]
v_pk_mul_f32 v[178:179], v[178:179], v[36:37] op_sel_hi:[1,0]
v_pk_mul_f32 v[200:201], v[200:201], v[36:37] op_sel_hi:[1,0]
v_pk_mul_f32 v[202:203], v[202:203], v[36:37] op_sel_hi:[1,0]
v_cvt_pk_bf16_f32 v8, v176, v177
v_cvt_pk_bf16_f32 v9, v178, v179
v_cvt_pk_bf16_f32 v10, v200, v201
v_cvt_pk_bf16_f32 v11, v202, v203
v_accvgpr_write_b32 a64, v8
v_accvgpr_write_b32 a65, v9
v_accvgpr_write_b32 a66, v10
v_accvgpr_write_b32 a67, v11
v_pk_mul_f32 v[224:225], v[224:225], v[36:37] op_sel_hi:[1,0]
v_pk_mul_f32 v[226:227], v[226:227], v[36:37] op_sel_hi:[1,0]
v_pk_mul_f32 v[248:249], v[248:249], v[36:37] op_sel_hi:[1,0]
v_pk_mul_f32 v[250:251], v[250:251], v[36:37] op_sel_hi:[1,0]
v_cvt_pk_bf16_f32 v12, v224, v225
v_cvt_pk_bf16_f32 v13, v226, v227
v_cvt_pk_bf16_f32 v14, v248, v249
v_cvt_pk_bf16_f32 v15, v250, v251
v_accvgpr_write_b32 a88, v12
v_accvgpr_write_b32 a89, v13
v_accvgpr_write_b32 a90, v14
v_accvgpr_write_b32 a91, v15
v_pk_mul_f32 v[84:85], v[84:85], v[36:37] op_sel:[0,1] op_sel_hi:[1,1]
v_pk_mul_f32 v[86:87], v[86:87], v[36:37] op_sel:[0,1] op_sel_hi:[1,1]
v_pk_mul_f32 v[108:109], v[108:109], v[36:37] op_sel:[0,1] op_sel_hi:[1,1]
v_pk_mul_f32 v[110:111], v[110:111], v[36:37] op_sel:[0,1] op_sel_hi:[1,1]
v_cvt_pk_bf16_f32 v16, v84, v85
v_cvt_pk_bf16_f32 v17, v86, v87
v_cvt_pk_bf16_f32 v18, v108, v109
v_cvt_pk_bf16_f32 v19, v110, v111
v_accvgpr_write_b32 a20, v16
v_accvgpr_write_b32 a21, v17
v_accvgpr_write_b32 a22, v18
v_accvgpr_write_b32 a23, v19
v_pk_mul_f32 v[132:133], v[132:133], v[36:37] op_sel:[0,1] op_sel_hi:[1,1]
v_pk_mul_f32 v[134:135], v[134:135], v[36:37] op_sel:[0,1] op_sel_hi:[1,1]
v_pk_mul_f32 v[156:157], v[156:157], v[36:37] op_sel:[0,1] op_sel_hi:[1,1]
v_pk_mul_f32 v[158:159], v[158:159], v[36:37] op_sel:[0,1] op_sel_hi:[1,1]
v_cvt_pk_bf16_f32 v20, v132, v133
v_cvt_pk_bf16_f32 v21, v134, v135
v_cvt_pk_bf16_f32 v22, v156, v157
v_cvt_pk_bf16_f32 v23, v158, v159
v_accvgpr_write_b32 a44, v20
v_accvgpr_write_b32 a45, v21
v_accvgpr_write_b32 a46, v22
v_accvgpr_write_b32 a47, v23
v_pk_mul_f32 v[180:181], v[180:181], v[36:37] op_sel:[0,1] op_sel_hi:[1,1]
v_pk_mul_f32 v[182:183], v[182:183], v[36:37] op_sel:[0,1] op_sel_hi:[1,1]
v_pk_mul_f32 v[204:205], v[204:205], v[36:37] op_sel:[0,1] op_sel_hi:[1,1]
v_pk_mul_f32 v[206:207], v[206:207], v[36:37] op_sel:[0,1] op_sel_hi:[1,1]
v_cvt_pk_bf16_f32 v24, v180, v181
v_cvt_pk_bf16_f32 v25, v182, v183
v_cvt_pk_bf16_f32 v26, v204, v205
v_cvt_pk_bf16_f32 v27, v206, v207
v_accvgpr_write_b32 a68, v24
v_accvgpr_write_b32 a69, v25
v_accvgpr_write_b32 a70, v26
v_accvgpr_write_b32 a71, v27
v_pk_mul_f32 v[228:229], v[228:229], v[36:37] op_sel:[0,1] op_sel_hi:[1,1]
v_pk_mul_f32 v[230:231], v[230:231], v[36:37] op_sel:[0,1] op_sel_hi:[1,1]
v_pk_mul_f32 v[252:253], v[252:253], v[36:37] op_sel:[0,1] op_sel_hi:[1,1]
v_pk_mul_f32 v[254:255], v[254:255], v[36:37] op_sel:[0,1] op_sel_hi:[1,1]
v_cvt_pk_bf16_f32 v28, v228, v229
v_cvt_pk_bf16_f32 v29, v230, v231
v_cvt_pk_bf16_f32 v30, v252, v253
v_cvt_pk_bf16_f32 v31, v254, v255
v_accvgpr_write_b32 a92, v28
v_accvgpr_write_b32 a93, v29
v_accvgpr_write_b32 a94, v30
v_accvgpr_write_b32 a95, v31
s_add_u32 s36, s36, 256
s_add_u32 s40, s40, 24576
s_mov_b32 s46, 1
s_mov_b32 s18, 50331648
s_branch L_A
L_B1:
s_waitcnt lgkmcnt(4)
v_mfma_f32_16x16x32_bf16 v[64:67], a[96:99], a[128:131], v[64:67]
s_add_u32 s42, s79, 896
s_and_b32 s42, s42, 1023
s_add_u32 s42, s42, s38
s_add_u32 m0, s39, 114688
s_nop 0
buffer_load_dwordx4 v7, s[4:7], s42 offen offset:3072  lds
v_mfma_f32_16x16x32_bf16 v[68:71], a[96:99], a[132:135], v[68:71]
v_mfma_f32_16x16x32_bf16 v[72:75], a[96:99], a[136:139], v[72:75]
v_mfma_f32_16x16x32_bf16 v[76:79], a[96:99], a[140:143], v[76:79]
s_add_u32 s42, s42, 32768
s_add_u32 m0, s39, 118784
s_nop 0
buffer_load_dwordx4 v62, s[4:7], s42 offen offset:0  lds
v_mfma_f32_16x16x32_bf16 v[80:83], a[96:99], a[144:147], v[80:83]
v_mfma_f32_16x16x32_bf16 v[84:87], a[96:99], a[148:151], v[84:87]
v_mfma_f32_16x16x32_bf16 v[88:91], a[100:103], a[128:131], v[88:91]
buffer_load_dwordx4 v63, s[4:7], s42 offen offset:1024  lds
v_mfma_f32_16x16x32_bf16 v[92:95], a[100:103], a[132:135], v[92:95]
v_mfma_f32_16x16x32_bf16 v[96:99], a[100:103], a[136:139], v[96:99]
v_mfma_f32_16x16x32_bf16 v[100:103], a[100:103], a[140:143], v[100:103]
v_mfma_f32_16x16x32_bf16 v[104:107], a[100:103], a[144:147], v[104:107]
s_waitcnt vmcnt(18)
v_mfma_f32_16x16x32_bf16 v[108:111], a[100:103], a[148:151], v[108:111]
s_waitcnt lgkmcnt(0)
s_barrier
v_mfma_f32_16x16x32_bf16 v[112:115], a[104:107], a[128:131], v[112:115]
ds_read_b64_tr_b16 a[96:97], v54 offset:16384
v_mfma_f32_16x16x32_bf16 v[116:119], a[104:107], a[132:135], v[116:119]
s_add_u32 s42, s78, 3932160
s_and_b32 s42, s42, 0x3fffff
s_add_u32 s42, s42, s36
s_add_u32 m0, s37, 65536
s_nop 0
buffer_load_dwordx4 v60, s[8:11], s42 offen offset:0  lds
v_mfma_f32_16x16x32_bf16 v[120:123], a[104:107], a[136:139], v[120:123]
v_mfma_f32_16x16x32_bf16 v[124:127], a[104:107], a[140:143], v[124:127]
ds_read_b64_tr_b16 a[98:99], v54 offset:18432
v_mfma_f32_16x16x32_bf16 v[128:131], a[104:107], a[144:147], v[128:131]
ds_read_b64_tr_b16 a[100:101], v54 offset:16392
v_mfma_f32_16x16x32_bf16 v[132:135], a[104:107], a[148:151], v[132:135]
ds_read_b64_tr_b16 a[102:103], v54 offset:18440
v_mfma_f32_16x16x32_bf16 v[136:139], a[108:111], a[128:131], v[136:139]
buffer_load_dwordx4 v61, s[8:11], s42 offen offset:1024  lds
v_mfma_f32_16x16x32_bf16 v[140:143], a[108:111], a[132:135], v[140:143]
ds_read_b64_tr_b16 a[104:105], v55 offset:16384
v_mfma_f32_16x16x32_bf16 v[144:147], a[108:111], a[136:139], v[144:147]
ds_read_b64_tr_b16 a[106:107], v55 offset:18432
v_mfma_f32_16x16x32_bf16 v[148:151], a[108:111], a[140:143], v[148:151]
ds_read_b128 a[152:155], v59 offset:24576
v_mfma_f32_16x16x32_bf16 v[152:155], a[108:111], a[144:147], v[152:155]
ds_read_b128 a[156:159], v59 offset:26624
v_mfma_f32_16x16x32_bf16 v[156:159], a[108:111], a[148:151], v[156:159]
buffer_load_dwordx4 v2, s[8:11], s42 offen offset:2048  lds
v_mfma_f32_16x16x32_bf16 v[160:163], a[112:115], a[128:131], v[160:163]
ds_read_b64_tr_b16 a[108:109], v55 offset:16392
v_mfma_f32_16x16x32_bf16 v[164:167], a[112:115], a[132:135], v[164:167]
ds_read_b64_tr_b16 a[110:111], v55 offset:18440
v_mfma_f32_16x16x32_bf16 v[168:171], a[112:115], a[136:139], v[168:171]
ds_read_b128 a[160:163], v59 offset:28672
v_mfma_f32_16x16x32_bf16 v[172:175], a[112:115], a[140:143], v[172:175]
ds_read_b128 a[164:167], v59 offset:30720
v_mfma_f32_16x16x32_bf16 v[176:179], a[112:115], a[144:147], v[176:179]
buffer_load_dwordx4 v3, s[8:11], s42 offen offset:3072  lds
v_mfma_f32_16x16x32_bf16 v[180:183], a[112:115], a[148:151], v[180:183]
ds_read_b64_tr_b16 a[112:113], v56 offset:16384
v_mfma_f32_16x16x32_bf16 v[184:187], a[116:119], a[128:131], v[184:187]
ds_read_b64_tr_b16 a[114:115], v56 offset:18432
v_mfma_f32_16x16x32_bf16 v[188:191], a[116:119], a[132:135], v[188:191]
ds_read_b128 a[168:171], v59 offset:32768
v_mfma_f32_16x16x32_bf16 v[192:195], a[116:119], a[136:139], v[192:195]
ds_read_b128 a[172:175], v59 offset:34816
v_mfma_f32_16x16x32_bf16 v[196:199], a[116:119], a[140:143], v[196:199]
v_mfma_f32_16x16x32_bf16 v[200:203], a[116:119], a[144:147], v[200:203]
s_add_u32 s74, s34, s84
s_add_u32 s84, s84, 8192
s_add_u32 m0, s35, 8192
s_nop 0
buffer_load_dwordx4 v50, s[12:15], s74 offen offset:0 nt lds
v_mfma_f32_16x16x32_bf16 v[204:207], a[116:119], a[148:151], v[204:207]
v_mfma_f32_16x16x32_bf16 v[208:211], a[120:123], a[128:131], v[208:211]
ds_read_b64_tr_b16 a[116:117], v56 offset:16392
v_mfma_f32_16x16x32_bf16 v[212:215], a[120:123], a[132:135], v[212:215]
buffer_load_dwordx4 v51, s[12:15], s74 offen offset:1024 nt lds
v_mfma_f32_16x16x32_bf16 v[216:219], a[120:123], a[136:139], v[216:219]
ds_read_b64_tr_b16 a[118:119], v56 offset:18440
v_mfma_f32_16x16x32_bf16 v[220:223], a[120:123], a[140:143], v[220:223]
v_mfma_f32_16x16x32_bf16 v[224:227], a[120:123], a[144:147], v[224:227]
v_mfma_f32_16x16x32_bf16 v[228:231], a[120:123], a[148:151], v[228:231]
buffer_load_dwordx4 v52, s[12:15], s74 offen offset:2048 nt lds
v_mfma_f32_16x16x32_bf16 v[232:235], a[124:127], a[128:131], v[232:235]
ds_read_b64_tr_b16 a[120:121], v57 offset:16384
v_mfma_f32_16x16x32_bf16 v[236:239], a[124:127], a[132:135], v[236:239]
ds_read_b64_tr_b16 a[122:123], v57 offset:18432
v_mfma_f32_16x16x32_bf16 v[240:243], a[124:127], a[136:139], v[240:243]
buffer_load_dwordx4 v53, s[12:15], s74 offen offset:3072 nt lds
v_mfma_f32_16x16x32_bf16 v[244:247], a[124:127], a[140:143], v[244:247]
v_mfma_f32_16x16x32_bf16 v[248:251], a[124:127], a[144:147], v[248:251]
v_mfma_f32_16x16x32_bf16 v[252:255], a[124:127], a[148:151], v[252:255]
ds_read_b64_tr_b16 a[124:125], v57 offset:16392
ds_read_b64_tr_b16 a[126:127], v57 offset:18440
s_waitcnt lgkmcnt(4)
v_mfma_f32_16x16x32_bf16 v[64:67], a[96:99], a[152:155], v[64:67]
v_mfma_f32_16x16x32_bf16 v[68:71], a[96:99], a[156:159], v[68:71]
v_mfma_f32_16x16x32_bf16 v[72:75], a[96:99], a[160:163], v[72:75]
v_mfma_f32_16x16x32_bf16 v[76:79], a[96:99], a[164:167], v[76:79]
v_mfma_f32_16x16x32_bf16 v[80:83], a[96:99], a[168:171], v[80:83]
v_mfma_f32_16x16x32_bf16 v[84:87], a[96:99], a[172:175], v[84:87]
v_mfma_f32_16x16x32_bf16 v[88:91], a[100:103], a[152:155], v[88:91]
v_mfma_f32_16x16x32_bf16 v[92:95], a[100:103], a[156:159], v[92:95]
v_mfma_f32_16x16x32_bf16 v[96:99], a[100:103], a[160:163], v[96:99]
v_mfma_f32_16x16x32_bf16 v[100:103], a[100:103], a[164:167], v[100:103]
v_mfma_f32_16x16x32_bf16 v[104:107], a[100:103], a[168:171], v[104:107]
s_waitcnt vmcnt(18)
s_waitcnt vmcnt(8)
v_mfma_f32_16x16x32_bf16 v[108:111], a[100:103], a[172:175], v[108:111]
s_waitcnt lgkmcnt(0)
s_barrier
v_mfma_f32_16x16x32_bf16 v[112:115], a[104:107], a[152:155], v[112:115]
ds_read_b64_tr_b16 a[96:97], v54 offset:32768
v_mfma_f32_16x16x32_bf16 v[116:119], a[104:107], a[156:159], v[116:119]
s_add_u32 s41, s74, 4096
s_add_u32 m0, s35, 12288
s_nop 0
buffer_load_dwordx4 v50, s[12:15], s41 offen offset:0 nt lds
v_mfma_f32_16x16x32_bf16 v[120:123], a[104:107], a[160:163], v[120:123]
v_mfma_f32_16x16x32_bf16 v[124:127], a[104:107], a[164:167], v[124:127]
ds_read_b64_tr_b16 a[98:99], v54 offset:34816
v_mfma_f32_16x16x32_bf16 v[128:131], a[104:107], a[168:171], v[128:131]
ds_read_b64_tr_b16 a[100:101], v54 offset:32776
v_mfma_f32_16x16x32_bf16 v[132:135], a[104:107], a[172:175], v[132:135]
ds_read_b64_tr_b16 a[102:103], v54 offset:34824
v_mfma_f32_16x16x32_bf16 v[136:139], a[108:111], a[152:155], v[136:139]
ds_read_b64_tr_b16 a[104:105], v55 offset:32768
v_mfma_f32_16x16x32_bf16 v[140:143], a[108:111], a[156:159], v[140:143]
ds_read_b64_tr_b16 a[106:107], v55 offset:34816
v_mfma_f32_16x16x32_bf16 v[144:147], a[108:111], a[160:163], v[144:147]
ds_read_b128 a[128:131], v58 offset:0
v_mfma_f32_16x16x32_bf16 v[148:151], a[108:111], a[164:167], v[148:151]
buffer_load_dwordx4 v51, s[12:15], s41 offen offset:1024 nt lds
v_mfma_f32_16x16x32_bf16 v[152:155], a[108:111], a[168:171], v[152:155]
ds_read_b128 a[132:135], v58 offset:2048
v_mfma_f32_16x16x32_bf16 v[156:159], a[108:111], a[172:175], v[156:159]
ds_read_b64_tr_b16 a[108:109], v55 offset:32776
v_mfma_f32_16x16x32_bf16 v[160:163], a[112:115], a[152:155], v[160:163]
ds_read_b64_tr_b16 a[110:111], v55 offset:34824
v_mfma_f32_16x16x32_bf16 v[164:167], a[112:115], a[156:159], v[164:167]
ds_read_b128 a[136:139], v58 offset:4096
v_mfma_f32_16x16x32_bf16 v[168:171], a[112:115], a[160:163], v[168:171]
ds_read_b128 a[140:143], v58 offset:6144
v_mfma_f32_16x16x32_bf16 v[172:175], a[112:115], a[164:167], v[172:175]
ds_read_b128 a[144:147], v58 offset:8192
v_mfma_f32_16x16x32_bf16 v[176:179], a[112:115], a[168:171], v[176:179]
ds_read_b128 a[148:151], v58 offset:10240
v_mfma_f32_16x16x32_bf16 v[180:183], a[112:115], a[172:175], v[180:183]
ds_read_b64_tr_b16 a[112:113], v56 offset:32768
v_mfma_f32_16x16x32_bf16 v[184:187], a[116:119], a[152:155], v[184:187]
buffer_load_dwordx4 v52, s[12:15], s41 offen offset:2048 nt lds
v_mfma_f32_16x16x32_bf16 v[188:191], a[116:119], a[156:159], v[188:191]
ds_read_b64_tr_b16 a[114:115], v56 offset:34816
v_mfma_f32_16x16x32_bf16 v[192:195], a[116:119], a[160:163], v[192:195]
v_mfma_f32_16x16x32_bf16 v[196:199], a[116:119], a[164:167], v[196:199]
v_mfma_f32_16x16x32_bf16 v[200:203], a[116:119], a[168:171], v[200:203]
v_mfma_f32_16x16x32_bf16 v[204:207], a[116:119], a[172:175], v[204:207]
ds_read_b64_tr_b16 a[116:117], v56 offset:32776
v_mfma_f32_16x16x32_bf16 v[208:211], a[120:123], a[152:155], v[208:211]
ds_read_b64_tr_b16 a[118:119], v56 offset:34824
v_mfma_f32_16x16x32_bf16 v[212:215], a[120:123], a[156:159], v[212:215]
v_mfma_f32_16x16x32_bf16 v[216:219], a[120:123], a[160:163], v[216:219]
v_mfma_f32_16x16x32_bf16 v[220:223], a[120:123], a[164:167], v[220:223]
buffer_load_dwordx4 v53, s[12:15], s41 offen offset:3072 nt lds
v_mfma_f32_16x16x32_bf16 v[224:227], a[120:123], a[168:171], v[224:227]
v_mfma_f32_16x16x32_bf16 v[228:231], a[120:123], a[172:175], v[228:231]
ds_read_b64_tr_b16 a[120:121], v57 offset:32768
v_mfma_f32_16x16x32_bf16 v[232:235], a[124:127], a[152:155], v[232:235]
ds_read_b64_tr_b16 a[122:123], v57 offset:34816
v_mfma_f32_16x16x32_bf16 v[236:239], a[124:127], a[156:159], v[236:239]
v_mfma_f32_16x16x32_bf16 v[240:243], a[124:127], a[160:163], v[240:243]
v_mfma_f32_16x16x32_bf16 v[244:247], a[124:127], a[164:167], v[244:247]
v_mfma_f32_16x16x32_bf16 v[248:251], a[124:127], a[168:171], v[248:251]
v_mfma_f32_16x16x32_bf16 v[252:255], a[124:127], a[172:175], v[252:255]
ds_read_b64_tr_b16 a[124:125], v57 offset:32776
ds_read_b64_tr_b16 a[126:127], v57 offset:34824
s_waitcnt lgkmcnt(4)
v_mfma_f32_16x16x32_bf16 v[64:67], a[96:99], a[128:131], v[64:67]
v_mfma_f32_16x16x32_bf16 v[68:71], a[96:99], a[132:135], v[68:71]
v_mfma_f32_16x16x32_bf16 v[72:75], a[96:99], a[136:139], v[72:75]
v_mfma_f32_16x16x32_bf16 v[76:79], a[96:99], a[140:143], v[76:79]
v_mfma_f32_16x16x32_bf16 v[80:83], a[96:99], a[144:147], v[80:83]
v_mfma_f32_16x16x32_bf16 v[84:87], a[96:99], a[148:151], v[84:87]
v_mfma_f32_16x16x32_bf16 v[88:91], a[100:103], a[128:131], v[88:91]
v_mfma_f32_16x16x32_bf16 v[92:95], a[100:103], a[132:135], v[92:95]
v_mfma_f32_16x16x32_bf16 v[96:99], a[100:103], a[136:139], v[96:99]
v_mfma_f32_16x16x32_bf16 v[100:103], a[100:103], a[140:143], v[100:103]
v_mfma_f32_16x16x32_bf16 v[104:107], a[100:103], a[144:147], v[104:107]
s_waitcnt vmcnt(8)
v_mfma_f32_16x16x32_bf16 v[108:111], a[100:103], a[148:151], v[108:111]
s_waitcnt lgkmcnt(0)
s_barrier
v_mfma_f32_16x16x32_bf16 v[112:115], a[104:107], a[128:131], v[112:115]
ds_read_b64_tr_b16 a[96:97], v54 offset:0
v_mfma_f32_16x16x32_bf16 v[116:119], a[104:107], a[132:135], v[116:119]
ds_read_b64_tr_b16 a[98:99], v54 offset:2048
v_mfma_f32_16x16x32_bf16 v[120:123], a[104:107], a[136:139], v[120:123]
ds_read_b64_tr_b16 a[100:101], v54 offset:8
v_mfma_f32_16x16x32_bf16 v[124:127], a[104:107], a[140:143], v[124:127]
ds_read_b64_tr_b16 a[102:103], v54 offset:2056
v_mfma_f32_16x16x32_bf16 v[128:131], a[104:107], a[144:147], v[128:131]
ds_read_b128 a[152:155], v59 offset:0
v_mfma_f32_16x16x32_bf16 v[132:135], a[104:107], a[148:151], v[132:135]
ds_read_b64_tr_b16 a[104:105], v55 offset:0
v_mfma_f32_16x16x32_bf16 v[136:139], a[108:111], a[128:131], v[136:139]
ds_read_b64_tr_b16 a[106:107], v55 offset:2048
v_mfma_f32_16x16x32_bf16 v[140:143], a[108:111], a[132:135], v[140:143]
ds_read_b128 a[156:159], v59 offset:2048
v_mfma_f32_16x16x32_bf16 v[144:147], a[108:111], a[136:139], v[144:147]
ds_read_b128 a[160:163], v59 offset:4096
v_mfma_f32_16x16x32_bf16 v[148:151], a[108:111], a[140:143], v[148:151]
ds_read_b128 a[164:167], v59 offset:6144
v_mfma_f32_16x16x32_bf16 v[152:155], a[108:111], a[144:147], v[152:155]
ds_read_b128 a[168:171], v59 offset:8192
v_mfma_f32_16x16x32_bf16 v[156:159], a[108:111], a[148:151], v[156:159]
ds_read_b64_tr_b16 a[108:109], v55 offset:8
v_mfma_f32_16x16x32_bf16 v[160:163], a[112:115], a[128:131], v[160:163]
ds_read_b64_tr_b16 a[110:111], v55 offset:2056
v_mfma_f32_16x16x32_bf16 v[164:167], a[112:115], a[132:135], v[164:167]
ds_read_b128 a[172:175], v59 offset:10240
v_mfma_f32_16x16x32_bf16 v[168:171], a[112:115], a[136:139], v[168:171]
v_mfma_f32_16x16x32_bf16 v[172:175], a[112:115], a[140:143], v[172:175]
v_mfma_f32_16x16x32_bf16 v[176:179], a[112:115], a[144:147], v[176:179]
v_mfma_f32_16x16x32_bf16 v[180:183], a[112:115], a[148:151], v[180:183]
ds_read_b64_tr_b16 a[112:113], v56 offset:0
v_mfma_f32_16x16x32_bf16 v[184:187], a[116:119], a[128:131], v[184:187]
ds_read_b64_tr_b16 a[114:115], v56 offset:2048
v_mfma_f32_16x16x32_bf16 v[188:191], a[116:119], a[132:135], v[188:191]
v_mfma_f32_16x16x32_bf16 v[192:195], a[116:119], a[136:139], v[192:195]
v_mfma_f32_16x16x32_bf16 v[196:199], a[116:119], a[140:143], v[196:199]
v_mfma_f32_16x16x32_bf16 v[200:203], a[116:119], a[144:147], v[200:203]
v_mfma_f32_16x16x32_bf16 v[204:207], a[116:119], a[148:151], v[204:207]
ds_read_b64_tr_b16 a[116:117], v56 offset:8
v_mfma_f32_16x16x32_bf16 v[208:211], a[120:123], a[128:131], v[208:211]
ds_read_b64_tr_b16 a[118:119], v56 offset:2056
v_mfma_f32_16x16x32_bf16 v[212:215], a[120:123], a[132:135], v[212:215]
v_mfma_f32_16x16x32_bf16 v[216:219], a[120:123], a[136:139], v[216:219]
v_mfma_f32_16x16x32_bf16 v[220:223], a[120:123], a[140:143], v[220:223]
v_mfma_f32_16x16x32_bf16 v[224:227], a[120:123], a[144:147], v[224:227]
v_mfma_f32_16x16x32_bf16 v[228:231], a[120:123], a[148:151], v[228:231]
ds_read_b64_tr_b16 a[120:121], v57 offset:0
v_mfma_f32_16x16x32_bf16 v[232:235], a[124:127], a[128:131], v[232:235]
ds_read_b64_tr_b16 a[122:123], v57 offset:2048
v_mfma_f32_16x16x32_bf16 v[236:239], a[124:127], a[132:135], v[236:239]
v_mfma_f32_16x16x32_bf16 v[240:243], a[124:127], a[136:139], v[240:243]
v_mfma_f32_16x16x32_bf16 v[244:247], a[124:127], a[140:143], v[244:247]
v_mfma_f32_16x16x32_bf16 v[248:251], a[124:127], a[144:147], v[248:251]
v_mfma_f32_16x16x32_bf16 v[252:255], a[124:127], a[148:151], v[252:255]
ds_read_b64_tr_b16 a[124:125], v57 offset:8
ds_read_b64_tr_b16 a[126:127], v57 offset:2056
s_waitcnt lgkmcnt(4)
v_mfma_f32_16x16x32_bf16 v[64:67], a[96:99], a[152:155], v[64:67]
v_mfma_f32_16x16x32_bf16 v[68:71], a[96:99], a[156:159], v[68:71]
v_mfma_f32_16x16x32_bf16 v[72:75], a[96:99], a[160:163], v[72:75]
v_mfma_f32_16x16x32_bf16 v[76:79], a[96:99], a[164:167], v[76:79]
v_mfma_f32_16x16x32_bf16 v[80:83], a[96:99], a[168:171], v[80:83]
v_mfma_f32_16x16x32_bf16 v[84:87], a[96:99], a[172:175], v[84:87]
v_mfma_f32_16x16x32_bf16 v[88:91], a[100:103], a[152:155], v[88:91]
v_mfma_f32_16x16x32_bf16 v[92:95], a[100:103], a[156:159], v[92:95]
v_mfma_f32_16x16x32_bf16 v[96:99], a[100:103], a[160:163], v[96:99]
v_mfma_f32_16x16x32_bf16 v[100:103], a[100:103], a[164:167], v[100:103]
v_mfma_f32_16x16x32_bf16 v[104:107], a[100:103], a[168:171], v[104:107]
s_waitcnt vmcnt(8)
v_mfma_f32_16x16x32_bf16 v[108:111], a[100:103], a[172:175], v[108:111]
s_waitcnt lgkmcnt(0)
s_barrier
v_mfma_f32_16x16x32_bf16 v[112:115], a[104:107], a[152:155], v[112:115]
s_add_u32 s74, s34, s84
s_add_u32 s84, s84, 8192
s_add_u32 m0, s35, 65536
s_nop 0
buffer_load_dwordx4 v50, s[12:15], s74 offen offset:0 nt lds
v_mfma_f32_16x16x32_bf16 v[116:119], a[104:107], a[156:159], v[116:119]
v_mfma_f32_16x16x32_bf16 v[120:123], a[104:107], a[160:163], v[120:123]
s_cmp_lg_u32 s28, 0
s_cbranch_scc1 L_sig1
v_mov_b32 v35, 1
v_mov_b32 v36, s97
s_mov_b64 exec, 1
buffer_atomic_add v35, v36, s[92:95], 0 offen sc1
s_mov_b64 exec, -1
L_sig1:
v_mfma_f32_16x16x32_bf16 v[124:127], a[104:107], a[164:167], v[124:127]
v_mfma_f32_16x16x32_bf16 v[128:131], a[104:107], a[168:171], v[128:131]
v_mfma_f32_16x16x32_bf16 v[132:135], a[104:107], a[172:175], v[132:135]
v_mfma_f32_16x16x32_bf16 v[136:139], a[108:111], a[152:155], v[136:139]
v_mfma_f32_16x16x32_bf16 v[140:143], a[108:111], a[156:159], v[140:143]
v_mfma_f32_16x16x32_bf16 v[144:147], a[108:111], a[160:163], v[144:147]
v_mfma_f32_16x16x32_bf16 v[148:151], a[108:111], a[164:167], v[148:151]
buffer_load_dwordx4 v51, s[12:15], s74 offen offset:1024 nt lds
v_mfma_f32_16x16x32_bf16 v[152:155], a[108:111], a[168:171], v[152:155]
v_mfma_f32_16x16x32_bf16 v[156:159], a[108:111], a[172:175], v[156:159]
v_mfma_f32_16x16x32_bf16 v[160:163], a[112:115], a[152:155], v[160:163]
v_mfma_f32_16x16x32_bf16 v[164:167], a[112:115], a[156:159], v[164:167]
v_mfma_f32_16x16x32_bf16 v[168:171], a[112:115], a[160:163], v[168:171]
v_mfma_f32_16x16x32_bf16 v[172:175], a[112:115], a[164:167], v[172:175]
v_mfma_f32_16x16x32_bf16 v[176:179], a[112:115], a[168:171], v[176:179]
v_mfma_f32_16x16x32_bf16 v[180:183], a[112:115], a[172:175], v[180:183]
v_mfma_f32_16x16x32_bf16 v[184:187], a[116:119], a[152:155], v[184:187]
buffer_load_dwordx4 v52, s[12:15], s74 offen offset:2048 nt lds
v_mfma_f32_16x16x32_bf16 v[188:191], a[116:119], a[156:159], v[188:191]
v_mfma_f32_16x16x32_bf16 v[192:195], a[116:119], a[160:163], v[192:195]
v_mfma_f32_16x16x32_bf16 v[196:199], a[116:119], a[164:167], v[196:199]
v_mfma_f32_16x16x32_bf16 v[200:203], a[116:119], a[168:171], v[200:203]
v_mfma_f32_16x16x32_bf16 v[204:207], a[116:119], a[172:175], v[204:207]
v_mfma_f32_16x16x32_bf16 v[208:211], a[120:123], a[152:155], v[208:211]
v_mfma_f32_16x16x32_bf16 v[212:215], a[120:123], a[156:159], v[212:215]
v_mfma_f32_16x16x32_bf16 v[216:219], a[120:123], a[160:163], v[216:219]
v_mfma_f32_16x16x32_bf16 v[220:223], a[120:123], a[164:167], v[220:223]
buffer_load_dwordx4 v53, s[12:15], s74 offen offset:3072 nt lds
v_mfma_f32_16x16x32_bf16 v[224:227], a[120:123], a[168:171], v[224:227]
v_mfma_f32_16x16x32_bf16 v[228:231], a[120:123], a[172:175], v[228:231]
v_mfma_f32_16x16x32_bf16 v[232:235], a[124:127], a[152:155], v[232:235]
v_mfma_f32_16x16x32_bf16 v[236:239], a[124:127], a[156:159], v[236:239]
v_mfma_f32_16x16x32_bf16 v[240:243], a[124:127], a[160:163], v[240:243]
v_mfma_f32_16x16x32_bf16 v[244:247], a[124:127], a[164:167], v[244:247]
v_mfma_f32_16x16x32_bf16 v[248:251], a[124:127], a[168:171], v[248:251]
v_mfma_f32_16x16x32_bf16 v[252:255], a[124:127], a[172:175], v[252:255]
ds_read_b128 a[96:99], v38 offset:0
ds_read_b128 a[100:103], v39 offset:0
ds_read_b128 a[104:107], v40 offset:0
ds_read_b128 a[108:111], v41 offset:0
ds_read_b128 a[112:115], v38 offset:4096
ds_read_b128 a[116:119], v39 offset:4096
ds_read_b128 a[120:123], v40 offset:4096
ds_read_b128 a[124:127], v41 offset:4096
v_pk_mul_f32 v[64:65], v[64:65], s[86:87]
v_pk_mul_f32 v[66:67], v[66:67], s[86:87]
v_pk_mul_f32 v[88:89], v[88:89], s[86:87]
v_pk_mul_f32 v[90:91], v[90:91], s[86:87]
v_cvt_pk_bf16_f32 v8, v64, v65
v_cvt_pk_bf16_f32 v9, v66, v67
v_cvt_pk_bf16_f32 v10, v88, v89
v_cvt_pk_bf16_f32 v11, v90, v91
v_accvgpr_write_b32 a0, v8
v_accvgpr_write_b32 a1, v9
v_accvgpr_write_b32 a2, v10
v_accvgpr_write_b32 a3, v11
v_pk_mul_f32 v[112:113], v[112:113], s[86:87]
v_pk_mul_f32 v[114:115], v[114:115], s[86:87]
v_pk_mul_f32 v[136:137], v[136:137], s[86:87]
v_pk_mul_f32 v[138:139], v[138:139], s[86:87]
v_cvt_pk_bf16_f32 v12, v112, v113
v_cvt_pk_bf16_f32 v13, v114, v115
v_cvt_pk_bf16_f32 v14, v136, v137
v_cvt_pk_bf16_f32 v15, v138, v139
v_accvgpr_write_b32 a4, v12
v_accvgpr_write_b32 a5, v13
v_accvgpr_write_b32 a6, v14
v_accvgpr_write_b32 a7, v15
v_pk_mul_f32 v[160:161], v[160:161], s[86:87]
v_pk_mul_f32 v[162:163], v[162:163], s[86:87]
v_pk_mul_f32 v[184:185], v[184:185], s[86:87]
v_pk_mul_f32 v[186:187], v[186:187], s[86:87]
v_cvt_pk_bf16_f32 v16, v160, v161
v_cvt_pk_bf16_f32 v17, v162, v163
v_cvt_pk_bf16_f32 v18, v184, v185
v_cvt_pk_bf16_f32 v19, v186, v187
v_accvgpr_write_b32 a8, v16
v_accvgpr_write_b32 a9, v17
v_accvgpr_write_b32 a10, v18
v_accvgpr_write_b32 a11, v19
v_pk_mul_f32 v[208:209], v[208:209], s[86:87]
v_pk_mul_f32 v[210:211], v[210:211], s[86:87]
v_pk_mul_f32 v[232:233], v[232:233], s[86:87]
v_pk_mul_f32 v[234:235], v[234:235], s[86:87]
v_cvt_pk_bf16_f32 v20, v208, v209
v_cvt_pk_bf16_f32 v21, v210, v211
v_cvt_pk_bf16_f32 v22, v232, v233
v_cvt_pk_bf16_f32 v23, v234, v235
v_accvgpr_write_b32 a12, v20
v_accvgpr_write_b32 a13, v21
v_accvgpr_write_b32 a14, v22
v_accvgpr_write_b32 a15, v23
ds_read_b64_tr_b16 a[160:161], v42 offset:0
ds_read_b64_tr_b16 a[162:163], v42 offset:4096
ds_read_b64_tr_b16 a[164:165], v43 offset:0
ds_read_b64_tr_b16 a[166:167], v43 offset:4096
v_pk_mul_f32 v[68:69], v[68:69], s[86:87]
v_pk_mul_f32 v[70:71], v[70:71], s[86:87]
v_pk_mul_f32 v[92:93], v[92:93], s[86:87]
v_pk_mul_f32 v[94:95], v[94:95], s[86:87]
v_cvt_pk_bf16_f32 v8, v68, v69
v_cvt_pk_bf16_f32 v9, v70, v71
v_cvt_pk_bf16_f32 v10, v92, v93
v_cvt_pk_bf16_f32 v11, v94, v95
v_accvgpr_write_b32 a16, v8
v_accvgpr_write_b32 a17, v9
v_accvgpr_write_b32 a18, v10
v_accvgpr_write_b32 a19, v11
v_pk_mul_f32 v[116:117], v[116:117], s[86:87]
v_pk_mul_f32 v[118:119], v[118:119], s[86:87]
v_pk_mul_f32 v[140:141], v[140:141], s[86:87]
v_pk_mul_f32 v[142:143], v[142:143], s[86:87]
v_cvt_pk_bf16_f32 v12, v116, v117
v_cvt_pk_bf16_f32 v13, v118, v119
v_cvt_pk_bf16_f32 v14, v140, v141
v_cvt_pk_bf16_f32 v15, v142, v143
v_accvgpr_write_b32 a20, v12
v_accvgpr_write_b32 a21, v13
v_accvgpr_write_b32 a22, v14
v_accvgpr_write_b32 a23, v15
v_pk_mul_f32 v[164:165], v[164:165], s[86:87]
v_pk_mul_f32 v[166:167], v[166:167], s[86:87]
v_pk_mul_f32 v[188:189], v[188:189], s[86:87]
v_pk_mul_f32 v[190:191], v[190:191], s[86:87]
v_cvt_pk_bf16_f32 v16, v164, v165
v_cvt_pk_bf16_f32 v17, v166, v167
v_cvt_pk_bf16_f32 v18, v188, v189
v_cvt_pk_bf16_f32 v19, v190, v191
v_accvgpr_write_b32 a24, v16
v_accvgpr_write_b32 a25, v17
v_accvgpr_write_b32 a26, v18
v_accvgpr_write_b32 a27, v19
v_pk_mul_f32 v[212:213], v[212:213], s[86:87]
v_pk_mul_f32 v[214:215], v[214:215], s[86:87]
v_pk_mul_f32 v[236:237], v[236:237], s[86:87]
v_pk_mul_f32 v[238:239], v[238:239], s[86:87]
v_cvt_pk_bf16_f32 v20, v212, v213
v_cvt_pk_bf16_f32 v21, v214, v215
v_cvt_pk_bf16_f32 v22, v236, v237
v_cvt_pk_bf16_f32 v23, v238, v239
v_accvgpr_write_b32 a28, v20
v_accvgpr_write_b32 a29, v21
v_accvgpr_write_b32 a30, v22
v_accvgpr_write_b32 a31, v23
s_add_u32 s41, s74, 4096
s_add_u32 m0, s35, 69632
s_nop 0
buffer_load_dwordx4 v50, s[12:15], s41 offen offset:0 nt lds
ds_read_b64_tr_b16 a[168:169], v44 offset:0
ds_read_b64_tr_b16 a[170:171], v44 offset:4096
ds_read_b64_tr_b16 a[172:173], v45 offset:0
ds_read_b64_tr_b16 a[174:175], v45 offset:4096
v_pk_mul_f32 v[72:73], v[72:73], s[86:87]
v_pk_mul_f32 v[74:75], v[74:75], s[86:87]
v_pk_mul_f32 v[96:97], v[96:97], s[86:87]
v_pk_mul_f32 v[98:99], v[98:99], s[86:87]
v_cvt_pk_bf16_f32 v8, v72, v73
v_cvt_pk_bf16_f32 v9, v74, v75
v_cvt_pk_bf16_f32 v10, v96, v97
v_cvt_pk_bf16_f32 v11, v98, v99
v_accvgpr_write_b32 a32, v8
v_accvgpr_write_b32 a33, v9
v_accvgpr_write_b32 a34, v10
v_accvgpr_write_b32 a35, v11
v_pk_mul_f32 v[120:121], v[120:121], s[86:87]
v_pk_mul_f32 v[122:123], v[122:123], s[86:87]
v_pk_mul_f32 v[144:145], v[144:145], s[86:87]
v_pk_mul_f32 v[146:147], v[146:147], s[86:87]
v_cvt_pk_bf16_f32 v12, v120, v121
v_cvt_pk_bf16_f32 v13, v122, v123
v_cvt_pk_bf16_f32 v14, v144, v145
v_cvt_pk_bf16_f32 v15, v146, v147
v_accvgpr_write_b32 a36, v12
v_accvgpr_write_b32 a37, v13
v_accvgpr_write_b32 a38, v14
v_accvgpr_write_b32 a39, v15
v_pk_mul_f32 v[168:169], v[168:169], s[86:87]
v_pk_mul_f32 v[170:171], v[170:171], s[86:87]
v_pk_mul_f32 v[192:193], v[192:193], s[86:87]
v_pk_mul_f32 v[194:195], v[194:195], s[86:87]
v_cvt_pk_bf16_f32 v16, v168, v169
v_cvt_pk_bf16_f32 v17, v170, v171
v_cvt_pk_bf16_f32 v18, v192, v193
v_cvt_pk_bf16_f32 v19, v194, v195
v_accvgpr_write_b32 a40, v16
v_accvgpr_write_b32 a41, v17
v_accvgpr_write_b32 a42, v18
v_accvgpr_write_b32 a43, v19
v_pk_mul_f32 v[216:217], v[216:217], s[86:87]
v_pk_mul_f32 v[218:219], v[218:219], s[86:87]
v_pk_mul_f32 v[240:241], v[240:241], s[86:87]
v_pk_mul_f32 v[242:243], v[242:243], s[86:87]
v_cvt_pk_bf16_f32 v20, v216, v217
v_cvt_pk_bf16_f32 v21, v218, v219
v_cvt_pk_bf16_f32 v22, v240, v241
v_cvt_pk_bf16_f32 v23, v242, v243
v_accvgpr_write_b32 a44, v20
v_accvgpr_write_b32 a45, v21
v_accvgpr_write_b32 a46, v22
v_accvgpr_write_b32 a47, v23
buffer_load_dwordx4 v51, s[12:15], s41 offen offset:1024 nt lds
ds_read_b64_tr_b16 a[176:177], v46 offset:0
ds_read_b64_tr_b16 a[178:179], v46 offset:4096
ds_read_b64_tr_b16 a[180:181], v47 offset:0
ds_read_b64_tr_b16 a[182:183], v47 offset:4096
v_pk_mul_f32 v[76:77], v[76:77], s[86:87]
v_pk_mul_f32 v[78:79], v[78:79], s[86:87]
v_pk_mul_f32 v[100:101], v[100:101], s[86:87]
v_pk_mul_f32 v[102:103], v[102:103], s[86:87]
v_cvt_pk_bf16_f32 v8, v76, v77
v_cvt_pk_bf16_f32 v9, v78, v79
v_cvt_pk_bf16_f32 v10, v100, v101
v_cvt_pk_bf16_f32 v11, v102, v103
v_accvgpr_write_b32 a48, v8
v_accvgpr_write_b32 a49, v9
v_accvgpr_write_b32 a50, v10
v_accvgpr_write_b32 a51, v11
v_pk_mul_f32 v[124:125], v[124:125], s[86:87]
v_pk_mul_f32 v[126:127], v[126:127], s[86:87]
v_pk_mul_f32 v[148:149], v[148:149], s[86:87]
v_pk_mul_f32 v[150:151], v[150:151], s[86:87]
v_cvt_pk_bf16_f32 v12, v124, v125
v_cvt_pk_bf16_f32 v13, v126, v127
v_cvt_pk_bf16_f32 v14, v148, v149
v_cvt_pk_bf16_f32 v15, v150, v151
v_accvgpr_write_b32 a52, v12
v_accvgpr_write_b32 a53, v13
v_accvgpr_write_b32 a54, v14
v_accvgpr_write_b32 a55, v15
v_pk_mul_f32 v[172:173], v[172:173], s[86:87]
v_pk_mul_f32 v[174:175], v[174:175], s[86:87]
v_pk_mul_f32 v[196:197], v[196:197], s[86:87]
v_pk_mul_f32 v[198:199], v[198:199], s[86:87]
v_cvt_pk_bf16_f32 v16, v172, v173
v_cvt_pk_bf16_f32 v17, v174, v175
v_cvt_pk_bf16_f32 v18, v196, v197
v_cvt_pk_bf16_f32 v19, v198, v199
v_accvgpr_write_b32 a56, v16
v_accvgpr_write_b32 a57, v17
v_accvgpr_write_b32 a58, v18
v_accvgpr_write_b32 a59, v19
v_pk_mul_f32 v[220:221], v[220:221], s[86:87]
v_pk_mul_f32 v[222:223], v[222:223], s[86:87]
v_pk_mul_f32 v[244:245], v[244:245], s[86:87]
v_pk_mul_f32 v[246:247], v[246:247], s[86:87]
v_cvt_pk_bf16_f32 v20, v220, v221
v_cvt_pk_bf16_f32 v21, v222, v223
v_cvt_pk_bf16_f32 v22, v244, v245
v_cvt_pk_bf16_f32 v23, v246, v247
v_accvgpr_write_b32 a60, v20
v_accvgpr_write_b32 a61, v21
v_accvgpr_write_b32 a62, v22
v_accvgpr_write_b32 a63, v23
buffer_load_dwordx4 v52, s[12:15], s41 offen offset:2048 nt lds
ds_read_b64_tr_b16 a[184:185], v48 offset:0
ds_read_b64_tr_b16 a[186:187], v48 offset:4096
ds_read_b64_tr_b16 a[188:189], v49 offset:0
ds_read_b64_tr_b16 a[190:191], v49 offset:4096
v_pk_mul_f32 v[80:81], v[80:81], s[86:87]
v_pk_mul_f32 v[82:83], v[82:83], s[86:87]
v_pk_mul_f32 v[104:105], v[104:105], s[86:87]
v_pk_mul_f32 v[106:107], v[106:107], s[86:87]
v_cvt_pk_bf16_f32 v8, v80, v81
v_cvt_pk_bf16_f32 v9, v82, v83
v_cvt_pk_bf16_f32 v10, v104, v105
v_cvt_pk_bf16_f32 v11, v106, v107
v_accvgpr_write_b32 a64, v8
v_accvgpr_write_b32 a65, v9
v_accvgpr_write_b32 a66, v10
v_accvgpr_write_b32 a67, v11
v_pk_mul_f32 v[128:129], v[128:129], s[86:87]
v_pk_mul_f32 v[130:131], v[130:131], s[86:87]
v_pk_mul_f32 v[152:153], v[152:153], s[86:87]
v_pk_mul_f32 v[154:155], v[154:155], s[86:87]
v_cvt_pk_bf16_f32 v12, v128, v129
v_cvt_pk_bf16_f32 v13, v130, v131
v_cvt_pk_bf16_f32 v14, v152, v153
v_cvt_pk_bf16_f32 v15, v154, v155
v_accvgpr_write_b32 a68, v12
v_accvgpr_write_b32 a69, v13
v_accvgpr_write_b32 a70, v14
v_accvgpr_write_b32 a71, v15
v_pk_mul_f32 v[176:177], v[176:177], s[86:87]
v_pk_mul_f32 v[178:179], v[178:179], s[86:87]
v_pk_mul_f32 v[200:201], v[200:201], s[86:87]
v_pk_mul_f32 v[202:203], v[202:203], s[86:87]
v_cvt_pk_bf16_f32 v16, v176, v177
v_cvt_pk_bf16_f32 v17, v178, v179
v_cvt_pk_bf16_f32 v18, v200, v201
v_cvt_pk_bf16_f32 v19, v202, v203
v_accvgpr_write_b32 a72, v16
v_accvgpr_write_b32 a73, v17
v_accvgpr_write_b32 a74, v18
v_accvgpr_write_b32 a75, v19
v_pk_mul_f32 v[224:225], v[224:225], s[86:87]
v_pk_mul_f32 v[226:227], v[226:227], s[86:87]
v_pk_mul_f32 v[248:249], v[248:249], s[86:87]
v_pk_mul_f32 v[250:251], v[250:251], s[86:87]
v_cvt_pk_bf16_f32 v20, v224, v225
v_cvt_pk_bf16_f32 v21, v226, v227
v_cvt_pk_bf16_f32 v22, v248, v249
v_cvt_pk_bf16_f32 v23, v250, v251
v_accvgpr_write_b32 a76, v20
v_accvgpr_write_b32 a77, v21
v_accvgpr_write_b32 a78, v22
v_accvgpr_write_b32 a79, v23
buffer_load_dwordx4 v53, s[12:15], s41 offen offset:3072 nt lds
v_pk_mul_f32 v[84:85], v[84:85], s[86:87]
v_pk_mul_f32 v[86:87], v[86:87], s[86:87]
v_pk_mul_f32 v[108:109], v[108:109], s[86:87]
v_pk_mul_f32 v[110:111], v[110:111], s[86:87]
v_cvt_pk_bf16_f32 v8, v84, v85
v_cvt_pk_bf16_f32 v9, v86, v87
v_cvt_pk_bf16_f32 v10, v108, v109
v_cvt_pk_bf16_f32 v11, v110, v111
v_accvgpr_write_b32 a80, v8
v_accvgpr_write_b32 a81, v9
v_accvgpr_write_b32 a82, v10
v_accvgpr_write_b32 a83, v11
v_pk_mul_f32 v[132:133], v[132:133], s[86:87]
v_pk_mul_f32 v[134:135], v[134:135], s[86:87]
v_pk_mul_f32 v[156:157], v[156:157], s[86:87]
v_pk_mul_f32 v[158:159], v[158:159], s[86:87]
v_cvt_pk_bf16_f32 v12, v132, v133
v_cvt_pk_bf16_f32 v13, v134, v135
v_cvt_pk_bf16_f32 v14, v156, v157
v_cvt_pk_bf16_f32 v15, v158, v159
v_accvgpr_write_b32 a84, v12
v_accvgpr_write_b32 a85, v13
v_accvgpr_write_b32 a86, v14
v_accvgpr_write_b32 a87, v15
v_pk_mul_f32 v[180:181], v[180:181], s[86:87]
v_pk_mul_f32 v[182:183], v[182:183], s[86:87]
v_pk_mul_f32 v[204:205], v[204:205], s[86:87]
v_pk_mul_f32 v[206:207], v[206:207], s[86:87]
v_cvt_pk_bf16_f32 v16, v180, v181
v_cvt_pk_bf16_f32 v17, v182, v183
v_cvt_pk_bf16_f32 v18, v204, v205
v_cvt_pk_bf16_f32 v19, v206, v207
v_accvgpr_write_b32 a88, v16
v_accvgpr_write_b32 a89, v17
v_accvgpr_write_b32 a90, v18
v_accvgpr_write_b32 a91, v19
v_pk_mul_f32 v[228:229], v[228:229], s[86:87]
v_pk_mul_f32 v[230:231], v[230:231], s[86:87]
v_pk_mul_f32 v[252:253], v[252:253], s[86:87]
v_pk_mul_f32 v[254:255], v[254:255], s[86:87]
v_cvt_pk_bf16_f32 v20, v228, v229
v_cvt_pk_bf16_f32 v21, v230, v231
v_cvt_pk_bf16_f32 v22, v252, v253
v_cvt_pk_bf16_f32 v23, v254, v255
v_accvgpr_write_b32 a92, v20
v_accvgpr_write_b32 a93, v21
v_accvgpr_write_b32 a94, v22
v_accvgpr_write_b32 a95, v23
s_branch L_C
L_D1:
s_waitcnt vmcnt(5)
s_waitcnt lgkmcnt(0)
s_barrier
v_xor_b32 v38, 65536, v38
v_xor_b32 v39, 65536, v39
v_xor_b32 v40, 65536, v40
v_xor_b32 v41, 65536, v41
v_mfma_f32_16x16x32_bf16 v[8:11], a[128:131], a[32:35], 0
v_exp_f32 v16, v16
v_mfma_f32_16x16x32_bf16 v[64:67], a[192:195], v[24:27], v[64:67]
ds_read_b128 a[96:99], v38 offset:0
v_mfma_f32_16x16x32_bf16 v[8:11], a[132:135], a[36:39], v[8:11]
v_exp_f32 v17, v17
v_mfma_f32_16x16x32_bf16 v[88:91], a[196:199], v[24:27], v[88:91]
v_cvt_pk_bf16_f32 v28, v16, v17
v_xor_b32 v42, 65536, v42
v_mfma_f32_16x16x32_bf16 v[8:11], a[136:139], a[40:43], v[8:11]
v_exp_f32 v18, v18
v_mfma_f32_16x16x32_bf16 v[112:115], a[200:203], v[24:27], v[112:115]
ds_read_b128 a[100:103], v39 offset:0
v_mfma_f32_16x16x32_bf16 v[8:11], a[140:143], a[44:47], v[8:11]
v_exp_f32 v19, v19
v_mfma_f32_16x16x32_bf16 v[136:139], a[204:207], v[24:27], v[136:139]
v_cvt_pk_bf16_f32 v29, v18, v19
v_xor_b32 v43, 65536, v43
v_mfma_f32_16x16x32_bf16 v[12:15], a[144:147], a[32:35], 0
v_exp_f32 v20, v20
v_mfma_f32_16x16x32_bf16 v[160:163], a[208:211], v[24:27], v[160:163]
ds_read_b128 a[104:107], v40 offset:0
v_mfma_f32_16x16x32_bf16 v[12:15], a[148:151], a[36:39], v[12:15]
v_exp_f32 v21, v21
v_mfma_f32_16x16x32_bf16 v[184:187], a[212:215], v[24:27], v[184:187]
v_cvt_pk_bf16_f32 v30, v20, v21
v_xor_b32 v44, 65536, v44
v_mfma_f32_16x16x32_bf16 v[12:15], a[152:155], a[40:43], v[12:15]
v_exp_f32 v22, v22
v_mfma_f32_16x16x32_bf16 v[208:211], a[216:219], v[24:27], v[208:211]
ds_read_b128 a[108:111], v41 offset:0
v_mfma_f32_16x16x32_bf16 v[12:15], a[156:159], a[44:47], v[12:15]
v_exp_f32 v23, v23
v_mfma_f32_16x16x32_bf16 v[232:235], a[220:223], v[24:27], v[232:235]
v_cvt_pk_bf16_f32 v31, v22, v23
v_xor_b32 v45, 65536, v45
v_mfma_f32_16x16x32_bf16 a[228:231], a[224:227], v[24:27], a[228:231]
s_and_b32 s88, s33, 3
s_lshr_b32 s89, s33, 2
s_lshl_b32 s90, s31, 2
s_add_u32 s90, s90, s88
s_lshl_b32 s90, s90, 7
s_lshl_b32 s91, s28, 5
s_add_u32 s90, s90, s91
s_lshl_b32 s90, s90, 13
s_and_b32 s82, s32, 3
s_add_u32 s82, s82, s28
s_add_u32 s91, s82, 0
s_and_b32 s91, s91, 3
s_lshl_b32 s91, s91, 11
s_add_u32 s74, s90, s91
s_add_u32 s91, s82, 1
v_mfma_f32_16x16x32_bf16 v[16:19], a[128:131], a[48:51], 0
v_exp_f32 v8, v8
v_mfma_f32_16x16x32_bf16 v[68:71], a[192:195], v[28:31], v[68:71]
ds_read_b128 a[112:115], v38 offset:4096
v_mfma_f32_16x16x32_bf16 v[16:19], a[132:135], a[52:55], v[16:19]
v_exp_f32 v9, v9
v_mfma_f32_16x16x32_bf16 v[92:95], a[196:199], v[28:31], v[92:95]
v_cvt_pk_bf16_f32 v24, v8, v9
v_xor_b32 v46, 65536, v46
v_mfma_f32_16x16x32_bf16 v[16:19], a[136:139], a[56:59], v[16:19]
v_exp_f32 v10, v10
v_mfma_f32_16x16x32_bf16 v[116:119], a[200:203], v[28:31], v[116:119]
ds_read_b128 a[116:119], v39 offset:4096
v_mfma_f32_16x16x32_bf16 v[16:19], a[140:143], a[60:63], v[16:19]
v_exp_f32 v11, v11
v_mfma_f32_16x16x32_bf16 v[140:143], a[204:207], v[28:31], v[140:143]
v_cvt_pk_bf16_f32 v25, v10, v11
v_xor_b32 v47, 65536, v47
v_mfma_f32_16x16x32_bf16 v[20:23], a[144:147], a[48:51], 0
v_exp_f32 v12, v12
v_mfma_f32_16x16x32_bf16 v[164:167], a[208:211], v[28:31], v[164:167]
ds_read_b128 a[120:123], v40 offset:4096
v_mfma_f32_16x16x32_bf16 v[20:23], a[148:151], a[52:55], v[20:23]
v_exp_f32 v13, v13
v_mfma_f32_16x16x32_bf16 v[188:191], a[212:215], v[28:31], v[188:191]
v_cvt_pk_bf16_f32 v26, v12, v13
v_xor_b32 v48, 65536, v48
v_mfma_f32_16x16x32_bf16 v[20:23], a[152:155], a[56:59], v[20:23]
v_exp_f32 v14, v14
v_mfma_f32_16x16x32_bf16 v[212:215], a[216:219], v[28:31], v[212:215]
ds_read_b128 a[124:127], v41 offset:4096
v_mfma_f32_16x16x32_bf16 v[20:23], a[156:159], a[60:63], v[20:23]
v_exp_f32 v15, v15
v_mfma_f32_16x16x32_bf16 v[236:239], a[220:223], v[28:31], v[236:239]
v_cvt_pk_bf16_f32 v27, v14, v15
v_xor_b32 v49, 65536, v49
v_mfma_f32_16x16x32_bf16 a[232:235], a[224:227], v[28:31], a[232:235]
s_and_b32 s91, s91, 3
s_lshl_b32 s91, s91, 11
s_add_u32 s75, s90, s91
s_add_u32 s91, s82, 2
s_and_b32 s91, s91, 3
s_lshl_b32 s91, s91, 11
s_add_u32 s76, s90, s91
s_add_u32 s91, s82, 3
s_and_b32 s91, s91, 3
s_lshl_b32 s91, s91, 11
s_add_u32 s77, s90, s91
s_lshr_b32 s91, s88, 1
s_add_u32 s85, s88, s91
s_add_u32 s91, s85, 0
s_cmp_ge_u32 s91, 6
v_mfma_f32_16x16x32_bf16 v[8:11], a[128:131], a[64:67], 0
v_exp_f32 v16, v16
v_mfma_f32_16x16x32_bf16 v[72:75], a[192:195], v[24:27], v[72:75]
ds_read_b64_tr_b16 a[160:161], v42 offset:0
v_mfma_f32_16x16x32_bf16 v[8:11], a[132:135], a[68:71], v[8:11]
v_exp_f32 v17, v17
v_mfma_f32_16x16x32_bf16 v[96:99], a[196:199], v[24:27], v[96:99]
v_cvt_pk_bf16_f32 v28, v16, v17
s_cselect_b32 s98, 6, 0
v_mfma_f32_16x16x32_bf16 v[8:11], a[136:139], a[72:75], v[8:11]
v_exp_f32 v18, v18
v_mfma_f32_16x16x32_bf16 v[120:123], a[200:203], v[24:27], v[120:123]
ds_read_b64_tr_b16 a[162:163], v42 offset:4096
v_mfma_f32_16x16x32_bf16 v[8:11], a[140:143], a[76:79], v[8:11]
v_exp_f32 v19, v19
v_mfma_f32_16x16x32_bf16 v[144:147], a[204:207], v[24:27], v[144:147]
v_cvt_pk_bf16_f32 v29, v18, v19
s_sub_u32 s91, s91, s98
v_mfma_f32_16x16x32_bf16 v[12:15], a[144:147], a[64:67], 0
v_exp_f32 v20, v20
v_mfma_f32_16x16x32_bf16 v[168:171], a[208:211], v[24:27], v[168:171]
ds_read_b64_tr_b16 a[164:165], v43 offset:0
v_mfma_f32_16x16x32_bf16 v[12:15], a[148:151], a[68:71], v[12:15]
v_exp_f32 v21, v21
v_mfma_f32_16x16x32_bf16 v[192:195], a[212:215], v[24:27], v[192:195]
v_cvt_pk_bf16_f32 v30, v20, v21
s_lshl_b32 s91, s91, 10
v_mfma_f32_16x16x32_bf16 v[12:15], a[152:155], a[72:75], v[12:15]
v_exp_f32 v22, v22
v_mfma_f32_16x16x32_bf16 v[216:219], a[216:219], v[24:27], v[216:219]
ds_read_b64_tr_b16 a[166:167], v43 offset:4096
v_mfma_f32_16x16x32_bf16 v[12:15], a[156:159], a[76:79], v[12:15]
v_exp_f32 v23, v23
v_mfma_f32_16x16x32_bf16 v[240:243], a[220:223], v[24:27], v[240:243]
v_cvt_pk_bf16_f32 v31, v22, v23
v_add_u32 v58, s91, v4
v_mfma_f32_16x16x32_bf16 a[236:239], a[224:227], v[24:27], a[236:239]
s_add_u32 s91, s85, 1
s_cmp_ge_u32 s91, 6
s_cselect_b32 s98, 6, 0
s_sub_u32 s91, s91, s98
s_lshl_b32 s91, s91, 10
v_add_u32 v59, s91, v4
s_add_u32 s91, s85, 2
s_cmp_ge_u32 s91, 6
s_cselect_b32 s98, 6, 0
s_sub_u32 s91, s91, s98
s_lshl_b32 s91, s91, 10
v_add_u32 v60, s91, v4
v_mfma_f32_16x16x32_bf16 v[16:19], a[128:131], a[80:83], 0
v_exp_f32 v8, v8
v_mfma_f32_16x16x32_bf16 v[76:79], a[192:195], v[28:31], v[76:79]
ds_read_b64_tr_b16 a[168:169], v44 offset:0
v_mfma_f32_16x16x32_bf16 v[16:19], a[132:135], a[84:87], v[16:19]
v_exp_f32 v9, v9
v_mfma_f32_16x16x32_bf16 v[100:103], a[196:199], v[28:31], v[100:103]
v_cvt_pk_bf16_f32 v24, v8, v9
s_add_u32 s91, s85, 3
v_mfma_f32_16x16x32_bf16 v[16:19], a[136:139], a[88:91], v[16:19]
v_exp_f32 v10, v10
v_mfma_f32_16x16x32_bf16 v[124:127], a[200:203], v[28:31], v[124:127]
ds_read_b64_tr_b16 a[170:171], v44 offset:4096
v_mfma_f32_16x16x32_bf16 v[16:19], a[140:143], a[92:95], v[16:19]
v_exp_f32 v11, v11
v_mfma_f32_16x16x32_bf16 v[148:151], a[204:207], v[28:31], v[148:151]
v_cvt_pk_bf16_f32 v25, v10, v11
s_cmp_ge_u32 s91, 6
v_mfma_f32_16x16x32_bf16 v[20:23], a[144:147], a[80:83], 0
v_exp_f32 v12, v12
v_mfma_f32_16x16x32_bf16 v[172:175], a[208:211], v[28:31], v[172:175]
ds_read_b64_tr_b16 a[172:173], v45 offset:0
v_mfma_f32_16x16x32_bf16 v[20:23], a[148:151], a[84:87], v[20:23]
v_exp_f32 v13, v13
v_mfma_f32_16x16x32_bf16 v[196:199], a[212:215], v[28:31], v[196:199]
v_cvt_pk_bf16_f32 v26, v12, v13
s_cselect_b32 s98, 6, 0
v_mfma_f32_16x16x32_bf16 v[20:23], a[152:155], a[88:91], v[20:23]
v_exp_f32 v14, v14
v_mfma_f32_16x16x32_bf16 v[220:223], a[216:219], v[28:31], v[220:223]
ds_read_b64_tr_b16 a[174:175], v45 offset:4096
v_mfma_f32_16x16x32_bf16 v[20:23], a[156:159], a[92:95], v[20:23]
v_exp_f32 v15, v15
v_mfma_f32_16x16x32_bf16 v[244:247], a[220:223], v[28:31], v[244:247]
v_cvt_pk_bf16_f32 v27, v14, v15
s_sub_u32 s91, s91, s98
v_mfma_f32_16x16x32_bf16 a[240:243], a[224:227], v[28:31], a[240:243]
s_lshl_b32 s91, s91, 10
v_add_u32 v61, s91, v4
s_add_u32 s91, s85, 4
s_cmp_ge_u32 s91, 6
s_cselect_b32 s98, 6, 0
s_sub_u32 s91, s91, s98
s_lshl_b32 s91, s91, 10
v_add_u32 v62, s91, v4
s_add_u32 s91, s85, 5
s_cmp_ge_u32 s91, 6
s_cselect_b32 s98, 6, 0
s_waitcnt lgkmcnt(15)
v_mfma_f32_16x16x32_bf16 v[8:11], a[96:99], a[0:3], 0
v_exp_f32 v16, v16
v_mfma_f32_16x16x32_bf16 v[80:83], a[192:195], v[24:27], v[80:83]
ds_read_b64_tr_b16 a[176:177], v46 offset:0
s_waitcnt lgkmcnt(15)
v_mfma_f32_16x16x32_bf16 v[8:11], a[100:103], a[4:7], v[8:11]
v_exp_f32 v17, v17
v_mfma_f32_16x16x32_bf16 v[104:107], a[196:199], v[24:27], v[104:107]
v_cvt_pk_bf16_f32 v28, v16, v17
s_sub_u32 s91, s91, s98
s_waitcnt lgkmcnt(14)
v_mfma_f32_16x16x32_bf16 v[8:11], a[104:107], a[8:11], v[8:11]
v_exp_f32 v18, v18
v_mfma_f32_16x16x32_bf16 v[128:131], a[200:203], v[24:27], v[128:131]
ds_read_b64_tr_b16 a[178:179], v46 offset:4096
s_waitcnt lgkmcnt(14)
v_mfma_f32_16x16x32_bf16 v[8:11], a[108:111], a[12:15], v[8:11]
v_exp_f32 v19, v19
v_mfma_f32_16x16x32_bf16 v[152:155], a[204:207], v[24:27], v[152:155]
v_cvt_pk_bf16_f32 v29, v18, v19
s_lshl_b32 s91, s91, 10
s_waitcnt lgkmcnt(13)
v_mfma_f32_16x16x32_bf16 v[12:15], a[112:115], a[0:3], 0
v_exp_f32 v20, v20
v_mfma_f32_16x16x32_bf16 v[176:179], a[208:211], v[24:27], v[176:179]
ds_read_b64_tr_b16 a[180:181], v47 offset:0
s_waitcnt lgkmcnt(13)
v_mfma_f32_16x16x32_bf16 v[12:15], a[116:119], a[4:7], v[12:15]
v_exp_f32 v21, v21
v_mfma_f32_16x16x32_bf16 v[200:203], a[212:215], v[24:27], v[200:203]
v_cvt_pk_bf16_f32 v30, v20, v21
v_add_u32 v63, s91, v4
s_waitcnt lgkmcnt(12)
v_mfma_f32_16x16x32_bf16 v[12:15], a[120:123], a[8:11], v[12:15]
v_exp_f32 v22, v22
v_mfma_f32_16x16x32_bf16 v[224:227], a[216:219], v[24:27], v[224:227]
ds_read_b64_tr_b16 a[182:183], v47 offset:4096
s_waitcnt lgkmcnt(12)
v_mfma_f32_16x16x32_bf16 v[12:15], a[124:127], a[12:15], v[12:15]
v_exp_f32 v23, v23
v_mfma_f32_16x16x32_bf16 v[248:251], a[220:223], v[24:27], v[248:251]
v_cvt_pk_bf16_f32 v31, v22, v23
s_lshl_b32 s90, s31, 4
v_mfma_f32_16x16x32_bf16 a[244:247], a[224:227], v[24:27], a[244:247]
s_add_u32 s90, s90, s32
s_lshl_b32 s90, s90, 1
s_add_u32 s90, s90, s89
s_lshl_b32 s90, s90, 7
s_lshl_b32 s91, s28, 5
s_add_u32 s90, s90, s91
s_mul_i32 s78, s90, 6144
s_mul_i32 s90, s32, 192
s_mul_i32 s91, s89, 96
s_add_u32 s90, s90, s91
s_lshl_b32 s90, s90, 11
v_mfma_f32_16x16x32_bf16 v[16:19], a[96:99], a[16:19], 0
v_exp_f32 v8, v8
v_mfma_f32_16x16x32_bf16 v[84:87], a[192:195], v[28:31], v[84:87]
ds_read_b64_tr_b16 a[184:185], v48 offset:0
v_mfma_f32_16x16x32_bf16 v[16:19], a[100:103], a[20:23], v[16:19]
v_exp_f32 v9, v9
v_mfma_f32_16x16x32_bf16 v[108:111], a[196:199], v[28:31], v[108:111]
v_cvt_pk_bf16_f32 v24, v8, v9
s_lshl_b32 s91, s31, 10
v_mfma_f32_16x16x32_bf16 v[16:19], a[104:107], a[24:27], v[16:19]
v_exp_f32 v10, v10
v_mfma_f32_16x16x32_bf16 v[132:135], a[200:203], v[28:31], v[132:135]
ds_read_b64_tr_b16 a[186:187], v48 offset:4096
v_mfma_f32_16x16x32_bf16 v[16:19], a[108:111], a[28:31], v[16:19]
v_exp_f32 v11, v11
v_mfma_f32_16x16x32_bf16 v[156:159], a[204:207], v[28:31], v[156:159]
v_cvt_pk_bf16_f32 v25, v10, v11
s_add_u32 s90, s90, s91
v_mfma_f32_16x16x32_bf16 v[20:23], a[112:115], a[16:19], 0
v_exp_f32 v12, v12
v_mfma_f32_16x16x32_bf16 v[180:183], a[208:211], v[28:31], v[180:183]
ds_read_b64_tr_b16 a[188:189], v49 offset:0
v_mfma_f32_16x16x32_bf16 v[20:23], a[116:119], a[20:23], v[20:23]
v_exp_f32 v13, v13
ds_read_b64_tr_b16 a[190:191], v49 offset:4096
v_mfma_f32_16x16x32_bf16 v[204:207], a[212:215], v[28:31], v[204:207]
v_cvt_pk_bf16_f32 v26, v12, v13
v_mfma_f32_16x16x32_bf16 v[20:23], a[120:123], a[24:27], v[20:23]
v_exp_f32 v14, v14
v_mfma_f32_16x16x32_bf16 v[228:231], a[216:219], v[28:31], v[228:231]
s_lshl_b32 s91, s88, 8
v_mfma_f32_16x16x32_bf16 v[20:23], a[124:127], a[28:31], v[20:23]
v_exp_f32 v15, v15
v_mfma_f32_16x16x32_bf16 v[252:255], a[220:223], v[28:31], v[252:255]
v_cvt_pk_bf16_f32 v27, v14, v15
s_add_u32 s90, s90, s91
v_mfma_f32_16x16x32_bf16 a[248:251], a[224:227], v[28:31], a[248:251]
s_and_b32 s91, s82, 3
s_lshl_b32 s91, s91, 6
s_add_u32 s79, s90, s91
s_mov_b32 s4, s68
s_mov_b32 s5, s69
s_mov_b32 s6, 6291456
s_mov_b32 s7, 0x00020000
v_add_u32 v6, 4096, v4
s_lshl_b32 s90, s28, 20
s_lshl_b32 s91, s88, 8
s_add_u32 s74, s90, s91
s_lshl_b32 s75, s28, 15
s_waitcnt vmcnt(0)
s_waitcnt lgkmcnt(0)
s_barrier
v_mfma_f32_16x16x32_bf16 v[8:11], a[96:99], a[32:35], 0
v_exp_f32 v16, v16
v_mfma_f32_16x16x32_bf16 v[64:67], a[160:163], v[24:27], v[64:67]
ds_read_b128 a[128:131], v38 offset:8192
v_mfma_f32_16x16x32_bf16 v[8:11], a[100:103], a[36:39], v[8:11]
v_exp_f32 v17, v17
v_mfma_f32_16x16x32_bf16 v[88:91], a[164:167], v[24:27], v[88:91]
v_cvt_pk_bf16_f32 v28, v16, v17
v_mfma_f32_16x16x32_bf16 v[8:11], a[104:107], a[40:43], v[8:11]
v_exp_f32 v18, v18
v_mfma_f32_16x16x32_bf16 v[112:115], a[168:171], v[24:27], v[112:115]
ds_read_b128 a[132:135], v39 offset:8192
v_mfma_f32_16x16x32_bf16 v[8:11], a[108:111], a[44:47], v[8:11]
v_exp_f32 v19, v19
v_mfma_f32_16x16x32_bf16 v[136:139], a[172:175], v[24:27], v[136:139]
v_cvt_pk_bf16_f32 v29, v18, v19
v_mfma_f32_16x16x32_bf16 v[12:15], a[112:115], a[32:35], 0
v_exp_f32 v20, v20
v_mfma_f32_16x16x32_bf16 v[160:163], a[176:179], v[24:27], v[160:163]
ds_read_b128 a[136:139], v40 offset:8192
v_mfma_f32_16x16x32_bf16 v[12:15], a[116:119], a[36:39], v[12:15]
v_exp_f32 v21, v21
v_mfma_f32_16x16x32_bf16 v[184:187], a[180:183], v[24:27], v[184:187]
v_cvt_pk_bf16_f32 v30, v20, v21
v_mfma_f32_16x16x32_bf16 v[12:15], a[120:123], a[40:43], v[12:15]
v_exp_f32 v22, v22
v_mfma_f32_16x16x32_bf16 v[208:211], a[184:187], v[24:27], v[208:211]
ds_read_b128 a[140:143], v41 offset:8192
v_mfma_f32_16x16x32_bf16 v[12:15], a[124:127], a[44:47], v[12:15]
v_exp_f32 v23, v23
v_mfma_f32_16x16x32_bf16 v[232:235], a[188:191], v[24:27], v[232:235]
v_cvt_pk_bf16_f32 v31, v22, v23
v_mfma_f32_16x16x32_bf16 a[228:231], a[224:227], v[24:27], a[228:231]
v_mov_b32 v37, s97
buffer_load_dword v34, v37, s[92:95], 0 offen sc1
v_and_b32 v32, 15, v0
v_lshrrev_b32 v33, 4, v0
v_lshlrev_b32 v35, 2, v33
v_xor_b32 v35, v35, v32
v_lshlrev_b32 v35, 4, v35
v_mfma_f32_16x16x32_bf16 v[16:19], a[96:99], a[48:51], 0
v_exp_f32 v8, v8
v_mfma_f32_16x16x32_bf16 v[68:71], a[160:163], v[28:31], v[68:71]
ds_read_b128 a[144:147], v38 offset:12288
v_mfma_f32_16x16x32_bf16 v[16:19], a[100:103], a[52:55], v[16:19]
v_exp_f32 v9, v9
v_mfma_f32_16x16x32_bf16 v[92:95], a[164:167], v[28:31], v[92:95]
v_cvt_pk_bf16_f32 v24, v8, v9
v_lshl_add_u32 v2, v33, 10, v35
v_mfma_f32_16x16x32_bf16 v[16:19], a[104:107], a[56:59], v[16:19]
v_exp_f32 v10, v10
v_mfma_f32_16x16x32_bf16 v[116:119], a[168:171], v[28:31], v[116:119]
ds_read_b128 a[148:151], v39 offset:12288
v_mfma_f32_16x16x32_bf16 v[16:19], a[108:111], a[60:63], v[16:19]
v_exp_f32 v11, v11
v_mfma_f32_16x16x32_bf16 v[140:143], a[172:175], v[28:31], v[140:143]
v_cvt_pk_bf16_f32 v25, v10, v11
v_add_u32 v3, 3072, v2
v_mfma_f32_16x16x32_bf16 v[20:23], a[112:115], a[48:51], 0
v_exp_f32 v12, v12
v_mfma_f32_16x16x32_bf16 v[164:167], a[176:179], v[28:31], v[164:167]
ds_read_b128 a[152:155], v40 offset:12288
v_mfma_f32_16x16x32_bf16 v[20:23], a[116:119], a[52:55], v[20:23]
v_exp_f32 v13, v13
v_mfma_f32_16x16x32_bf16 v[188:191], a[180:183], v[28:31], v[188:191]
v_cvt_pk_bf16_f32 v26, v12, v13
v_add_u32 v6, 6144, v2
v_mfma_f32_16x16x32_bf16 v[20:23], a[120:123], a[56:59], v[20:23]
v_exp_f32 v14, v14
v_mfma_f32_16x16x32_bf16 v[212:215], a[184:187], v[28:31], v[212:215]
ds_read_b128 a[156:159], v41 offset:12288
v_mfma_f32_16x16x32_bf16 v[20:23], a[124:127], a[60:63], v[20:23]
v_exp_f32 v15, v15
v_mfma_f32_16x16x32_bf16 v[236:239], a[188:191], v[28:31], v[236:239]
v_cvt_pk_bf16_f32 v27, v14, v15
v_add_u32 v7, 9216, v2
v_mfma_f32_16x16x32_bf16 a[232:235], a[224:227], v[28:31], a[232:235]
v_lshrrev_b32 v35, 2, v32
v_and_b32 v32, 3, v32
v_lshl_add_u32 v33, v33, 2, v35
v_mfma_f32_16x16x32_bf16 v[8:11], a[96:99], a[64:67], 0
v_exp_f32 v16, v16
v_mfma_f32_16x16x32_bf16 v[72:75], a[160:163], v[24:27], v[72:75]
ds_read_b64_tr_b16 a[192:193], v42 offset:8192
v_mfma_f32_16x16x32_bf16 v[8:11], a[100:103], a[68:71], v[8:11]
v_exp_f32 v17, v17
v_mfma_f32_16x16x32_bf16 v[96:99], a[164:167], v[24:27], v[96:99]
v_cvt_pk_bf16_f32 v28, v16, v17
v_lshlrev_b32 v33, 8, v33
v_mfma_f32_16x16x32_bf16 v[8:11], a[104:107], a[72:75], v[8:11]
v_exp_f32 v18, v18
v_mfma_f32_16x16x32_bf16 v[120:123], a[168:171], v[24:27], v[120:123]
ds_read_b64_tr_b16 a[194:195], v42 offset:12288
v_mfma_f32_16x16x32_bf16 v[8:11], a[108:111], a[76:79], v[8:11]
v_exp_f32 v19, v19
v_mfma_f32_16x16x32_bf16 v[144:147], a[172:175], v[24:27], v[144:147]
v_cvt_pk_bf16_f32 v29, v18, v19
v_add_u32 v33, s75, v33
v_mfma_f32_16x16x32_bf16 v[12:15], a[112:115], a[64:67], 0
v_exp_f32 v20, v20
v_mfma_f32_16x16x32_bf16 v[168:171], a[176:179], v[24:27], v[168:171]
ds_read_b64_tr_b16 a[196:197], v43 offset:8192
v_mfma_f32_16x16x32_bf16 v[12:15], a[116:119], a[68:71], v[12:15]
v_exp_f32 v21, v21
v_mfma_f32_16x16x32_bf16 v[192:195], a[180:183], v[24:27], v[192:195]
v_cvt_pk_bf16_f32 v30, v20, v21
v_lshlrev_b32 v35, 2, v35
v_mfma_f32_16x16x32_bf16 v[12:15], a[120:123], a[72:75], v[12:15]
v_exp_f32 v22, v22
v_mfma_f32_16x16x32_bf16 v[216:219], a[184:187], v[24:27], v[216:219]
ds_read_b64_tr_b16 a[198:199], v43 offset:12288
v_mfma_f32_16x16x32_bf16 v[12:15], a[124:127], a[76:79], v[12:15]
v_exp_f32 v23, v23
v_mfma_f32_16x16x32_bf16 v[240:243], a[188:191], v[24:27], v[240:243]
v_cvt_pk_bf16_f32 v31, v22, v23
s_add_u32 s91, s82, 0
v_mfma_f32_16x16x32_bf16 a[236:239], a[224:227], v[24:27], a[236:239]
s_and_b32 s91, s91, 3
s_lshl_b32 s91, s91, 2
v_add_u32 v54, s91, v32
v_mfma_f32_16x16x32_bf16 v[16:19], a[96:99], a[80:83], 0
v_exp_f32 v8, v8
v_mfma_f32_16x16x32_bf16 v[76:79], a[160:163], v[28:31], v[76:79]
ds_read_b64_tr_b16 a[200:201], v44 offset:8192
v_mfma_f32_16x16x32_bf16 v[16:19], a[100:103], a[84:87], v[16:19]
v_exp_f32 v9, v9
v_mfma_f32_16x16x32_bf16 v[100:103], a[164:167], v[28:31], v[100:103]
v_cvt_pk_bf16_f32 v24, v8, v9
v_xor_b32 v54, v54, v35
v_mfma_f32_16x16x32_bf16 v[16:19], a[104:107], a[88:91], v[16:19]
v_exp_f32 v10, v10
v_mfma_f32_16x16x32_bf16 v[124:127], a[168:171], v[28:31], v[124:127]
ds_read_b64_tr_b16 a[202:203], v44 offset:12288
v_mfma_f32_16x16x32_bf16 v[16:19], a[108:111], a[92:95], v[16:19]
v_exp_f32 v11, v11
v_mfma_f32_16x16x32_bf16 v[148:151], a[172:175], v[28:31], v[148:151]
v_cvt_pk_bf16_f32 v25, v10, v11
v_lshl_add_u32 v54, v54, 4, v33
v_mfma_f32_16x16x32_bf16 v[20:23], a[112:115], a[80:83], 0
v_exp_f32 v12, v12
v_mfma_f32_16x16x32_bf16 v[172:175], a[176:179], v[28:31], v[172:175]
ds_read_b64_tr_b16 a[204:205], v45 offset:8192
v_mfma_f32_16x16x32_bf16 v[20:23], a[116:119], a[84:87], v[20:23]
v_exp_f32 v13, v13
v_mfma_f32_16x16x32_bf16 v[196:199], a[180:183], v[28:31], v[196:199]
v_cvt_pk_bf16_f32 v26, v12, v13
s_add_u32 s91, s82, 1
v_mfma_f32_16x16x32_bf16 v[20:23], a[120:123], a[88:91], v[20:23]
v_exp_f32 v14, v14
v_mfma_f32_16x16x32_bf16 v[220:223], a[184:187], v[28:31], v[220:223]
ds_read_b64_tr_b16 a[206:207], v45 offset:12288
v_mfma_f32_16x16x32_bf16 v[20:23], a[124:127], a[92:95], v[20:23]
v_exp_f32 v15, v15
v_mfma_f32_16x16x32_bf16 v[244:247], a[188:191], v[28:31], v[244:247]
v_cvt_pk_bf16_f32 v27, v14, v15
s_and_b32 s91, s91, 3
v_mfma_f32_16x16x32_bf16 a[240:243], a[224:227], v[28:31], a[240:243]
s_lshl_b32 s91, s91, 2
v_add_u32 v55, s91, v32
s_waitcnt lgkmcnt(15)
v_mfma_f32_16x16x32_bf16 v[8:11], a[128:131], a[0:3], 0
v_exp_f32 v16, v16
v_mfma_f32_16x16x32_bf16 v[80:83], a[160:163], v[24:27], v[80:83]
ds_read_b64_tr_b16 a[208:209], v46 offset:8192
s_waitcnt lgkmcnt(15)
v_mfma_f32_16x16x32_bf16 v[8:11], a[132:135], a[4:7], v[8:11]
v_exp_f32 v17, v17
v_mfma_f32_16x16x32_bf16 v[104:107], a[164:167], v[24:27], v[104:107]
v_cvt_pk_bf16_f32 v28, v16, v17
v_xor_b32 v55, v55, v35
s_waitcnt lgkmcnt(14)
v_mfma_f32_16x16x32_bf16 v[8:11], a[136:139], a[8:11], v[8:11]
v_exp_f32 v18, v18
v_mfma_f32_16x16x32_bf16 v[128:131], a[168:171], v[24:27], v[128:131]
ds_read_b64_tr_b16 a[210:211], v46 offset:12288
s_waitcnt lgkmcnt(14)
v_mfma_f32_16x16x32_bf16 v[8:11], a[140:143], a[12:15], v[8:11]
v_exp_f32 v19, v19
v_mfma_f32_16x16x32_bf16 v[152:155], a[172:175], v[24:27], v[152:155]
v_cvt_pk_bf16_f32 v29, v18, v19
v_lshl_add_u32 v55, v55, 4, v33
s_waitcnt lgkmcnt(13)
v_mfma_f32_16x16x32_bf16 v[12:15], a[144:147], a[0:3], 0
v_exp_f32 v20, v20
v_mfma_f32_16x16x32_bf16 v[176:179], a[176:179], v[24:27], v[176:179]
ds_read_b64_tr_b16 a[212:213], v47 offset:8192
s_waitcnt lgkmcnt(13)
v_mfma_f32_16x16x32_bf16 v[12:15], a[148:151], a[4:7], v[12:15]
v_exp_f32 v21, v21
v_mfma_f32_16x16x32_bf16 v[200:203], a[180:183], v[24:27], v[200:203]
v_cvt_pk_bf16_f32 v30, v20, v21
s_add_u32 s91, s82, 2
s_waitcnt lgkmcnt(12)
v_mfma_f32_16x16x32_bf16 v[12:15], a[152:155], a[8:11], v[12:15]
v_exp_f32 v22, v22
v_mfma_f32_16x16x32_bf16 v[224:227], a[184:187], v[24:27], v[224:227]
ds_read_b64_tr_b16 a[214:215], v47 offset:12288
s_waitcnt lgkmcnt(12)
v_mfma_f32_16x16x32_bf16 v[12:15], a[156:159], a[12:15], v[12:15]
v_exp_f32 v23, v23
v_mfma_f32_16x16x32_bf16 v[248:251], a[188:191], v[24:27], v[248:251]
v_cvt_pk_bf16_f32 v31, v22, v23
s_and_b32 s91, s91, 3
v_mfma_f32_16x16x32_bf16 a[244:247], a[224:227], v[24:27], a[244:247]
s_lshl_b32 s91, s91, 2
v_add_u32 v56, s91, v32
v_xor_b32 v56, v56, v35
v_mfma_f32_16x16x32_bf16 v[16:19], a[128:131], a[16:19], 0
v_exp_f32 v8, v8
v_mfma_f32_16x16x32_bf16 v[84:87], a[160:163], v[28:31], v[84:87]
ds_read_b64_tr_b16 a[216:217], v48 offset:8192
v_mfma_f32_16x16x32_bf16 v[16:19], a[132:135], a[20:23], v[16:19]
v_exp_f32 v9, v9
v_mfma_f32_16x16x32_bf16 v[108:111], a[164:167], v[28:31], v[108:111]
v_cvt_pk_bf16_f32 v24, v8, v9
v_lshl_add_u32 v56, v56, 4, v33
v_mfma_f32_16x16x32_bf16 v[16:19], a[136:139], a[24:27], v[16:19]
v_exp_f32 v10, v10
v_mfma_f32_16x16x32_bf16 v[132:135], a[168:171], v[28:31], v[132:135]
ds_read_b64_tr_b16 a[218:219], v48 offset:12288
v_mfma_f32_16x16x32_bf16 v[16:19], a[140:143], a[28:31], v[16:19]
v_exp_f32 v11, v11
v_mfma_f32_16x16x32_bf16 v[156:159], a[172:175], v[28:31], v[156:159]
v_cvt_pk_bf16_f32 v25, v10, v11
s_add_u32 s91, s82, 3
v_mfma_f32_16x16x32_bf16 v[20:23], a[144:147], a[16:19], 0
v_exp_f32 v12, v12
v_mfma_f32_16x16x32_bf16 v[180:183], a[176:179], v[28:31], v[180:183]
ds_read_b64_tr_b16 a[220:221], v49 offset:8192
v_mfma_f32_16x16x32_bf16 v[20:23], a[148:151], a[20:23], v[20:23]
v_exp_f32 v13, v13
ds_read_b64_tr_b16 a[222:223], v49 offset:12288
v_mfma_f32_16x16x32_bf16 v[204:207], a[180:183], v[28:31], v[204:207]
v_cvt_pk_bf16_f32 v26, v12, v13
v_mfma_f32_16x16x32_bf16 v[20:23], a[152:155], a[24:27], v[20:23]
v_exp_f32 v14, v14
v_mfma_f32_16x16x32_bf16 v[228:231], a[184:187], v[28:31], v[228:231]
s_and_b32 s91, s91, 3
v_mfma_f32_16x16x32_bf16 v[20:23], a[156:159], a[28:31], v[20:23]
v_exp_f32 v15, v15
v_mfma_f32_16x16x32_bf16 v[252:255], a[188:191], v[28:31], v[252:255]
v_cvt_pk_bf16_f32 v27, v14, v15
s_lshl_b32 s91, s91, 2
v_mfma_f32_16x16x32_bf16 a[248:251], a[224:227], v[28:31], a[248:251]
v_add_u32 v57, s91, v32
v_xor_b32 v57, v57, v35
v_lshl_add_u32 v57, v57, 4, v33
s_waitcnt lgkmcnt(0)
s_barrier
v_xor_b32 v38, 65536, v38
v_xor_b32 v39, 65536, v39
v_xor_b32 v40, 65536, v40
v_xor_b32 v41, 65536, v41
v_mfma_f32_16x16x32_bf16 v[8:11], a[128:131], a[32:35], 0
v_exp_f32 v16, v16
v_mfma_f32_16x16x32_bf16 v[64:67], a[192:195], v[24:27], v[64:67]
s_add_u32 s81, s74, 0
s_add_u32 m0, s75, 0
v_mfma_f32_16x16x32_bf16 v[8:11], a[132:135], a[36:39], v[8:11]
v_exp_f32 v17, v17
v_mfma_f32_16x16x32_bf16 v[88:91], a[196:199], v[24:27], v[88:91]
v_cvt_pk_bf16_f32 v28, v16, v17
buffer_load_dwordx4 v2, s[20:23], s81 offen offset:0 lds
v_mfma_f32_16x16x32_bf16 v[8:11], a[136:139], a[40:43], v[8:11]
v_exp_f32 v18, v18
v_mfma_f32_16x16x32_bf16 v[112:115], a[200:203], v[24:27], v[112:115]
v_xor_b32 v42, 65536, v42
v_mfma_f32_16x16x32_bf16 v[8:11], a[140:143], a[44:47], v[8:11]
v_exp_f32 v19, v19
v_mfma_f32_16x16x32_bf16 v[136:139], a[204:207], v[24:27], v[136:139]
v_cvt_pk_bf16_f32 v29, v18, v19
buffer_load_dwordx4 v3, s[20:23], s81 offen offset:1024 lds
v_mfma_f32_16x16x32_bf16 v[12:15], a[144:147], a[32:35], 0
v_exp_f32 v20, v20
v_mfma_f32_16x16x32_bf16 v[160:163], a[208:211], v[24:27], v[160:163]
v_xor_b32 v43, 65536, v43
v_mfma_f32_16x16x32_bf16 v[12:15], a[148:151], a[36:39], v[12:15]
v_exp_f32 v21, v21
v_mfma_f32_16x16x32_bf16 v[184:187], a[212:215], v[24:27], v[184:187]
v_cvt_pk_bf16_f32 v30, v20, v21
buffer_load_dwordx4 v6, s[20:23], s81 offen offset:2048 lds
v_mfma_f32_16x16x32_bf16 v[12:15], a[152:155], a[40:43], v[12:15]
v_exp_f32 v22, v22
v_mfma_f32_16x16x32_bf16 v[208:211], a[216:219], v[24:27], v[208:211]
v_xor_b32 v44, 65536, v44
v_mfma_f32_16x16x32_bf16 v[12:15], a[156:159], a[44:47], v[12:15]
v_exp_f32 v23, v23
v_mfma_f32_16x16x32_bf16 v[232:235], a[220:223], v[24:27], v[232:235]
v_cvt_pk_bf16_f32 v31, v22, v23
v_xor_b32 v45, 65536, v45
v_mfma_f32_16x16x32_bf16 a[228:231], a[224:227], v[24:27], a[228:231]
buffer_load_dwordx4 v7, s[20:23], s81 offen offset:3072 lds
v_mfma_f32_16x16x32_bf16 v[16:19], a[128:131], a[48:51], 0
v_exp_f32 v8, v8
v_mfma_f32_16x16x32_bf16 v[68:71], a[192:195], v[28:31], v[68:71]
s_add_u32 s81, s74, 16384
s_add_u32 m0, s75, 4096
v_mfma_f32_16x16x32_bf16 v[16:19], a[132:135], a[52:55], v[16:19]
v_exp_f32 v9, v9
v_mfma_f32_16x16x32_bf16 v[92:95], a[196:199], v[28:31], v[92:95]
v_cvt_pk_bf16_f32 v24, v8, v9
buffer_load_dwordx4 v2, s[20:23], s81 offen offset:0 lds
v_mfma_f32_16x16x32_bf16 v[16:19], a[136:139], a[56:59], v[16:19]
v_exp_f32 v10, v10
v_mfma_f32_16x16x32_bf16 v[116:119], a[200:203], v[28:31], v[116:119]
v_xor_b32 v46, 65536, v46
v_mfma_f32_16x16x32_bf16 v[16:19], a[140:143], a[60:63], v[16:19]
v_exp_f32 v11, v11
v_mfma_f32_16x16x32_bf16 v[140:143], a[204:207], v[28:31], v[140:143]
v_cvt_pk_bf16_f32 v25, v10, v11
buffer_load_dwordx4 v3, s[20:23], s81 offen offset:1024 lds
v_mfma_f32_16x16x32_bf16 v[20:23], a[144:147], a[48:51], 0
v_exp_f32 v12, v12
v_mfma_f32_16x16x32_bf16 v[164:167], a[208:211], v[28:31], v[164:167]
v_xor_b32 v47, 65536, v47
v_mfma_f32_16x16x32_bf16 v[20:23], a[148:151], a[52:55], v[20:23]
v_exp_f32 v13, v13
v_mfma_f32_16x16x32_bf16 v[188:191], a[212:215], v[28:31], v[188:191]
v_cvt_pk_bf16_f32 v26, v12, v13
buffer_load_dwordx4 v6, s[20:23], s81 offen offset:2048 lds
v_mfma_f32_16x16x32_bf16 v[20:23], a[152:155], a[56:59], v[20:23]
v_exp_f32 v14, v14
v_mfma_f32_16x16x32_bf16 v[212:215], a[216:219], v[28:31], v[212:215]
v_xor_b32 v48, 65536, v48
v_mfma_f32_16x16x32_bf16 v[20:23], a[156:159], a[60:63], v[20:23]
v_exp_f32 v15, v15
v_mfma_f32_16x16x32_bf16 v[236:239], a[220:223], v[28:31], v[236:239]
v_cvt_pk_bf16_f32 v27, v14, v15
v_xor_b32 v49, 65536, v49
v_mfma_f32_16x16x32_bf16 a[232:235], a[224:227], v[28:31], a[232:235]
buffer_load_dwordx4 v7, s[20:23], s81 offen offset:3072 lds
v_mfma_f32_16x16x32_bf16 v[8:11], a[128:131], a[64:67], 0
v_exp_f32 v16, v16
v_mfma_f32_16x16x32_bf16 v[72:75], a[192:195], v[24:27], v[72:75]
s_add_u32 s81, s74, 32768
s_add_u32 m0, s75, 8192
v_mfma_f32_16x16x32_bf16 v[8:11], a[132:135], a[68:71], v[8:11]
v_exp_f32 v17, v17
v_mfma_f32_16x16x32_bf16 v[96:99], a[196:199], v[24:27], v[96:99]
v_cvt_pk_bf16_f32 v28, v16, v17
buffer_load_dwordx4 v2, s[20:23], s81 offen offset:0 lds
v_mfma_f32_16x16x32_bf16 v[8:11], a[136:139], a[72:75], v[8:11]
v_exp_f32 v18, v18
v_mfma_f32_16x16x32_bf16 v[120:123], a[200:203], v[24:27], v[120:123]
v_mfma_f32_16x16x32_bf16 v[8:11], a[140:143], a[76:79], v[8:11]
v_exp_f32 v19, v19
v_mfma_f32_16x16x32_bf16 v[144:147], a[204:207], v[24:27], v[144:147]
v_cvt_pk_bf16_f32 v29, v18, v19
buffer_load_dwordx4 v3, s[20:23], s81 offen offset:1024 lds
v_mfma_f32_16x16x32_bf16 v[12:15], a[144:147], a[64:67], 0
v_exp_f32 v20, v20
v_mfma_f32_16x16x32_bf16 v[168:171], a[208:211], v[24:27], v[168:171]
v_mfma_f32_16x16x32_bf16 v[12:15], a[148:151], a[68:71], v[12:15]
v_exp_f32 v21, v21
v_mfma_f32_16x16x32_bf16 v[192:195], a[212:215], v[24:27], v[192:195]
v_cvt_pk_bf16_f32 v30, v20, v21
buffer_load_dwordx4 v6, s[20:23], s81 offen offset:2048 lds
v_mfma_f32_16x16x32_bf16 v[12:15], a[152:155], a[72:75], v[12:15]
v_exp_f32 v22, v22
v_mfma_f32_16x16x32_bf16 v[216:219], a[216:219], v[24:27], v[216:219]
v_mfma_f32_16x16x32_bf16 v[12:15], a[156:159], a[76:79], v[12:15]
v_exp_f32 v23, v23
v_mfma_f32_16x16x32_bf16 v[240:243], a[220:223], v[24:27], v[240:243]
v_cvt_pk_bf16_f32 v31, v22, v23
v_mfma_f32_16x16x32_bf16 a[236:239], a[224:227], v[24:27], a[236:239]
buffer_load_dwordx4 v7, s[20:23], s81 offen offset:3072 lds
v_mfma_f32_16x16x32_bf16 v[16:19], a[128:131], a[80:83], 0
v_exp_f32 v8, v8
v_mfma_f32_16x16x32_bf16 v[76:79], a[192:195], v[28:31], v[76:79]
s_add_u32 s81, s74, 49152
s_add_u32 m0, s75, 12288
v_mfma_f32_16x16x32_bf16 v[16:19], a[132:135], a[84:87], v[16:19]
v_exp_f32 v9, v9
v_mfma_f32_16x16x32_bf16 v[100:103], a[196:199], v[28:31], v[100:103]
v_cvt_pk_bf16_f32 v24, v8, v9
buffer_load_dwordx4 v2, s[20:23], s81 offen offset:0 lds
v_mfma_f32_16x16x32_bf16 v[16:19], a[136:139], a[88:91], v[16:19]
v_exp_f32 v10, v10
v_mfma_f32_16x16x32_bf16 v[124:127], a[200:203], v[28:31], v[124:127]
v_mfma_f32_16x16x32_bf16 v[16:19], a[140:143], a[92:95], v[16:19]
v_exp_f32 v11, v11
v_mfma_f32_16x16x32_bf16 v[148:151], a[204:207], v[28:31], v[148:151]
v_cvt_pk_bf16_f32 v25, v10, v11
buffer_load_dwordx4 v3, s[20:23], s81 offen offset:1024 lds
v_mfma_f32_16x16x32_bf16 v[20:23], a[144:147], a[80:83], 0
v_exp_f32 v12, v12
v_mfma_f32_16x16x32_bf16 v[172:175], a[208:211], v[28:31], v[172:175]
v_mfma_f32_16x16x32_bf16 v[20:23], a[148:151], a[84:87], v[20:23]
v_exp_f32 v13, v13
v_mfma_f32_16x16x32_bf16 v[196:199], a[212:215], v[28:31], v[196:199]
v_cvt_pk_bf16_f32 v26, v12, v13
buffer_load_dwordx4 v6, s[20:23], s81 offen offset:2048 lds
v_mfma_f32_16x16x32_bf16 v[20:23], a[152:155], a[88:91], v[20:23]
v_exp_f32 v14, v14
v_mfma_f32_16x16x32_bf16 v[220:223], a[216:219], v[28:31], v[220:223]
v_mfma_f32_16x16x32_bf16 v[20:23], a[156:159], a[92:95], v[20:23]
v_exp_f32 v15, v15
v_mfma_f32_16x16x32_bf16 v[244:247], a[220:223], v[28:31], v[244:247]
v_cvt_pk_bf16_f32 v27, v14, v15
v_mfma_f32_16x16x32_bf16 a[240:243], a[224:227], v[28:31], a[240:243]
buffer_load_dwordx4 v7, s[20:23], s81 offen offset:3072 lds
v_mfma_f32_16x16x32_bf16 v[80:83], a[192:195], v[24:27], v[80:83]
v_exp_f32 v16, v16
s_add_u32 s81, s74, 65536
s_add_u32 m0, s75, 16384
v_mfma_f32_16x16x32_bf16 v[104:107], a[196:199], v[24:27], v[104:107]
v_exp_f32 v17, v17
s_nop 0
v_cvt_pk_bf16_f32 v28, v16, v17
buffer_load_dwordx4 v2, s[20:23], s81 offen offset:0 lds
v_mfma_f32_16x16x32_bf16 v[128:131], a[200:203], v[24:27], v[128:131]
v_exp_f32 v18, v18
v_mfma_f32_16x16x32_bf16 v[152:155], a[204:207], v[24:27], v[152:155]
v_exp_f32 v19, v19
s_nop 0
v_cvt_pk_bf16_f32 v29, v18, v19
buffer_load_dwordx4 v3, s[20:23], s81 offen offset:1024 lds
v_mfma_f32_16x16x32_bf16 v[176:179], a[208:211], v[24:27], v[176:179]
v_exp_f32 v20, v20
v_mfma_f32_16x16x32_bf16 v[200:203], a[212:215], v[24:27], v[200:203]
v_exp_f32 v21, v21
s_nop 0
v_cvt_pk_bf16_f32 v30, v20, v21
buffer_load_dwordx4 v6, s[20:23], s81 offen offset:2048 lds
v_mfma_f32_16x16x32_bf16 v[224:227], a[216:219], v[24:27], v[224:227]
v_exp_f32 v22, v22
v_mfma_f32_16x16x32_bf16 v[248:251], a[220:223], v[24:27], v[248:251]
v_exp_f32 v23, v23
s_nop 0
v_cvt_pk_bf16_f32 v31, v22, v23
v_mfma_f32_16x16x32_bf16 a[244:247], a[224:227], v[24:27], a[244:247]
buffer_load_dwordx4 v7, s[20:23], s81 offen offset:3072 lds
v_mfma_f32_16x16x32_bf16 v[84:87], a[192:195], v[28:31], v[84:87]
s_add_u32 s81, s74, 81920
s_add_u32 m0, s75, 20480
v_mfma_f32_16x16x32_bf16 v[108:111], a[196:199], v[28:31], v[108:111]
buffer_load_dwordx4 v2, s[20:23], s81 offen offset:0 lds
v_mfma_f32_16x16x32_bf16 v[132:135], a[200:203], v[28:31], v[132:135]
v_mfma_f32_16x16x32_bf16 v[156:159], a[204:207], v[28:31], v[156:159]
buffer_load_dwordx4 v3, s[20:23], s81 offen offset:1024 lds
v_mfma_f32_16x16x32_bf16 v[180:183], a[208:211], v[28:31], v[180:183]
v_mfma_f32_16x16x32_bf16 v[204:207], a[212:215], v[28:31], v[204:207]
buffer_load_dwordx4 v6, s[20:23], s81 offen offset:2048 lds
v_mfma_f32_16x16x32_bf16 v[228:231], a[216:219], v[28:31], v[228:231]
v_mfma_f32_16x16x32_bf16 v[252:255], a[220:223], v[28:31], v[252:255]
v_mfma_f32_16x16x32_bf16 a[248:251], a[224:227], v[28:31], a[248:251]
buffer_load_dwordx4 v7, s[20:23], s81 offen offset:3072 lds
s_waitcnt vmcnt(24)
v_readfirstlane_b32 s88, v34
s_nop 3
s_cmp_ge_u32 s88, 8
s_cbranch_scc1 L_ok2
s_mov_b32 s89, 0x40000
L_spin2:
s_sleep 2
buffer_load_dword v34, v37, s[92:95], 0 offen sc1
s_waitcnt vmcnt(0)
v_readfirstlane_b32 s88, v34
s_nop 3
s_sub_u32 s89, s89, 1
s_cmp_eq_u32 s89, 0
s_cbranch_scc1 L_ok2
s_cmp_lt_u32 s88, 8
s_cbranch_scc1 L_spin2
L_ok2:
v_accvgpr_read_b32 v8, a228
v_accvgpr_read_b32 v9, a232
v_accvgpr_read_b32 v10, a236
v_accvgpr_read_b32 v11, a240
v_accvgpr_read_b32 v12, a244
v_accvgpr_read_b32 v13, a248
v_max3_f32 v14, v8, v9, v10
v_min3_f32 v15, v8, v9, v10
v_max3_f32 v14, v14, v11, v12
v_min3_f32 v15, v15, v11, v12
v_max_f32 v14, v14, v13
v_min_f32 v15, v15, v13
v_cmp_nge_f32 vcc, 0x49800000, v14
s_nop 3
s_mov_b64 s[88:89], vcc
v_cmp_nle_f32 vcc, 0x39800000, v15
s_nop 3
s_or_b64 s[88:89], s[88:89], vcc
s_cmp_lg_u64 s[88:89], 0
s_cselect_b32 s88, 1, 0
v_mov_b32 v8, s88
s_lshl_b32 s89, s28, 2
s_add_u32 s89, s89, 131072
v_mov_b32 v9, s89
ds_write_b32 v9, v8
s_waitcnt lgkmcnt(0)
s_barrier
v_mov_b32 v9, 131072
ds_read_b128 v[12:15], v9
s_waitcnt lgkmcnt(0)
v_or_b32 v12, v12, v13
v_or_b32 v14, v14, v15
v_or_b32 v12, v12, v14
s_nop 0
v_readfirstlane_b32 s88, v12
s_nop 3
s_cmp_lg_u32 s88, 0
s_cbranch_scc1 L_FB
L_OE1:
v_accvgpr_read_b32 v32, a228
v_accvgpr_read_b32 v33, a232
v_accvgpr_read_b32 v34, a236
v_accvgpr_read_b32 v35, a240
v_accvgpr_read_b32 v36, a244
v_accvgpr_read_b32 v37, a248
v_rcp_f32 v32, v32
v_rcp_f32 v33, v33
v_rcp_f32 v34, v34
v_rcp_f32 v35, v35
v_rcp_f32 v36, v36
v_rcp_f32 v37, v37
v_pk_mul_f32 v[64:65], v[64:65], v[32:33] op_sel_hi:[1,0]
v_pk_mul_f32 v[66:67], v[66:67], v[32:33] op_sel_hi:[1,0]
v_pk_mul_f32 v[88:89], v[88:89], v[32:33] op_sel_hi:[1,0]
v_pk_mul_f32 v[90:91], v[90:91], v[32:33] op_sel_hi:[1,0]
v_cvt_pk_bf16_f32 v12, v64, v65
v_cvt_pk_bf16_f32 v13, v66, v67
v_cvt_pk_bf16_f32 v14, v88, v89
v_cvt_pk_bf16_f32 v15, v90, v91
s_add_u32 s80, s78, 0
buffer_load_dwordx4 a[64:67], v58, s[16:19], s80 offen sc1
buffer_load_dwordx4 a[68:71], v59, s[16:19], s80 offen sc1
s_add_u32 s41, s40, 0
buffer_store_dwordx4 v[12:15], v4, s[16:19], s41 offen sc1
v_pk_mul_f32 v[112:113], v[112:113], v[32:33] op_sel_hi:[1,0]
v_pk_mul_f32 v[114:115], v[114:115], v[32:33] op_sel_hi:[1,0]
v_pk_mul_f32 v[136:137], v[136:137], v[32:33] op_sel_hi:[1,0]
v_pk_mul_f32 v[138:139], v[138:139], v[32:33] op_sel_hi:[1,0]
v_cvt_pk_bf16_f32 v8, v112, v113
v_cvt_pk_bf16_f32 v9, v114, v115
v_cvt_pk_bf16_f32 v10, v136, v137
v_cvt_pk_bf16_f32 v11, v138, v139
buffer_load_dwordx4 a[72:75], v60, s[16:19], s80 offen sc1
buffer_load_dwordx4 a[76:79], v61, s[16:19], s80 offen sc1
s_add_u32 s41, s40, 6144
buffer_store_dwordx4 v[8:11], v4, s[16:19], s41 offen sc1
v_pk_mul_f32 v[160:161], v[160:161], v[32:33] op_sel_hi:[1,0]
v_pk_mul_f32 v[162:163], v[162:163], v[32:33] op_sel_hi:[1,0]
v_pk_mul_f32 v[184:185], v[184:185], v[32:33] op_sel_hi:[1,0]
v_pk_mul_f32 v[186:187], v[186:187], v[32:33] op_sel_hi:[1,0]
v_cvt_pk_bf16_f32 v12, v160, v161
v_cvt_pk_bf16_f32 v13, v162, v163
v_cvt_pk_bf16_f32 v14, v184, v185
v_cvt_pk_bf16_f32 v15, v186, v187
buffer_load_dwordx4 a[80:83], v62, s[16:19], s80 offen sc1
buffer_load_dwordx4 a[84:87], v63, s[16:19], s80 offen sc1
s_add_u32 s41, s40, 12288
buffer_store_dwordx4 v[12:15], v4, s[16:19], s41 offen sc1
v_pk_mul_f32 v[208:209], v[208:209], v[32:33] op_sel_hi:[1,0]
v_pk_mul_f32 v[210:211], v[210:211], v[32:33] op_sel_hi:[1,0]
v_pk_mul_f32 v[232:233], v[232:233], v[32:33] op_sel_hi:[1,0]
v_pk_mul_f32 v[234:235], v[234:235], v[32:33] op_sel_hi:[1,0]
v_cvt_pk_bf16_f32 v8, v208, v209
v_cvt_pk_bf16_f32 v9, v210, v211
v_cvt_pk_bf16_f32 v10, v232, v233
v_cvt_pk_bf16_f32 v11, v234, v235
s_add_u32 s80, s78, 6144
buffer_load_dwordx4 a[88:91], v58, s[16:19], s80 offen sc1
buffer_load_dwordx4 a[92:95], v59, s[16:19], s80 offen sc1
s_add_u32 s41, s40, 18432
buffer_store_dwordx4 v[8:11], v4, s[16:19], s41 offen sc1
v_pk_mul_f32 v[68:69], v[68:69], v[32:33] op_sel:[0,1] op_sel_hi:[1,1]
v_pk_mul_f32 v[70:71], v[70:71], v[32:33] op_sel:[0,1] op_sel_hi:[1,1]
v_pk_mul_f32 v[92:93], v[92:93], v[32:33] op_sel:[0,1] op_sel_hi:[1,1]
v_pk_mul_f32 v[94:95], v[94:95], v[32:33] op_sel:[0,1] op_sel_hi:[1,1]
v_cvt_pk_bf16_f32 v12, v68, v69
v_cvt_pk_bf16_f32 v13, v70, v71
v_cvt_pk_bf16_f32 v14, v92, v93
v_cvt_pk_bf16_f32 v15, v94, v95
buffer_load_dwordx4 a[96:99], v60, s[16:19], s80 offen sc1
buffer_load_dwordx4 a[100:103], v61, s[16:19], s80 offen sc1
v_accvgpr_write_b32 a160, v12
v_accvgpr_write_b32 a161, v13
v_accvgpr_write_b32 a162, v14
v_accvgpr_write_b32 a163, v15
v_pk_mul_f32 v[116:117], v[116:117], v[32:33] op_sel:[0,1] op_sel_hi:[1,1]
v_pk_mul_f32 v[118:119], v[118:119], v[32:33] op_sel:[0,1] op_sel_hi:[1,1]
v_pk_mul_f32 v[140:141], v[140:141], v[32:33] op_sel:[0,1] op_sel_hi:[1,1]
v_pk_mul_f32 v[142:143], v[142:143], v[32:33] op_sel:[0,1] op_sel_hi:[1,1]
v_cvt_pk_bf16_f32 v8, v116, v117
v_cvt_pk_bf16_f32 v9, v118, v119
v_cvt_pk_bf16_f32 v10, v140, v141
v_cvt_pk_bf16_f32 v11, v142, v143
buffer_load_dwordx4 a[104:107], v62, s[16:19], s80 offen sc1
buffer_load_dwordx4 a[108:111], v63, s[16:19], s80 offen sc1
v_accvgpr_write_b32 a164, v8
v_accvgpr_write_b32 a165, v9
v_accvgpr_write_b32 a166, v10
v_accvgpr_write_b32 a167, v11
v_pk_mul_f32 v[164:165], v[164:165], v[32:33] op_sel:[0,1] op_sel_hi:[1,1]
v_pk_mul_f32 v[166:167], v[166:167], v[32:33] op_sel:[0,1] op_sel_hi:[1,1]
v_pk_mul_f32 v[188:189], v[188:189], v[32:33] op_sel:[0,1] op_sel_hi:[1,1]
v_pk_mul_f32 v[190:191], v[190:191], v[32:33] op_sel:[0,1] op_sel_hi:[1,1]
v_cvt_pk_bf16_f32 v12, v164, v165
v_cvt_pk_bf16_f32 v13, v166, v167
v_cvt_pk_bf16_f32 v14, v188, v189
v_cvt_pk_bf16_f32 v15, v190, v191
s_add_u32 s80, s78, 12288
buffer_load_dwordx4 a[112:115], v58, s[16:19], s80 offen sc1
buffer_load_dwordx4 a[116:119], v59, s[16:19], s80 offen sc1
v_accvgpr_write_b32 a168, v12
v_accvgpr_write_b32 a169, v13
v_accvgpr_write_b32 a170, v14
v_accvgpr_write_b32 a171, v15
v_pk_mul_f32 v[212:213], v[212:213], v[32:33] op_sel:[0,1] op_sel_hi:[1,1]
v_pk_mul_f32 v[214:215], v[214:215], v[32:33] op_sel:[0,1] op_sel_hi:[1,1]
v_pk_mul_f32 v[236:237], v[236:237], v[32:33] op_sel:[0,1] op_sel_hi:[1,1]
v_pk_mul_f32 v[238:239], v[238:239], v[32:33] op_sel:[0,1] op_sel_hi:[1,1]
v_cvt_pk_bf16_f32 v8, v212, v213
v_cvt_pk_bf16_f32 v9, v214, v215
v_cvt_pk_bf16_f32 v10, v236, v237
v_cvt_pk_bf16_f32 v11, v238, v239
buffer_load_dwordx4 a[120:123], v60, s[16:19], s80 offen sc1
buffer_load_dwordx4 a[124:127], v61, s[16:19], s80 offen sc1
v_accvgpr_write_b32 a172, v8
v_accvgpr_write_b32 a173, v9
v_accvgpr_write_b32 a174, v10
v_accvgpr_write_b32 a175, v11
v_pk_mul_f32 v[72:73], v[72:73], v[34:35] op_sel_hi:[1,0]
v_pk_mul_f32 v[74:75], v[74:75], v[34:35] op_sel_hi:[1,0]
v_pk_mul_f32 v[96:97], v[96:97], v[34:35] op_sel_hi:[1,0]
v_pk_mul_f32 v[98:99], v[98:99], v[34:35] op_sel_hi:[1,0]
v_cvt_pk_bf16_f32 v12, v72, v73
v_cvt_pk_bf16_f32 v13, v74, v75
v_cvt_pk_bf16_f32 v14, v96, v97
v_cvt_pk_bf16_f32 v15, v98, v99
buffer_load_dwordx4 a[128:131], v62, s[16:19], s80 offen sc1
buffer_load_dwordx4 a[132:135], v63, s[16:19], s80 offen sc1
v_accvgpr_write_b32 a176, v12
v_accvgpr_write_b32 a177, v13
v_accvgpr_write_b32 a178, v14
v_accvgpr_write_b32 a179, v15
v_pk_mul_f32 v[120:121], v[120:121], v[34:35] op_sel_hi:[1,0]
v_pk_mul_f32 v[122:123], v[122:123], v[34:35] op_sel_hi:[1,0]
v_pk_mul_f32 v[144:145], v[144:145], v[34:35] op_sel_hi:[1,0]
v_pk_mul_f32 v[146:147], v[146:147], v[34:35] op_sel_hi:[1,0]
v_cvt_pk_bf16_f32 v8, v120, v121
v_cvt_pk_bf16_f32 v9, v122, v123
v_cvt_pk_bf16_f32 v10, v144, v145
v_cvt_pk_bf16_f32 v11, v146, v147
v_accvgpr_write_b32 a180, v8
v_accvgpr_write_b32 a181, v9
v_accvgpr_write_b32 a182, v10
v_accvgpr_write_b32 a183, v11
v_pk_mul_f32 v[168:169], v[168:169], v[34:35] op_sel_hi:[1,0]
v_pk_mul_f32 v[170:171], v[170:171], v[34:35] op_sel_hi:[1,0]
v_pk_mul_f32 v[192:193], v[192:193], v[34:35] op_sel_hi:[1,0]
v_pk_mul_f32 v[194:195], v[194:195], v[34:35] op_sel_hi:[1,0]
v_cvt_pk_bf16_f32 v12, v168, v169
v_cvt_pk_bf16_f32 v13, v170, v171
v_cvt_pk_bf16_f32 v14, v192, v193
v_cvt_pk_bf16_f32 v15, v194, v195
v_accvgpr_write_b32 a184, v12
v_accvgpr_write_b32 a185, v13
v_accvgpr_write_b32 a186, v14
v_accvgpr_write_b32 a187, v15
v_pk_mul_f32 v[216:217], v[216:217], v[34:35] op_sel_hi:[1,0]
v_pk_mul_f32 v[218:219], v[218:219], v[34:35] op_sel_hi:[1,0]
v_pk_mul_f32 v[240:241], v[240:241], v[34:35] op_sel_hi:[1,0]
v_pk_mul_f32 v[242:243], v[242:243], v[34:35] op_sel_hi:[1,0]
v_cvt_pk_bf16_f32 v8, v216, v217
v_cvt_pk_bf16_f32 v9, v218, v219
v_cvt_pk_bf16_f32 v10, v240, v241
v_cvt_pk_bf16_f32 v11, v242, v243
v_accvgpr_write_b32 a188, v8
v_accvgpr_write_b32 a189, v9
v_accvgpr_write_b32 a190, v10
v_accvgpr_write_b32 a191, v11
v_pk_mul_f32 v[76:77], v[76:77], v[34:35] op_sel:[0,1] op_sel_hi:[1,1]
v_pk_mul_f32 v[78:79], v[78:79], v[34:35] op_sel:[0,1] op_sel_hi:[1,1]
v_pk_mul_f32 v[100:101], v[100:101], v[34:35] op_sel:[0,1] op_sel_hi:[1,1]
v_pk_mul_f32 v[102:103], v[102:103], v[34:35] op_sel:[0,1] op_sel_hi:[1,1]
v_cvt_pk_bf16_f32 v12, v76, v77
v_cvt_pk_bf16_f32 v13, v78, v79
v_cvt_pk_bf16_f32 v14, v100, v101
v_cvt_pk_bf16_f32 v15, v102, v103
v_accvgpr_write_b32 a192, v12
v_accvgpr_write_b32 a193, v13
v_accvgpr_write_b32 a194, v14
v_accvgpr_write_b32 a195, v15
v_pk_mul_f32 v[124:125], v[124:125], v[34:35] op_sel:[0,1] op_sel_hi:[1,1]
v_pk_mul_f32 v[126:127], v[126:127], v[34:35] op_sel:[0,1] op_sel_hi:[1,1]
v_pk_mul_f32 v[148:149], v[148:149], v[34:35] op_sel:[0,1] op_sel_hi:[1,1]
v_pk_mul_f32 v[150:151], v[150:151], v[34:35] op_sel:[0,1] op_sel_hi:[1,1]
v_cvt_pk_bf16_f32 v8, v124, v125
v_cvt_pk_bf16_f32 v9, v126, v127
v_cvt_pk_bf16_f32 v10, v148, v149
v_cvt_pk_bf16_f32 v11, v150, v151
v_accvgpr_write_b32 a196, v8
v_accvgpr_write_b32 a197, v9
v_accvgpr_write_b32 a198, v10
v_accvgpr_write_b32 a199, v11
v_pk_mul_f32 v[172:173], v[172:173], v[34:35] op_sel:[0,1] op_sel_hi:[1,1]
v_pk_mul_f32 v[174:175], v[174:175], v[34:35] op_sel:[0,1] op_sel_hi:[1,1]
v_pk_mul_f32 v[196:197], v[196:197], v[34:35] op_sel:[0,1] op_sel_hi:[1,1]
v_pk_mul_f32 v[198:199], v[198:199], v[34:35] op_sel:[0,1] op_sel_hi:[1,1]
v_cvt_pk_bf16_f32 v12, v172, v173
v_cvt_pk_bf16_f32 v13, v174, v175
v_cvt_pk_bf16_f32 v14, v196, v197
v_cvt_pk_bf16_f32 v15, v198, v199
v_accvgpr_write_b32 a200, v12
v_accvgpr_write_b32 a201, v13
v_accvgpr_write_b32 a202, v14
v_accvgpr_write_b32 a203, v15
v_pk_mul_f32 v[220:221], v[220:221], v[34:35] op_sel:[0,1] op_sel_hi:[1,1]
v_pk_mul_f32 v[222:223], v[222:223], v[34:35] op_sel:[0,1] op_sel_hi:[1,1]
v_pk_mul_f32 v[244:245], v[244:245], v[34:35] op_sel:[0,1] op_sel_hi:[1,1]
v_pk_mul_f32 v[246:247], v[246:247], v[34:35] op_sel:[0,1] op_sel_hi:[1,1]
v_cvt_pk_bf16_f32 v8, v220, v221
v_cvt_pk_bf16_f32 v9, v222, v223
v_cvt_pk_bf16_f32 v10, v244, v245
v_cvt_pk_bf16_f32 v11, v246, v247
v_accvgpr_write_b32 a204, v8
v_accvgpr_write_b32 a205, v9
v_accvgpr_write_b32 a206, v10
v_accvgpr_write_b32 a207, v11
v_pk_mul_f32 v[80:81], v[80:81], v[36:37] op_sel_hi:[1,0]
v_pk_mul_f32 v[82:83], v[82:83], v[36:37] op_sel_hi:[1,0]
v_pk_mul_f32 v[104:105], v[104:105], v[36:37] op_sel_hi:[1,0]
v_pk_mul_f32 v[106:107], v[106:107], v[36:37] op_sel_hi:[1,0]
v_cvt_pk_bf16_f32 v12, v80, v81
v_cvt_pk_bf16_f32 v13, v82, v83
v_cvt_pk_bf16_f32 v14, v104, v105
v_cvt_pk_bf16_f32 v15, v106, v107
v_accvgpr_write_b32 a208, v12
v_accvgpr_write_b32 a209, v13
v_accvgpr_write_b32 a210, v14
v_accvgpr_write_b32 a211, v15
v_pk_mul_f32 v[128:129], v[128:129], v[36:37] op_sel_hi:[1,0]
v_pk_mul_f32 v[130:131], v[130:131], v[36:37] op_sel_hi:[1,0]
v_pk_mul_f32 v[152:153], v[152:153], v[36:37] op_sel_hi:[1,0]
v_pk_mul_f32 v[154:155], v[154:155], v[36:37] op_sel_hi:[1,0]
v_cvt_pk_bf16_f32 v8, v128, v129
v_cvt_pk_bf16_f32 v9, v130, v131
v_cvt_pk_bf16_f32 v10, v152, v153
v_cvt_pk_bf16_f32 v11, v154, v155
v_accvgpr_write_b32 a212, v8
v_accvgpr_write_b32 a213, v9
v_accvgpr_write_b32 a214, v10
v_accvgpr_write_b32 a215, v11
v_pk_mul_f32 v[176:177], v[176:177], v[36:37] op_sel_hi:[1,0]
v_pk_mul_f32 v[178:179], v[178:179], v[36:37] op_sel_hi:[1,0]
v_pk_mul_f32 v[200:201], v[200:201], v[36:37] op_sel_hi:[1,0]
v_pk_mul_f32 v[202:203], v[202:203], v[36:37] op_sel_hi:[1,0]
v_cvt_pk_bf16_f32 v12, v176, v177
v_cvt_pk_bf16_f32 v13, v178, v179
v_cvt_pk_bf16_f32 v14, v200, v201
v_cvt_pk_bf16_f32 v15, v202, v203
v_accvgpr_write_b32 a216, v12
v_accvgpr_write_b32 a217, v13
v_accvgpr_write_b32 a218, v14
v_accvgpr_write_b32 a219, v15
v_pk_mul_f32 v[224:225], v[224:225], v[36:37] op_sel_hi:[1,0]
v_pk_mul_f32 v[226:227], v[226:227], v[36:37] op_sel_hi:[1,0]
v_pk_mul_f32 v[248:249], v[248:249], v[36:37] op_sel_hi:[1,0]
v_pk_mul_f32 v[250:251], v[250:251], v[36:37] op_sel_hi:[1,0]
v_cvt_pk_bf16_f32 v8, v224, v225
v_cvt_pk_bf16_f32 v9, v226, v227
v_cvt_pk_bf16_f32 v10, v248, v249
v_cvt_pk_bf16_f32 v11, v250, v251
v_accvgpr_write_b32 a220, v8
v_accvgpr_write_b32 a221, v9
v_accvgpr_write_b32 a222, v10
v_accvgpr_write_b32 a223, v11
v_pk_mul_f32 v[84:85], v[84:85], v[36:37] op_sel:[0,1] op_sel_hi:[1,1]
v_pk_mul_f32 v[86:87], v[86:87], v[36:37] op_sel:[0,1] op_sel_hi:[1,1]
v_pk_mul_f32 v[108:109], v[108:109], v[36:37] op_sel:[0,1] op_sel_hi:[1,1]
v_pk_mul_f32 v[110:111], v[110:111], v[36:37] op_sel:[0,1] op_sel_hi:[1,1]
v_cvt_pk_bf16_f32 v12, v84, v85
v_cvt_pk_bf16_f32 v13, v86, v87
v_cvt_pk_bf16_f32 v14, v108, v109
v_cvt_pk_bf16_f32 v15, v110, v111
v_accvgpr_write_b32 a224, v12
v_accvgpr_write_b32 a225, v13
v_accvgpr_write_b32 a226, v14
v_accvgpr_write_b32 a227, v15
v_pk_mul_f32 v[132:133], v[132:133], v[36:37] op_sel:[0,1] op_sel_hi:[1,1]
v_pk_mul_f32 v[134:135], v[134:135], v[36:37] op_sel:[0,1] op_sel_hi:[1,1]
v_pk_mul_f32 v[156:157], v[156:157], v[36:37] op_sel:[0,1] op_sel_hi:[1,1]
v_pk_mul_f32 v[158:159], v[158:159], v[36:37] op_sel:[0,1] op_sel_hi:[1,1]
v_cvt_pk_bf16_f32 v8, v132, v133
v_cvt_pk_bf16_f32 v9, v134, v135
v_cvt_pk_bf16_f32 v10, v156, v157
v_cvt_pk_bf16_f32 v11, v158, v159
v_accvgpr_write_b32 a228, v8
v_accvgpr_write_b32 a229, v9
v_accvgpr_write_b32 a230, v10
v_accvgpr_write_b32 a231, v11
v_pk_mul_f32 v[180:181], v[180:181], v[36:37] op_sel:[0,1] op_sel_hi:[1,1]
v_pk_mul_f32 v[182:183], v[182:183], v[36:37] op_sel:[0,1] op_sel_hi:[1,1]
v_pk_mul_f32 v[204:205], v[204:205], v[36:37] op_sel:[0,1] op_sel_hi:[1,1]
v_pk_mul_f32 v[206:207], v[206:207], v[36:37] op_sel:[0,1] op_sel_hi:[1,1]
v_cvt_pk_bf16_f32 v12, v180, v181
v_cvt_pk_bf16_f32 v13, v182, v183
v_cvt_pk_bf16_f32 v14, v204, v205
v_cvt_pk_bf16_f32 v15, v206, v207
v_accvgpr_write_b32 a232, v12
v_accvgpr_write_b32 a233, v13
v_accvgpr_write_b32 a234, v14
v_accvgpr_write_b32 a235, v15
v_pk_mul_f32 v[228:229], v[228:229], v[36:37] op_sel:[0,1] op_sel_hi:[1,1]
v_pk_mul_f32 v[230:231], v[230:231], v[36:37] op_sel:[0,1] op_sel_hi:[1,1]
v_pk_mul_f32 v[252:253], v[252:253], v[36:37] op_sel:[0,1] op_sel_hi:[1,1]
v_pk_mul_f32 v[254:255], v[254:255], v[36:37] op_sel:[0,1] op_sel_hi:[1,1]
v_cvt_pk_bf16_f32 v8, v228, v229
v_cvt_pk_bf16_f32 v9, v230, v231
v_cvt_pk_bf16_f32 v10, v252, v253
v_cvt_pk_bf16_f32 v11, v254, v255
v_accvgpr_write_b32 a236, v8
v_accvgpr_write_b32 a237, v9
v_accvgpr_write_b32 a238, v10
v_accvgpr_write_b32 a239, v11
s_waitcnt vmcnt(38)
ds_read_b64_tr_b16 a[0:1], v54 offset:0
ds_read_b64_tr_b16 a[2:3], v54 offset:4096
ds_read_b64_tr_b16 a[4:5], v54 offset:8
ds_read_b64_tr_b16 a[6:7], v54 offset:4104
ds_read_b64_tr_b16 a[8:9], v55 offset:0
ds_read_b64_tr_b16 a[10:11], v55 offset:4096
ds_read_b64_tr_b16 a[12:13], v55 offset:8
ds_read_b64_tr_b16 a[14:15], v55 offset:4104
ds_read_b64_tr_b16 a[16:17], v56 offset:0
ds_read_b64_tr_b16 a[18:19], v56 offset:4096
ds_read_b64_tr_b16 a[20:21], v56 offset:8
ds_read_b64_tr_b16 a[22:23], v56 offset:4104
ds_read_b64_tr_b16 a[24:25], v57 offset:0
ds_read_b64_tr_b16 a[26:27], v57 offset:4096
ds_read_b64_tr_b16 a[28:29], v57 offset:8
ds_read_b64_tr_b16 a[30:31], v57 offset:4104
s_waitcnt vmcnt(30)
s_waitcnt lgkmcnt(14)
s_waitcnt vmcnt(21)
v_mfma_f32_16x16x32_bf16 v[64:67], a[0:3], a[64:67], 0
s_waitcnt vmcnt(20)
v_mfma_f32_16x16x32_bf16 v[68:71], a[0:3], a[68:71], 0
s_add_u32 s81, s74, 98304
s_add_u32 m0, s75, 24576
s_nop 0
buffer_load_dwordx4 v2, s[20:23], s81 offen offset:0 lds
s_waitcnt vmcnt(19)
v_mfma_f32_16x16x32_bf16 v[72:75], a[0:3], a[72:75], 0
ds_read_b64_tr_b16 a[32:33], v54 offset:8192
s_waitcnt vmcnt(18)
v_mfma_f32_16x16x32_bf16 v[76:79], a[0:3], a[76:79], 0
ds_read_b64_tr_b16 a[34:35], v54 offset:12288
s_waitcnt vmcnt(16)
v_mfma_f32_16x16x32_bf16 v[80:83], a[0:3], a[80:83], 0
buffer_load_dwordx4 v3, s[20:23], s81 offen offset:1024 lds
s_waitcnt vmcnt(16)
v_mfma_f32_16x16x32_bf16 v[84:87], a[0:3], a[84:87], 0
ds_read_b64_tr_b16 a[36:37], v54 offset:8200
s_waitcnt lgkmcnt(15)
v_mfma_f32_16x16x32_bf16 v[88:91], a[4:7], a[64:67], 0
ds_read_b64_tr_b16 a[38:39], v54 offset:12296
v_mfma_f32_16x16x32_bf16 v[92:95], a[4:7], a[68:71], 0
buffer_load_dwordx4 v6, s[20:23], s81 offen offset:2048 lds
v_mfma_f32_16x16x32_bf16 v[96:99], a[4:7], a[72:75], 0
ds_read_b64_tr_b16 a[40:41], v55 offset:8192
s_add_u32 s83, s40, 1024
buffer_store_dwordx4 a[160:163], v4, s[16:19], s83 offen sc1
v_mfma_f32_16x16x32_bf16 v[100:103], a[4:7], a[76:79], 0
ds_read_b64_tr_b16 a[42:43], v55 offset:12288
v_mfma_f32_16x16x32_bf16 v[104:107], a[4:7], a[80:83], 0
buffer_load_dwordx4 v7, s[20:23], s81 offen offset:3072 lds
v_mfma_f32_16x16x32_bf16 v[108:111], a[4:7], a[84:87], 0
ds_read_b64_tr_b16 a[44:45], v55 offset:8200
s_waitcnt lgkmcnt(15)
v_mfma_f32_16x16x32_bf16 v[112:115], a[8:11], a[64:67], 0
ds_read_b64_tr_b16 a[46:47], v55 offset:12296
v_mfma_f32_16x16x32_bf16 v[116:119], a[8:11], a[68:71], 0
s_add_u32 s81, s74, 114688
s_add_u32 m0, s75, 28672
s_nop 0
buffer_load_dwordx4 v2, s[20:23], s81 offen offset:0 lds
v_mfma_f32_16x16x32_bf16 v[120:123], a[8:11], a[72:75], 0
ds_read_b64_tr_b16 a[48:49], v56 offset:8192
v_mfma_f32_16x16x32_bf16 v[124:127], a[8:11], a[76:79], 0
ds_read_b64_tr_b16 a[50:51], v56 offset:12288
v_mfma_f32_16x16x32_bf16 v[128:131], a[8:11], a[80:83], 0
buffer_load_dwordx4 v3, s[20:23], s81 offen offset:1024 lds
v_mfma_f32_16x16x32_bf16 v[132:135], a[8:11], a[84:87], 0
ds_read_b64_tr_b16 a[52:53], v56 offset:8200
s_add_u32 s83, s40, 7168
buffer_store_dwordx4 a[164:167], v4, s[16:19], s83 offen sc1
v_mfma_f32_16x16x32_bf16 v[136:139], a[12:15], a[64:67], 0
ds_read_b64_tr_b16 a[54:55], v56 offset:12296
v_mfma_f32_16x16x32_bf16 v[140:143], a[12:15], a[68:71], 0
buffer_load_dwordx4 v6, s[20:23], s81 offen offset:2048 lds
v_mfma_f32_16x16x32_bf16 v[144:147], a[12:15], a[72:75], 0
ds_read_b64_tr_b16 a[56:57], v57 offset:8192
v_mfma_f32_16x16x32_bf16 v[148:151], a[12:15], a[76:79], 0
ds_read_b64_tr_b16 a[58:59], v57 offset:12288
v_mfma_f32_16x16x32_bf16 v[152:155], a[12:15], a[80:83], 0
buffer_load_dwordx4 v7, s[20:23], s81 offen offset:3072 lds
v_mfma_f32_16x16x32_bf16 v[156:159], a[12:15], a[84:87], 0
ds_read_b64_tr_b16 a[60:61], v57 offset:8200
s_waitcnt lgkmcnt(15)
v_mfma_f32_16x16x32_bf16 v[160:163], a[16:19], a[64:67], 0
ds_read_b64_tr_b16 a[62:63], v57 offset:12296
v_mfma_f32_16x16x32_bf16 v[164:167], a[16:19], a[68:71], 0
s_add_u32 s80, s78, 18432
buffer_load_dwordx4 a[136:139], v58, s[16:19], s80 offen sc1
v_mfma_f32_16x16x32_bf16 v[168:171], a[16:19], a[72:75], 0
s_add_u32 s83, s40, 13312
buffer_store_dwordx4 a[168:171], v4, s[16:19], s83 offen sc1
v_mfma_f32_16x16x32_bf16 v[172:175], a[16:19], a[76:79], 0
v_mfma_f32_16x16x32_bf16 v[176:179], a[16:19], a[80:83], 0
buffer_load_dwordx4 a[140:143], v59, s[16:19], s80 offen sc1
v_mfma_f32_16x16x32_bf16 v[180:183], a[16:19], a[84:87], 0
v_mfma_f32_16x16x32_bf16 v[184:187], a[20:23], a[64:67], 0
v_mfma_f32_16x16x32_bf16 v[188:191], a[20:23], a[68:71], 0
buffer_load_dwordx4 a[144:147], v60, s[16:19], s80 offen sc1
v_mfma_f32_16x16x32_bf16 v[192:195], a[20:23], a[72:75], 0
v_mfma_f32_16x16x32_bf16 v[196:199], a[20:23], a[76:79], 0
v_mfma_f32_16x16x32_bf16 v[200:203], a[20:23], a[80:83], 0
buffer_load_dwordx4 a[148:151], v61, s[16:19], s80 offen sc1
v_mfma_f32_16x16x32_bf16 v[204:207], a[20:23], a[84:87], 0
s_add_u32 s83, s40, 19456
buffer_store_dwordx4 a[172:175], v4, s[16:19], s83 offen sc1
v_mfma_f32_16x16x32_bf16 v[208:211], a[24:27], a[64:67], 0
v_mfma_f32_16x16x32_bf16 v[212:215], a[24:27], a[68:71], 0
buffer_load_dwordx4 a[152:155], v62, s[16:19], s80 offen sc1
v_mfma_f32_16x16x32_bf16 v[216:219], a[24:27], a[72:75], 0
v_mfma_f32_16x16x32_bf16 v[220:223], a[24:27], a[76:79], 0
v_mfma_f32_16x16x32_bf16 v[224:227], a[24:27], a[80:83], 0
buffer_load_dwordx4 a[156:159], v63, s[16:19], s80 offen sc1
v_mfma_f32_16x16x32_bf16 v[228:231], a[24:27], a[84:87], 0
v_mfma_f32_16x16x32_bf16 v[232:235], a[28:31], a[64:67], 0
v_mfma_f32_16x16x32_bf16 v[236:239], a[28:31], a[68:71], 0
s_add_u32 s83, s40, 2048
buffer_store_dwordx4 a[176:179], v4, s[16:19], s83 offen sc1
v_mfma_f32_16x16x32_bf16 v[240:243], a[28:31], a[72:75], 0
s_add_u32 s74, s74, 262144
s_add_u32 s78, s78, 49152
v_mfma_f32_16x16x32_bf16 v[244:247], a[28:31], a[76:79], 0
v_mfma_f32_16x16x32_bf16 v[248:251], a[28:31], a[80:83], 0
v_mfma_f32_16x16x32_bf16 v[252:255], a[28:31], a[84:87], 0
s_waitcnt vmcnt(33)
s_waitcnt lgkmcnt(14)
s_waitcnt vmcnt(31)
v_mfma_f32_16x16x32_bf16 v[64:67], a[32:35], a[88:91], v[64:67]
s_waitcnt vmcnt(30)
v_mfma_f32_16x16x32_bf16 v[68:71], a[32:35], a[92:95], v[68:71]
s_add_u32 s81, s74, 0
s_add_u32 m0, s75, 0
s_nop 0
buffer_load_dwordx4 v2, s[20:23], s81 offen offset:0 lds
s_waitcnt vmcnt(29)
v_mfma_f32_16x16x32_bf16 v[72:75], a[32:35], a[96:99], v[72:75]
ds_read_b64_tr_b16 a[0:1], v54 offset:16384
s_waitcnt vmcnt(28)
v_mfma_f32_16x16x32_bf16 v[76:79], a[32:35], a[100:103], v[76:79]
ds_read_b64_tr_b16 a[2:3], v54 offset:20480
s_waitcnt vmcnt(27)
v_mfma_f32_16x16x32_bf16 v[80:83], a[32:35], a[104:107], v[80:83]
buffer_load_dwordx4 v3, s[20:23], s81 offen offset:1024 lds
s_waitcnt vmcnt(27)
v_mfma_f32_16x16x32_bf16 v[84:87], a[32:35], a[108:111], v[84:87]
ds_read_b64_tr_b16 a[4:5], v54 offset:16392
s_waitcnt lgkmcnt(15)
v_mfma_f32_16x16x32_bf16 v[88:91], a[36:39], a[88:91], v[88:91]
ds_read_b64_tr_b16 a[6:7], v54 offset:20488
v_mfma_f32_16x16x32_bf16 v[92:95], a[36:39], a[92:95], v[92:95]
buffer_load_dwordx4 v6, s[20:23], s81 offen offset:2048 lds
v_mfma_f32_16x16x32_bf16 v[96:99], a[36:39], a[96:99], v[96:99]
ds_read_b64_tr_b16 a[8:9], v55 offset:16384
s_add_u32 s83, s40, 8192
buffer_store_dwordx4 a[180:183], v4, s[16:19], s83 offen sc1
v_mfma_f32_16x16x32_bf16 v[100:103], a[36:39], a[100:103], v[100:103]
ds_read_b64_tr_b16 a[10:11], v55 offset:20480
v_mfma_f32_16x16x32_bf16 v[104:107], a[36:39], a[104:107], v[104:107]
buffer_load_dwordx4 v7, s[20:23], s81 offen offset:3072 lds
v_mfma_f32_16x16x32_bf16 v[108:111], a[36:39], a[108:111], v[108:111]
ds_read_b64_tr_b16 a[12:13], v55 offset:16392
s_waitcnt lgkmcnt(15)
v_mfma_f32_16x16x32_bf16 v[112:115], a[40:43], a[88:91], v[112:115]
ds_read_b64_tr_b16 a[14:15], v55 offset:20488
v_mfma_f32_16x16x32_bf16 v[116:119], a[40:43], a[92:95], v[116:119]
s_add_u32 s81, s74, 16384
s_add_u32 m0, s75, 4096
s_nop 0
buffer_load_dwordx4 v2, s[20:23], s81 offen offset:0 lds
v_mfma_f32_16x16x32_bf16 v[120:123], a[40:43], a[96:99], v[120:123]
ds_read_b64_tr_b16 a[16:17], v56 offset:16384
v_mfma_f32_16x16x32_bf16 v[124:127], a[40:43], a[100:103], v[124:127]
ds_read_b64_tr_b16 a[18:19], v56 offset:20480
v_mfma_f32_16x16x32_bf16 v[128:131], a[40:43], a[104:107], v[128:131]
buffer_load_dwordx4 v3, s[20:23], s81 offen offset:1024 lds
v_mfma_f32_16x16x32_bf16 v[132:135], a[40:43], a[108:111], v[132:135]
ds_read_b64_tr_b16 a[20:21], v56 offset:16392
s_add_u32 s83, s40, 14336
buffer_store_dwordx4 a[184:187], v4, s[16:19], s83 offen sc1
v_mfma_f32_16x16x32_bf16 v[136:139], a[44:47], a[88:91], v[136:139]
ds_read_b64_tr_b16 a[22:23], v56 offset:20488
v_mfma_f32_16x16x32_bf16 v[140:143], a[44:47], a[92:95], v[140:143]
buffer_load_dwordx4 v6, s[20:23], s81 offen offset:2048 lds
v_mfma_f32_16x16x32_bf16 v[144:147], a[44:47], a[96:99], v[144:147]
ds_read_b64_tr_b16 a[24:25], v57 offset:16384
v_mfma_f32_16x16x32_bf16 v[148:151], a[44:47], a[100:103], v[148:151]
ds_read_b64_tr_b16 a[26:27], v57 offset:20480
v_mfma_f32_16x16x32_bf16 v[152:155], a[44:47], a[104:107], v[152:155]
buffer_load_dwordx4 v7, s[20:23], s81 offen offset:3072 lds
v_mfma_f32_16x16x32_bf16 v[156:159], a[44:47], a[108:111], v[156:159]
ds_read_b64_tr_b16 a[28:29], v57 offset:16392
s_waitcnt lgkmcnt(15)
v_mfma_f32_16x16x32_bf16 v[160:163], a[48:51], a[88:91], v[160:163]
ds_read_b64_tr_b16 a[30:31], v57 offset:20488
v_mfma_f32_16x16x32_bf16 v[164:167], a[48:51], a[92:95], v[164:167]
s_add_u32 s80, s78, 0
buffer_load_dwordx4 a[64:67], v58, s[16:19], s80 offen sc1
v_mfma_f32_16x16x32_bf16 v[168:171], a[48:51], a[96:99], v[168:171]
s_add_u32 s83, s40, 20480
buffer_store_dwordx4 a[188:191], v4, s[16:19], s83 offen sc1
v_mfma_f32_16x16x32_bf16 v[172:175], a[48:51], a[100:103], v[172:175]
v_mfma_f32_16x16x32_bf16 v[176:179], a[48:51], a[104:107], v[176:179]
buffer_load_dwordx4 a[68:71], v59, s[16:19], s80 offen sc1
v_mfma_f32_16x16x32_bf16 v[180:183], a[48:51], a[108:111], v[180:183]
v_mfma_f32_16x16x32_bf16 v[184:187], a[52:55], a[88:91], v[184:187]
v_mfma_f32_16x16x32_bf16 v[188:191], a[52:55], a[92:95], v[188:191]
buffer_load_dwordx4 a[72:75], v60, s[16:19], s80 offen sc1
v_mfma_f32_16x16x32_bf16 v[192:195], a[52:55], a[96:99], v[192:195]
v_mfma_f32_16x16x32_bf16 v[196:199], a[52:55], a[100:103], v[196:199]
v_mfma_f32_16x16x32_bf16 v[200:203], a[52:55], a[104:107], v[200:203]
buffer_load_dwordx4 a[76:79], v61, s[16:19], s80 offen sc1
v_mfma_f32_16x16x32_bf16 v[204:207], a[52:55], a[108:111], v[204:207]
s_add_u32 s83, s40, 3072
buffer_store_dwordx4 a[192:195], v4, s[16:19], s83 offen sc1
v_mfma_f32_16x16x32_bf16 v[208:211], a[56:59], a[88:91], v[208:211]
v_mfma_f32_16x16x32_bf16 v[212:215], a[56:59], a[92:95], v[212:215]
buffer_load_dwordx4 a[80:83], v62, s[16:19], s80 offen sc1
v_mfma_f32_16x16x32_bf16 v[216:219], a[56:59], a[96:99], v[216:219]
v_mfma_f32_16x16x32_bf16 v[220:223], a[56:59], a[100:103], v[220:223]
v_mfma_f32_16x16x32_bf16 v[224:227], a[56:59], a[104:107], v[224:227]
buffer_load_dwordx4 a[84:87], v63, s[16:19], s80 offen sc1
v_mfma_f32_16x16x32_bf16 v[228:231], a[56:59], a[108:111], v[228:231]
v_mfma_f32_16x16x32_bf16 v[232:235], a[60:63], a[88:91], v[232:235]
v_mfma_f32_16x16x32_bf16 v[236:239], a[60:63], a[92:95], v[236:239]
s_add_u32 s83, s40, 9216
buffer_store_dwordx4 a[196:199], v4, s[16:19], s83 offen sc1
v_mfma_f32_16x16x32_bf16 v[240:243], a[60:63], a[96:99], v[240:243]
v_mfma_f32_16x16x32_bf16 v[244:247], a[60:63], a[100:103], v[244:247]
v_mfma_f32_16x16x32_bf16 v[248:251], a[60:63], a[104:107], v[248:251]
v_mfma_f32_16x16x32_bf16 v[252:255], a[60:63], a[108:111], v[252:255]
s_waitcnt vmcnt(28)
s_waitcnt lgkmcnt(14)
v_mfma_f32_16x16x32_bf16 v[64:67], a[0:3], a[112:115], v[64:67]
v_mfma_f32_16x16x32_bf16 v[68:71], a[0:3], a[116:119], v[68:71]
s_add_u32 s81, s74, 32768
s_add_u32 m0, s75, 8192
s_nop 0
buffer_load_dwordx4 v2, s[20:23], s81 offen offset:0 lds
v_mfma_f32_16x16x32_bf16 v[72:75], a[0:3], a[120:123], v[72:75]
ds_read_b64_tr_b16 a[32:33], v54 offset:24576
v_mfma_f32_16x16x32_bf16 v[76:79], a[0:3], a[124:127], v[76:79]
ds_read_b64_tr_b16 a[34:35], v54 offset:28672
v_mfma_f32_16x16x32_bf16 v[80:83], a[0:3], a[128:131], v[80:83]
buffer_load_dwordx4 v3, s[20:23], s81 offen offset:1024 lds
v_mfma_f32_16x16x32_bf16 v[84:87], a[0:3], a[132:135], v[84:87]
ds_read_b64_tr_b16 a[36:37], v54 offset:24584
s_waitcnt lgkmcnt(15)
v_mfma_f32_16x16x32_bf16 v[88:91], a[4:7], a[112:115], v[88:91]
ds_read_b64_tr_b16 a[38:39], v54 offset:28680
v_mfma_f32_16x16x32_bf16 v[92:95], a[4:7], a[116:119], v[92:95]
buffer_load_dwordx4 v6, s[20:23], s81 offen offset:2048 lds
v_mfma_f32_16x16x32_bf16 v[96:99], a[4:7], a[120:123], v[96:99]
ds_read_b64_tr_b16 a[40:41], v55 offset:24576
s_add_u32 s83, s40, 15360
buffer_store_dwordx4 a[200:203], v4, s[16:19], s83 offen sc1
v_mfma_f32_16x16x32_bf16 v[100:103], a[4:7], a[124:127], v[100:103]
ds_read_b64_tr_b16 a[42:43], v55 offset:28672
v_mfma_f32_16x16x32_bf16 v[104:107], a[4:7], a[128:131], v[104:107]
buffer_load_dwordx4 v7, s[20:23], s81 offen offset:3072 lds
v_mfma_f32_16x16x32_bf16 v[108:111], a[4:7], a[132:135], v[108:111]
ds_read_b64_tr_b16 a[44:45], v55 offset:24584
s_waitcnt lgkmcnt(15)
v_mfma_f32_16x16x32_bf16 v[112:115], a[8:11], a[112:115], v[112:115]
ds_read_b64_tr_b16 a[46:47], v55 offset:28680
v_mfma_f32_16x16x32_bf16 v[116:119], a[8:11], a[116:119], v[116:119]
s_add_u32 s81, s74, 49152
s_add_u32 m0, s75, 12288
s_nop 0
buffer_load_dwordx4 v2, s[20:23], s81 offen offset:0 lds
v_mfma_f32_16x16x32_bf16 v[120:123], a[8:11], a[120:123], v[120:123]
ds_read_b64_tr_b16 a[48:49], v56 offset:24576
v_mfma_f32_16x16x32_bf16 v[124:127], a[8:11], a[124:127], v[124:127]
ds_read_b64_tr_b16 a[50:51], v56 offset:28672
v_mfma_f32_16x16x32_bf16 v[128:131], a[8:11], a[128:131], v[128:131]
buffer_load_dwordx4 v3, s[20:23], s81 offen offset:1024 lds
v_mfma_f32_16x16x32_bf16 v[132:135], a[8:11], a[132:135], v[132:135]
ds_read_b64_tr_b16 a[52:53], v56 offset:24584
s_add_u32 s83, s40, 21504
buffer_store_dwordx4 a[204:207], v4, s[16:19], s83 offen sc1
v_mfma_f32_16x16x32_bf16 v[136:139], a[12:15], a[112:115], v[136:139]
ds_read_b64_tr_b16 a[54:55], v56 offset:28680
v_mfma_f32_16x16x32_bf16 v[140:143], a[12:15], a[116:119], v[140:143]
buffer_load_dwordx4 v6, s[20:23], s81 offen offset:2048 lds
v_mfma_f32_16x16x32_bf16 v[144:147], a[12:15], a[120:123], v[144:147]
ds_read_b64_tr_b16 a[56:57], v57 offset:24576
v_mfma_f32_16x16x32_bf16 v[148:151], a[12:15], a[124:127], v[148:151]
ds_read_b64_tr_b16 a[58:59], v57 offset:28672
v_mfma_f32_16x16x32_bf16 v[152:155], a[12:15], a[128:131], v[152:155]
buffer_load_dwordx4 v7, s[20:23], s81 offen offset:3072 lds
v_mfma_f32_16x16x32_bf16 v[156:159], a[12:15], a[132:135], v[156:159]
ds_read_b64_tr_b16 a[60:61], v57 offset:24584
s_waitcnt lgkmcnt(15)
v_mfma_f32_16x16x32_bf16 v[160:163], a[16:19], a[112:115], v[160:163]
ds_read_b64_tr_b16 a[62:63], v57 offset:28680
v_mfma_f32_16x16x32_bf16 v[164:167], a[16:19], a[116:119], v[164:167]
s_add_u32 s80, s78, 6144
buffer_load_dwordx4 a[88:91], v58, s[16:19], s80 offen sc1
v_mfma_f32_16x16x32_bf16 v[168:171], a[16:19], a[120:123], v[168:171]
s_add_u32 s83, s40, 4096
buffer_store_dwordx4 a[208:211], v4, s[16:19], s83 offen sc1
v_mfma_f32_16x16x32_bf16 v[172:175], a[16:19], a[124:127], v[172:175]
v_mfma_f32_16x16x32_bf16 v[176:179], a[16:19], a[128:131], v[176:179]
buffer_load_dwordx4 a[92:95], v59, s[16:19], s80 offen sc1
v_mfma_f32_16x16x32_bf16 v[180:183], a[16:19], a[132:135], v[180:183]
v_mfma_f32_16x16x32_bf16 v[184:187], a[20:23], a[112:115], v[184:187]
v_mfma_f32_16x16x32_bf16 v[188:191], a[20:23], a[116:119], v[188:191]
buffer_load_dwordx4 a[96:99], v60, s[16:19], s80 offen sc1
v_mfma_f32_16x16x32_bf16 v[192:195], a[20:23], a[120:123], v[192:195]
v_mfma_f32_16x16x32_bf16 v[196:199], a[20:23], a[124:127], v[196:199]
v_mfma_f32_16x16x32_bf16 v[200:203], a[20:23], a[128:131], v[200:203]
buffer_load_dwordx4 a[100:103], v61, s[16:19], s80 offen sc1
v_mfma_f32_16x16x32_bf16 v[204:207], a[20:23], a[132:135], v[204:207]
s_add_u32 s83, s40, 10240
buffer_store_dwordx4 a[212:215], v4, s[16:19], s83 offen sc1
v_mfma_f32_16x16x32_bf16 v[208:211], a[24:27], a[112:115], v[208:211]
v_mfma_f32_16x16x32_bf16 v[212:215], a[24:27], a[116:119], v[212:215]
buffer_load_dwordx4 a[104:107], v62, s[16:19], s80 offen sc1
v_mfma_f32_16x16x32_bf16 v[216:219], a[24:27], a[120:123], v[216:219]
v_mfma_f32_16x16x32_bf16 v[220:223], a[24:27], a[124:127], v[220:223]
v_mfma_f32_16x16x32_bf16 v[224:227], a[24:27], a[128:131], v[224:227]
buffer_load_dwordx4 a[108:111], v63, s[16:19], s80 offen sc1
v_mfma_f32_16x16x32_bf16 v[228:231], a[24:27], a[132:135], v[228:231]
v_mfma_f32_16x16x32_bf16 v[232:235], a[28:31], a[112:115], v[232:235]
v_mfma_f32_16x16x32_bf16 v[236:239], a[28:31], a[116:119], v[236:239]
s_add_u32 s83, s40, 16384
buffer_store_dwordx4 a[216:219], v4, s[16:19], s83 offen sc1
v_mfma_f32_16x16x32_bf16 v[240:243], a[28:31], a[120:123], v[240:243]
v_mfma_f32_16x16x32_bf16 v[244:247], a[28:31], a[124:127], v[244:247]
v_mfma_f32_16x16x32_bf16 v[248:251], a[28:31], a[128:131], v[248:251]
v_mfma_f32_16x16x32_bf16 v[252:255], a[28:31], a[132:135], v[252:255]
s_waitcnt vmcnt(28)
s_waitcnt lgkmcnt(14)
v_mfma_f32_16x16x32_bf16 v[64:67], a[32:35], a[136:139], v[64:67]
v_mfma_f32_16x16x32_bf16 v[68:71], a[32:35], a[140:143], v[68:71]
s_add_u32 s81, s74, 65536
s_add_u32 m0, s75, 16384
s_nop 0
buffer_load_dwordx4 v2, s[20:23], s81 offen offset:0 lds
v_mfma_f32_16x16x32_bf16 v[72:75], a[32:35], a[144:147], v[72:75]
ds_read_b64_tr_b16 a[0:1], v54 offset:0
v_mfma_f32_16x16x32_bf16 v[76:79], a[32:35], a[148:151], v[76:79]
ds_read_b64_tr_b16 a[2:3], v54 offset:4096
v_mfma_f32_16x16x32_bf16 v[80:83], a[32:35], a[152:155], v[80:83]
buffer_load_dwordx4 v3, s[20:23], s81 offen offset:1024 lds
v_mfma_f32_16x16x32_bf16 v[84:87], a[32:35], a[156:159], v[84:87]
ds_read_b64_tr_b16 a[4:5], v54 offset:8
s_waitcnt lgkmcnt(15)
v_mfma_f32_16x16x32_bf16 v[88:91], a[36:39], a[136:139], v[88:91]
ds_read_b64_tr_b16 a[6:7], v54 offset:4104
v_mfma_f32_16x16x32_bf16 v[92:95], a[36:39], a[140:143], v[92:95]
buffer_load_dwordx4 v6, s[20:23], s81 offen offset:2048 lds
v_mfma_f32_16x16x32_bf16 v[96:99], a[36:39], a[144:147], v[96:99]
ds_read_b64_tr_b16 a[8:9], v55 offset:0
s_add_u32 s83, s40, 22528
buffer_store_dwordx4 a[220:223], v4, s[16:19], s83 offen sc1
v_mfma_f32_16x16x32_bf16 v[100:103], a[36:39], a[148:151], v[100:103]
ds_read_b64_tr_b16 a[10:11], v55 offset:4096
v_mfma_f32_16x16x32_bf16 v[104:107], a[36:39], a[152:155], v[104:107]
buffer_load_dwordx4 v7, s[20:23], s81 offen offset:3072 lds
v_mfma_f32_16x16x32_bf16 v[108:111], a[36:39], a[156:159], v[108:111]
ds_read_b64_tr_b16 a[12:13], v55 offset:8
s_waitcnt lgkmcnt(15)
v_mfma_f32_16x16x32_bf16 v[112:115], a[40:43], a[136:139], v[112:115]
ds_read_b64_tr_b16 a[14:15], v55 offset:4104
v_mfma_f32_16x16x32_bf16 v[116:119], a[40:43], a[140:143], v[116:119]
s_add_u32 s81, s74, 81920
s_add_u32 m0, s75, 20480
s_nop 0
buffer_load_dwordx4 v2, s[20:23], s81 offen offset:0 lds
v_mfma_f32_16x16x32_bf16 v[120:123], a[40:43], a[144:147], v[120:123]
ds_read_b64_tr_b16 a[16:17], v56 offset:0
v_mfma_f32_16x16x32_bf16 v[124:127], a[40:43], a[148:151], v[124:127]
ds_read_b64_tr_b16 a[18:19], v56 offset:4096
v_mfma_f32_16x16x32_bf16 v[128:131], a[40:43], a[152:155], v[128:131]
buffer_load_dwordx4 v3, s[20:23], s81 offen offset:1024 lds
v_mfma_f32_16x16x32_bf16 v[132:135], a[40:43], a[156:159], v[132:135]
ds_read_b64_tr_b16 a[20:21], v56 offset:8
s_add_u32 s83, s40, 5120
buffer_store_dwordx4 a[224:227], v4, s[16:19], s83 offen sc1
v_mfma_f32_16x16x32_bf16 v[136:139], a[44:47], a[136:139], v[136:139]
ds_read_b64_tr_b16 a[22:23], v56 offset:4104
v_mfma_f32_16x16x32_bf16 v[140:143], a[44:47], a[140:143], v[140:143]
buffer_load_dwordx4 v6, s[20:23], s81 offen offset:2048 lds
v_mfma_f32_16x16x32_bf16 v[144:147], a[44:47], a[144:147], v[144:147]
ds_read_b64_tr_b16 a[24:25], v57 offset:0
v_mfma_f32_16x16x32_bf16 v[148:151], a[44:47], a[148:151], v[148:151]
ds_read_b64_tr_b16 a[26:27], v57 offset:4096
v_mfma_f32_16x16x32_bf16 v[152:155], a[44:47], a[152:155], v[152:155]
buffer_load_dwordx4 v7, s[20:23], s81 offen offset:3072 lds
v_mfma_f32_16x16x32_bf16 v[156:159], a[44:47], a[156:159], v[156:159]
ds_read_b64_tr_b16 a[28:29], v57 offset:8
s_waitcnt lgkmcnt(15)
v_mfma_f32_16x16x32_bf16 v[160:163], a[48:51], a[136:139], v[160:163]
ds_read_b64_tr_b16 a[30:31], v57 offset:4104
v_mfma_f32_16x16x32_bf16 v[164:167], a[48:51], a[140:143], v[164:167]
s_add_u32 s80, s78, 12288
buffer_load_dwordx4 a[112:115], v58, s[16:19], s80 offen sc1
v_mfma_f32_16x16x32_bf16 v[168:171], a[48:51], a[144:147], v[168:171]
s_add_u32 s83, s40, 11264
buffer_store_dwordx4 a[228:231], v4, s[16:19], s83 offen sc1
v_mfma_f32_16x16x32_bf16 v[172:175], a[48:51], a[148:151], v[172:175]
v_mfma_f32_16x16x32_bf16 v[176:179], a[48:51], a[152:155], v[176:179]
buffer_load_dwordx4 a[116:119], v59, s[16:19], s80 offen sc1
v_mfma_f32_16x16x32_bf16 v[180:183], a[48:51], a[156:159], v[180:183]
v_mfma_f32_16x16x32_bf16 v[184:187], a[52:55], a[136:139], v[184:187]
v_mfma_f32_16x16x32_bf16 v[188:191], a[52:55], a[140:143], v[188:191]
buffer_load_dwordx4 a[120:123], v60, s[16:19], s80 offen sc1
v_mfma_f32_16x16x32_bf16 v[192:195], a[52:55], a[144:147], v[192:195]
v_mfma_f32_16x16x32_bf16 v[196:199], a[52:55], a[148:151], v[196:199]
v_mfma_f32_16x16x32_bf16 v[200:203], a[52:55], a[152:155], v[200:203]
buffer_load_dwordx4 a[124:127], v61, s[16:19], s80 offen sc1
v_mfma_f32_16x16x32_bf16 v[204:207], a[52:55], a[156:159], v[204:207]
s_add_u32 s83, s40, 17408
buffer_store_dwordx4 a[232:235], v4, s[16:19], s83 offen sc1
v_mfma_f32_16x16x32_bf16 v[208:211], a[56:59], a[136:139], v[208:211]
v_mfma_f32_16x16x32_bf16 v[212:215], a[56:59], a[140:143], v[212:215]
buffer_load_dwordx4 a[128:131], v62, s[16:19], s80 offen sc1
v_mfma_f32_16x16x32_bf16 v[216:219], a[56:59], a[144:147], v[216:219]
v_mfma_f32_16x16x32_bf16 v[220:223], a[56:59], a[148:151], v[220:223]
v_mfma_f32_16x16x32_bf16 v[224:227], a[56:59], a[152:155], v[224:227]
buffer_load_dwordx4 a[132:135], v63, s[16:19], s80 offen sc1
v_mfma_f32_16x16x32_bf16 v[228:231], a[56:59], a[156:159], v[228:231]
v_mfma_f32_16x16x32_bf16 v[232:235], a[60:63], a[136:139], v[232:235]
v_mfma_f32_16x16x32_bf16 v[236:239], a[60:63], a[140:143], v[236:239]
s_add_u32 s83, s40, 23552
buffer_store_dwordx4 a[236:239], v4, s[16:19], s83 offen sc1
v_mfma_f32_16x16x32_bf16 v[240:243], a[60:63], a[144:147], v[240:243]
v_mfma_f32_16x16x32_bf16 v[244:247], a[60:63], a[148:151], v[244:247]
v_mfma_f32_16x16x32_bf16 v[248:251], a[60:63], a[152:155], v[248:251]
v_mfma_f32_16x16x32_bf16 v[252:255], a[60:63], a[156:159], v[252:255]
s_waitcnt vmcnt(28)
s_waitcnt lgkmcnt(14)
v_mfma_f32_16x16x32_bf16 v[64:67], a[0:3], a[64:67], v[64:67]
v_mfma_f32_16x16x32_bf16 v[68:71], a[0:3], a[68:71], v[68:71]
s_add_u32 s81, s74, 98304
s_add_u32 m0, s75, 24576
s_nop 0
buffer_load_dwordx4 v2, s[20:23], s81 offen offset:0 lds
v_mfma_f32_16x16x32_bf16 v[72:75], a[0:3], a[72:75], v[72:75]
ds_read_b64_tr_b16 a[32:33], v54 offset:8192
v_mfma_f32_16x16x32_bf16 v[76:79], a[0:3], a[76:79], v[76:79]
ds_read_b64_tr_b16 a[34:35], v54 offset:12288
v_mfma_f32_16x16x32_bf16 v[80:83], a[0:3], a[80:83], v[80:83]
buffer_load_dwordx4 v3, s[20:23], s81 offen offset:1024 lds
v_mfma_f32_16x16x32_bf16 v[84:87], a[0:3], a[84:87], v[84:87]
ds_read_b64_tr_b16 a[36:37], v54 offset:8200
s_waitcnt lgkmcnt(15)
v_mfma_f32_16x16x32_bf16 v[88:91], a[4:7], a[64:67], v[88:91]
ds_read_b64_tr_b16 a[38:39], v54 offset:12296
v_mfma_f32_16x16x32_bf16 v[92:95], a[4:7], a[68:71], v[92:95]
buffer_load_dwordx4 v6, s[20:23], s81 offen offset:2048 lds
v_mfma_f32_16x16x32_bf16 v[96:99], a[4:7], a[72:75], v[96:99]
ds_read_b64_tr_b16 a[40:41], v55 offset:8192
v_mfma_f32_16x16x32_bf16 v[100:103], a[4:7], a[76:79], v[100:103]
ds_read_b64_tr_b16 a[42:43], v55 offset:12288
v_mfma_f32_16x16x32_bf16 v[104:107], a[4:7], a[80:83], v[104:107]
buffer_load_dwordx4 v7, s[20:23], s81 offen offset:3072 lds
v_mfma_f32_16x16x32_bf16 v[108:111], a[4:7], a[84:87], v[108:111]
ds_read_b64_tr_b16 a[44:45], v55 offset:8200
s_waitcnt lgkmcnt(15)
v_mfma_f32_16x16x32_bf16 v[112:115], a[8:11], a[64:67], v[112:115]
ds_read_b64_tr_b16 a[46:47], v55 offset:12296
v_mfma_f32_16x16x32_bf16 v[116:119], a[8:11], a[68:71], v[116:119]
s_add_u32 s81, s74, 114688
s_add_u32 m0, s75, 28672
s_nop 0
buffer_load_dwordx4 v2, s[20:23], s81 offen offset:0 lds
v_mfma_f32_16x16x32_bf16 v[120:123], a[8:11], a[72:75], v[120:123]
ds_read_b64_tr_b16 a[48:49], v56 offset:8192
v_mfma_f32_16x16x32_bf16 v[124:127], a[8:11], a[76:79], v[124:127]
ds_read_b64_tr_b16 a[50:51], v56 offset:12288
v_mfma_f32_16x16x32_bf16 v[128:131], a[8:11], a[80:83], v[128:131]
buffer_load_dwordx4 v3, s[20:23], s81 offen offset:1024 lds
v_mfma_f32_16x16x32_bf16 v[132:135], a[8:11], a[84:87], v[132:135]
ds_read_b64_tr_b16 a[52:53], v56 offset:8200
v_mfma_f32_16x16x32_bf16 v[136:139], a[12:15], a[64:67], v[136:139]
ds_read_b64_tr_b16 a[54:55], v56 offset:12296
v_mfma_f32_16x16x32_bf16 v[140:143], a[12:15], a[68:71], v[140:143]
buffer_load_dwordx4 v6, s[20:23], s81 offen offset:2048 lds
v_mfma_f32_16x16x32_bf16 v[144:147], a[12:15], a[72:75], v[144:147]
ds_read_b64_tr_b16 a[56:57], v57 offset:8192
v_mfma_f32_16x16x32_bf16 v[148:151], a[12:15], a[76:79], v[148:151]
ds_read_b64_tr_b16 a[58:59], v57 offset:12288
v_mfma_f32_16x16x32_bf16 v[152:155], a[12:15], a[80:83], v[152:155]
buffer_load_dwordx4 v7, s[20:23], s81 offen offset:3072 lds
v_mfma_f32_16x16x32_bf16 v[156:159], a[12:15], a[84:87], v[156:159]
ds_read_b64_tr_b16 a[60:61], v57 offset:8200
s_waitcnt lgkmcnt(15)
v_mfma_f32_16x16x32_bf16 v[160:163], a[16:19], a[64:67], v[160:163]
ds_read_b64_tr_b16 a[62:63], v57 offset:12296
v_mfma_f32_16x16x32_bf16 v[164:167], a[16:19], a[68:71], v[164:167]
s_add_u32 s80, s78, 18432
buffer_load_dwordx4 a[136:139], v58, s[16:19], s80 offen sc1
v_mfma_f32_16x16x32_bf16 v[168:171], a[16:19], a[72:75], v[168:171]
v_mfma_f32_16x16x32_bf16 v[172:175], a[16:19], a[76:79], v[172:175]
v_mfma_f32_16x16x32_bf16 v[176:179], a[16:19], a[80:83], v[176:179]
buffer_load_dwordx4 a[140:143], v59, s[16:19], s80 offen sc1
v_mfma_f32_16x16x32_bf16 v[180:183], a[16:19], a[84:87], v[180:183]
v_mfma_f32_16x16x32_bf16 v[184:187], a[20:23], a[64:67], v[184:187]
v_mfma_f32_16x16x32_bf16 v[188:191], a[20:23], a[68:71], v[188:191]
buffer_load_dwordx4 a[144:147], v60, s[16:19], s80 offen sc1
v_mfma_f32_16x16x32_bf16 v[192:195], a[20:23], a[72:75], v[192:195]
v_mfma_f32_16x16x32_bf16 v[196:199], a[20:23], a[76:79], v[196:199]
v_mfma_f32_16x16x32_bf16 v[200:203], a[20:23], a[80:83], v[200:203]
buffer_load_dwordx4 a[148:151], v61, s[16:19], s80 offen sc1
v_mfma_f32_16x16x32_bf16 v[204:207], a[20:23], a[84:87], v[204:207]
v_mfma_f32_16x16x32_bf16 v[208:211], a[24:27], a[64:67], v[208:211]
v_mfma_f32_16x16x32_bf16 v[212:215], a[24:27], a[68:71], v[212:215]
buffer_load_dwordx4 a[152:155], v62, s[16:19], s80 offen sc1
v_mfma_f32_16x16x32_bf16 v[216:219], a[24:27], a[72:75], v[216:219]
v_mfma_f32_16x16x32_bf16 v[220:223], a[24:27], a[76:79], v[220:223]
v_mfma_f32_16x16x32_bf16 v[224:227], a[24:27], a[80:83], v[224:227]
buffer_load_dwordx4 a[156:159], v63, s[16:19], s80 offen sc1
v_mfma_f32_16x16x32_bf16 v[228:231], a[24:27], a[84:87], v[228:231]
v_mfma_f32_16x16x32_bf16 v[232:235], a[28:31], a[64:67], v[232:235]
v_mfma_f32_16x16x32_bf16 v[236:239], a[28:31], a[68:71], v[236:239]
v_mfma_f32_16x16x32_bf16 v[240:243], a[28:31], a[72:75], v[240:243]
s_add_u32 s74, s74, 262144
s_add_u32 s78, s78, 49152
v_mfma_f32_16x16x32_bf16 v[244:247], a[28:31], a[76:79], v[244:247]
v_mfma_f32_16x16x32_bf16 v[248:251], a[28:31], a[80:83], v[248:251]
v_mfma_f32_16x16x32_bf16 v[252:255], a[28:31], a[84:87], v[252:255]
s_waitcnt vmcnt(23)
s_waitcnt lgkmcnt(14)
v_mfma_f32_16x16x32_bf16 v[64:67], a[32:35], a[88:91], v[64:67]
v_mfma_f32_16x16x32_bf16 v[68:71], a[32:35], a[92:95], v[68:71]
s_add_u32 s81, s74, 0
s_add_u32 m0, s75, 0
s_nop 0
buffer_load_dwordx4 v2, s[20:23], s81 offen offset:0 lds
v_mfma_f32_16x16x32_bf16 v[72:75], a[32:35], a[96:99], v[72:75]
ds_read_b64_tr_b16 a[0:1], v54 offset:16384
v_mfma_f32_16x16x32_bf16 v[76:79], a[32:35], a[100:103], v[76:79]
ds_read_b64_tr_b16 a[2:3], v54 offset:20480
v_mfma_f32_16x16x32_bf16 v[80:83], a[32:35], a[104:107], v[80:83]
buffer_load_dwordx4 v3, s[20:23], s81 offen offset:1024 lds
v_mfma_f32_16x16x32_bf16 v[84:87], a[32:35], a[108:111], v[84:87]
ds_read_b64_tr_b16 a[4:5], v54 offset:16392
s_waitcnt lgkmcnt(15)
v_mfma_f32_16x16x32_bf16 v[88:91], a[36:39], a[88:91], v[88:91]
ds_read_b64_tr_b16 a[6:7], v54 offset:20488
v_mfma_f32_16x16x32_bf16 v[92:95], a[36:39], a[92:95], v[92:95]
buffer_load_dwordx4 v6, s[20:23], s81 offen offset:2048 lds
v_mfma_f32_16x16x32_bf16 v[96:99], a[36:39], a[96:99], v[96:99]
ds_read_b64_tr_b16 a[8:9], v55 offset:16384
v_mfma_f32_16x16x32_bf16 v[100:103], a[36:39], a[100:103], v[100:103]
ds_read_b64_tr_b16 a[10:11], v55 offset:20480
v_mfma_f32_16x16x32_bf16 v[104:107], a[36:39], a[104:107], v[104:107]
buffer_load_dwordx4 v7, s[20:23], s81 offen offset:3072 lds
v_mfma_f32_16x16x32_bf16 v[108:111], a[36:39], a[108:111], v[108:111]
ds_read_b64_tr_b16 a[12:13], v55 offset:16392
s_waitcnt lgkmcnt(15)
v_mfma_f32_16x16x32_bf16 v[112:115], a[40:43], a[88:91], v[112:115]
ds_read_b64_tr_b16 a[14:15], v55 offset:20488
v_mfma_f32_16x16x32_bf16 v[116:119], a[40:43], a[92:95], v[116:119]
s_add_u32 s81, s74, 16384
s_add_u32 m0, s75, 4096
s_nop 0
buffer_load_dwordx4 v2, s[20:23], s81 offen offset:0 lds
v_mfma_f32_16x16x32_bf16 v[120:123], a[40:43], a[96:99], v[120:123]
ds_read_b64_tr_b16 a[16:17], v56 offset:16384
v_mfma_f32_16x16x32_bf16 v[124:127], a[40:43], a[100:103], v[124:127]
ds_read_b64_tr_b16 a[18:19], v56 offset:20480
v_mfma_f32_16x16x32_bf16 v[128:131], a[40:43], a[104:107], v[128:131]
buffer_load_dwordx4 v3, s[20:23], s81 offen offset:1024 lds
v_mfma_f32_16x16x32_bf16 v[132:135], a[40:43], a[108:111], v[132:135]
ds_read_b64_tr_b16 a[20:21], v56 offset:16392
v_mfma_f32_16x16x32_bf16 v[136:139], a[44:47], a[88:91], v[136:139]
ds_read_b64_tr_b16 a[22:23], v56 offset:20488
v_mfma_f32_16x16x32_bf16 v[140:143], a[44:47], a[92:95], v[140:143]
buffer_load_dwordx4 v6, s[20:23], s81 offen offset:2048 lds
v_mfma_f32_16x16x32_bf16 v[144:147], a[44:47], a[96:99], v[144:147]
ds_read_b64_tr_b16 a[24:25], v57 offset:16384
v_mfma_f32_16x16x32_bf16 v[148:151], a[44:47], a[100:103], v[148:151]
ds_read_b64_tr_b16 a[26:27], v57 offset:20480
v_mfma_f32_16x16x32_bf16 v[152:155], a[44:47], a[104:107], v[152:155]
buffer_load_dwordx4 v7, s[20:23], s81 offen offset:3072 lds
v_mfma_f32_16x16x32_bf16 v[156:159], a[44:47], a[108:111], v[156:159]
ds_read_b64_tr_b16 a[28:29], v57 offset:16392
s_waitcnt lgkmcnt(15)
v_mfma_f32_16x16x32_bf16 v[160:163], a[48:51], a[88:91], v[160:163]
ds_read_b64_tr_b16 a[30:31], v57 offset:20488
v_mfma_f32_16x16x32_bf16 v[164:167], a[48:51], a[92:95], v[164:167]
s_add_u32 s80, s78, 0
buffer_load_dwordx4 a[64:67], v58, s[16:19], s80 offen sc1
v_mfma_f32_16x16x32_bf16 v[168:171], a[48:51], a[96:99], v[168:171]
v_mfma_f32_16x16x32_bf16 v[172:175], a[48:51], a[100:103], v[172:175]
v_mfma_f32_16x16x32_bf16 v[176:179], a[48:51], a[104:107], v[176:179]
buffer_load_dwordx4 a[68:71], v59, s[16:19], s80 offen sc1
v_mfma_f32_16x16x32_bf16 v[180:183], a[48:51], a[108:111], v[180:183]
v_mfma_f32_16x16x32_bf16 v[184:187], a[52:55], a[88:91], v[184:187]
v_mfma_f32_16x16x32_bf16 v[188:191], a[52:55], a[92:95], v[188:191]
buffer_load_dwordx4 a[72:75], v60, s[16:19], s80 offen sc1
v_mfma_f32_16x16x32_bf16 v[192:195], a[52:55], a[96:99], v[192:195]
v_mfma_f32_16x16x32_bf16 v[196:199], a[52:55], a[100:103], v[196:199]
v_mfma_f32_16x16x32_bf16 v[200:203], a[52:55], a[104:107], v[200:203]
buffer_load_dwordx4 a[76:79], v61, s[16:19], s80 offen sc1
v_mfma_f32_16x16x32_bf16 v[204:207], a[52:55], a[108:111], v[204:207]
v_mfma_f32_16x16x32_bf16 v[208:211], a[56:59], a[88:91], v[208:211]
v_mfma_f32_16x16x32_bf16 v[212:215], a[56:59], a[92:95], v[212:215]
buffer_load_dwordx4 a[80:83], v62, s[16:19], s80 offen sc1
v_mfma_f32_16x16x32_bf16 v[216:219], a[56:59], a[96:99], v[216:219]
v_mfma_f32_16x16x32_bf16 v[220:223], a[56:59], a[100:103], v[220:223]
v_mfma_f32_16x16x32_bf16 v[224:227], a[56:59], a[104:107], v[224:227]
buffer_load_dwordx4 a[84:87], v63, s[16:19], s80 offen sc1
v_mfma_f32_16x16x32_bf16 v[228:231], a[56:59], a[108:111], v[228:231]
v_mfma_f32_16x16x32_bf16 v[232:235], a[60:63], a[88:91], v[232:235]
v_mfma_f32_16x16x32_bf16 v[236:239], a[60:63], a[92:95], v[236:239]
v_mfma_f32_16x16x32_bf16 v[240:243], a[60:63], a[96:99], v[240:243]
v_mfma_f32_16x16x32_bf16 v[244:247], a[60:63], a[100:103], v[244:247]
v_mfma_f32_16x16x32_bf16 v[248:251], a[60:63], a[104:107], v[248:251]
v_mfma_f32_16x16x32_bf16 v[252:255], a[60:63], a[108:111], v[252:255]
s_waitcnt vmcnt(20)
s_waitcnt lgkmcnt(14)
v_mfma_f32_16x16x32_bf16 v[64:67], a[0:3], a[112:115], v[64:67]
v_mfma_f32_16x16x32_bf16 v[68:71], a[0:3], a[116:119], v[68:71]
s_add_u32 s81, s74, 32768
s_add_u32 m0, s75, 8192
s_nop 0
buffer_load_dwordx4 v2, s[20:23], s81 offen offset:0 lds
v_mfma_f32_16x16x32_bf16 v[72:75], a[0:3], a[120:123], v[72:75]
ds_read_b64_tr_b16 a[32:33], v54 offset:24576
v_mfma_f32_16x16x32_bf16 v[76:79], a[0:3], a[124:127], v[76:79]
ds_read_b64_tr_b16 a[34:35], v54 offset:28672
v_mfma_f32_16x16x32_bf16 v[80:83], a[0:3], a[128:131], v[80:83]
buffer_load_dwordx4 v3, s[20:23], s81 offen offset:1024 lds
v_mfma_f32_16x16x32_bf16 v[84:87], a[0:3], a[132:135], v[84:87]
ds_read_b64_tr_b16 a[36:37], v54 offset:24584
s_waitcnt lgkmcnt(15)
v_mfma_f32_16x16x32_bf16 v[88:91], a[4:7], a[112:115], v[88:91]
ds_read_b64_tr_b16 a[38:39], v54 offset:28680
v_mfma_f32_16x16x32_bf16 v[92:95], a[4:7], a[116:119], v[92:95]
buffer_load_dwordx4 v6, s[20:23], s81 offen offset:2048 lds
v_mfma_f32_16x16x32_bf16 v[96:99], a[4:7], a[120:123], v[96:99]
ds_read_b64_tr_b16 a[40:41], v55 offset:24576
v_mfma_f32_16x16x32_bf16 v[100:103], a[4:7], a[124:127], v[100:103]
ds_read_b64_tr_b16 a[42:43], v55 offset:28672
v_mfma_f32_16x16x32_bf16 v[104:107], a[4:7], a[128:131], v[104:107]
buffer_load_dwordx4 v7, s[20:23], s81 offen offset:3072 lds
v_mfma_f32_16x16x32_bf16 v[108:111], a[4:7], a[132:135], v[108:111]
ds_read_b64_tr_b16 a[44:45], v55 offset:24584
s_waitcnt lgkmcnt(15)
v_mfma_f32_16x16x32_bf16 v[112:115], a[8:11], a[112:115], v[112:115]
ds_read_b64_tr_b16 a[46:47], v55 offset:28680
v_mfma_f32_16x16x32_bf16 v[116:119], a[8:11], a[116:119], v[116:119]
s_add_u32 s81, s74, 49152
s_add_u32 m0, s75, 12288
s_nop 0
buffer_load_dwordx4 v2, s[20:23], s81 offen offset:0 lds
v_mfma_f32_16x16x32_bf16 v[120:123], a[8:11], a[120:123], v[120:123]
ds_read_b64_tr_b16 a[48:49], v56 offset:24576
v_mfma_f32_16x16x32_bf16 v[124:127], a[8:11], a[124:127], v[124:127]
ds_read_b64_tr_b16 a[50:51], v56 offset:28672
v_mfma_f32_16x16x32_bf16 v[128:131], a[8:11], a[128:131], v[128:131]
buffer_load_dwordx4 v3, s[20:23], s81 offen offset:1024 lds
v_mfma_f32_16x16x32_bf16 v[132:135], a[8:11], a[132:135], v[132:135]
ds_read_b64_tr_b16 a[52:53], v56 offset:24584
v_mfma_f32_16x16x32_bf16 v[136:139], a[12:15], a[112:115], v[136:139]
ds_read_b64_tr_b16 a[54:55], v56 offset:28680
v_mfma_f32_16x16x32_bf16 v[140:143], a[12:15], a[116:119], v[140:143]
buffer_load_dwordx4 v6, s[20:23], s81 offen offset:2048 lds
v_mfma_f32_16x16x32_bf16 v[144:147], a[12:15], a[120:123], v[144:147]
ds_read_b64_tr_b16 a[56:57], v57 offset:24576
v_mfma_f32_16x16x32_bf16 v[148:151], a[12:15], a[124:127], v[148:151]
ds_read_b64_tr_b16 a[58:59], v57 offset:28672
v_mfma_f32_16x16x32_bf16 v[152:155], a[12:15], a[128:131], v[152:155]
buffer_load_dwordx4 v7, s[20:23], s81 offen offset:3072 lds
v_mfma_f32_16x16x32_bf16 v[156:159], a[12:15], a[132:135], v[156:159]
ds_read_b64_tr_b16 a[60:61], v57 offset:24584
s_waitcnt lgkmcnt(15)
v_mfma_f32_16x16x32_bf16 v[160:163], a[16:19], a[112:115], v[160:163]
ds_read_b64_tr_b16 a[62:63], v57 offset:28680
v_mfma_f32_16x16x32_bf16 v[164:167], a[16:19], a[116:119], v[164:167]
s_add_u32 s80, s78, 6144
buffer_load_dwordx4 a[88:91], v58, s[16:19], s80 offen sc1
v_mfma_f32_16x16x32_bf16 v[168:171], a[16:19], a[120:123], v[168:171]
v_mfma_f32_16x16x32_bf16 v[172:175], a[16:19], a[124:127], v[172:175]
v_mfma_f32_16x16x32_bf16 v[176:179], a[16:19], a[128:131], v[176:179]
buffer_load_dwordx4 a[92:95], v59, s[16:19], s80 offen sc1
v_mfma_f32_16x16x32_bf16 v[180:183], a[16:19], a[132:135], v[180:183]
v_mfma_f32_16x16x32_bf16 v[184:187], a[20:23], a[112:115], v[184:187]
v_mfma_f32_16x16x32_bf16 v[188:191], a[20:23], a[116:119], v[188:191]
buffer_load_dwordx4 a[96:99], v60, s[16:19], s80 offen sc1
v_mfma_f32_16x16x32_bf16 v[192:195], a[20:23], a[120:123], v[192:195]
v_mfma_f32_16x16x32_bf16 v[196:199], a[20:23], a[124:127], v[196:199]
v_mfma_f32_16x16x32_bf16 v[200:203], a[20:23], a[128:131], v[200:203]
buffer_load_dwordx4 a[100:103], v61, s[16:19], s80 offen sc1
v_mfma_f32_16x16x32_bf16 v[204:207], a[20:23], a[132:135], v[204:207]
v_mfma_f32_16x16x32_bf16 v[208:211], a[24:27], a[112:115], v[208:211]
v_mfma_f32_16x16x32_bf16 v[212:215], a[24:27], a[116:119], v[212:215]
buffer_load_dwordx4 a[104:107], v62, s[16:19], s80 offen sc1
v_mfma_f32_16x16x32_bf16 v[216:219], a[24:27], a[120:123], v[216:219]
v_mfma_f32_16x16x32_bf16 v[220:223], a[24:27], a[124:127], v[220:223]
v_mfma_f32_16x16x32_bf16 v[224:227], a[24:27], a[128:131], v[224:227]
buffer_load_dwordx4 a[108:111], v63, s[16:19], s80 offen sc1
v_mfma_f32_16x16x32_bf16 v[228:231], a[24:27], a[132:135], v[228:231]
v_mfma_f32_16x16x32_bf16 v[232:235], a[28:31], a[112:115], v[232:235]
v_mfma_f32_16x16x32_bf16 v[236:239], a[28:31], a[116:119], v[236:239]
v_mfma_f32_16x16x32_bf16 v[240:243], a[28:31], a[120:123], v[240:243]
v_mfma_f32_16x16x32_bf16 v[244:247], a[28:31], a[124:127], v[244:247]
v_mfma_f32_16x16x32_bf16 v[248:251], a[28:31], a[128:131], v[248:251]
v_mfma_f32_16x16x32_bf16 v[252:255], a[28:31], a[132:135], v[252:255]
s_waitcnt vmcnt(20)
s_waitcnt lgkmcnt(14)
v_mfma_f32_16x16x32_bf16 v[64:67], a[32:35], a[136:139], v[64:67]
v_mfma_f32_16x16x32_bf16 v[68:71], a[32:35], a[140:143], v[68:71]
s_add_u32 s81, s74, 65536
s_add_u32 m0, s75, 16384
s_nop 0
buffer_load_dwordx4 v2, s[20:23], s81 offen offset:0 lds
v_mfma_f32_16x16x32_bf16 v[72:75], a[32:35], a[144:147], v[72:75]
ds_read_b64_tr_b16 a[0:1], v54 offset:0
v_mfma_f32_16x16x32_bf16 v[76:79], a[32:35], a[148:151], v[76:79]
ds_read_b64_tr_b16 a[2:3], v54 offset:4096
v_mfma_f32_16x16x32_bf16 v[80:83], a[32:35], a[152:155], v[80:83]
buffer_load_dwordx4 v3, s[20:23], s81 offen offset:1024 lds
v_mfma_f32_16x16x32_bf16 v[84:87], a[32:35], a[156:159], v[84:87]
ds_read_b64_tr_b16 a[4:5], v54 offset:8
s_waitcnt lgkmcnt(15)
v_mfma_f32_16x16x32_bf16 v[88:91], a[36:39], a[136:139], v[88:91]
ds_read_b64_tr_b16 a[6:7], v54 offset:4104
v_mfma_f32_16x16x32_bf16 v[92:95], a[36:39], a[140:143], v[92:95]
buffer_load_dwordx4 v6, s[20:23], s81 offen offset:2048 lds
v_mfma_f32_16x16x32_bf16 v[96:99], a[36:39], a[144:147], v[96:99]
ds_read_b64_tr_b16 a[8:9], v55 offset:0
v_mfma_f32_16x16x32_bf16 v[100:103], a[36:39], a[148:151], v[100:103]
ds_read_b64_tr_b16 a[10:11], v55 offset:4096
v_mfma_f32_16x16x32_bf16 v[104:107], a[36:39], a[152:155], v[104:107]
buffer_load_dwordx4 v7, s[20:23], s81 offen offset:3072 lds
v_mfma_f32_16x16x32_bf16 v[108:111], a[36:39], a[156:159], v[108:111]
ds_read_b64_tr_b16 a[12:13], v55 offset:8
s_waitcnt lgkmcnt(15)
v_mfma_f32_16x16x32_bf16 v[112:115], a[40:43], a[136:139], v[112:115]
ds_read_b64_tr_b16 a[14:15], v55 offset:4104
v_mfma_f32_16x16x32_bf16 v[116:119], a[40:43], a[140:143], v[116:119]
s_add_u32 s81, s74, 81920
s_add_u32 m0, s75, 20480
s_nop 0
buffer_load_dwordx4 v2, s[20:23], s81 offen offset:0 lds
v_mfma_f32_16x16x32_bf16 v[120:123], a[40:43], a[144:147], v[120:123]
ds_read_b64_tr_b16 a[16:17], v56 offset:0
v_mfma_f32_16x16x32_bf16 v[124:127], a[40:43], a[148:151], v[124:127]
ds_read_b64_tr_b16 a[18:19], v56 offset:4096
v_mfma_f32_16x16x32_bf16 v[128:131], a[40:43], a[152:155], v[128:131]
buffer_load_dwordx4 v3, s[20:23], s81 offen offset:1024 lds
v_mfma_f32_16x16x32_bf16 v[132:135], a[40:43], a[156:159], v[132:135]
ds_read_b64_tr_b16 a[20:21], v56 offset:8
v_mfma_f32_16x16x32_bf16 v[136:139], a[44:47], a[136:139], v[136:139]
ds_read_b64_tr_b16 a[22:23], v56 offset:4104
v_mfma_f32_16x16x32_bf16 v[140:143], a[44:47], a[140:143], v[140:143]
buffer_load_dwordx4 v6, s[20:23], s81 offen offset:2048 lds
v_mfma_f32_16x16x32_bf16 v[144:147], a[44:47], a[144:147], v[144:147]
ds_read_b64_tr_b16 a[24:25], v57 offset:0
v_mfma_f32_16x16x32_bf16 v[148:151], a[44:47], a[148:151], v[148:151]
ds_read_b64_tr_b16 a[26:27], v57 offset:4096
v_mfma_f32_16x16x32_bf16 v[152:155], a[44:47], a[152:155], v[152:155]
buffer_load_dwordx4 v7, s[20:23], s81 offen offset:3072 lds
v_mfma_f32_16x16x32_bf16 v[156:159], a[44:47], a[156:159], v[156:159]
ds_read_b64_tr_b16 a[28:29], v57 offset:8
s_waitcnt lgkmcnt(15)
v_mfma_f32_16x16x32_bf16 v[160:163], a[48:51], a[136:139], v[160:163]
ds_read_b64_tr_b16 a[30:31], v57 offset:4104
v_mfma_f32_16x16x32_bf16 v[164:167], a[48:51], a[140:143], v[164:167]
s_add_u32 s80, s78, 12288
buffer_load_dwordx4 a[112:115], v58, s[16:19], s80 offen sc1
v_mfma_f32_16x16x32_bf16 v[168:171], a[48:51], a[144:147], v[168:171]
v_mfma_f32_16x16x32_bf16 v[172:175], a[48:51], a[148:151], v[172:175]
v_mfma_f32_16x16x32_bf16 v[176:179], a[48:51], a[152:155], v[176:179]
buffer_load_dwordx4 a[116:119], v59, s[16:19], s80 offen sc1
v_mfma_f32_16x16x32_bf16 v[180:183], a[48:51], a[156:159], v[180:183]
v_mfma_f32_16x16x32_bf16 v[184:187], a[52:55], a[136:139], v[184:187]
v_mfma_f32_16x16x32_bf16 v[188:191], a[52:55], a[140:143], v[188:191]
buffer_load_dwordx4 a[120:123], v60, s[16:19], s80 offen sc1
v_mfma_f32_16x16x32_bf16 v[192:195], a[52:55], a[144:147], v[192:195]
v_mfma_f32_16x16x32_bf16 v[196:199], a[52:55], a[148:151], v[196:199]
v_mfma_f32_16x16x32_bf16 v[200:203], a[52:55], a[152:155], v[200:203]
buffer_load_dwordx4 a[124:127], v61, s[16:19], s80 offen sc1
v_mfma_f32_16x16x32_bf16 v[204:207], a[52:55], a[156:159], v[204:207]
v_mfma_f32_16x16x32_bf16 v[208:211], a[56:59], a[136:139], v[208:211]
v_mfma_f32_16x16x32_bf16 v[212:215], a[56:59], a[140:143], v[212:215]
buffer_load_dwordx4 a[128:131], v62, s[16:19], s80 offen sc1
v_mfma_f32_16x16x32_bf16 v[216:219], a[56:59], a[144:147], v[216:219]
v_mfma_f32_16x16x32_bf16 v[220:223], a[56:59], a[148:151], v[220:223]
v_mfma_f32_16x16x32_bf16 v[224:227], a[56:59], a[152:155], v[224:227]
buffer_load_dwordx4 a[132:135], v63, s[16:19], s80 offen sc1
v_mfma_f32_16x16x32_bf16 v[228:231], a[56:59], a[156:159], v[228:231]
v_mfma_f32_16x16x32_bf16 v[232:235], a[60:63], a[136:139], v[232:235]
v_mfma_f32_16x16x32_bf16 v[236:239], a[60:63], a[140:143], v[236:239]
v_mfma_f32_16x16x32_bf16 v[240:243], a[60:63], a[144:147], v[240:243]
v_mfma_f32_16x16x32_bf16 v[244:247], a[60:63], a[148:151], v[244:247]
v_mfma_f32_16x16x32_bf16 v[248:251], a[60:63], a[152:155], v[248:251]
v_mfma_f32_16x16x32_bf16 v[252:255], a[60:63], a[156:159], v[252:255]
s_waitcnt vmcnt(34)
s_barrier
s_cmp_lg_u32 s28, 0
s_cbranch_scc1 L_sigg2
v_mov_b32 v35, 1
v_mov_b32 v36, s96
s_mov_b64 exec, 1
buffer_atomic_add v35, v36, s[92:95], 0 offen sc1
s_mov_b64 exec, -1
L_sigg2:
s_waitcnt vmcnt(20)
s_waitcnt lgkmcnt(14)
v_mfma_f32_16x16x32_bf16 v[64:67], a[0:3], a[64:67], v[64:67]
v_mfma_f32_16x16x32_bf16 v[68:71], a[0:3], a[68:71], v[68:71]
s_add_u32 s81, s74, 98304
s_add_u32 m0, s75, 24576
s_nop 0
buffer_load_dwordx4 v2, s[20:23], s81 offen offset:0 lds
v_mfma_f32_16x16x32_bf16 v[72:75], a[0:3], a[72:75], v[72:75]
ds_read_b64_tr_b16 a[32:33], v54 offset:8192
v_mfma_f32_16x16x32_bf16 v[76:79], a[0:3], a[76:79], v[76:79]
ds_read_b64_tr_b16 a[34:35], v54 offset:12288
v_mfma_f32_16x16x32_bf16 v[80:83], a[0:3], a[80:83], v[80:83]
buffer_load_dwordx4 v3, s[20:23], s81 offen offset:1024 lds
v_mfma_f32_16x16x32_bf16 v[84:87], a[0:3], a[84:87], v[84:87]
ds_read_b64_tr_b16 a[36:37], v54 offset:8200
s_waitcnt lgkmcnt(15)
v_mfma_f32_16x16x32_bf16 v[88:91], a[4:7], a[64:67], v[88:91]
ds_read_b64_tr_b16 a[38:39], v54 offset:12296
v_mfma_f32_16x16x32_bf16 v[92:95], a[4:7], a[68:71], v[92:95]
buffer_load_dwordx4 v6, s[20:23], s81 offen offset:2048 lds
v_mfma_f32_16x16x32_bf16 v[96:99], a[4:7], a[72:75], v[96:99]
ds_read_b64_tr_b16 a[40:41], v55 offset:8192
v_mfma_f32_16x16x32_bf16 v[100:103], a[4:7], a[76:79], v[100:103]
ds_read_b64_tr_b16 a[42:43], v55 offset:12288
v_mfma_f32_16x16x32_bf16 v[104:107], a[4:7], a[80:83], v[104:107]
buffer_load_dwordx4 v7, s[20:23], s81 offen offset:3072 lds
v_mfma_f32_16x16x32_bf16 v[108:111], a[4:7], a[84:87], v[108:111]
ds_read_b64_tr_b16 a[44:45], v55 offset:8200
s_waitcnt lgkmcnt(15)
v_mfma_f32_16x16x32_bf16 v[112:115], a[8:11], a[64:67], v[112:115]
ds_read_b64_tr_b16 a[46:47], v55 offset:12296
v_mfma_f32_16x16x32_bf16 v[116:119], a[8:11], a[68:71], v[116:119]
s_add_u32 s81, s74, 114688
s_add_u32 m0, s75, 28672
s_nop 0
buffer_load_dwordx4 v2, s[20:23], s81 offen offset:0 lds
v_mfma_f32_16x16x32_bf16 v[120:123], a[8:11], a[72:75], v[120:123]
ds_read_b64_tr_b16 a[48:49], v56 offset:8192
v_mfma_f32_16x16x32_bf16 v[124:127], a[8:11], a[76:79], v[124:127]
ds_read_b64_tr_b16 a[50:51], v56 offset:12288
v_mfma_f32_16x16x32_bf16 v[128:131], a[8:11], a[80:83], v[128:131]
buffer_load_dwordx4 v3, s[20:23], s81 offen offset:1024 lds
v_mfma_f32_16x16x32_bf16 v[132:135], a[8:11], a[84:87], v[132:135]
ds_read_b64_tr_b16 a[52:53], v56 offset:8200
v_mfma_f32_16x16x32_bf16 v[136:139], a[12:15], a[64:67], v[136:139]
ds_read_b64_tr_b16 a[54:55], v56 offset:12296
v_mfma_f32_16x16x32_bf16 v[140:143], a[12:15], a[68:71], v[140:143]
buffer_load_dwordx4 v6, s[20:23], s81 offen offset:2048 lds
v_mfma_f32_16x16x32_bf16 v[144:147], a[12:15], a[72:75], v[144:147]
ds_read_b64_tr_b16 a[56:57], v57 offset:8192
v_mfma_f32_16x16x32_bf16 v[148:151], a[12:15], a[76:79], v[148:151]
ds_read_b64_tr_b16 a[58:59], v57 offset:12288
v_mfma_f32_16x16x32_bf16 v[152:155], a[12:15], a[80:83], v[152:155]
buffer_load_dwordx4 v7, s[20:23], s81 offen offset:3072 lds
v_mfma_f32_16x16x32_bf16 v[156:159], a[12:15], a[84:87], v[156:159]
ds_read_b64_tr_b16 a[60:61], v57 offset:8200
s_waitcnt lgkmcnt(15)
v_mfma_f32_16x16x32_bf16 v[160:163], a[16:19], a[64:67], v[160:163]
ds_read_b64_tr_b16 a[62:63], v57 offset:12296
v_mfma_f32_16x16x32_bf16 v[164:167], a[16:19], a[68:71], v[164:167]
s_add_u32 s80, s78, 18432
buffer_load_dwordx4 a[136:139], v58, s[16:19], s80 offen sc1
v_mfma_f32_16x16x32_bf16 v[168:171], a[16:19], a[72:75], v[168:171]
v_mfma_f32_16x16x32_bf16 v[172:175], a[16:19], a[76:79], v[172:175]
v_mfma_f32_16x16x32_bf16 v[176:179], a[16:19], a[80:83], v[176:179]
buffer_load_dwordx4 a[140:143], v59, s[16:19], s80 offen sc1
v_mfma_f32_16x16x32_bf16 v[180:183], a[16:19], a[84:87], v[180:183]
v_mfma_f32_16x16x32_bf16 v[184:187], a[20:23], a[64:67], v[184:187]
v_mfma_f32_16x16x32_bf16 v[188:191], a[20:23], a[68:71], v[188:191]
buffer_load_dwordx4 a[144:147], v60, s[16:19], s80 offen sc1
v_mfma_f32_16x16x32_bf16 v[192:195], a[20:23], a[72:75], v[192:195]
v_mfma_f32_16x16x32_bf16 v[196:199], a[20:23], a[76:79], v[196:199]
v_mfma_f32_16x16x32_bf16 v[200:203], a[20:23], a[80:83], v[200:203]
buffer_load_dwordx4 a[148:151], v61, s[16:19], s80 offen sc1
v_mfma_f32_16x16x32_bf16 v[204:207], a[20:23], a[84:87], v[204:207]
v_mfma_f32_16x16x32_bf16 v[208:211], a[24:27], a[64:67], v[208:211]
v_mfma_f32_16x16x32_bf16 v[212:215], a[24:27], a[68:71], v[212:215]
buffer_load_dwordx4 a[152:155], v62, s[16:19], s80 offen sc1
v_mfma_f32_16x16x32_bf16 v[216:219], a[24:27], a[72:75], v[216:219]
v_mfma_f32_16x16x32_bf16 v[220:223], a[24:27], a[76:79], v[220:223]
v_mfma_f32_16x16x32_bf16 v[224:227], a[24:27], a[80:83], v[224:227]
buffer_load_dwordx4 a[156:159], v63, s[16:19], s80 offen sc1
v_mfma_f32_16x16x32_bf16 v[228:231], a[24:27], a[84:87], v[228:231]
v_mfma_f32_16x16x32_bf16 v[232:235], a[28:31], a[64:67], v[232:235]
v_mfma_f32_16x16x32_bf16 v[236:239], a[28:31], a[68:71], v[236:239]
v_mfma_f32_16x16x32_bf16 v[240:243], a[28:31], a[72:75], v[240:243]
s_add_u32 s74, s74, 262144
s_add_u32 s78, s78, 49152
v_mfma_f32_16x16x32_bf16 v[244:247], a[28:31], a[76:79], v[244:247]
v_mfma_f32_16x16x32_bf16 v[248:251], a[28:31], a[80:83], v[248:251]
v_mfma_f32_16x16x32_bf16 v[252:255], a[28:31], a[84:87], v[252:255]
s_waitcnt vmcnt(20)
s_waitcnt lgkmcnt(14)
v_mfma_f32_16x16x32_bf16 v[64:67], a[32:35], a[88:91], v[64:67]
v_mfma_f32_16x16x32_bf16 v[68:71], a[32:35], a[92:95], v[68:71]
s_add_u32 s81, s74, 0
s_add_u32 m0, s75, 0
s_nop 0
buffer_load_dwordx4 v2, s[20:23], s81 offen offset:0 lds
v_mfma_f32_16x16x32_bf16 v[72:75], a[32:35], a[96:99], v[72:75]
ds_read_b64_tr_b16 a[0:1], v54 offset:16384
v_mfma_f32_16x16x32_bf16 v[76:79], a[32:35], a[100:103], v[76:79]
ds_read_b64_tr_b16 a[2:3], v54 offset:20480
v_mfma_f32_16x16x32_bf16 v[80:83], a[32:35], a[104:107], v[80:83]
buffer_load_dwordx4 v3, s[20:23], s81 offen offset:1024 lds
v_mfma_f32_16x16x32_bf16 v[84:87], a[32:35], a[108:111], v[84:87]
ds_read_b64_tr_b16 a[4:5], v54 offset:16392
s_waitcnt lgkmcnt(15)
v_mfma_f32_16x16x32_bf16 v[88:91], a[36:39], a[88:91], v[88:91]
ds_read_b64_tr_b16 a[6:7], v54 offset:20488
v_mfma_f32_16x16x32_bf16 v[92:95], a[36:39], a[92:95], v[92:95]
buffer_load_dwordx4 v6, s[20:23], s81 offen offset:2048 lds
v_mfma_f32_16x16x32_bf16 v[96:99], a[36:39], a[96:99], v[96:99]
ds_read_b64_tr_b16 a[8:9], v55 offset:16384
v_mfma_f32_16x16x32_bf16 v[100:103], a[36:39], a[100:103], v[100:103]
ds_read_b64_tr_b16 a[10:11], v55 offset:20480
v_mfma_f32_16x16x32_bf16 v[104:107], a[36:39], a[104:107], v[104:107]
buffer_load_dwordx4 v7, s[20:23], s81 offen offset:3072 lds
v_mfma_f32_16x16x32_bf16 v[108:111], a[36:39], a[108:111], v[108:111]
ds_read_b64_tr_b16 a[12:13], v55 offset:16392
s_waitcnt lgkmcnt(15)
v_mfma_f32_16x16x32_bf16 v[112:115], a[40:43], a[88:91], v[112:115]
ds_read_b64_tr_b16 a[14:15], v55 offset:20488
v_mfma_f32_16x16x32_bf16 v[116:119], a[40:43], a[92:95], v[116:119]
s_add_u32 s81, s74, 16384
s_add_u32 m0, s75, 4096
s_nop 0
buffer_load_dwordx4 v2, s[20:23], s81 offen offset:0 lds
v_mfma_f32_16x16x32_bf16 v[120:123], a[40:43], a[96:99], v[120:123]
ds_read_b64_tr_b16 a[16:17], v56 offset:16384
v_mfma_f32_16x16x32_bf16 v[124:127], a[40:43], a[100:103], v[124:127]
ds_read_b64_tr_b16 a[18:19], v56 offset:20480
v_mfma_f32_16x16x32_bf16 v[128:131], a[40:43], a[104:107], v[128:131]
buffer_load_dwordx4 v3, s[20:23], s81 offen offset:1024 lds
v_mfma_f32_16x16x32_bf16 v[132:135], a[40:43], a[108:111], v[132:135]
ds_read_b64_tr_b16 a[20:21], v56 offset:16392
v_mfma_f32_16x16x32_bf16 v[136:139], a[44:47], a[88:91], v[136:139]
ds_read_b64_tr_b16 a[22:23], v56 offset:20488
v_mfma_f32_16x16x32_bf16 v[140:143], a[44:47], a[92:95], v[140:143]
buffer_load_dwordx4 v6, s[20:23], s81 offen offset:2048 lds
v_mfma_f32_16x16x32_bf16 v[144:147], a[44:47], a[96:99], v[144:147]
ds_read_b64_tr_b16 a[24:25], v57 offset:16384
v_mfma_f32_16x16x32_bf16 v[148:151], a[44:47], a[100:103], v[148:151]
ds_read_b64_tr_b16 a[26:27], v57 offset:20480
v_mfma_f32_16x16x32_bf16 v[152:155], a[44:47], a[104:107], v[152:155]
buffer_load_dwordx4 v7, s[20:23], s81 offen offset:3072 lds
v_mfma_f32_16x16x32_bf16 v[156:159], a[44:47], a[108:111], v[156:159]
ds_read_b64_tr_b16 a[28:29], v57 offset:16392
s_waitcnt lgkmcnt(15)
v_mfma_f32_16x16x32_bf16 v[160:163], a[48:51], a[88:91], v[160:163]
ds_read_b64_tr_b16 a[30:31], v57 offset:20488
v_mfma_f32_16x16x32_bf16 v[164:167], a[48:51], a[92:95], v[164:167]
s_add_u32 s80, s78, 0
buffer_load_dwordx4 a[64:67], v58, s[16:19], s80 offen sc1
v_mfma_f32_16x16x32_bf16 v[168:171], a[48:51], a[96:99], v[168:171]
v_mfma_f32_16x16x32_bf16 v[172:175], a[48:51], a[100:103], v[172:175]
v_mfma_f32_16x16x32_bf16 v[176:179], a[48:51], a[104:107], v[176:179]
buffer_load_dwordx4 a[68:71], v59, s[16:19], s80 offen sc1
v_mfma_f32_16x16x32_bf16 v[180:183], a[48:51], a[108:111], v[180:183]
v_mfma_f32_16x16x32_bf16 v[184:187], a[52:55], a[88:91], v[184:187]
v_mfma_f32_16x16x32_bf16 v[188:191], a[52:55], a[92:95], v[188:191]
buffer_load_dwordx4 a[72:75], v60, s[16:19], s80 offen sc1
v_mfma_f32_16x16x32_bf16 v[192:195], a[52:55], a[96:99], v[192:195]
v_mfma_f32_16x16x32_bf16 v[196:199], a[52:55], a[100:103], v[196:199]
v_mfma_f32_16x16x32_bf16 v[200:203], a[52:55], a[104:107], v[200:203]
buffer_load_dwordx4 a[76:79], v61, s[16:19], s80 offen sc1
v_mfma_f32_16x16x32_bf16 v[204:207], a[52:55], a[108:111], v[204:207]
v_mfma_f32_16x16x32_bf16 v[208:211], a[56:59], a[88:91], v[208:211]
v_mfma_f32_16x16x32_bf16 v[212:215], a[56:59], a[92:95], v[212:215]
buffer_load_dwordx4 a[80:83], v62, s[16:19], s80 offen sc1
v_mfma_f32_16x16x32_bf16 v[216:219], a[56:59], a[96:99], v[216:219]
v_mfma_f32_16x16x32_bf16 v[220:223], a[56:59], a[100:103], v[220:223]
v_mfma_f32_16x16x32_bf16 v[224:227], a[56:59], a[104:107], v[224:227]
buffer_load_dwordx4 a[84:87], v63, s[16:19], s80 offen sc1
v_mfma_f32_16x16x32_bf16 v[228:231], a[56:59], a[108:111], v[228:231]
v_mfma_f32_16x16x32_bf16 v[232:235], a[60:63], a[88:91], v[232:235]
v_mfma_f32_16x16x32_bf16 v[236:239], a[60:63], a[92:95], v[236:239]
v_mfma_f32_16x16x32_bf16 v[240:243], a[60:63], a[96:99], v[240:243]
v_mfma_f32_16x16x32_bf16 v[244:247], a[60:63], a[100:103], v[244:247]
v_mfma_f32_16x16x32_bf16 v[248:251], a[60:63], a[104:107], v[248:251]
v_mfma_f32_16x16x32_bf16 v[252:255], a[60:63], a[108:111], v[252:255]
s_waitcnt vmcnt(20)
s_waitcnt lgkmcnt(14)
v_mfma_f32_16x16x32_bf16 v[64:67], a[0:3], a[112:115], v[64:67]
v_mfma_f32_16x16x32_bf16 v[68:71], a[0:3], a[116:119], v[68:71]
s_add_u32 s81, s74, 32768
s_add_u32 m0, s75, 8192
s_nop 0
buffer_load_dwordx4 v2, s[20:23], s81 offen offset:0 lds
v_mfma_f32_16x16x32_bf16 v[72:75], a[0:3], a[120:123], v[72:75]
ds_read_b64_tr_b16 a[32:33], v54 offset:24576
v_mfma_f32_16x16x32_bf16 v[76:79], a[0:3], a[124:127], v[76:79]
ds_read_b64_tr_b16 a[34:35], v54 offset:28672
v_mfma_f32_16x16x32_bf16 v[80:83], a[0:3], a[128:131], v[80:83]
buffer_load_dwordx4 v3, s[20:23], s81 offen offset:1024 lds
v_mfma_f32_16x16x32_bf16 v[84:87], a[0:3], a[132:135], v[84:87]
ds_read_b64_tr_b16 a[36:37], v54 offset:24584
s_waitcnt lgkmcnt(15)
v_mfma_f32_16x16x32_bf16 v[88:91], a[4:7], a[112:115], v[88:91]
ds_read_b64_tr_b16 a[38:39], v54 offset:28680
v_mfma_f32_16x16x32_bf16 v[92:95], a[4:7], a[116:119], v[92:95]
buffer_load_dwordx4 v6, s[20:23], s81 offen offset:2048 lds
v_mfma_f32_16x16x32_bf16 v[96:99], a[4:7], a[120:123], v[96:99]
ds_read_b64_tr_b16 a[40:41], v55 offset:24576
v_mfma_f32_16x16x32_bf16 v[100:103], a[4:7], a[124:127], v[100:103]
ds_read_b64_tr_b16 a[42:43], v55 offset:28672
v_mfma_f32_16x16x32_bf16 v[104:107], a[4:7], a[128:131], v[104:107]
buffer_load_dwordx4 v7, s[20:23], s81 offen offset:3072 lds
v_mfma_f32_16x16x32_bf16 v[108:111], a[4:7], a[132:135], v[108:111]
ds_read_b64_tr_b16 a[44:45], v55 offset:24584
s_waitcnt lgkmcnt(15)
v_mfma_f32_16x16x32_bf16 v[112:115], a[8:11], a[112:115], v[112:115]
ds_read_b64_tr_b16 a[46:47], v55 offset:28680
v_mfma_f32_16x16x32_bf16 v[116:119], a[8:11], a[116:119], v[116:119]
s_add_u32 s81, s74, 49152
s_add_u32 m0, s75, 12288
s_nop 0
buffer_load_dwordx4 v2, s[20:23], s81 offen offset:0 lds
v_mfma_f32_16x16x32_bf16 v[120:123], a[8:11], a[120:123], v[120:123]
ds_read_b64_tr_b16 a[48:49], v56 offset:24576
v_mfma_f32_16x16x32_bf16 v[124:127], a[8:11], a[124:127], v[124:127]
ds_read_b64_tr_b16 a[50:51], v56 offset:28672
v_mfma_f32_16x16x32_bf16 v[128:131], a[8:11], a[128:131], v[128:131]
buffer_load_dwordx4 v3, s[20:23], s81 offen offset:1024 lds
v_mfma_f32_16x16x32_bf16 v[132:135], a[8:11], a[132:135], v[132:135]
ds_read_b64_tr_b16 a[52:53], v56 offset:24584
v_mfma_f32_16x16x32_bf16 v[136:139], a[12:15], a[112:115], v[136:139]
ds_read_b64_tr_b16 a[54:55], v56 offset:28680
v_mfma_f32_16x16x32_bf16 v[140:143], a[12:15], a[116:119], v[140:143]
buffer_load_dwordx4 v6, s[20:23], s81 offen offset:2048 lds
v_mfma_f32_16x16x32_bf16 v[144:147], a[12:15], a[120:123], v[144:147]
ds_read_b64_tr_b16 a[56:57], v57 offset:24576
v_mfma_f32_16x16x32_bf16 v[148:151], a[12:15], a[124:127], v[148:151]
ds_read_b64_tr_b16 a[58:59], v57 offset:28672
v_mfma_f32_16x16x32_bf16 v[152:155], a[12:15], a[128:131], v[152:155]
buffer_load_dwordx4 v7, s[20:23], s81 offen offset:3072 lds
v_mfma_f32_16x16x32_bf16 v[156:159], a[12:15], a[132:135], v[156:159]
ds_read_b64_tr_b16 a[60:61], v57 offset:24584
s_waitcnt lgkmcnt(15)
v_mfma_f32_16x16x32_bf16 v[160:163], a[16:19], a[112:115], v[160:163]
ds_read_b64_tr_b16 a[62:63], v57 offset:28680
v_mfma_f32_16x16x32_bf16 v[164:167], a[16:19], a[116:119], v[164:167]
s_add_u32 s80, s78, 6144
buffer_load_dwordx4 a[88:91], v58, s[16:19], s80 offen sc1
v_mfma_f32_16x16x32_bf16 v[168:171], a[16:19], a[120:123], v[168:171]
v_mfma_f32_16x16x32_bf16 v[172:175], a[16:19], a[124:127], v[172:175]
v_mfma_f32_16x16x32_bf16 v[176:179], a[16:19], a[128:131], v[176:179]
buffer_load_dwordx4 a[92:95], v59, s[16:19], s80 offen sc1
v_mfma_f32_16x16x32_bf16 v[180:183], a[16:19], a[132:135], v[180:183]
v_mfma_f32_16x16x32_bf16 v[184:187], a[20:23], a[112:115], v[184:187]
v_mfma_f32_16x16x32_bf16 v[188:191], a[20:23], a[116:119], v[188:191]
buffer_load_dwordx4 a[96:99], v60, s[16:19], s80 offen sc1
v_mfma_f32_16x16x32_bf16 v[192:195], a[20:23], a[120:123], v[192:195]
v_mfma_f32_16x16x32_bf16 v[196:199], a[20:23], a[124:127], v[196:199]
v_mfma_f32_16x16x32_bf16 v[200:203], a[20:23], a[128:131], v[200:203]
buffer_load_dwordx4 a[100:103], v61, s[16:19], s80 offen sc1
v_mfma_f32_16x16x32_bf16 v[204:207], a[20:23], a[132:135], v[204:207]
v_mfma_f32_16x16x32_bf16 v[208:211], a[24:27], a[112:115], v[208:211]
v_mfma_f32_16x16x32_bf16 v[212:215], a[24:27], a[116:119], v[212:215]
buffer_load_dwordx4 a[104:107], v62, s[16:19], s80 offen sc1
v_mfma_f32_16x16x32_bf16 v[216:219], a[24:27], a[120:123], v[216:219]
v_mfma_f32_16x16x32_bf16 v[220:223], a[24:27], a[124:127], v[220:223]
v_mfma_f32_16x16x32_bf16 v[224:227], a[24:27], a[128:131], v[224:227]
buffer_load_dwordx4 a[108:111], v63, s[16:19], s80 offen sc1
v_mfma_f32_16x16x32_bf16 v[228:231], a[24:27], a[132:135], v[228:231]
v_mfma_f32_16x16x32_bf16 v[232:235], a[28:31], a[112:115], v[232:235]
v_mfma_f32_16x16x32_bf16 v[236:239], a[28:31], a[116:119], v[236:239]
v_mfma_f32_16x16x32_bf16 v[240:243], a[28:31], a[120:123], v[240:243]
v_mfma_f32_16x16x32_bf16 v[244:247], a[28:31], a[124:127], v[244:247]
v_mfma_f32_16x16x32_bf16 v[248:251], a[28:31], a[128:131], v[248:251]
v_mfma_f32_16x16x32_bf16 v[252:255], a[28:31], a[132:135], v[252:255]
s_waitcnt vmcnt(20)
s_waitcnt lgkmcnt(14)
v_mfma_f32_16x16x32_bf16 v[64:67], a[32:35], a[136:139], v[64:67]
v_mfma_f32_16x16x32_bf16 v[68:71], a[32:35], a[140:143], v[68:71]
s_add_u32 s81, s74, 65536
s_add_u32 m0, s75, 16384
s_nop 0
buffer_load_dwordx4 v2, s[20:23], s81 offen offset:0 lds
v_mfma_f32_16x16x32_bf16 v[72:75], a[32:35], a[144:147], v[72:75]
ds_read_b64_tr_b16 a[0:1], v54 offset:0
v_mfma_f32_16x16x32_bf16 v[76:79], a[32:35], a[148:151], v[76:79]
ds_read_b64_tr_b16 a[2:3], v54 offset:4096
v_mfma_f32_16x16x32_bf16 v[80:83], a[32:35], a[152:155], v[80:83]
buffer_load_dwordx4 v3, s[20:23], s81 offen offset:1024 lds
v_mfma_f32_16x16x32_bf16 v[84:87], a[32:35], a[156:159], v[84:87]
ds_read_b64_tr_b16 a[4:5], v54 offset:8
s_waitcnt lgkmcnt(15)
v_mfma_f32_16x16x32_bf16 v[88:91], a[36:39], a[136:139], v[88:91]
ds_read_b64_tr_b16 a[6:7], v54 offset:4104
v_mfma_f32_16x16x32_bf16 v[92:95], a[36:39], a[140:143], v[92:95]
buffer_load_dwordx4 v6, s[20:23], s81 offen offset:2048 lds
v_mfma_f32_16x16x32_bf16 v[96:99], a[36:39], a[144:147], v[96:99]
ds_read_b64_tr_b16 a[8:9], v55 offset:0
v_mfma_f32_16x16x32_bf16 v[100:103], a[36:39], a[148:151], v[100:103]
ds_read_b64_tr_b16 a[10:11], v55 offset:4096
v_mfma_f32_16x16x32_bf16 v[104:107], a[36:39], a[152:155], v[104:107]
buffer_load_dwordx4 v7, s[20:23], s81 offen offset:3072 lds
v_mfma_f32_16x16x32_bf16 v[108:111], a[36:39], a[156:159], v[108:111]
ds_read_b64_tr_b16 a[12:13], v55 offset:8
s_waitcnt lgkmcnt(15)
v_mfma_f32_16x16x32_bf16 v[112:115], a[40:43], a[136:139], v[112:115]
ds_read_b64_tr_b16 a[14:15], v55 offset:4104
v_mfma_f32_16x16x32_bf16 v[116:119], a[40:43], a[140:143], v[116:119]
s_add_u32 s81, s74, 81920
s_add_u32 m0, s75, 20480
s_nop 0
buffer_load_dwordx4 v2, s[20:23], s81 offen offset:0 lds
v_mfma_f32_16x16x32_bf16 v[120:123], a[40:43], a[144:147], v[120:123]
ds_read_b64_tr_b16 a[16:17], v56 offset:0
v_mfma_f32_16x16x32_bf16 v[124:127], a[40:43], a[148:151], v[124:127]
ds_read_b64_tr_b16 a[18:19], v56 offset:4096
v_mfma_f32_16x16x32_bf16 v[128:131], a[40:43], a[152:155], v[128:131]
buffer_load_dwordx4 v3, s[20:23], s81 offen offset:1024 lds
v_mfma_f32_16x16x32_bf16 v[132:135], a[40:43], a[156:159], v[132:135]
ds_read_b64_tr_b16 a[20:21], v56 offset:8
v_mfma_f32_16x16x32_bf16 v[136:139], a[44:47], a[136:139], v[136:139]
ds_read_b64_tr_b16 a[22:23], v56 offset:4104
v_mfma_f32_16x16x32_bf16 v[140:143], a[44:47], a[140:143], v[140:143]
buffer_load_dwordx4 v6, s[20:23], s81 offen offset:2048 lds
v_mfma_f32_16x16x32_bf16 v[144:147], a[44:47], a[144:147], v[144:147]
ds_read_b64_tr_b16 a[24:25], v57 offset:0
v_mfma_f32_16x16x32_bf16 v[148:151], a[44:47], a[148:151], v[148:151]
ds_read_b64_tr_b16 a[26:27], v57 offset:4096
v_mfma_f32_16x16x32_bf16 v[152:155], a[44:47], a[152:155], v[152:155]
buffer_load_dwordx4 v7, s[20:23], s81 offen offset:3072 lds
v_mfma_f32_16x16x32_bf16 v[156:159], a[44:47], a[156:159], v[156:159]
ds_read_b64_tr_b16 a[28:29], v57 offset:8
s_waitcnt lgkmcnt(15)
v_mfma_f32_16x16x32_bf16 v[160:163], a[48:51], a[136:139], v[160:163]
ds_read_b64_tr_b16 a[30:31], v57 offset:4104
v_mfma_f32_16x16x32_bf16 v[164:167], a[48:51], a[140:143], v[164:167]
s_add_u32 s80, s78, 12288
buffer_load_dwordx4 a[112:115], v58, s[16:19], s80 offen sc1
v_mfma_f32_16x16x32_bf16 v[168:171], a[48:51], a[144:147], v[168:171]
v_mfma_f32_16x16x32_bf16 v[172:175], a[48:51], a[148:151], v[172:175]
v_mfma_f32_16x16x32_bf16 v[176:179], a[48:51], a[152:155], v[176:179]
buffer_load_dwordx4 a[116:119], v59, s[16:19], s80 offen sc1
v_mfma_f32_16x16x32_bf16 v[180:183], a[48:51], a[156:159], v[180:183]
v_mfma_f32_16x16x32_bf16 v[184:187], a[52:55], a[136:139], v[184:187]
v_mfma_f32_16x16x32_bf16 v[188:191], a[52:55], a[140:143], v[188:191]
buffer_load_dwordx4 a[120:123], v60, s[16:19], s80 offen sc1
v_mfma_f32_16x16x32_bf16 v[192:195], a[52:55], a[144:147], v[192:195]
v_mfma_f32_16x16x32_bf16 v[196:199], a[52:55], a[148:151], v[196:199]
v_mfma_f32_16x16x32_bf16 v[200:203], a[52:55], a[152:155], v[200:203]
buffer_load_dwordx4 a[124:127], v61, s[16:19], s80 offen sc1
v_mfma_f32_16x16x32_bf16 v[204:207], a[52:55], a[156:159], v[204:207]
v_mfma_f32_16x16x32_bf16 v[208:211], a[56:59], a[136:139], v[208:211]
v_mfma_f32_16x16x32_bf16 v[212:215], a[56:59], a[140:143], v[212:215]
buffer_load_dwordx4 a[128:131], v62, s[16:19], s80 offen sc1
v_mfma_f32_16x16x32_bf16 v[216:219], a[56:59], a[144:147], v[216:219]
v_mfma_f32_16x16x32_bf16 v[220:223], a[56:59], a[148:151], v[220:223]
v_mfma_f32_16x16x32_bf16 v[224:227], a[56:59], a[152:155], v[224:227]
buffer_load_dwordx4 a[132:135], v63, s[16:19], s80 offen sc1
v_mfma_f32_16x16x32_bf16 v[228:231], a[56:59], a[156:159], v[228:231]
v_mfma_f32_16x16x32_bf16 v[232:235], a[60:63], a[136:139], v[232:235]
v_mfma_f32_16x16x32_bf16 v[236:239], a[60:63], a[140:143], v[236:239]
v_mfma_f32_16x16x32_bf16 v[240:243], a[60:63], a[144:147], v[240:243]
v_mfma_f32_16x16x32_bf16 v[244:247], a[60:63], a[148:151], v[244:247]
v_mfma_f32_16x16x32_bf16 v[248:251], a[60:63], a[152:155], v[248:251]
v_mfma_f32_16x16x32_bf16 v[252:255], a[60:63], a[156:159], v[252:255]
v_mov_b32 v37, s96
buffer_load_dword v34, v37, s[92:95], 0 offen sc1
s_waitcnt vmcnt(21)
s_waitcnt lgkmcnt(14)
v_mfma_f32_16x16x32_bf16 v[64:67], a[0:3], a[64:67], v[64:67]
v_mfma_f32_16x16x32_bf16 v[68:71], a[0:3], a[68:71], v[68:71]
s_add_u32 s81, s74, 98304
s_add_u32 m0, s75, 24576
s_nop 0
buffer_load_dwordx4 v2, s[20:23], s81 offen offset:0 lds
v_mfma_f32_16x16x32_bf16 v[72:75], a[0:3], a[72:75], v[72:75]
ds_read_b64_tr_b16 a[32:33], v54 offset:8192
v_mfma_f32_16x16x32_bf16 v[76:79], a[0:3], a[76:79], v[76:79]
ds_read_b64_tr_b16 a[34:35], v54 offset:12288
v_mfma_f32_16x16x32_bf16 v[80:83], a[0:3], a[80:83], v[80:83]
buffer_load_dwordx4 v3, s[20:23], s81 offen offset:1024 lds
v_mfma_f32_16x16x32_bf16 v[84:87], a[0:3], a[84:87], v[84:87]
ds_read_b64_tr_b16 a[36:37], v54 offset:8200
s_waitcnt lgkmcnt(15)
v_mfma_f32_16x16x32_bf16 v[88:91], a[4:7], a[64:67], v[88:91]
ds_read_b64_tr_b16 a[38:39], v54 offset:12296
v_mfma_f32_16x16x32_bf16 v[92:95], a[4:7], a[68:71], v[92:95]
buffer_load_dwordx4 v6, s[20:23], s81 offen offset:2048 lds
v_mfma_f32_16x16x32_bf16 v[96:99], a[4:7], a[72:75], v[96:99]
ds_read_b64_tr_b16 a[40:41], v55 offset:8192
v_mfma_f32_16x16x32_bf16 v[100:103], a[4:7], a[76:79], v[100:103]
ds_read_b64_tr_b16 a[42:43], v55 offset:12288
v_mfma_f32_16x16x32_bf16 v[104:107], a[4:7], a[80:83], v[104:107]
buffer_load_dwordx4 v7, s[20:23], s81 offen offset:3072 lds
v_mfma_f32_16x16x32_bf16 v[108:111], a[4:7], a[84:87], v[108:111]
ds_read_b64_tr_b16 a[44:45], v55 offset:8200
s_waitcnt lgkmcnt(15)
v_mfma_f32_16x16x32_bf16 v[112:115], a[8:11], a[64:67], v[112:115]
ds_read_b64_tr_b16 a[46:47], v55 offset:12296
v_mfma_f32_16x16x32_bf16 v[116:119], a[8:11], a[68:71], v[116:119]
s_add_u32 s81, s74, 114688
s_add_u32 m0, s75, 28672
s_nop 0
buffer_load_dwordx4 v2, s[20:23], s81 offen offset:0 lds
v_mfma_f32_16x16x32_bf16 v[120:123], a[8:11], a[72:75], v[120:123]
ds_read_b64_tr_b16 a[48:49], v56 offset:8192
v_mfma_f32_16x16x32_bf16 v[124:127], a[8:11], a[76:79], v[124:127]
ds_read_b64_tr_b16 a[50:51], v56 offset:12288
v_mfma_f32_16x16x32_bf16 v[128:131], a[8:11], a[80:83], v[128:131]
buffer_load_dwordx4 v3, s[20:23], s81 offen offset:1024 lds
v_mfma_f32_16x16x32_bf16 v[132:135], a[8:11], a[84:87], v[132:135]
ds_read_b64_tr_b16 a[52:53], v56 offset:8200
v_mfma_f32_16x16x32_bf16 v[136:139], a[12:15], a[64:67], v[136:139]
ds_read_b64_tr_b16 a[54:55], v56 offset:12296
v_mfma_f32_16x16x32_bf16 v[140:143], a[12:15], a[68:71], v[140:143]
buffer_load_dwordx4 v6, s[20:23], s81 offen offset:2048 lds
v_mfma_f32_16x16x32_bf16 v[144:147], a[12:15], a[72:75], v[144:147]
ds_read_b64_tr_b16 a[56:57], v57 offset:8192
v_mfma_f32_16x16x32_bf16 v[148:151], a[12:15], a[76:79], v[148:151]
ds_read_b64_tr_b16 a[58:59], v57 offset:12288
v_mfma_f32_16x16x32_bf16 v[152:155], a[12:15], a[80:83], v[152:155]
buffer_load_dwordx4 v7, s[20:23], s81 offen offset:3072 lds
v_mfma_f32_16x16x32_bf16 v[156:159], a[12:15], a[84:87], v[156:159]
ds_read_b64_tr_b16 a[60:61], v57 offset:8200
s_waitcnt lgkmcnt(15)
v_mfma_f32_16x16x32_bf16 v[160:163], a[16:19], a[64:67], v[160:163]
ds_read_b64_tr_b16 a[62:63], v57 offset:12296
v_mfma_f32_16x16x32_bf16 v[164:167], a[16:19], a[68:71], v[164:167]
s_add_u32 s80, s78, 18432
buffer_load_dwordx4 a[136:139], v58, s[16:19], s80 offen sc1
v_mfma_f32_16x16x32_bf16 v[168:171], a[16:19], a[72:75], v[168:171]
v_mfma_f32_16x16x32_bf16 v[172:175], a[16:19], a[76:79], v[172:175]
v_mfma_f32_16x16x32_bf16 v[176:179], a[16:19], a[80:83], v[176:179]
buffer_load_dwordx4 a[140:143], v59, s[16:19], s80 offen sc1
v_mfma_f32_16x16x32_bf16 v[180:183], a[16:19], a[84:87], v[180:183]
v_mfma_f32_16x16x32_bf16 v[184:187], a[20:23], a[64:67], v[184:187]
v_mfma_f32_16x16x32_bf16 v[188:191], a[20:23], a[68:71], v[188:191]
buffer_load_dwordx4 a[144:147], v60, s[16:19], s80 offen sc1
v_mfma_f32_16x16x32_bf16 v[192:195], a[20:23], a[72:75], v[192:195]
v_mfma_f32_16x16x32_bf16 v[196:199], a[20:23], a[76:79], v[196:199]
v_mfma_f32_16x16x32_bf16 v[200:203], a[20:23], a[80:83], v[200:203]
buffer_load_dwordx4 a[148:151], v61, s[16:19], s80 offen sc1
v_mfma_f32_16x16x32_bf16 v[204:207], a[20:23], a[84:87], v[204:207]
v_mfma_f32_16x16x32_bf16 v[208:211], a[24:27], a[64:67], v[208:211]
v_mfma_f32_16x16x32_bf16 v[212:215], a[24:27], a[68:71], v[212:215]
buffer_load_dwordx4 a[152:155], v62, s[16:19], s80 offen sc1
v_mfma_f32_16x16x32_bf16 v[216:219], a[24:27], a[72:75], v[216:219]
v_mfma_f32_16x16x32_bf16 v[220:223], a[24:27], a[76:79], v[220:223]
v_mfma_f32_16x16x32_bf16 v[224:227], a[24:27], a[80:83], v[224:227]
buffer_load_dwordx4 a[156:159], v63, s[16:19], s80 offen sc1
v_mfma_f32_16x16x32_bf16 v[228:231], a[24:27], a[84:87], v[228:231]
v_mfma_f32_16x16x32_bf16 v[232:235], a[28:31], a[64:67], v[232:235]
v_mfma_f32_16x16x32_bf16 v[236:239], a[28:31], a[68:71], v[236:239]
v_mfma_f32_16x16x32_bf16 v[240:243], a[28:31], a[72:75], v[240:243]
s_add_u32 s74, s74, 262144
s_add_u32 s78, s78, 49152
v_mfma_f32_16x16x32_bf16 v[244:247], a[28:31], a[76:79], v[244:247]
v_mfma_f32_16x16x32_bf16 v[248:251], a[28:31], a[80:83], v[248:251]
v_mfma_f32_16x16x32_bf16 v[252:255], a[28:31], a[84:87], v[252:255]
s_add_u32 s74, s74, 4294049792
s_add_u32 s78, s78, 4294795264
s_waitcnt vmcnt(14)
v_readfirstlane_b32 s88, v34
s_nop 3
s_cmp_ge_u32 s88, 16
s_cbranch_scc1 L_ok3
s_mov_b32 s89, 0x40000
L_spin3:
s_sleep 2
buffer_load_dword v34, v37, s[92:95], 0 offen sc1
s_waitcnt vmcnt(0)
v_readfirstlane_b32 s88, v34
s_nop 3
s_sub_u32 s89, s89, 1
s_cmp_eq_u32 s89, 0
s_cbranch_scc1 L_ok3
s_cmp_lt_u32 s88, 16
s_cbranch_scc1 L_spin3
L_ok3:
s_waitcnt vmcnt(14)
s_waitcnt lgkmcnt(14)
v_mfma_f32_16x16x32_bf16 v[64:67], a[32:35], a[88:91], v[64:67]
v_mfma_f32_16x16x32_bf16 v[68:71], a[32:35], a[92:95], v[68:71]
s_add_u32 s81, s74, 0
s_add_u32 m0, s75, 0
s_nop 0
buffer_load_dwordx4 v2, s[20:23], s81 offen offset:0 lds
v_mfma_f32_16x16x32_bf16 v[72:75], a[32:35], a[96:99], v[72:75]
ds_read_b64_tr_b16 a[0:1], v54 offset:16384
v_mfma_f32_16x16x32_bf16 v[76:79], a[32:35], a[100:103], v[76:79]
ds_read_b64_tr_b16 a[2:3], v54 offset:20480
v_mfma_f32_16x16x32_bf16 v[80:83], a[32:35], a[104:107], v[80:83]
buffer_load_dwordx4 v3, s[20:23], s81 offen offset:1024 lds
v_mfma_f32_16x16x32_bf16 v[84:87], a[32:35], a[108:111], v[84:87]
ds_read_b64_tr_b16 a[4:5], v54 offset:16392
s_waitcnt lgkmcnt(15)
v_mfma_f32_16x16x32_bf16 v[88:91], a[36:39], a[88:91], v[88:91]
ds_read_b64_tr_b16 a[6:7], v54 offset:20488
v_mfma_f32_16x16x32_bf16 v[92:95], a[36:39], a[92:95], v[92:95]
buffer_load_dwordx4 v6, s[20:23], s81 offen offset:2048 lds
v_mfma_f32_16x16x32_bf16 v[96:99], a[36:39], a[96:99], v[96:99]
ds_read_b64_tr_b16 a[8:9], v55 offset:16384
v_mfma_f32_16x16x32_bf16 v[100:103], a[36:39], a[100:103], v[100:103]
ds_read_b64_tr_b16 a[10:11], v55 offset:20480
v_mfma_f32_16x16x32_bf16 v[104:107], a[36:39], a[104:107], v[104:107]
buffer_load_dwordx4 v7, s[20:23], s81 offen offset:3072 lds
v_mfma_f32_16x16x32_bf16 v[108:111], a[36:39], a[108:111], v[108:111]
ds_read_b64_tr_b16 a[12:13], v55 offset:16392
s_waitcnt lgkmcnt(15)
v_mfma_f32_16x16x32_bf16 v[112:115], a[40:43], a[88:91], v[112:115]
ds_read_b64_tr_b16 a[14:15], v55 offset:20488
v_mfma_f32_16x16x32_bf16 v[116:119], a[40:43], a[92:95], v[116:119]
s_add_u32 s81, s74, 16384
s_add_u32 m0, s75, 4096
s_nop 0
buffer_load_dwordx4 v2, s[20:23], s81 offen offset:0 lds
v_mfma_f32_16x16x32_bf16 v[120:123], a[40:43], a[96:99], v[120:123]
ds_read_b64_tr_b16 a[16:17], v56 offset:16384
v_mfma_f32_16x16x32_bf16 v[124:127], a[40:43], a[100:103], v[124:127]
ds_read_b64_tr_b16 a[18:19], v56 offset:20480
v_mfma_f32_16x16x32_bf16 v[128:131], a[40:43], a[104:107], v[128:131]
buffer_load_dwordx4 v3, s[20:23], s81 offen offset:1024 lds
v_mfma_f32_16x16x32_bf16 v[132:135], a[40:43], a[108:111], v[132:135]
ds_read_b64_tr_b16 a[20:21], v56 offset:16392
v_mfma_f32_16x16x32_bf16 v[136:139], a[44:47], a[88:91], v[136:139]
ds_read_b64_tr_b16 a[22:23], v56 offset:20488
v_mfma_f32_16x16x32_bf16 v[140:143], a[44:47], a[92:95], v[140:143]
buffer_load_dwordx4 v6, s[20:23], s81 offen offset:2048 lds
v_mfma_f32_16x16x32_bf16 v[144:147], a[44:47], a[96:99], v[144:147]
ds_read_b64_tr_b16 a[24:25], v57 offset:16384
v_mfma_f32_16x16x32_bf16 v[148:151], a[44:47], a[100:103], v[148:151]
ds_read_b64_tr_b16 a[26:27], v57 offset:20480
v_mfma_f32_16x16x32_bf16 v[152:155], a[44:47], a[104:107], v[152:155]
buffer_load_dwordx4 v7, s[20:23], s81 offen offset:3072 lds
v_mfma_f32_16x16x32_bf16 v[156:159], a[44:47], a[108:111], v[156:159]
ds_read_b64_tr_b16 a[28:29], v57 offset:16392
s_waitcnt lgkmcnt(15)
v_mfma_f32_16x16x32_bf16 v[160:163], a[48:51], a[88:91], v[160:163]
ds_read_b64_tr_b16 a[30:31], v57 offset:20488
v_mfma_f32_16x16x32_bf16 v[164:167], a[48:51], a[92:95], v[164:167]
s_add_u32 s80, s78, 0
buffer_load_dwordx4 a[64:67], v58, s[16:19], s80 offen sc1
v_mfma_f32_16x16x32_bf16 v[168:171], a[48:51], a[96:99], v[168:171]
v_mfma_f32_16x16x32_bf16 v[172:175], a[48:51], a[100:103], v[172:175]
v_mfma_f32_16x16x32_bf16 v[176:179], a[48:51], a[104:107], v[176:179]
buffer_load_dwordx4 a[68:71], v59, s[16:19], s80 offen sc1
v_mfma_f32_16x16x32_bf16 v[180:183], a[48:51], a[108:111], v[180:183]
v_mfma_f32_16x16x32_bf16 v[184:187], a[52:55], a[88:91], v[184:187]
v_mfma_f32_16x16x32_bf16 v[188:191], a[52:55], a[92:95], v[188:191]
buffer_load_dwordx4 a[72:75], v60, s[16:19], s80 offen sc1
v_mfma_f32_16x16x32_bf16 v[192:195], a[52:55], a[96:99], v[192:195]
v_mfma_f32_16x16x32_bf16 v[196:199], a[52:55], a[100:103], v[196:199]
v_mfma_f32_16x16x32_bf16 v[200:203], a[52:55], a[104:107], v[200:203]
buffer_load_dwordx4 a[76:79], v61, s[16:19], s80 offen sc1
v_mfma_f32_16x16x32_bf16 v[204:207], a[52:55], a[108:111], v[204:207]
v_mfma_f32_16x16x32_bf16 v[208:211], a[56:59], a[88:91], v[208:211]
v_mfma_f32_16x16x32_bf16 v[212:215], a[56:59], a[92:95], v[212:215]
buffer_load_dwordx4 a[80:83], v62, s[16:19], s80 offen sc1
v_mfma_f32_16x16x32_bf16 v[216:219], a[56:59], a[96:99], v[216:219]
v_mfma_f32_16x16x32_bf16 v[220:223], a[56:59], a[100:103], v[220:223]
v_mfma_f32_16x16x32_bf16 v[224:227], a[56:59], a[104:107], v[224:227]
buffer_load_dwordx4 a[84:87], v63, s[16:19], s80 offen sc1
v_mfma_f32_16x16x32_bf16 v[228:231], a[56:59], a[108:111], v[228:231]
v_mfma_f32_16x16x32_bf16 v[232:235], a[60:63], a[88:91], v[232:235]
v_mfma_f32_16x16x32_bf16 v[236:239], a[60:63], a[92:95], v[236:239]
v_mfma_f32_16x16x32_bf16 v[240:243], a[60:63], a[96:99], v[240:243]
v_mfma_f32_16x16x32_bf16 v[244:247], a[60:63], a[100:103], v[244:247]
v_mfma_f32_16x16x32_bf16 v[248:251], a[60:63], a[104:107], v[248:251]
v_mfma_f32_16x16x32_bf16 v[252:255], a[60:63], a[108:111], v[252:255]
s_waitcnt vmcnt(20)
s_waitcnt lgkmcnt(14)
v_mfma_f32_16x16x32_bf16 v[64:67], a[0:3], a[112:115], v[64:67]
v_mfma_f32_16x16x32_bf16 v[68:71], a[0:3], a[116:119], v[68:71]
s_add_u32 s81, s74, 32768
s_add_u32 m0, s75, 8192
s_nop 0
buffer_load_dwordx4 v2, s[20:23], s81 offen offset:0 lds
v_mfma_f32_16x16x32_bf16 v[72:75], a[0:3], a[120:123], v[72:75]
ds_read_b64_tr_b16 a[32:33], v54 offset:24576
v_mfma_f32_16x16x32_bf16 v[76:79], a[0:3], a[124:127], v[76:79]
ds_read_b64_tr_b16 a[34:35], v54 offset:28672
v_mfma_f32_16x16x32_bf16 v[80:83], a[0:3], a[128:131], v[80:83]
buffer_load_dwordx4 v3, s[20:23], s81 offen offset:1024 lds
v_mfma_f32_16x16x32_bf16 v[84:87], a[0:3], a[132:135], v[84:87]
ds_read_b64_tr_b16 a[36:37], v54 offset:24584
s_waitcnt lgkmcnt(15)
v_mfma_f32_16x16x32_bf16 v[88:91], a[4:7], a[112:115], v[88:91]
ds_read_b64_tr_b16 a[38:39], v54 offset:28680
v_mfma_f32_16x16x32_bf16 v[92:95], a[4:7], a[116:119], v[92:95]
buffer_load_dwordx4 v6, s[20:23], s81 offen offset:2048 lds
v_mfma_f32_16x16x32_bf16 v[96:99], a[4:7], a[120:123], v[96:99]
ds_read_b64_tr_b16 a[40:41], v55 offset:24576
v_mfma_f32_16x16x32_bf16 v[100:103], a[4:7], a[124:127], v[100:103]
ds_read_b64_tr_b16 a[42:43], v55 offset:28672
v_mfma_f32_16x16x32_bf16 v[104:107], a[4:7], a[128:131], v[104:107]
buffer_load_dwordx4 v7, s[20:23], s81 offen offset:3072 lds
v_mfma_f32_16x16x32_bf16 v[108:111], a[4:7], a[132:135], v[108:111]
ds_read_b64_tr_b16 a[44:45], v55 offset:24584
s_waitcnt lgkmcnt(15)
v_mfma_f32_16x16x32_bf16 v[112:115], a[8:11], a[112:115], v[112:115]
ds_read_b64_tr_b16 a[46:47], v55 offset:28680
v_mfma_f32_16x16x32_bf16 v[116:119], a[8:11], a[116:119], v[116:119]
s_add_u32 s81, s74, 49152
s_add_u32 m0, s75, 12288
s_nop 0
buffer_load_dwordx4 v2, s[20:23], s81 offen offset:0 lds
v_mfma_f32_16x16x32_bf16 v[120:123], a[8:11], a[120:123], v[120:123]
ds_read_b64_tr_b16 a[48:49], v56 offset:24576
v_mfma_f32_16x16x32_bf16 v[124:127], a[8:11], a[124:127], v[124:127]
ds_read_b64_tr_b16 a[50:51], v56 offset:28672
v_mfma_f32_16x16x32_bf16 v[128:131], a[8:11], a[128:131], v[128:131]
buffer_load_dwordx4 v3, s[20:23], s81 offen offset:1024 lds
v_mfma_f32_16x16x32_bf16 v[132:135], a[8:11], a[132:135], v[132:135]
ds_read_b64_tr_b16 a[52:53], v56 offset:24584
v_mfma_f32_16x16x32_bf16 v[136:139], a[12:15], a[112:115], v[136:139]
ds_read_b64_tr_b16 a[54:55], v56 offset:28680
v_mfma_f32_16x16x32_bf16 v[140:143], a[12:15], a[116:119], v[140:143]
buffer_load_dwordx4 v6, s[20:23], s81 offen offset:2048 lds
v_mfma_f32_16x16x32_bf16 v[144:147], a[12:15], a[120:123], v[144:147]
ds_read_b64_tr_b16 a[56:57], v57 offset:24576
v_mfma_f32_16x16x32_bf16 v[148:151], a[12:15], a[124:127], v[148:151]
ds_read_b64_tr_b16 a[58:59], v57 offset:28672
v_mfma_f32_16x16x32_bf16 v[152:155], a[12:15], a[128:131], v[152:155]
buffer_load_dwordx4 v7, s[20:23], s81 offen offset:3072 lds
v_mfma_f32_16x16x32_bf16 v[156:159], a[12:15], a[132:135], v[156:159]
ds_read_b64_tr_b16 a[60:61], v57 offset:24584
s_waitcnt lgkmcnt(15)
v_mfma_f32_16x16x32_bf16 v[160:163], a[16:19], a[112:115], v[160:163]
ds_read_b64_tr_b16 a[62:63], v57 offset:28680
v_mfma_f32_16x16x32_bf16 v[164:167], a[16:19], a[116:119], v[164:167]
s_add_u32 s80, s78, 6144
buffer_load_dwordx4 a[88:91], v58, s[16:19], s80 offen sc1
v_mfma_f32_16x16x32_bf16 v[168:171], a[16:19], a[120:123], v[168:171]
v_mfma_f32_16x16x32_bf16 v[172:175], a[16:19], a[124:127], v[172:175]
v_mfma_f32_16x16x32_bf16 v[176:179], a[16:19], a[128:131], v[176:179]
buffer_load_dwordx4 a[92:95], v59, s[16:19], s80 offen sc1
v_mfma_f32_16x16x32_bf16 v[180:183], a[16:19], a[132:135], v[180:183]
v_mfma_f32_16x16x32_bf16 v[184:187], a[20:23], a[112:115], v[184:187]
v_mfma_f32_16x16x32_bf16 v[188:191], a[20:23], a[116:119], v[188:191]
buffer_load_dwordx4 a[96:99], v60, s[16:19], s80 offen sc1
v_mfma_f32_16x16x32_bf16 v[192:195], a[20:23], a[120:123], v[192:195]
v_mfma_f32_16x16x32_bf16 v[196:199], a[20:23], a[124:127], v[196:199]
v_mfma_f32_16x16x32_bf16 v[200:203], a[20:23], a[128:131], v[200:203]
buffer_load_dwordx4 a[100:103], v61, s[16:19], s80 offen sc1
v_mfma_f32_16x16x32_bf16 v[204:207], a[20:23], a[132:135], v[204:207]
v_mfma_f32_16x16x32_bf16 v[208:211], a[24:27], a[112:115], v[208:211]
v_mfma_f32_16x16x32_bf16 v[212:215], a[24:27], a[116:119], v[212:215]
buffer_load_dwordx4 a[104:107], v62, s[16:19], s80 offen sc1
v_mfma_f32_16x16x32_bf16 v[216:219], a[24:27], a[120:123], v[216:219]
v_mfma_f32_16x16x32_bf16 v[220:223], a[24:27], a[124:127], v[220:223]
v_mfma_f32_16x16x32_bf16 v[224:227], a[24:27], a[128:131], v[224:227]
buffer_load_dwordx4 a[108:111], v63, s[16:19], s80 offen sc1
v_mfma_f32_16x16x32_bf16 v[228:231], a[24:27], a[132:135], v[228:231]
v_mfma_f32_16x16x32_bf16 v[232:235], a[28:31], a[112:115], v[232:235]
v_mfma_f32_16x16x32_bf16 v[236:239], a[28:31], a[116:119], v[236:239]
v_mfma_f32_16x16x32_bf16 v[240:243], a[28:31], a[120:123], v[240:243]
v_mfma_f32_16x16x32_bf16 v[244:247], a[28:31], a[124:127], v[244:247]
v_mfma_f32_16x16x32_bf16 v[248:251], a[28:31], a[128:131], v[248:251]
v_mfma_f32_16x16x32_bf16 v[252:255], a[28:31], a[132:135], v[252:255]
s_waitcnt vmcnt(20)
s_waitcnt lgkmcnt(14)
v_mfma_f32_16x16x32_bf16 v[64:67], a[32:35], a[136:139], v[64:67]
v_mfma_f32_16x16x32_bf16 v[68:71], a[32:35], a[140:143], v[68:71]
s_add_u32 s81, s74, 65536
s_add_u32 m0, s75, 16384
s_nop 0
buffer_load_dwordx4 v2, s[20:23], s81 offen offset:0 lds
v_mfma_f32_16x16x32_bf16 v[72:75], a[32:35], a[144:147], v[72:75]
ds_read_b64_tr_b16 a[0:1], v54 offset:0
v_mfma_f32_16x16x32_bf16 v[76:79], a[32:35], a[148:151], v[76:79]
ds_read_b64_tr_b16 a[2:3], v54 offset:4096
v_mfma_f32_16x16x32_bf16 v[80:83], a[32:35], a[152:155], v[80:83]
buffer_load_dwordx4 v3, s[20:23], s81 offen offset:1024 lds
v_mfma_f32_16x16x32_bf16 v[84:87], a[32:35], a[156:159], v[84:87]
ds_read_b64_tr_b16 a[4:5], v54 offset:8
s_waitcnt lgkmcnt(15)
v_mfma_f32_16x16x32_bf16 v[88:91], a[36:39], a[136:139], v[88:91]
ds_read_b64_tr_b16 a[6:7], v54 offset:4104
v_mfma_f32_16x16x32_bf16 v[92:95], a[36:39], a[140:143], v[92:95]
buffer_load_dwordx4 v6, s[20:23], s81 offen offset:2048 lds
v_mfma_f32_16x16x32_bf16 v[96:99], a[36:39], a[144:147], v[96:99]
ds_read_b64_tr_b16 a[8:9], v55 offset:0
v_mfma_f32_16x16x32_bf16 v[100:103], a[36:39], a[148:151], v[100:103]
ds_read_b64_tr_b16 a[10:11], v55 offset:4096
v_mfma_f32_16x16x32_bf16 v[104:107], a[36:39], a[152:155], v[104:107]
buffer_load_dwordx4 v7, s[20:23], s81 offen offset:3072 lds
v_mfma_f32_16x16x32_bf16 v[108:111], a[36:39], a[156:159], v[108:111]
ds_read_b64_tr_b16 a[12:13], v55 offset:8
s_waitcnt lgkmcnt(15)
v_mfma_f32_16x16x32_bf16 v[112:115], a[40:43], a[136:139], v[112:115]
ds_read_b64_tr_b16 a[14:15], v55 offset:4104
v_mfma_f32_16x16x32_bf16 v[116:119], a[40:43], a[140:143], v[116:119]
s_add_u32 s81, s74, 81920
s_add_u32 m0, s75, 20480
s_nop 0
buffer_load_dwordx4 v2, s[20:23], s81 offen offset:0 lds
v_mfma_f32_16x16x32_bf16 v[120:123], a[40:43], a[144:147], v[120:123]
ds_read_b64_tr_b16 a[16:17], v56 offset:0
v_mfma_f32_16x16x32_bf16 v[124:127], a[40:43], a[148:151], v[124:127]
ds_read_b64_tr_b16 a[18:19], v56 offset:4096
v_mfma_f32_16x16x32_bf16 v[128:131], a[40:43], a[152:155], v[128:131]
buffer_load_dwordx4 v3, s[20:23], s81 offen offset:1024 lds
v_mfma_f32_16x16x32_bf16 v[132:135], a[40:43], a[156:159], v[132:135]
ds_read_b64_tr_b16 a[20:21], v56 offset:8
v_mfma_f32_16x16x32_bf16 v[136:139], a[44:47], a[136:139], v[136:139]
ds_read_b64_tr_b16 a[22:23], v56 offset:4104
v_mfma_f32_16x16x32_bf16 v[140:143], a[44:47], a[140:143], v[140:143]
buffer_load_dwordx4 v6, s[20:23], s81 offen offset:2048 lds
v_mfma_f32_16x16x32_bf16 v[144:147], a[44:47], a[144:147], v[144:147]
ds_read_b64_tr_b16 a[24:25], v57 offset:0
v_mfma_f32_16x16x32_bf16 v[148:151], a[44:47], a[148:151], v[148:151]
ds_read_b64_tr_b16 a[26:27], v57 offset:4096
v_mfma_f32_16x16x32_bf16 v[152:155], a[44:47], a[152:155], v[152:155]
buffer_load_dwordx4 v7, s[20:23], s81 offen offset:3072 lds
v_mfma_f32_16x16x32_bf16 v[156:159], a[44:47], a[156:159], v[156:159]
ds_read_b64_tr_b16 a[28:29], v57 offset:8
s_waitcnt lgkmcnt(15)
v_mfma_f32_16x16x32_bf16 v[160:163], a[48:51], a[136:139], v[160:163]
ds_read_b64_tr_b16 a[30:31], v57 offset:4104
v_mfma_f32_16x16x32_bf16 v[164:167], a[48:51], a[140:143], v[164:167]
s_add_u32 s80, s78, 12288
buffer_load_dwordx4 a[112:115], v58, s[16:19], s80 offen sc1
v_mfma_f32_16x16x32_bf16 v[168:171], a[48:51], a[144:147], v[168:171]
v_mfma_f32_16x16x32_bf16 v[172:175], a[48:51], a[148:151], v[172:175]
v_mfma_f32_16x16x32_bf16 v[176:179], a[48:51], a[152:155], v[176:179]
buffer_load_dwordx4 a[116:119], v59, s[16:19], s80 offen sc1
v_mfma_f32_16x16x32_bf16 v[180:183], a[48:51], a[156:159], v[180:183]
v_mfma_f32_16x16x32_bf16 v[184:187], a[52:55], a[136:139], v[184:187]
v_mfma_f32_16x16x32_bf16 v[188:191], a[52:55], a[140:143], v[188:191]
buffer_load_dwordx4 a[120:123], v60, s[16:19], s80 offen sc1
v_mfma_f32_16x16x32_bf16 v[192:195], a[52:55], a[144:147], v[192:195]
v_mfma_f32_16x16x32_bf16 v[196:199], a[52:55], a[148:151], v[196:199]
v_mfma_f32_16x16x32_bf16 v[200:203], a[52:55], a[152:155], v[200:203]
buffer_load_dwordx4 a[124:127], v61, s[16:19], s80 offen sc1
v_mfma_f32_16x16x32_bf16 v[204:207], a[52:55], a[156:159], v[204:207]
v_mfma_f32_16x16x32_bf16 v[208:211], a[56:59], a[136:139], v[208:211]
v_mfma_f32_16x16x32_bf16 v[212:215], a[56:59], a[140:143], v[212:215]
buffer_load_dwordx4 a[128:131], v62, s[16:19], s80 offen sc1
v_mfma_f32_16x16x32_bf16 v[216:219], a[56:59], a[144:147], v[216:219]
v_mfma_f32_16x16x32_bf16 v[220:223], a[56:59], a[148:151], v[220:223]
v_mfma_f32_16x16x32_bf16 v[224:227], a[56:59], a[152:155], v[224:227]
buffer_load_dwordx4 a[132:135], v63, s[16:19], s80 offen sc1
v_mfma_f32_16x16x32_bf16 v[228:231], a[56:59], a[156:159], v[228:231]
v_mfma_f32_16x16x32_bf16 v[232:235], a[60:63], a[136:139], v[232:235]
v_mfma_f32_16x16x32_bf16 v[236:239], a[60:63], a[140:143], v[236:239]
v_mfma_f32_16x16x32_bf16 v[240:243], a[60:63], a[144:147], v[240:243]
v_mfma_f32_16x16x32_bf16 v[244:247], a[60:63], a[148:151], v[244:247]
v_mfma_f32_16x16x32_bf16 v[248:251], a[60:63], a[152:155], v[248:251]
v_mfma_f32_16x16x32_bf16 v[252:255], a[60:63], a[156:159], v[252:255]
s_waitcnt vmcnt(20)
s_waitcnt lgkmcnt(14)
v_mfma_f32_16x16x32_bf16 v[64:67], a[0:3], a[64:67], v[64:67]
v_mfma_f32_16x16x32_bf16 v[68:71], a[0:3], a[68:71], v[68:71]
s_add_u32 s81, s74, 98304
s_add_u32 m0, s75, 24576
s_nop 0
buffer_load_dwordx4 v2, s[20:23], s81 offen offset:0 lds
v_mfma_f32_16x16x32_bf16 v[72:75], a[0:3], a[72:75], v[72:75]
ds_read_b64_tr_b16 a[32:33], v54 offset:8192
v_mfma_f32_16x16x32_bf16 v[76:79], a[0:3], a[76:79], v[76:79]
ds_read_b64_tr_b16 a[34:35], v54 offset:12288
v_mfma_f32_16x16x32_bf16 v[80:83], a[0:3], a[80:83], v[80:83]
buffer_load_dwordx4 v3, s[20:23], s81 offen offset:1024 lds
v_mfma_f32_16x16x32_bf16 v[84:87], a[0:3], a[84:87], v[84:87]
ds_read_b64_tr_b16 a[36:37], v54 offset:8200
s_waitcnt lgkmcnt(15)
v_mfma_f32_16x16x32_bf16 v[88:91], a[4:7], a[64:67], v[88:91]
ds_read_b64_tr_b16 a[38:39], v54 offset:12296
v_mfma_f32_16x16x32_bf16 v[92:95], a[4:7], a[68:71], v[92:95]
buffer_load_dwordx4 v6, s[20:23], s81 offen offset:2048 lds
v_mfma_f32_16x16x32_bf16 v[96:99], a[4:7], a[72:75], v[96:99]
ds_read_b64_tr_b16 a[40:41], v55 offset:8192
v_mfma_f32_16x16x32_bf16 v[100:103], a[4:7], a[76:79], v[100:103]
ds_read_b64_tr_b16 a[42:43], v55 offset:12288
v_mfma_f32_16x16x32_bf16 v[104:107], a[4:7], a[80:83], v[104:107]
buffer_load_dwordx4 v7, s[20:23], s81 offen offset:3072 lds
v_mfma_f32_16x16x32_bf16 v[108:111], a[4:7], a[84:87], v[108:111]
ds_read_b64_tr_b16 a[44:45], v55 offset:8200
s_waitcnt lgkmcnt(15)
v_mfma_f32_16x16x32_bf16 v[112:115], a[8:11], a[64:67], v[112:115]
ds_read_b64_tr_b16 a[46:47], v55 offset:12296
v_mfma_f32_16x16x32_bf16 v[116:119], a[8:11], a[68:71], v[116:119]
s_add_u32 s81, s74, 114688
s_add_u32 m0, s75, 28672
s_nop 0
buffer_load_dwordx4 v2, s[20:23], s81 offen offset:0 lds
v_mfma_f32_16x16x32_bf16 v[120:123], a[8:11], a[72:75], v[120:123]
ds_read_b64_tr_b16 a[48:49], v56 offset:8192
v_mfma_f32_16x16x32_bf16 v[124:127], a[8:11], a[76:79], v[124:127]
ds_read_b64_tr_b16 a[50:51], v56 offset:12288
v_mfma_f32_16x16x32_bf16 v[128:131], a[8:11], a[80:83], v[128:131]
buffer_load_dwordx4 v3, s[20:23], s81 offen offset:1024 lds
v_mfma_f32_16x16x32_bf16 v[132:135], a[8:11], a[84:87], v[132:135]
ds_read_b64_tr_b16 a[52:53], v56 offset:8200
v_mfma_f32_16x16x32_bf16 v[136:139], a[12:15], a[64:67], v[136:139]
ds_read_b64_tr_b16 a[54:55], v56 offset:12296
v_mfma_f32_16x16x32_bf16 v[140:143], a[12:15], a[68:71], v[140:143]
buffer_load_dwordx4 v6, s[20:23], s81 offen offset:2048 lds
v_mfma_f32_16x16x32_bf16 v[144:147], a[12:15], a[72:75], v[144:147]
ds_read_b64_tr_b16 a[56:57], v57 offset:8192
v_mfma_f32_16x16x32_bf16 v[148:151], a[12:15], a[76:79], v[148:151]
ds_read_b64_tr_b16 a[58:59], v57 offset:12288
v_mfma_f32_16x16x32_bf16 v[152:155], a[12:15], a[80:83], v[152:155]
buffer_load_dwordx4 v7, s[20:23], s81 offen offset:3072 lds
v_mfma_f32_16x16x32_bf16 v[156:159], a[12:15], a[84:87], v[156:159]
ds_read_b64_tr_b16 a[60:61], v57 offset:8200
s_waitcnt lgkmcnt(15)
v_mfma_f32_16x16x32_bf16 v[160:163], a[16:19], a[64:67], v[160:163]
ds_read_b64_tr_b16 a[62:63], v57 offset:12296
v_mfma_f32_16x16x32_bf16 v[164:167], a[16:19], a[68:71], v[164:167]
s_add_u32 s80, s78, 18432
buffer_load_dwordx4 a[136:139], v58, s[16:19], s80 offen sc1
v_mfma_f32_16x16x32_bf16 v[168:171], a[16:19], a[72:75], v[168:171]
v_mfma_f32_16x16x32_bf16 v[172:175], a[16:19], a[76:79], v[172:175]
v_mfma_f32_16x16x32_bf16 v[176:179], a[16:19], a[80:83], v[176:179]
buffer_load_dwordx4 a[140:143], v59, s[16:19], s80 offen sc1
v_mfma_f32_16x16x32_bf16 v[180:183], a[16:19], a[84:87], v[180:183]
v_mfma_f32_16x16x32_bf16 v[184:187], a[20:23], a[64:67], v[184:187]
v_mfma_f32_16x16x32_bf16 v[188:191], a[20:23], a[68:71], v[188:191]
buffer_load_dwordx4 a[144:147], v60, s[16:19], s80 offen sc1
v_mfma_f32_16x16x32_bf16 v[192:195], a[20:23], a[72:75], v[192:195]
v_mfma_f32_16x16x32_bf16 v[196:199], a[20:23], a[76:79], v[196:199]
v_mfma_f32_16x16x32_bf16 v[200:203], a[20:23], a[80:83], v[200:203]
buffer_load_dwordx4 a[148:151], v61, s[16:19], s80 offen sc1
v_mfma_f32_16x16x32_bf16 v[204:207], a[20:23], a[84:87], v[204:207]
v_mfma_f32_16x16x32_bf16 v[208:211], a[24:27], a[64:67], v[208:211]
v_mfma_f32_16x16x32_bf16 v[212:215], a[24:27], a[68:71], v[212:215]
buffer_load_dwordx4 a[152:155], v62, s[16:19], s80 offen sc1
v_mfma_f32_16x16x32_bf16 v[216:219], a[24:27], a[72:75], v[216:219]
v_mfma_f32_16x16x32_bf16 v[220:223], a[24:27], a[76:79], v[220:223]
v_mfma_f32_16x16x32_bf16 v[224:227], a[24:27], a[80:83], v[224:227]
buffer_load_dwordx4 a[156:159], v63, s[16:19], s80 offen sc1
v_mfma_f32_16x16x32_bf16 v[228:231], a[24:27], a[84:87], v[228:231]
v_mfma_f32_16x16x32_bf16 v[232:235], a[28:31], a[64:67], v[232:235]
v_mfma_f32_16x16x32_bf16 v[236:239], a[28:31], a[68:71], v[236:239]
v_mfma_f32_16x16x32_bf16 v[240:243], a[28:31], a[72:75], v[240:243]
s_add_u32 s74, s74, 262144
s_add_u32 s78, s78, 49152
v_mfma_f32_16x16x32_bf16 v[244:247], a[28:31], a[76:79], v[244:247]
v_mfma_f32_16x16x32_bf16 v[248:251], a[28:31], a[80:83], v[248:251]
v_mfma_f32_16x16x32_bf16 v[252:255], a[28:31], a[84:87], v[252:255]
s_mov_b32 s47, 3
L_k3b:
s_waitcnt vmcnt(20)
s_waitcnt lgkmcnt(14)
v_mfma_f32_16x16x32_bf16 v[64:67], a[32:35], a[88:91], v[64:67]
v_mfma_f32_16x16x32_bf16 v[68:71], a[32:35], a[92:95], v[68:71]
s_add_u32 s81, s74, 0
s_add_u32 m0, s75, 0
s_nop 0
buffer_load_dwordx4 v2, s[20:23], s81 offen offset:0 lds
v_mfma_f32_16x16x32_bf16 v[72:75], a[32:35], a[96:99], v[72:75]
ds_read_b64_tr_b16 a[0:1], v54 offset:16384
v_mfma_f32_16x16x32_bf16 v[76:79], a[32:35], a[100:103], v[76:79]
ds_read_b64_tr_b16 a[2:3], v54 offset:20480
v_mfma_f32_16x16x32_bf16 v[80:83], a[32:35], a[104:107], v[80:83]
buffer_load_dwordx4 v3, s[20:23], s81 offen offset:1024 lds
v_mfma_f32_16x16x32_bf16 v[84:87], a[32:35], a[108:111], v[84:87]
ds_read_b64_tr_b16 a[4:5], v54 offset:16392
s_waitcnt lgkmcnt(15)
v_mfma_f32_16x16x32_bf16 v[88:91], a[36:39], a[88:91], v[88:91]
ds_read_b64_tr_b16 a[6:7], v54 offset:20488
v_mfma_f32_16x16x32_bf16 v[92:95], a[36:39], a[92:95], v[92:95]
buffer_load_dwordx4 v6, s[20:23], s81 offen offset:2048 lds
v_mfma_f32_16x16x32_bf16 v[96:99], a[36:39], a[96:99], v[96:99]
ds_read_b64_tr_b16 a[8:9], v55 offset:16384
v_mfma_f32_16x16x32_bf16 v[100:103], a[36:39], a[100:103], v[100:103]
ds_read_b64_tr_b16 a[10:11], v55 offset:20480
v_mfma_f32_16x16x32_bf16 v[104:107], a[36:39], a[104:107], v[104:107]
buffer_load_dwordx4 v7, s[20:23], s81 offen offset:3072 lds
v_mfma_f32_16x16x32_bf16 v[108:111], a[36:39], a[108:111], v[108:111]
ds_read_b64_tr_b16 a[12:13], v55 offset:16392
s_waitcnt lgkmcnt(15)
v_mfma_f32_16x16x32_bf16 v[112:115], a[40:43], a[88:91], v[112:115]
ds_read_b64_tr_b16 a[14:15], v55 offset:20488
v_mfma_f32_16x16x32_bf16 v[116:119], a[40:43], a[92:95], v[116:119]
s_add_u32 s81, s74, 16384
s_add_u32 m0, s75, 4096
s_nop 0
buffer_load_dwordx4 v2, s[20:23], s81 offen offset:0 lds
v_mfma_f32_16x16x32_bf16 v[120:123], a[40:43], a[96:99], v[120:123]
ds_read_b64_tr_b16 a[16:17], v56 offset:16384
v_mfma_f32_16x16x32_bf16 v[124:127], a[40:43], a[100:103], v[124:127]
ds_read_b64_tr_b16 a[18:19], v56 offset:20480
v_mfma_f32_16x16x32_bf16 v[128:131], a[40:43], a[104:107], v[128:131]
buffer_load_dwordx4 v3, s[20:23], s81 offen offset:1024 lds
v_mfma_f32_16x16x32_bf16 v[132:135], a[40:43], a[108:111], v[132:135]
ds_read_b64_tr_b16 a[20:21], v56 offset:16392
v_mfma_f32_16x16x32_bf16 v[136:139], a[44:47], a[88:91], v[136:139]
ds_read_b64_tr_b16 a[22:23], v56 offset:20488
v_mfma_f32_16x16x32_bf16 v[140:143], a[44:47], a[92:95], v[140:143]
buffer_load_dwordx4 v6, s[20:23], s81 offen offset:2048 lds
v_mfma_f32_16x16x32_bf16 v[144:147], a[44:47], a[96:99], v[144:147]
ds_read_b64_tr_b16 a[24:25], v57 offset:16384
v_mfma_f32_16x16x32_bf16 v[148:151], a[44:47], a[100:103], v[148:151]
ds_read_b64_tr_b16 a[26:27], v57 offset:20480
v_mfma_f32_16x16x32_bf16 v[152:155], a[44:47], a[104:107], v[152:155]
buffer_load_dwordx4 v7, s[20:23], s81 offen offset:3072 lds
v_mfma_f32_16x16x32_bf16 v[156:159], a[44:47], a[108:111], v[156:159]
ds_read_b64_tr_b16 a[28:29], v57 offset:16392
s_waitcnt lgkmcnt(15)
v_mfma_f32_16x16x32_bf16 v[160:163], a[48:51], a[88:91], v[160:163]
ds_read_b64_tr_b16 a[30:31], v57 offset:20488
v_mfma_f32_16x16x32_bf16 v[164:167], a[48:51], a[92:95], v[164:167]
s_add_u32 s80, s78, 0
buffer_load_dwordx4 a[64:67], v58, s[16:19], s80 offen sc1
v_mfma_f32_16x16x32_bf16 v[168:171], a[48:51], a[96:99], v[168:171]
v_mfma_f32_16x16x32_bf16 v[172:175], a[48:51], a[100:103], v[172:175]
v_mfma_f32_16x16x32_bf16 v[176:179], a[48:51], a[104:107], v[176:179]
buffer_load_dwordx4 a[68:71], v59, s[16:19], s80 offen sc1
v_mfma_f32_16x16x32_bf16 v[180:183], a[48:51], a[108:111], v[180:183]
v_mfma_f32_16x16x32_bf16 v[184:187], a[52:55], a[88:91], v[184:187]
v_mfma_f32_16x16x32_bf16 v[188:191], a[52:55], a[92:95], v[188:191]
buffer_load_dwordx4 a[72:75], v60, s[16:19], s80 offen sc1
v_mfma_f32_16x16x32_bf16 v[192:195], a[52:55], a[96:99], v[192:195]
v_mfma_f32_16x16x32_bf16 v[196:199], a[52:55], a[100:103], v[196:199]
v_mfma_f32_16x16x32_bf16 v[200:203], a[52:55], a[104:107], v[200:203]
buffer_load_dwordx4 a[76:79], v61, s[16:19], s80 offen sc1
v_mfma_f32_16x16x32_bf16 v[204:207], a[52:55], a[108:111], v[204:207]
v_mfma_f32_16x16x32_bf16 v[208:211], a[56:59], a[88:91], v[208:211]
v_mfma_f32_16x16x32_bf16 v[212:215], a[56:59], a[92:95], v[212:215]
buffer_load_dwordx4 a[80:83], v62, s[16:19], s80 offen sc1
v_mfma_f32_16x16x32_bf16 v[216:219], a[56:59], a[96:99], v[216:219]
v_mfma_f32_16x16x32_bf16 v[220:223], a[56:59], a[100:103], v[220:223]
v_mfma_f32_16x16x32_bf16 v[224:227], a[56:59], a[104:107], v[224:227]
buffer_load_dwordx4 a[84:87], v63, s[16:19], s80 offen sc1
v_mfma_f32_16x16x32_bf16 v[228:231], a[56:59], a[108:111], v[228:231]
v_mfma_f32_16x16x32_bf16 v[232:235], a[60:63], a[88:91], v[232:235]
v_mfma_f32_16x16x32_bf16 v[236:239], a[60:63], a[92:95], v[236:239]
v_mfma_f32_16x16x32_bf16 v[240:243], a[60:63], a[96:99], v[240:243]
v_mfma_f32_16x16x32_bf16 v[244:247], a[60:63], a[100:103], v[244:247]
v_mfma_f32_16x16x32_bf16 v[248:251], a[60:63], a[104:107], v[248:251]
v_mfma_f32_16x16x32_bf16 v[252:255], a[60:63], a[108:111], v[252:255]
s_waitcnt vmcnt(20)
s_waitcnt lgkmcnt(14)
v_mfma_f32_16x16x32_bf16 v[64:67], a[0:3], a[112:115], v[64:67]
v_mfma_f32_16x16x32_bf16 v[68:71], a[0:3], a[116:119], v[68:71]
s_add_u32 s81, s74, 32768
s_add_u32 m0, s75, 8192
s_nop 0
buffer_load_dwordx4 v2, s[20:23], s81 offen offset:0 lds
v_mfma_f32_16x16x32_bf16 v[72:75], a[0:3], a[120:123], v[72:75]
ds_read_b64_tr_b16 a[32:33], v54 offset:24576
v_mfma_f32_16x16x32_bf16 v[76:79], a[0:3], a[124:127], v[76:79]
ds_read_b64_tr_b16 a[34:35], v54 offset:28672
v_mfma_f32_16x16x32_bf16 v[80:83], a[0:3], a[128:131], v[80:83]
buffer_load_dwordx4 v3, s[20:23], s81 offen offset:1024 lds
v_mfma_f32_16x16x32_bf16 v[84:87], a[0:3], a[132:135], v[84:87]
ds_read_b64_tr_b16 a[36:37], v54 offset:24584
s_waitcnt lgkmcnt(15)
v_mfma_f32_16x16x32_bf16 v[88:91], a[4:7], a[112:115], v[88:91]
ds_read_b64_tr_b16 a[38:39], v54 offset:28680
v_mfma_f32_16x16x32_bf16 v[92:95], a[4:7], a[116:119], v[92:95]
buffer_load_dwordx4 v6, s[20:23], s81 offen offset:2048 lds
v_mfma_f32_16x16x32_bf16 v[96:99], a[4:7], a[120:123], v[96:99]
ds_read_b64_tr_b16 a[40:41], v55 offset:24576
v_mfma_f32_16x16x32_bf16 v[100:103], a[4:7], a[124:127], v[100:103]
ds_read_b64_tr_b16 a[42:43], v55 offset:28672
v_mfma_f32_16x16x32_bf16 v[104:107], a[4:7], a[128:131], v[104:107]
buffer_load_dwordx4 v7, s[20:23], s81 offen offset:3072 lds
v_mfma_f32_16x16x32_bf16 v[108:111], a[4:7], a[132:135], v[108:111]
ds_read_b64_tr_b16 a[44:45], v55 offset:24584
s_waitcnt lgkmcnt(15)
v_mfma_f32_16x16x32_bf16 v[112:115], a[8:11], a[112:115], v[112:115]
ds_read_b64_tr_b16 a[46:47], v55 offset:28680
v_mfma_f32_16x16x32_bf16 v[116:119], a[8:11], a[116:119], v[116:119]
s_add_u32 s81, s74, 49152
s_add_u32 m0, s75, 12288
s_nop 0
buffer_load_dwordx4 v2, s[20:23], s81 offen offset:0 lds
v_mfma_f32_16x16x32_bf16 v[120:123], a[8:11], a[120:123], v[120:123]
ds_read_b64_tr_b16 a[48:49], v56 offset:24576
v_mfma_f32_16x16x32_bf16 v[124:127], a[8:11], a[124:127], v[124:127]
ds_read_b64_tr_b16 a[50:51], v56 offset:28672
v_mfma_f32_16x16x32_bf16 v[128:131], a[8:11], a[128:131], v[128:131]
buffer_load_dwordx4 v3, s[20:23], s81 offen offset:1024 lds
v_mfma_f32_16x16x32_bf16 v[132:135], a[8:11], a[132:135], v[132:135]
ds_read_b64_tr_b16 a[52:53], v56 offset:24584
v_mfma_f32_16x16x32_bf16 v[136:139], a[12:15], a[112:115], v[136:139]
ds_read_b64_tr_b16 a[54:55], v56 offset:28680
v_mfma_f32_16x16x32_bf16 v[140:143], a[12:15], a[116:119], v[140:143]
buffer_load_dwordx4 v6, s[20:23], s81 offen offset:2048 lds
v_mfma_f32_16x16x32_bf16 v[144:147], a[12:15], a[120:123], v[144:147]
ds_read_b64_tr_b16 a[56:57], v57 offset:24576
v_mfma_f32_16x16x32_bf16 v[148:151], a[12:15], a[124:127], v[148:151]
ds_read_b64_tr_b16 a[58:59], v57 offset:28672
v_mfma_f32_16x16x32_bf16 v[152:155], a[12:15], a[128:131], v[152:155]
buffer_load_dwordx4 v7, s[20:23], s81 offen offset:3072 lds
v_mfma_f32_16x16x32_bf16 v[156:159], a[12:15], a[132:135], v[156:159]
ds_read_b64_tr_b16 a[60:61], v57 offset:24584
s_waitcnt lgkmcnt(15)
v_mfma_f32_16x16x32_bf16 v[160:163], a[16:19], a[112:115], v[160:163]
ds_read_b64_tr_b16 a[62:63], v57 offset:28680
v_mfma_f32_16x16x32_bf16 v[164:167], a[16:19], a[116:119], v[164:167]
s_add_u32 s80, s78, 6144
buffer_load_dwordx4 a[88:91], v58, s[16:19], s80 offen sc1
v_mfma_f32_16x16x32_bf16 v[168:171], a[16:19], a[120:123], v[168:171]
v_mfma_f32_16x16x32_bf16 v[172:175], a[16:19], a[124:127], v[172:175]
v_mfma_f32_16x16x32_bf16 v[176:179], a[16:19], a[128:131], v[176:179]
buffer_load_dwordx4 a[92:95], v59, s[16:19], s80 offen sc1
v_mfma_f32_16x16x32_bf16 v[180:183], a[16:19], a[132:135], v[180:183]
v_mfma_f32_16x16x32_bf16 v[184:187], a[20:23], a[112:115], v[184:187]
v_mfma_f32_16x16x32_bf16 v[188:191], a[20:23], a[116:119], v[188:191]
buffer_load_dwordx4 a[96:99], v60, s[16:19], s80 offen sc1
v_mfma_f32_16x16x32_bf16 v[192:195], a[20:23], a[120:123], v[192:195]
v_mfma_f32_16x16x32_bf16 v[196:199], a[20:23], a[124:127], v[196:199]
v_mfma_f32_16x16x32_bf16 v[200:203], a[20:23], a[128:131], v[200:203]
buffer_load_dwordx4 a[100:103], v61, s[16:19], s80 offen sc1
v_mfma_f32_16x16x32_bf16 v[204:207], a[20:23], a[132:135], v[204:207]
v_mfma_f32_16x16x32_bf16 v[208:211], a[24:27], a[112:115], v[208:211]
v_mfma_f32_16x16x32_bf16 v[212:215], a[24:27], a[116:119], v[212:215]
buffer_load_dwordx4 a[104:107], v62, s[16:19], s80 offen sc1
v_mfma_f32_16x16x32_bf16 v[216:219], a[24:27], a[120:123], v[216:219]
v_mfma_f32_16x16x32_bf16 v[220:223], a[24:27], a[124:127], v[220:223]
v_mfma_f32_16x16x32_bf16 v[224:227], a[24:27], a[128:131], v[224:227]
buffer_load_dwordx4 a[108:111], v63, s[16:19], s80 offen sc1
v_mfma_f32_16x16x32_bf16 v[228:231], a[24:27], a[132:135], v[228:231]
v_mfma_f32_16x16x32_bf16 v[232:235], a[28:31], a[112:115], v[232:235]
v_mfma_f32_16x16x32_bf16 v[236:239], a[28:31], a[116:119], v[236:239]
v_mfma_f32_16x16x32_bf16 v[240:243], a[28:31], a[120:123], v[240:243]
v_mfma_f32_16x16x32_bf16 v[244:247], a[28:31], a[124:127], v[244:247]
v_mfma_f32_16x16x32_bf16 v[248:251], a[28:31], a[128:131], v[248:251]
v_mfma_f32_16x16x32_bf16 v[252:255], a[28:31], a[132:135], v[252:255]
s_waitcnt vmcnt(20)
s_waitcnt lgkmcnt(14)
v_mfma_f32_16x16x32_bf16 v[64:67], a[32:35], a[136:139], v[64:67]
v_mfma_f32_16x16x32_bf16 v[68:71], a[32:35], a[140:143], v[68:71]
s_add_u32 s81, s74, 65536
s_add_u32 m0, s75, 16384
s_nop 0
buffer_load_dwordx4 v2, s[20:23], s81 offen offset:0 lds
v_mfma_f32_16x16x32_bf16 v[72:75], a[32:35], a[144:147], v[72:75]
ds_read_b64_tr_b16 a[0:1], v54 offset:0
v_mfma_f32_16x16x32_bf16 v[76:79], a[32:35], a[148:151], v[76:79]
ds_read_b64_tr_b16 a[2:3], v54 offset:4096
v_mfma_f32_16x16x32_bf16 v[80:83], a[32:35], a[152:155], v[80:83]
buffer_load_dwordx4 v3, s[20:23], s81 offen offset:1024 lds
v_mfma_f32_16x16x32_bf16 v[84:87], a[32:35], a[156:159], v[84:87]
ds_read_b64_tr_b16 a[4:5], v54 offset:8
s_waitcnt lgkmcnt(15)
v_mfma_f32_16x16x32_bf16 v[88:91], a[36:39], a[136:139], v[88:91]
ds_read_b64_tr_b16 a[6:7], v54 offset:4104
v_mfma_f32_16x16x32_bf16 v[92:95], a[36:39], a[140:143], v[92:95]
buffer_load_dwordx4 v6, s[20:23], s81 offen offset:2048 lds
v_mfma_f32_16x16x32_bf16 v[96:99], a[36:39], a[144:147], v[96:99]
ds_read_b64_tr_b16 a[8:9], v55 offset:0
v_mfma_f32_16x16x32_bf16 v[100:103], a[36:39], a[148:151], v[100:103]
ds_read_b64_tr_b16 a[10:11], v55 offset:4096
v_mfma_f32_16x16x32_bf16 v[104:107], a[36:39], a[152:155], v[104:107]
buffer_load_dwordx4 v7, s[20:23], s81 offen offset:3072 lds
v_mfma_f32_16x16x32_bf16 v[108:111], a[36:39], a[156:159], v[108:111]
ds_read_b64_tr_b16 a[12:13], v55 offset:8
s_waitcnt lgkmcnt(15)
v_mfma_f32_16x16x32_bf16 v[112:115], a[40:43], a[136:139], v[112:115]
ds_read_b64_tr_b16 a[14:15], v55 offset:4104
v_mfma_f32_16x16x32_bf16 v[116:119], a[40:43], a[140:143], v[116:119]
s_add_u32 s81, s74, 81920
s_add_u32 m0, s75, 20480
s_nop 0
buffer_load_dwordx4 v2, s[20:23], s81 offen offset:0 lds
v_mfma_f32_16x16x32_bf16 v[120:123], a[40:43], a[144:147], v[120:123]
ds_read_b64_tr_b16 a[16:17], v56 offset:0
v_mfma_f32_16x16x32_bf16 v[124:127], a[40:43], a[148:151], v[124:127]
ds_read_b64_tr_b16 a[18:19], v56 offset:4096
v_mfma_f32_16x16x32_bf16 v[128:131], a[40:43], a[152:155], v[128:131]
buffer_load_dwordx4 v3, s[20:23], s81 offen offset:1024 lds
v_mfma_f32_16x16x32_bf16 v[132:135], a[40:43], a[156:159], v[132:135]
ds_read_b64_tr_b16 a[20:21], v56 offset:8
v_mfma_f32_16x16x32_bf16 v[136:139], a[44:47], a[136:139], v[136:139]
ds_read_b64_tr_b16 a[22:23], v56 offset:4104
v_mfma_f32_16x16x32_bf16 v[140:143], a[44:47], a[140:143], v[140:143]
buffer_load_dwordx4 v6, s[20:23], s81 offen offset:2048 lds
v_mfma_f32_16x16x32_bf16 v[144:147], a[44:47], a[144:147], v[144:147]
ds_read_b64_tr_b16 a[24:25], v57 offset:0
v_mfma_f32_16x16x32_bf16 v[148:151], a[44:47], a[148:151], v[148:151]
ds_read_b64_tr_b16 a[26:27], v57 offset:4096
v_mfma_f32_16x16x32_bf16 v[152:155], a[44:47], a[152:155], v[152:155]
buffer_load_dwordx4 v7, s[20:23], s81 offen offset:3072 lds
v_mfma_f32_16x16x32_bf16 v[156:159], a[44:47], a[156:159], v[156:159]
ds_read_b64_tr_b16 a[28:29], v57 offset:8
s_waitcnt lgkmcnt(15)
v_mfma_f32_16x16x32_bf16 v[160:163], a[48:51], a[136:139], v[160:163]
ds_read_b64_tr_b16 a[30:31], v57 offset:4104
v_mfma_f32_16x16x32_bf16 v[164:167], a[48:51], a[140:143], v[164:167]
s_add_u32 s80, s78, 12288
buffer_load_dwordx4 a[112:115], v58, s[16:19], s80 offen sc1
v_mfma_f32_16x16x32_bf16 v[168:171], a[48:51], a[144:147], v[168:171]
v_mfma_f32_16x16x32_bf16 v[172:175], a[48:51], a[148:151], v[172:175]
v_mfma_f32_16x16x32_bf16 v[176:179], a[48:51], a[152:155], v[176:179]
buffer_load_dwordx4 a[116:119], v59, s[16:19], s80 offen sc1
v_mfma_f32_16x16x32_bf16 v[180:183], a[48:51], a[156:159], v[180:183]
v_mfma_f32_16x16x32_bf16 v[184:187], a[52:55], a[136:139], v[184:187]
v_mfma_f32_16x16x32_bf16 v[188:191], a[52:55], a[140:143], v[188:191]
buffer_load_dwordx4 a[120:123], v60, s[16:19], s80 offen sc1
v_mfma_f32_16x16x32_bf16 v[192:195], a[52:55], a[144:147], v[192:195]
v_mfma_f32_16x16x32_bf16 v[196:199], a[52:55], a[148:151], v[196:199]
v_mfma_f32_16x16x32_bf16 v[200:203], a[52:55], a[152:155], v[200:203]
buffer_load_dwordx4 a[124:127], v61, s[16:19], s80 offen sc1
v_mfma_f32_16x16x32_bf16 v[204:207], a[52:55], a[156:159], v[204:207]
v_mfma_f32_16x16x32_bf16 v[208:211], a[56:59], a[136:139], v[208:211]
v_mfma_f32_16x16x32_bf16 v[212:215], a[56:59], a[140:143], v[212:215]
buffer_load_dwordx4 a[128:131], v62, s[16:19], s80 offen sc1
v_mfma_f32_16x16x32_bf16 v[216:219], a[56:59], a[144:147], v[216:219]
v_mfma_f32_16x16x32_bf16 v[220:223], a[56:59], a[148:151], v[220:223]
v_mfma_f32_16x16x32_bf16 v[224:227], a[56:59], a[152:155], v[224:227]
buffer_load_dwordx4 a[132:135], v63, s[16:19], s80 offen sc1
v_mfma_f32_16x16x32_bf16 v[228:231], a[56:59], a[156:159], v[228:231]
v_mfma_f32_16x16x32_bf16 v[232:235], a[60:63], a[136:139], v[232:235]
v_mfma_f32_16x16x32_bf16 v[236:239], a[60:63], a[140:143], v[236:239]
v_mfma_f32_16x16x32_bf16 v[240:243], a[60:63], a[144:147], v[240:243]
v_mfma_f32_16x16x32_bf16 v[244:247], a[60:63], a[148:151], v[244:247]
v_mfma_f32_16x16x32_bf16 v[248:251], a[60:63], a[152:155], v[248:251]
v_mfma_f32_16x16x32_bf16 v[252:255], a[60:63], a[156:159], v[252:255]
s_waitcnt vmcnt(20)
s_waitcnt lgkmcnt(14)
v_mfma_f32_16x16x32_bf16 v[64:67], a[0:3], a[64:67], v[64:67]
v_mfma_f32_16x16x32_bf16 v[68:71], a[0:3], a[68:71], v[68:71]
s_add_u32 s81, s74, 98304
s_add_u32 m0, s75, 24576
s_nop 0
buffer_load_dwordx4 v2, s[20:23], s81 offen offset:0 lds
v_mfma_f32_16x16x32_bf16 v[72:75], a[0:3], a[72:75], v[72:75]
ds_read_b64_tr_b16 a[32:33], v54 offset:8192
v_mfma_f32_16x16x32_bf16 v[76:79], a[0:3], a[76:79], v[76:79]
ds_read_b64_tr_b16 a[34:35], v54 offset:12288
v_mfma_f32_16x16x32_bf16 v[80:83], a[0:3], a[80:83], v[80:83]
buffer_load_dwordx4 v3, s[20:23], s81 offen offset:1024 lds
v_mfma_f32_16x16x32_bf16 v[84:87], a[0:3], a[84:87], v[84:87]
ds_read_b64_tr_b16 a[36:37], v54 offset:8200
s_waitcnt lgkmcnt(15)
v_mfma_f32_16x16x32_bf16 v[88:91], a[4:7], a[64:67], v[88:91]
ds_read_b64_tr_b16 a[38:39], v54 offset:12296
v_mfma_f32_16x16x32_bf16 v[92:95], a[4:7], a[68:71], v[92:95]
buffer_load_dwordx4 v6, s[20:23], s81 offen offset:2048 lds
v_mfma_f32_16x16x32_bf16 v[96:99], a[4:7], a[72:75], v[96:99]
ds_read_b64_tr_b16 a[40:41], v55 offset:8192
v_mfma_f32_16x16x32_bf16 v[100:103], a[4:7], a[76:79], v[100:103]
ds_read_b64_tr_b16 a[42:43], v55 offset:12288
v_mfma_f32_16x16x32_bf16 v[104:107], a[4:7], a[80:83], v[104:107]
buffer_load_dwordx4 v7, s[20:23], s81 offen offset:3072 lds
v_mfma_f32_16x16x32_bf16 v[108:111], a[4:7], a[84:87], v[108:111]
ds_read_b64_tr_b16 a[44:45], v55 offset:8200
s_waitcnt lgkmcnt(15)
v_mfma_f32_16x16x32_bf16 v[112:115], a[8:11], a[64:67], v[112:115]
ds_read_b64_tr_b16 a[46:47], v55 offset:12296
v_mfma_f32_16x16x32_bf16 v[116:119], a[8:11], a[68:71], v[116:119]
s_add_u32 s81, s74, 114688
s_add_u32 m0, s75, 28672
s_nop 0
buffer_load_dwordx4 v2, s[20:23], s81 offen offset:0 lds
v_mfma_f32_16x16x32_bf16 v[120:123], a[8:11], a[72:75], v[120:123]
ds_read_b64_tr_b16 a[48:49], v56 offset:8192
v_mfma_f32_16x16x32_bf16 v[124:127], a[8:11], a[76:79], v[124:127]
ds_read_b64_tr_b16 a[50:51], v56 offset:12288
v_mfma_f32_16x16x32_bf16 v[128:131], a[8:11], a[80:83], v[128:131]
buffer_load_dwordx4 v3, s[20:23], s81 offen offset:1024 lds
v_mfma_f32_16x16x32_bf16 v[132:135], a[8:11], a[84:87], v[132:135]
ds_read_b64_tr_b16 a[52:53], v56 offset:8200
v_mfma_f32_16x16x32_bf16 v[136:139], a[12:15], a[64:67], v[136:139]
ds_read_b64_tr_b16 a[54:55], v56 offset:12296
v_mfma_f32_16x16x32_bf16 v[140:143], a[12:15], a[68:71], v[140:143]
buffer_load_dwordx4 v6, s[20:23], s81 offen offset:2048 lds
v_mfma_f32_16x16x32_bf16 v[144:147], a[12:15], a[72:75], v[144:147]
ds_read_b64_tr_b16 a[56:57], v57 offset:8192
v_mfma_f32_16x16x32_bf16 v[148:151], a[12:15], a[76:79], v[148:151]
ds_read_b64_tr_b16 a[58:59], v57 offset:12288
v_mfma_f32_16x16x32_bf16 v[152:155], a[12:15], a[80:83], v[152:155]
buffer_load_dwordx4 v7, s[20:23], s81 offen offset:3072 lds
v_mfma_f32_16x16x32_bf16 v[156:159], a[12:15], a[84:87], v[156:159]
ds_read_b64_tr_b16 a[60:61], v57 offset:8200
s_waitcnt lgkmcnt(15)
v_mfma_f32_16x16x32_bf16 v[160:163], a[16:19], a[64:67], v[160:163]
ds_read_b64_tr_b16 a[62:63], v57 offset:12296
v_mfma_f32_16x16x32_bf16 v[164:167], a[16:19], a[68:71], v[164:167]
s_add_u32 s80, s78, 18432
buffer_load_dwordx4 a[136:139], v58, s[16:19], s80 offen sc1
v_mfma_f32_16x16x32_bf16 v[168:171], a[16:19], a[72:75], v[168:171]
v_mfma_f32_16x16x32_bf16 v[172:175], a[16:19], a[76:79], v[172:175]
v_mfma_f32_16x16x32_bf16 v[176:179], a[16:19], a[80:83], v[176:179]
buffer_load_dwordx4 a[140:143], v59, s[16:19], s80 offen sc1
v_mfma_f32_16x16x32_bf16 v[180:183], a[16:19], a[84:87], v[180:183]
v_mfma_f32_16x16x32_bf16 v[184:187], a[20:23], a[64:67], v[184:187]
v_mfma_f32_16x16x32_bf16 v[188:191], a[20:23], a[68:71], v[188:191]
buffer_load_dwordx4 a[144:147], v60, s[16:19], s80 offen sc1
v_mfma_f32_16x16x32_bf16 v[192:195], a[20:23], a[72:75], v[192:195]
v_mfma_f32_16x16x32_bf16 v[196:199], a[20:23], a[76:79], v[196:199]
v_mfma_f32_16x16x32_bf16 v[200:203], a[20:23], a[80:83], v[200:203]
buffer_load_dwordx4 a[148:151], v61, s[16:19], s80 offen sc1
v_mfma_f32_16x16x32_bf16 v[204:207], a[20:23], a[84:87], v[204:207]
v_mfma_f32_16x16x32_bf16 v[208:211], a[24:27], a[64:67], v[208:211]
v_mfma_f32_16x16x32_bf16 v[212:215], a[24:27], a[68:71], v[212:215]
buffer_load_dwordx4 a[152:155], v62, s[16:19], s80 offen sc1
v_mfma_f32_16x16x32_bf16 v[216:219], a[24:27], a[72:75], v[216:219]
v_mfma_f32_16x16x32_bf16 v[220:223], a[24:27], a[76:79], v[220:223]
v_mfma_f32_16x16x32_bf16 v[224:227], a[24:27], a[80:83], v[224:227]
buffer_load_dwordx4 a[156:159], v63, s[16:19], s80 offen sc1
v_mfma_f32_16x16x32_bf16 v[228:231], a[24:27], a[84:87], v[228:231]
v_mfma_f32_16x16x32_bf16 v[232:235], a[28:31], a[64:67], v[232:235]
v_mfma_f32_16x16x32_bf16 v[236:239], a[28:31], a[68:71], v[236:239]
v_mfma_f32_16x16x32_bf16 v[240:243], a[28:31], a[72:75], v[240:243]
s_add_u32 s74, s74, 262144
s_add_u32 s78, s78, 49152
v_mfma_f32_16x16x32_bf16 v[244:247], a[28:31], a[76:79], v[244:247]
v_mfma_f32_16x16x32_bf16 v[248:251], a[28:31], a[80:83], v[248:251]
v_mfma_f32_16x16x32_bf16 v[252:255], a[28:31], a[84:87], v[252:255]
s_sub_u32 s47, s47, 1
s_cmp_lg_u32 s47, 0
s_cbranch_scc1 L_k3b
s_waitcnt vmcnt(20)
s_waitcnt lgkmcnt(14)
v_mfma_f32_16x16x32_bf16 v[64:67], a[32:35], a[88:91], v[64:67]
v_mfma_f32_16x16x32_bf16 v[68:71], a[32:35], a[92:95], v[68:71]
v_mfma_f32_16x16x32_bf16 v[72:75], a[32:35], a[96:99], v[72:75]
ds_read_b64_tr_b16 a[0:1], v54 offset:16384
v_mfma_f32_16x16x32_bf16 v[76:79], a[32:35], a[100:103], v[76:79]
ds_read_b64_tr_b16 a[2:3], v54 offset:20480
v_mfma_f32_16x16x32_bf16 v[80:83], a[32:35], a[104:107], v[80:83]
v_mfma_f32_16x16x32_bf16 v[84:87], a[32:35], a[108:111], v[84:87]
ds_read_b64_tr_b16 a[4:5], v54 offset:16392
s_waitcnt lgkmcnt(15)
v_mfma_f32_16x16x32_bf16 v[88:91], a[36:39], a[88:91], v[88:91]
ds_read_b64_tr_b16 a[6:7], v54 offset:20488
v_mfma_f32_16x16x32_bf16 v[92:95], a[36:39], a[92:95], v[92:95]
v_mfma_f32_16x16x32_bf16 v[96:99], a[36:39], a[96:99], v[96:99]
ds_read_b64_tr_b16 a[8:9], v55 offset:16384
v_mfma_f32_16x16x32_bf16 v[100:103], a[36:39], a[100:103], v[100:103]
ds_read_b64_tr_b16 a[10:11], v55 offset:20480
v_mfma_f32_16x16x32_bf16 v[104:107], a[36:39], a[104:107], v[104:107]
v_mfma_f32_16x16x32_bf16 v[108:111], a[36:39], a[108:111], v[108:111]
ds_read_b64_tr_b16 a[12:13], v55 offset:16392
s_waitcnt lgkmcnt(15)
v_mfma_f32_16x16x32_bf16 v[112:115], a[40:43], a[88:91], v[112:115]
ds_read_b64_tr_b16 a[14:15], v55 offset:20488
v_mfma_f32_16x16x32_bf16 v[116:119], a[40:43], a[92:95], v[116:119]
v_mfma_f32_16x16x32_bf16 v[120:123], a[40:43], a[96:99], v[120:123]
ds_read_b64_tr_b16 a[16:17], v56 offset:16384
v_mfma_f32_16x16x32_bf16 v[124:127], a[40:43], a[100:103], v[124:127]
ds_read_b64_tr_b16 a[18:19], v56 offset:20480
v_mfma_f32_16x16x32_bf16 v[128:131], a[40:43], a[104:107], v[128:131]
v_mfma_f32_16x16x32_bf16 v[132:135], a[40:43], a[108:111], v[132:135]
ds_read_b64_tr_b16 a[20:21], v56 offset:16392
v_mfma_f32_16x16x32_bf16 v[136:139], a[44:47], a[88:91], v[136:139]
ds_read_b64_tr_b16 a[22:23], v56 offset:20488
v_mfma_f32_16x16x32_bf16 v[140:143], a[44:47], a[92:95], v[140:143]
v_mfma_f32_16x16x32_bf16 v[144:147], a[44:47], a[96:99], v[144:147]
ds_read_b64_tr_b16 a[24:25], v57 offset:16384
v_mfma_f32_16x16x32_bf16 v[148:151], a[44:47], a[100:103], v[148:151]
ds_read_b64_tr_b16 a[26:27], v57 offset:20480
v_mfma_f32_16x16x32_bf16 v[152:155], a[44:47], a[104:107], v[152:155]
v_mfma_f32_16x16x32_bf16 v[156:159], a[44:47], a[108:111], v[156:159]
ds_read_b64_tr_b16 a[28:29], v57 offset:16392
s_waitcnt lgkmcnt(15)
v_mfma_f32_16x16x32_bf16 v[160:163], a[48:51], a[88:91], v[160:163]
ds_read_b64_tr_b16 a[30:31], v57 offset:20488
v_mfma_f32_16x16x32_bf16 v[164:167], a[48:51], a[92:95], v[164:167]
v_mfma_f32_16x16x32_bf16 v[168:171], a[48:51], a[96:99], v[168:171]
v_mfma_f32_16x16x32_bf16 v[172:175], a[48:51], a[100:103], v[172:175]
v_mfma_f32_16x16x32_bf16 v[176:179], a[48:51], a[104:107], v[176:179]
v_mfma_f32_16x16x32_bf16 v[180:183], a[48:51], a[108:111], v[180:183]
v_mfma_f32_16x16x32_bf16 v[184:187], a[52:55], a[88:91], v[184:187]
v_mfma_f32_16x16x32_bf16 v[188:191], a[52:55], a[92:95], v[188:191]
v_mfma_f32_16x16x32_bf16 v[192:195], a[52:55], a[96:99], v[192:195]
v_mfma_f32_16x16x32_bf16 v[196:199], a[52:55], a[100:103], v[196:199]
v_mfma_f32_16x16x32_bf16 v[200:203], a[52:55], a[104:107], v[200:203]
v_mfma_f32_16x16x32_bf16 v[204:207], a[52:55], a[108:111], v[204:207]
v_mfma_f32_16x16x32_bf16 v[208:211], a[56:59], a[88:91], v[208:211]
v_mfma_f32_16x16x32_bf16 v[212:215], a[56:59], a[92:95], v[212:215]
v_mfma_f32_16x16x32_bf16 v[216:219], a[56:59], a[96:99], v[216:219]
v_mfma_f32_16x16x32_bf16 v[220:223], a[56:59], a[100:103], v[220:223]
v_mfma_f32_16x16x32_bf16 v[224:227], a[56:59], a[104:107], v[224:227]
v_mfma_f32_16x16x32_bf16 v[228:231], a[56:59], a[108:111], v[228:231]
v_mfma_f32_16x16x32_bf16 v[232:235], a[60:63], a[88:91], v[232:235]
v_mfma_f32_16x16x32_bf16 v[236:239], a[60:63], a[92:95], v[236:239]
v_mfma_f32_16x16x32_bf16 v[240:243], a[60:63], a[96:99], v[240:243]
v_mfma_f32_16x16x32_bf16 v[244:247], a[60:63], a[100:103], v[244:247]
v_mfma_f32_16x16x32_bf16 v[248:251], a[60:63], a[104:107], v[248:251]
v_mfma_f32_16x16x32_bf16 v[252:255], a[60:63], a[108:111], v[252:255]
s_waitcnt vmcnt(6)
s_waitcnt lgkmcnt(14)
v_mfma_f32_16x16x32_bf16 v[64:67], a[0:3], a[112:115], v[64:67]
v_mfma_f32_16x16x32_bf16 v[68:71], a[0:3], a[116:119], v[68:71]
v_mfma_f32_16x16x32_bf16 v[72:75], a[0:3], a[120:123], v[72:75]
ds_read_b64_tr_b16 a[32:33], v54 offset:24576
v_mfma_f32_16x16x32_bf16 v[76:79], a[0:3], a[124:127], v[76:79]
ds_read_b64_tr_b16 a[34:35], v54 offset:28672
v_mfma_f32_16x16x32_bf16 v[80:83], a[0:3], a[128:131], v[80:83]
v_mfma_f32_16x16x32_bf16 v[84:87], a[0:3], a[132:135], v[84:87]
ds_read_b64_tr_b16 a[36:37], v54 offset:24584
s_waitcnt lgkmcnt(15)
v_mfma_f32_16x16x32_bf16 v[88:91], a[4:7], a[112:115], v[88:91]
ds_read_b64_tr_b16 a[38:39], v54 offset:28680
v_mfma_f32_16x16x32_bf16 v[92:95], a[4:7], a[116:119], v[92:95]
v_mfma_f32_16x16x32_bf16 v[96:99], a[4:7], a[120:123], v[96:99]
ds_read_b64_tr_b16 a[40:41], v55 offset:24576
v_mfma_f32_16x16x32_bf16 v[100:103], a[4:7], a[124:127], v[100:103]
ds_read_b64_tr_b16 a[42:43], v55 offset:28672
v_mfma_f32_16x16x32_bf16 v[104:107], a[4:7], a[128:131], v[104:107]
v_mfma_f32_16x16x32_bf16 v[108:111], a[4:7], a[132:135], v[108:111]
ds_read_b64_tr_b16 a[44:45], v55 offset:24584
s_waitcnt lgkmcnt(15)
v_mfma_f32_16x16x32_bf16 v[112:115], a[8:11], a[112:115], v[112:115]
ds_read_b64_tr_b16 a[46:47], v55 offset:28680
v_mfma_f32_16x16x32_bf16 v[116:119], a[8:11], a[116:119], v[116:119]
v_mfma_f32_16x16x32_bf16 v[120:123], a[8:11], a[120:123], v[120:123]
ds_read_b64_tr_b16 a[48:49], v56 offset:24576
v_mfma_f32_16x16x32_bf16 v[124:127], a[8:11], a[124:127], v[124:127]
ds_read_b64_tr_b16 a[50:51], v56 offset:28672
v_mfma_f32_16x16x32_bf16 v[128:131], a[8:11], a[128:131], v[128:131]
v_mfma_f32_16x16x32_bf16 v[132:135], a[8:11], a[132:135], v[132:135]
ds_read_b64_tr_b16 a[52:53], v56 offset:24584
v_mfma_f32_16x16x32_bf16 v[136:139], a[12:15], a[112:115], v[136:139]
ds_read_b64_tr_b16 a[54:55], v56 offset:28680
v_mfma_f32_16x16x32_bf16 v[140:143], a[12:15], a[116:119], v[140:143]
v_mfma_f32_16x16x32_bf16 v[144:147], a[12:15], a[120:123], v[144:147]
ds_read_b64_tr_b16 a[56:57], v57 offset:24576
v_mfma_f32_16x16x32_bf16 v[148:151], a[12:15], a[124:127], v[148:151]
ds_read_b64_tr_b16 a[58:59], v57 offset:28672
v_mfma_f32_16x16x32_bf16 v[152:155], a[12:15], a[128:131], v[152:155]
v_mfma_f32_16x16x32_bf16 v[156:159], a[12:15], a[132:135], v[156:159]
ds_read_b64_tr_b16 a[60:61], v57 offset:24584
s_waitcnt lgkmcnt(15)
v_mfma_f32_16x16x32_bf16 v[160:163], a[16:19], a[112:115], v[160:163]
ds_read_b64_tr_b16 a[62:63], v57 offset:28680
v_mfma_f32_16x16x32_bf16 v[164:167], a[16:19], a[116:119], v[164:167]
v_mfma_f32_16x16x32_bf16 v[168:171], a[16:19], a[120:123], v[168:171]
v_mfma_f32_16x16x32_bf16 v[172:175], a[16:19], a[124:127], v[172:175]
v_mfma_f32_16x16x32_bf16 v[176:179], a[16:19], a[128:131], v[176:179]
v_mfma_f32_16x16x32_bf16 v[180:183], a[16:19], a[132:135], v[180:183]
v_mfma_f32_16x16x32_bf16 v[184:187], a[20:23], a[112:115], v[184:187]
v_mfma_f32_16x16x32_bf16 v[188:191], a[20:23], a[116:119], v[188:191]
v_mfma_f32_16x16x32_bf16 v[192:195], a[20:23], a[120:123], v[192:195]
v_mfma_f32_16x16x32_bf16 v[196:199], a[20:23], a[124:127], v[196:199]
v_mfma_f32_16x16x32_bf16 v[200:203], a[20:23], a[128:131], v[200:203]
v_mfma_f32_16x16x32_bf16 v[204:207], a[20:23], a[132:135], v[204:207]
v_mfma_f32_16x16x32_bf16 v[208:211], a[24:27], a[112:115], v[208:211]
v_mfma_f32_16x16x32_bf16 v[212:215], a[24:27], a[116:119], v[212:215]
v_mfma_f32_16x16x32_bf16 v[216:219], a[24:27], a[120:123], v[216:219]
v_mfma_f32_16x16x32_bf16 v[220:223], a[24:27], a[124:127], v[220:223]
v_mfma_f32_16x16x32_bf16 v[224:227], a[24:27], a[128:131], v[224:227]
v_mfma_f32_16x16x32_bf16 v[228:231], a[24:27], a[132:135], v[228:231]
v_mfma_f32_16x16x32_bf16 v[232:235], a[28:31], a[112:115], v[232:235]
v_mfma_f32_16x16x32_bf16 v[236:239], a[28:31], a[116:119], v[236:239]
v_mfma_f32_16x16x32_bf16 v[240:243], a[28:31], a[120:123], v[240:243]
v_mfma_f32_16x16x32_bf16 v[244:247], a[28:31], a[124:127], v[244:247]
v_mfma_f32_16x16x32_bf16 v[248:251], a[28:31], a[128:131], v[248:251]
v_mfma_f32_16x16x32_bf16 v[252:255], a[28:31], a[132:135], v[252:255]
s_add_u32 s88, s28, 1
s_and_b32 s88, s88, 3
s_mul_i32 s88, s88, 36864
s_add_u32 s88, s88, 0
v_add_u32 v7, s88, v4
s_add_u32 s88, s28, 2
s_and_b32 s88, s88, 3
s_mul_i32 s88, s88, 36864
s_add_u32 s88, s88, 12288
v_add_u32 v2, s88, v4
s_add_u32 s88, s28, 3
s_and_b32 s88, s88, 3
s_mul_i32 s88, s88, 36864
s_add_u32 s88, s88, 24576
v_add_u32 v3, s88, v4
s_waitcnt lgkmcnt(0)
s_barrier
s_waitcnt vmcnt(5)
v_mfma_f32_16x16x32_bf16 v[112:115], a[40:43], a[136:139], v[112:115]
s_waitcnt vmcnt(4)
v_mfma_f32_16x16x32_bf16 v[116:119], a[40:43], a[140:143], v[116:119]
s_waitcnt vmcnt(3)
v_mfma_f32_16x16x32_bf16 v[120:123], a[40:43], a[144:147], v[120:123]
s_waitcnt vmcnt(2)
v_mfma_f32_16x16x32_bf16 v[124:127], a[40:43], a[148:151], v[124:127]
s_waitcnt vmcnt(1)
v_mfma_f32_16x16x32_bf16 v[128:131], a[40:43], a[152:155], v[128:131]
s_waitcnt vmcnt(0)
v_mfma_f32_16x16x32_bf16 v[132:135], a[40:43], a[156:159], v[132:135]
v_mfma_f32_16x16x32_bf16 v[136:139], a[44:47], a[136:139], v[136:139]
v_mfma_f32_16x16x32_bf16 v[140:143], a[44:47], a[140:143], v[140:143]
ds_write_b128 v7, v[112:115] offset:0
v_mfma_f32_16x16x32_bf16 v[144:147], a[44:47], a[144:147], v[144:147]
v_mfma_f32_16x16x32_bf16 v[148:151], a[44:47], a[148:151], v[148:151]
ds_write_b128 v7, v[116:119] offset:1024
v_mfma_f32_16x16x32_bf16 v[152:155], a[44:47], a[152:155], v[152:155]
v_mfma_f32_16x16x32_bf16 v[156:159], a[44:47], a[156:159], v[156:159]
ds_write_b128 v7, v[120:123] offset:2048
v_mfma_f32_16x16x32_bf16 v[160:163], a[48:51], a[136:139], v[160:163]
v_mfma_f32_16x16x32_bf16 v[164:167], a[48:51], a[140:143], v[164:167]
ds_write_b128 v7, v[124:127] offset:3072
v_mfma_f32_16x16x32_bf16 v[168:171], a[48:51], a[144:147], v[168:171]
v_mfma_f32_16x16x32_bf16 v[172:175], a[48:51], a[148:151], v[172:175]
ds_write_b128 v7, v[128:131] offset:4096
v_mfma_f32_16x16x32_bf16 v[176:179], a[48:51], a[152:155], v[176:179]
v_mfma_f32_16x16x32_bf16 v[180:183], a[48:51], a[156:159], v[180:183]
ds_write_b128 v7, v[132:135] offset:5120
v_mfma_f32_16x16x32_bf16 v[184:187], a[52:55], a[136:139], v[184:187]
v_mfma_f32_16x16x32_bf16 v[188:191], a[52:55], a[140:143], v[188:191]
ds_write_b128 v7, v[136:139] offset:6144
v_mfma_f32_16x16x32_bf16 v[192:195], a[52:55], a[144:147], v[192:195]
v_mfma_f32_16x16x32_bf16 v[196:199], a[52:55], a[148:151], v[196:199]
ds_write_b128 v7, v[140:143] offset:7168
v_mfma_f32_16x16x32_bf16 v[200:203], a[52:55], a[152:155], v[200:203]
v_mfma_f32_16x16x32_bf16 v[204:207], a[52:55], a[156:159], v[204:207]
ds_write_b128 v7, v[144:147] offset:8192
v_mfma_f32_16x16x32_bf16 v[208:211], a[56:59], a[136:139], v[208:211]
v_mfma_f32_16x16x32_bf16 v[212:215], a[56:59], a[140:143], v[212:215]
ds_write_b128 v7, v[148:151] offset:9216
v_mfma_f32_16x16x32_bf16 v[216:219], a[56:59], a[144:147], v[216:219]
v_mfma_f32_16x16x32_bf16 v[220:223], a[56:59], a[148:151], v[220:223]
ds_write_b128 v7, v[152:155] offset:10240
v_mfma_f32_16x16x32_bf16 v[224:227], a[56:59], a[152:155], v[224:227]
v_mfma_f32_16x16x32_bf16 v[228:231], a[56:59], a[156:159], v[228:231]
ds_write_b128 v7, v[156:159] offset:11264
v_mfma_f32_16x16x32_bf16 v[232:235], a[60:63], a[136:139], v[232:235]
v_mfma_f32_16x16x32_bf16 v[236:239], a[60:63], a[140:143], v[236:239]
ds_write_b128 v2, v[160:163] offset:0
v_mfma_f32_16x16x32_bf16 v[240:243], a[60:63], a[144:147], v[240:243]
v_mfma_f32_16x16x32_bf16 v[244:247], a[60:63], a[148:151], v[244:247]
ds_write_b128 v2, v[164:167] offset:1024
v_mfma_f32_16x16x32_bf16 v[248:251], a[60:63], a[152:155], v[248:251]
v_mfma_f32_16x16x32_bf16 v[252:255], a[60:63], a[156:159], v[252:255]
ds_write_b128 v2, v[168:171] offset:2048
v_mfma_f32_16x16x32_bf16 v[64:67], a[32:35], a[136:139], v[64:67]
v_mfma_f32_16x16x32_bf16 v[68:71], a[32:35], a[140:143], v[68:71]
ds_write_b128 v2, v[172:175] offset:3072
v_mfma_f32_16x16x32_bf16 v[72:75], a[32:35], a[144:147], v[72:75]
v_mfma_f32_16x16x32_bf16 v[76:79], a[32:35], a[148:151], v[76:79]
ds_write_b128 v2, v[176:179] offset:4096
v_mfma_f32_16x16x32_bf16 v[80:83], a[32:35], a[152:155], v[80:83]
v_mfma_f32_16x16x32_bf16 v[84:87], a[32:35], a[156:159], v[84:87]
ds_write_b128 v2, v[180:183] offset:5120
v_mfma_f32_16x16x32_bf16 v[88:91], a[36:39], a[136:139], v[88:91]
v_mfma_f32_16x16x32_bf16 v[92:95], a[36:39], a[140:143], v[92:95]
ds_write_b128 v2, v[184:187] offset:6144
v_mfma_f32_16x16x32_bf16 v[96:99], a[36:39], a[144:147], v[96:99]
v_mfma_f32_16x16x32_bf16 v[100:103], a[36:39], a[148:151], v[100:103]
ds_write_b128 v2, v[188:191] offset:7168
v_mfma_f32_16x16x32_bf16 v[104:107], a[36:39], a[152:155], v[104:107]
v_mfma_f32_16x16x32_bf16 v[108:111], a[36:39], a[156:159], v[108:111]
ds_write_b128 v2, v[192:195] offset:8192
ds_write_b128 v2, v[196:199] offset:9216
ds_write_b128 v2, v[200:203] offset:10240
ds_write_b128 v2, v[204:207] offset:11264
ds_write_b128 v3, v[208:211] offset:0
ds_write_b128 v3, v[212:215] offset:1024
ds_write_b128 v3, v[216:219] offset:2048
ds_write_b128 v3, v[220:223] offset:3072
ds_write_b128 v3, v[224:227] offset:4096
ds_write_b128 v3, v[228:231] offset:5120
ds_write_b128 v3, v[232:235] offset:6144
ds_write_b128 v3, v[236:239] offset:7168
ds_write_b128 v3, v[240:243] offset:8192
ds_write_b128 v3, v[244:247] offset:9216
ds_write_b128 v3, v[248:251] offset:10240
ds_write_b128 v3, v[252:255] offset:11264
s_mul_i32 s88, s28, 36864
v_add_u32 v8, s88, v4
s_waitcnt lgkmcnt(0)
s_barrier
ds_read_b128 v[112:115], v8 offset:0
ds_read_b128 v[116:119], v8 offset:1024
ds_read_b128 v[120:123], v8 offset:2048
ds_read_b128 v[124:127], v8 offset:3072
ds_read_b128 v[128:131], v8 offset:4096
ds_read_b128 v[132:135], v8 offset:5120
ds_read_b128 v[136:139], v8 offset:6144
ds_read_b128 v[140:143], v8 offset:7168
ds_read_b128 v[144:147], v8 offset:8192
ds_read_b128 v[148:151], v8 offset:9216
ds_read_b128 v[152:155], v8 offset:10240
ds_read_b128 v[156:159], v8 offset:11264
ds_read_b128 v[160:163], v8 offset:12288
ds_read_b128 v[164:167], v8 offset:13312
ds_read_b128 v[168:171], v8 offset:14336
ds_read_b128 v[172:175], v8 offset:15360
ds_read_b128 v[176:179], v8 offset:16384
ds_read_b128 v[180:183], v8 offset:17408
ds_read_b128 v[184:187], v8 offset:18432
ds_read_b128 v[188:191], v8 offset:19456
ds_read_b128 v[192:195], v8 offset:20480
ds_read_b128 v[196:199], v8 offset:21504
ds_read_b128 v[200:203], v8 offset:22528
ds_read_b128 v[204:207], v8 offset:23552
ds_read_b128 v[208:211], v8 offset:24576
ds_read_b128 v[212:215], v8 offset:25600
ds_read_b128 v[216:219], v8 offset:26624
ds_read_b128 v[220:223], v8 offset:27648
ds_read_b128 v[224:227], v8 offset:28672
ds_read_b128 v[228:231], v8 offset:29696
ds_read_b128 v[232:235], v8 offset:30720
ds_read_b128 v[236:239], v8 offset:31744
ds_read_b128 v[240:243], v8 offset:32768
ds_read_b128 v[244:247], v8 offset:33792
ds_read_b128 v[248:251], v8 offset:34816
ds_read_b128 v[252:255], v8 offset:35840
v_and_b32 v12, 15, v0
v_lshrrev_b32 v13, 4, v0
v_lshlrev_b32 v12, 11, v12
v_lshl_add_u32 v9, v13, 4, v12
s_waitcnt lgkmcnt(15)
v_pk_add_f32 v[64:65], v[64:65], v[112:113]
v_pk_add_f32 v[66:67], v[66:67], v[114:115]
v_pk_add_f32 v[64:65], v[64:65], v[160:161]
v_pk_add_f32 v[66:67], v[66:67], v[162:163]
s_waitcnt lgkmcnt(11)
v_pk_add_f32 v[64:65], v[64:65], v[208:209]
v_pk_add_f32 v[66:67], v[66:67], v[210:211]
v_pk_add_f32 v[88:89], v[88:89], v[136:137]
v_pk_add_f32 v[90:91], v[90:91], v[138:139]
v_pk_add_f32 v[88:89], v[88:89], v[184:185]
v_pk_add_f32 v[90:91], v[90:91], v[186:187]
s_waitcnt lgkmcnt(5)
v_pk_add_f32 v[88:89], v[88:89], v[232:233]
v_pk_add_f32 v[90:91], v[90:91], v[234:235]
v_cvt_pk_bf16_f32 v16, v64, v65
v_cvt_pk_bf16_f32 v17, v66, v67
v_cvt_pk_bf16_f32 v18, v88, v89
v_cvt_pk_bf16_f32 v19, v90, v91
s_add_u32 s88, s85, 0
s_cmp_ge_u32 s88, 6
s_cselect_b32 s89, 6, 0
s_sub_u32 s88, s88, s89
s_lshl_b32 s88, s88, 15
s_add_u32 s80, s79, s88
buffer_store_dwordx4 v[16:19], v9, s[4:7], s80 offen sc1
v_pk_add_f32 v[68:69], v[68:69], v[116:117]
v_pk_add_f32 v[70:71], v[70:71], v[118:119]
v_pk_add_f32 v[68:69], v[68:69], v[164:165]
v_pk_add_f32 v[70:71], v[70:71], v[166:167]
v_pk_add_f32 v[68:69], v[68:69], v[212:213]
v_pk_add_f32 v[70:71], v[70:71], v[214:215]
v_pk_add_f32 v[92:93], v[92:93], v[140:141]
v_pk_add_f32 v[94:95], v[94:95], v[142:143]
v_pk_add_f32 v[92:93], v[92:93], v[188:189]
v_pk_add_f32 v[94:95], v[94:95], v[190:191]
s_waitcnt lgkmcnt(4)
v_pk_add_f32 v[92:93], v[92:93], v[236:237]
v_pk_add_f32 v[94:95], v[94:95], v[238:239]
v_cvt_pk_bf16_f32 v20, v68, v69
v_cvt_pk_bf16_f32 v21, v70, v71
v_cvt_pk_bf16_f32 v22, v92, v93
v_cvt_pk_bf16_f32 v23, v94, v95
s_add_u32 s88, s85, 1
s_cmp_ge_u32 s88, 6
s_cselect_b32 s89, 6, 0
s_sub_u32 s88, s88, s89
s_lshl_b32 s88, s88, 15
s_add_u32 s80, s79, s88
buffer_store_dwordx4 v[20:23], v9, s[4:7], s80 offen sc1
v_pk_add_f32 v[72:73], v[72:73], v[120:121]
v_pk_add_f32 v[74:75], v[74:75], v[122:123]
v_pk_add_f32 v[72:73], v[72:73], v[168:169]
v_pk_add_f32 v[74:75], v[74:75], v[170:171]
v_pk_add_f32 v[72:73], v[72:73], v[216:217]
v_pk_add_f32 v[74:75], v[74:75], v[218:219]
v_pk_add_f32 v[96:97], v[96:97], v[144:145]
v_pk_add_f32 v[98:99], v[98:99], v[146:147]
v_pk_add_f32 v[96:97], v[96:97], v[192:193]
v_pk_add_f32 v[98:99], v[98:99], v[194:195]
s_waitcnt lgkmcnt(3)
v_pk_add_f32 v[96:97], v[96:97], v[240:241]
v_pk_add_f32 v[98:99], v[98:99], v[242:243]
v_cvt_pk_bf16_f32 v24, v72, v73
v_cvt_pk_bf16_f32 v25, v74, v75
v_cvt_pk_bf16_f32 v26, v96, v97
v_cvt_pk_bf16_f32 v27, v98, v99
s_add_u32 s88, s85, 2
s_cmp_ge_u32 s88, 6
s_cselect_b32 s89, 6, 0
s_sub_u32 s88, s88, s89
s_lshl_b32 s88, s88, 15
s_add_u32 s80, s79, s88
buffer_store_dwordx4 v[24:27], v9, s[4:7], s80 offen sc1
v_pk_add_f32 v[76:77], v[76:77], v[124:125]
v_pk_add_f32 v[78:79], v[78:79], v[126:127]
v_pk_add_f32 v[76:77], v[76:77], v[172:173]
v_pk_add_f32 v[78:79], v[78:79], v[174:175]
v_pk_add_f32 v[76:77], v[76:77], v[220:221]
v_pk_add_f32 v[78:79], v[78:79], v[222:223]
v_pk_add_f32 v[100:101], v[100:101], v[148:149]
v_pk_add_f32 v[102:103], v[102:103], v[150:151]
v_pk_add_f32 v[100:101], v[100:101], v[196:197]
v_pk_add_f32 v[102:103], v[102:103], v[198:199]
s_waitcnt lgkmcnt(2)
v_pk_add_f32 v[100:101], v[100:101], v[244:245]
v_pk_add_f32 v[102:103], v[102:103], v[246:247]
v_cvt_pk_bf16_f32 v28, v76, v77
v_cvt_pk_bf16_f32 v29, v78, v79
v_cvt_pk_bf16_f32 v30, v100, v101
v_cvt_pk_bf16_f32 v31, v102, v103
s_add_u32 s88, s85, 3
s_cmp_ge_u32 s88, 6
s_cselect_b32 s89, 6, 0
s_sub_u32 s88, s88, s89
s_lshl_b32 s88, s88, 15
s_add_u32 s80, s79, s88
buffer_store_dwordx4 v[28:31], v9, s[4:7], s80 offen sc1
v_pk_add_f32 v[80:81], v[80:81], v[128:129]
v_pk_add_f32 v[82:83], v[82:83], v[130:131]
v_pk_add_f32 v[80:81], v[80:81], v[176:177]
v_pk_add_f32 v[82:83], v[82:83], v[178:179]
v_pk_add_f32 v[80:81], v[80:81], v[224:225]
v_pk_add_f32 v[82:83], v[82:83], v[226:227]
v_pk_add_f32 v[104:105], v[104:105], v[152:153]
v_pk_add_f32 v[106:107], v[106:107], v[154:155]
v_pk_add_f32 v[104:105], v[104:105], v[200:201]
v_pk_add_f32 v[106:107], v[106:107], v[202:203]
s_waitcnt lgkmcnt(1)
v_pk_add_f32 v[104:105], v[104:105], v[248:249]
v_pk_add_f32 v[106:107], v[106:107], v[250:251]
v_cvt_pk_bf16_f32 v16, v80, v81
v_cvt_pk_bf16_f32 v17, v82, v83
v_cvt_pk_bf16_f32 v18, v104, v105
v_cvt_pk_bf16_f32 v19, v106, v107
s_add_u32 s88, s85, 4
s_cmp_ge_u32 s88, 6
s_cselect_b32 s89, 6, 0
s_sub_u32 s88, s88, s89
s_lshl_b32 s88, s88, 15
s_add_u32 s80, s79, s88
buffer_store_dwordx4 v[16:19], v9, s[4:7], s80 offen sc1
v_pk_add_f32 v[84:85], v[84:85], v[132:133]
v_pk_add_f32 v[86:87], v[86:87], v[134:135]
v_pk_add_f32 v[84:85], v[84:85], v[180:181]
v_pk_add_f32 v[86:87], v[86:87], v[182:183]
v_pk_add_f32 v[84:85], v[84:85], v[228:229]
v_pk_add_f32 v[86:87], v[86:87], v[230:231]
v_pk_add_f32 v[108:109], v[108:109], v[156:157]
v_pk_add_f32 v[110:111], v[110:111], v[158:159]
v_pk_add_f32 v[108:109], v[108:109], v[204:205]
v_pk_add_f32 v[110:111], v[110:111], v[206:207]
s_waitcnt lgkmcnt(0)
v_pk_add_f32 v[108:109], v[108:109], v[252:253]
v_pk_add_f32 v[110:111], v[110:111], v[254:255]
v_cvt_pk_bf16_f32 v20, v84, v85
v_cvt_pk_bf16_f32 v21, v86, v87
v_cvt_pk_bf16_f32 v22, v108, v109
v_cvt_pk_bf16_f32 v23, v110, v111
s_add_u32 s88, s85, 5
s_cmp_ge_u32 s88, 6
s_cselect_b32 s89, 6, 0
s_sub_u32 s88, s88, s89
s_lshl_b32 s88, s88, 15
s_add_u32 s80, s79, s88
buffer_store_dwordx4 v[20:23], v9, s[4:7], s80 offen sc1
s_waitcnt vmcnt(0)
s_waitcnt vmcnt(0)
K2_END:
s_endpgm
L_FB:
s_waitcnt vmcnt(0) lgkmcnt(0)
s_barrier
s_mov_b32 s14, 67108864
v_mov_b32 v32, 0xff800000
v_mov_b32 v33, 0xff800000
v_mov_b32 v34, 0xff800000
v_mov_b32 v35, 0xff800000
v_mov_b32 v36, 0xff800000
v_mov_b32 v37, 0xff800000
s_lshl_b32 s84, s46, 17
s_mov_b32 s47, 16
L_FB1:
s_mov_b32 s83, s84
s_add_u32 s74, s34, s84
s_add_u32 s84, s84, 8192
s_add_u32 m0, s35, 0
s_nop 0
buffer_load_dwordx4 v50, s[12:15], s74 offen offset:0 nt lds
buffer_load_dwordx4 v51, s[12:15], s74 offen offset:1024 nt lds
buffer_load_dwordx4 v52, s[12:15], s74 offen offset:2048 nt lds
buffer_load_dwordx4 v53, s[12:15], s74 offen offset:3072 nt lds
s_add_u32 s41, s74, 4096
s_add_u32 m0, s35, 4096
s_nop 0
buffer_load_dwordx4 v50, s[12:15], s41 offen offset:0 nt lds
buffer_load_dwordx4 v51, s[12:15], s41 offen offset:1024 nt lds
buffer_load_dwordx4 v52, s[12:15], s41 offen offset:2048 nt lds
buffer_load_dwordx4 v53, s[12:15], s41 offen offset:3072 nt lds
s_waitcnt vmcnt(0)
s_barrier
ds_read_b128 a[96:99], v38 offset:0
ds_read_b128 a[100:103], v39 offset:0
ds_read_b128 a[104:107], v40 offset:0
ds_read_b128 a[108:111], v41 offset:0
ds_read_b128 a[112:115], v38 offset:4096
ds_read_b128 a[116:119], v39 offset:4096
ds_read_b128 a[120:123], v40 offset:4096
ds_read_b128 a[124:127], v41 offset:4096
s_waitcnt lgkmcnt(7)
v_mfma_f32_16x16x32_bf16 v[8:11], a[96:99], a[0:3], 0
s_waitcnt lgkmcnt(6)
v_mfma_f32_16x16x32_bf16 v[8:11], a[100:103], a[4:7], v[8:11]
s_waitcnt lgkmcnt(5)
v_mfma_f32_16x16x32_bf16 v[8:11], a[104:107], a[8:11], v[8:11]
s_waitcnt lgkmcnt(4)
v_mfma_f32_16x16x32_bf16 v[8:11], a[108:111], a[12:15], v[8:11]
s_waitcnt lgkmcnt(3)
v_mfma_f32_16x16x32_bf16 v[12:15], a[112:115], a[0:3], 0
s_waitcnt lgkmcnt(2)
v_mfma_f32_16x16x32_bf16 v[12:15], a[116:119], a[4:7], v[12:15]
s_waitcnt lgkmcnt(1)
v_mfma_f32_16x16x32_bf16 v[12:15], a[120:123], a[8:11], v[12:15]
s_waitcnt lgkmcnt(0)
v_mfma_f32_16x16x32_bf16 v[12:15], a[124:127], a[12:15], v[12:15]
v_max3_f32 v32, v8, v9, v32
v_max3_f32 v32, v10, v11, v32
s_nop 5
v_max3_f32 v32, v12, v13, v32
v_max3_f32 v32, v14, v15, v32
v_mfma_f32_16x16x32_bf16 v[8:11], a[96:99], a[16:19], 0
v_mfma_f32_16x16x32_bf16 v[8:11], a[100:103], a[20:23], v[8:11]
v_mfma_f32_16x16x32_bf16 v[8:11], a[104:107], a[24:27], v[8:11]
v_mfma_f32_16x16x32_bf16 v[8:11], a[108:111], a[28:31], v[8:11]
v_mfma_f32_16x16x32_bf16 v[12:15], a[112:115], a[16:19], 0
v_mfma_f32_16x16x32_bf16 v[12:15], a[116:119], a[20:23], v[12:15]
v_mfma_f32_16x16x32_bf16 v[12:15], a[120:123], a[24:27], v[12:15]
v_mfma_f32_16x16x32_bf16 v[12:15], a[124:127], a[28:31], v[12:15]
s_nop 3
v_max3_f32 v33, v8, v9, v33
v_max3_f32 v33, v10, v11, v33
s_nop 1
v_max3_f32 v33, v12, v13, v33
v_max3_f32 v33, v14, v15, v33
v_mfma_f32_16x16x32_bf16 v[8:11], a[96:99], a[32:35], 0
v_mfma_f32_16x16x32_bf16 v[8:11], a[100:103], a[36:39], v[8:11]
v_mfma_f32_16x16x32_bf16 v[8:11], a[104:107], a[40:43], v[8:11]
v_mfma_f32_16x16x32_bf16 v[8:11], a[108:111], a[44:47], v[8:11]
v_mfma_f32_16x16x32_bf16 v[12:15], a[112:115], a[32:35], 0
v_mfma_f32_16x16x32_bf16 v[12:15], a[116:119], a[36:39], v[12:15]
v_mfma_f32_16x16x32_bf16 v[12:15], a[120:123], a[40:43], v[12:15]
v_mfma_f32_16x16x32_bf16 v[12:15], a[124:127], a[44:47], v[12:15]
s_nop 3
v_max3_f32 v34, v8, v9, v34
v_max3_f32 v34, v10, v11, v34
s_nop 1
v_max3_f32 v34, v12, v13, v34
v_max3_f32 v34, v14, v15, v34
v_mfma_f32_16x16x32_bf16 v[8:11], a[96:99], a[48:51], 0
v_mfma_f32_16x16x32_bf16 v[8:11], a[100:103], a[52:55], v[8:11]
v_mfma_f32_16x16x32_bf16 v[8:11], a[104:107], a[56:59], v[8:11]
v_mfma_f32_16x16x32_bf16 v[8:11], a[108:111], a[60:63], v[8:11]
v_mfma_f32_16x16x32_bf16 v[12:15], a[112:115], a[48:51], 0
v_mfma_f32_16x16x32_bf16 v[12:15], a[116:119], a[52:55], v[12:15]
v_mfma_f32_16x16x32_bf16 v[12:15], a[120:123], a[56:59], v[12:15]
v_mfma_f32_16x16x32_bf16 v[12:15], a[124:127], a[60:63], v[12:15]
s_nop 3
v_max3_f32 v35, v8, v9, v35
v_max3_f32 v35, v10, v11, v35
s_nop 1
v_max3_f32 v35, v12, v13, v35
v_max3_f32 v35, v14, v15, v35
v_mfma_f32_16x16x32_bf16 v[8:11], a[96:99], a[64:67], 0
v_mfma_f32_16x16x32_bf16 v[8:11], a[100:103], a[68:71], v[8:11]
v_mfma_f32_16x16x32_bf16 v[8:11], a[104:107], a[72:75], v[8:11]
v_mfma_f32_16x16x32_bf16 v[8:11], a[108:111], a[76:79], v[8:11]
v_mfma_f32_16x16x32_bf16 v[12:15], a[112:115], a[64:67], 0
v_mfma_f32_16x16x32_bf16 v[12:15], a[116:119], a[68:71], v[12:15]
v_mfma_f32_16x16x32_bf16 v[12:15], a[120:123], a[72:75], v[12:15]
v_mfma_f32_16x16x32_bf16 v[12:15], a[124:127], a[76:79], v[12:15]
s_nop 3
v_max3_f32 v36, v8, v9, v36
v_max3_f32 v36, v10, v11, v36
s_nop 1
v_max3_f32 v36, v12, v13, v36
v_max3_f32 v36, v14, v15, v36
v_mfma_f32_16x16x32_bf16 v[8:11], a[96:99], a[80:83], 0
v_mfma_f32_16x16x32_bf16 v[8:11], a[100:103], a[84:87], v[8:11]
v_mfma_f32_16x16x32_bf16 v[8:11], a[104:107], a[88:91], v[8:11]
v_mfma_f32_16x16x32_bf16 v[8:11], a[108:111], a[92:95], v[8:11]
v_mfma_f32_16x16x32_bf16 v[12:15], a[112:115], a[80:83], 0
v_mfma_f32_16x16x32_bf16 v[12:15], a[116:119], a[84:87], v[12:15]
v_mfma_f32_16x16x32_bf16 v[12:15], a[120:123], a[88:91], v[12:15]
v_mfma_f32_16x16x32_bf16 v[12:15], a[124:127], a[92:95], v[12:15]
s_nop 3
v_max3_f32 v37, v8, v9, v37
v_max3_f32 v37, v10, v11, v37
s_nop 1
v_max3_f32 v37, v12, v13, v37
v_max3_f32 v37, v14, v15, v37
s_waitcnt lgkmcnt(0)
s_barrier
s_sub_u32 s47, s47, 1
s_cmp_lg_u32 s47, 0
s_cbranch_scc1 L_FB1
v_mov_b32 v16, v32
s_nop 1
v_permlane32_swap_b32 v16, v32
v_max_f32 v32, v32, v16
v_mov_b32 v16, v32
s_nop 1
v_permlane16_swap_b32 v16, v32
v_max_f32 v32, v32, v16
v_mov_b32 v16, v33
s_nop 1
v_permlane32_swap_b32 v16, v33
v_max_f32 v33, v33, v16
v_mov_b32 v16, v33
s_nop 1
v_permlane16_swap_b32 v16, v33
v_max_f32 v33, v33, v16
v_mov_b32 v16, v34
s_nop 1
v_permlane32_swap_b32 v16, v34
v_max_f32 v34, v34, v16
v_mov_b32 v16, v34
s_nop 1
v_permlane16_swap_b32 v16, v34
v_max_f32 v34, v34, v16
v_mov_b32 v16, v35
s_nop 1
v_permlane32_swap_b32 v16, v35
v_max_f32 v35, v35, v16
v_mov_b32 v16, v35
s_nop 1
v_permlane16_swap_b32 v16, v35
v_max_f32 v35, v35, v16
v_mov_b32 v16, v36
s_nop 1
v_permlane32_swap_b32 v16, v36
v_max_f32 v36, v36, v16
v_mov_b32 v16, v36
s_nop 1
v_permlane16_swap_b32 v16, v36
v_max_f32 v36, v36, v16
v_mov_b32 v16, v37
s_nop 1
v_permlane32_swap_b32 v16, v37
v_max_f32 v37, v37, v16
v_mov_b32 v16, v37
s_nop 1
v_permlane16_swap_b32 v16, v37
v_max_f32 v37, v37, v16
v_mov_b32 v64, 0
v_mov_b32 v65, 0
v_mov_b32 v66, 0
v_mov_b32 v67, 0
v_mov_b32 v68, 0
v_mov_b32 v69, 0
v_mov_b32 v70, 0
v_mov_b32 v71, 0
v_mov_b32 v72, 0
v_mov_b32 v73, 0
v_mov_b32 v74, 0
v_mov_b32 v75, 0
v_mov_b32 v76, 0
v_mov_b32 v77, 0
v_mov_b32 v78, 0
v_mov_b32 v79, 0
v_mov_b32 v80, 0
v_mov_b32 v81, 0
v_mov_b32 v82, 0
v_mov_b32 v83, 0
v_mov_b32 v84, 0
v_mov_b32 v85, 0
v_mov_b32 v86, 0
v_mov_b32 v87, 0
v_mov_b32 v88, 0
v_mov_b32 v89, 0
v_mov_b32 v90, 0
v_mov_b32 v91, 0
v_mov_b32 v92, 0
v_mov_b32 v93, 0
v_mov_b32 v94, 0
v_mov_b32 v95, 0
v_mov_b32 v96, 0
v_mov_b32 v97, 0
v_mov_b32 v98, 0
v_mov_b32 v99, 0
v_mov_b32 v100, 0
v_mov_b32 v101, 0
v_mov_b32 v102, 0
v_mov_b32 v103, 0
v_mov_b32 v104, 0
v_mov_b32 v105, 0
v_mov_b32 v106, 0
v_mov_b32 v107, 0
v_mov_b32 v108, 0
v_mov_b32 v109, 0
v_mov_b32 v110, 0
v_mov_b32 v111, 0
v_mov_b32 v112, 0
v_mov_b32 v113, 0
v_mov_b32 v114, 0
v_mov_b32 v115, 0
v_mov_b32 v116, 0
v_mov_b32 v117, 0
v_mov_b32 v118, 0
v_mov_b32 v119, 0
v_mov_b32 v120, 0
v_mov_b32 v121, 0
v_mov_b32 v122, 0
v_mov_b32 v123, 0
v_mov_b32 v124, 0
v_mov_b32 v125, 0
v_mov_b32 v126, 0
v_mov_b32 v127, 0
v_mov_b32 v128, 0
v_mov_b32 v129, 0
v_mov_b32 v130, 0
v_mov_b32 v131, 0
v_mov_b32 v132, 0
v_mov_b32 v133, 0
v_mov_b32 v134, 0
v_mov_b32 v135, 0
v_mov_b32 v136, 0
v_mov_b32 v137, 0
v_mov_b32 v138, 0
v_mov_b32 v139, 0
v_mov_b32 v140, 0
v_mov_b32 v141, 0
v_mov_b32 v142, 0
v_mov_b32 v143, 0
v_mov_b32 v144, 0
v_mov_b32 v145, 0
v_mov_b32 v146, 0
v_mov_b32 v147, 0
v_mov_b32 v148, 0
v_mov_b32 v149, 0
v_mov_b32 v150, 0
v_mov_b32 v151, 0
v_mov_b32 v152, 0
v_mov_b32 v153, 0
v_mov_b32 v154, 0
v_mov_b32 v155, 0
v_mov_b32 v156, 0
v_mov_b32 v157, 0
v_mov_b32 v158, 0
v_mov_b32 v159, 0
v_mov_b32 v160, 0
v_mov_b32 v161, 0
v_mov_b32 v162, 0
v_mov_b32 v163, 0
v_mov_b32 v164, 0
v_mov_b32 v165, 0
v_mov_b32 v166, 0
v_mov_b32 v167, 0
v_mov_b32 v168, 0
v_mov_b32 v169, 0
v_mov_b32 v170, 0
v_mov_b32 v171, 0
v_mov_b32 v172, 0
v_mov_b32 v173, 0
v_mov_b32 v174, 0
v_mov_b32 v175, 0
v_mov_b32 v176, 0
v_mov_b32 v177, 0
v_mov_b32 v178, 0
v_mov_b32 v179, 0
v_mov_b32 v180, 0
v_mov_b32 v181, 0
v_mov_b32 v182, 0
v_mov_b32 v183, 0
v_mov_b32 v184, 0
v_mov_b32 v185, 0
v_mov_b32 v186, 0
v_mov_b32 v187, 0
v_mov_b32 v188, 0
v_mov_b32 v189, 0
v_mov_b32 v190, 0
v_mov_b32 v191, 0
v_mov_b32 v192, 0
v_mov_b32 v193, 0
v_mov_b32 v194, 0
v_mov_b32 v195, 0
v_mov_b32 v196, 0
v_mov_b32 v197, 0
v_mov_b32 v198, 0
v_mov_b32 v199, 0
v_mov_b32 v200, 0
v_mov_b32 v201, 0
v_mov_b32 v202, 0
v_mov_b32 v203, 0
v_mov_b32 v204, 0
v_mov_b32 v205, 0
v_mov_b32 v206, 0
v_mov_b32 v207, 0
v_mov_b32 v208, 0
v_mov_b32 v209, 0
v_mov_b32 v210, 0
v_mov_b32 v211, 0
v_mov_b32 v212, 0
v_mov_b32 v213, 0
v_mov_b32 v214, 0
v_mov_b32 v215, 0
v_mov_b32 v216, 0
v_mov_b32 v217, 0
v_mov_b32 v218, 0
v_mov_b32 v219, 0
v_mov_b32 v220, 0
v_mov_b32 v221, 0
v_mov_b32 v222, 0
v_mov_b32 v223, 0
v_mov_b32 v224, 0
v_mov_b32 v225, 0
v_mov_b32 v226, 0
v_mov_b32 v227, 0
v_mov_b32 v228, 0
v_mov_b32 v229, 0
v_mov_b32 v230, 0
v_mov_b32 v231, 0
v_mov_b32 v232, 0
v_mov_b32 v233, 0
v_mov_b32 v234, 0
v_mov_b32 v235, 0
v_mov_b32 v236, 0
v_mov_b32 v237, 0
v_mov_b32 v238, 0
v_mov_b32 v239, 0
v_mov_b32 v240, 0
v_mov_b32 v241, 0
v_mov_b32 v242, 0
v_mov_b32 v243, 0
v_mov_b32 v244, 0
v_mov_b32 v245, 0
v_mov_b32 v246, 0
v_mov_b32 v247, 0
v_mov_b32 v248, 0
v_mov_b32 v249, 0
v_mov_b32 v250, 0
v_mov_b32 v251, 0
v_mov_b32 v252, 0
v_mov_b32 v253, 0
v_mov_b32 v254, 0
v_mov_b32 v255, 0
v_mov_b32 v16, 0
v_accvgpr_write_b32 a228, v16
v_accvgpr_write_b32 a229, v16
v_accvgpr_write_b32 a230, v16
v_accvgpr_write_b32 a231, v16
v_accvgpr_write_b32 a232, v16
v_accvgpr_write_b32 a233, v16
v_accvgpr_write_b32 a234, v16
v_accvgpr_write_b32 a235, v16
v_accvgpr_write_b32 a236, v16
v_accvgpr_write_b32 a237, v16
v_accvgpr_write_b32 a238, v16
v_accvgpr_write_b32 a239, v16
v_accvgpr_write_b32 a240, v16
v_accvgpr_write_b32 a241, v16
v_accvgpr_write_b32 a242, v16
v_accvgpr_write_b32 a243, v16
v_accvgpr_write_b32 a244, v16
v_accvgpr_write_b32 a245, v16
v_accvgpr_write_b32 a246, v16
v_accvgpr_write_b32 a247, v16
v_accvgpr_write_b32 a248, v16
v_accvgpr_write_b32 a249, v16
v_accvgpr_write_b32 a250, v16
v_accvgpr_write_b32 a251, v16
s_lshl_b32 s84, s46, 17
s_mov_b32 s47, 16
s_nop 7
L_FB2:
s_mov_b32 s83, s84
s_add_u32 s74, s34, s84
s_add_u32 s84, s84, 8192
s_add_u32 m0, s35, 0
s_nop 0
buffer_load_dwordx4 v50, s[12:15], s74 offen offset:0 nt lds
buffer_load_dwordx4 v51, s[12:15], s74 offen offset:1024 nt lds
buffer_load_dwordx4 v52, s[12:15], s74 offen offset:2048 nt lds
buffer_load_dwordx4 v53, s[12:15], s74 offen offset:3072 nt lds
s_add_u32 s41, s74, 4096
s_add_u32 m0, s35, 4096
s_nop 0
buffer_load_dwordx4 v50, s[12:15], s41 offen offset:0 nt lds
buffer_load_dwordx4 v51, s[12:15], s41 offen offset:1024 nt lds
buffer_load_dwordx4 v52, s[12:15], s41 offen offset:2048 nt lds
buffer_load_dwordx4 v53, s[12:15], s41 offen offset:3072 nt lds
s_waitcnt vmcnt(0)
s_barrier
ds_read_b128 a[96:99], v38 offset:0
ds_read_b128 a[100:103], v39 offset:0
ds_read_b128 a[104:107], v40 offset:0
ds_read_b128 a[108:111], v41 offset:0
ds_read_b128 a[112:115], v38 offset:4096
ds_read_b128 a[116:119], v39 offset:4096
ds_read_b128 a[120:123], v40 offset:4096
ds_read_b128 a[124:127], v41 offset:4096
ds_read_b64_tr_b16 a[160:161], v42 offset:0
ds_read_b64_tr_b16 a[162:163], v42 offset:4096
ds_read_b64_tr_b16 a[164:165], v43 offset:0
ds_read_b64_tr_b16 a[166:167], v43 offset:4096
ds_read_b64_tr_b16 a[168:169], v44 offset:0
ds_read_b64_tr_b16 a[170:171], v44 offset:4096
ds_read_b64_tr_b16 a[172:173], v45 offset:0
ds_read_b64_tr_b16 a[174:175], v45 offset:4096
ds_read_b64_tr_b16 a[176:177], v46 offset:0
ds_read_b64_tr_b16 a[178:179], v46 offset:4096
ds_read_b64_tr_b16 a[180:181], v47 offset:0
ds_read_b64_tr_b16 a[182:183], v47 offset:4096
ds_read_b64_tr_b16 a[184:185], v48 offset:0
ds_read_b64_tr_b16 a[186:187], v48 offset:4096
ds_read_b64_tr_b16 a[188:189], v49 offset:0
ds_read_b64_tr_b16 a[190:191], v49 offset:4096
s_waitcnt lgkmcnt(15)
v_mfma_f32_16x16x32_bf16 v[8:11], a[96:99], a[0:3], 0
v_mfma_f32_16x16x32_bf16 v[8:11], a[100:103], a[4:7], v[8:11]
v_mfma_f32_16x16x32_bf16 v[8:11], a[104:107], a[8:11], v[8:11]
v_mfma_f32_16x16x32_bf16 v[8:11], a[108:111], a[12:15], v[8:11]
v_mfma_f32_16x16x32_bf16 v[12:15], a[112:115], a[0:3], 0
v_mfma_f32_16x16x32_bf16 v[12:15], a[116:119], a[4:7], v[12:15]
v_mfma_f32_16x16x32_bf16 v[12:15], a[120:123], a[8:11], v[12:15]
v_mfma_f32_16x16x32_bf16 v[12:15], a[124:127], a[12:15], v[12:15]
s_nop 3
v_sub_f32 v8, v8, v32
v_sub_f32 v9, v9, v32
v_sub_f32 v10, v10, v32
v_sub_f32 v11, v11, v32
v_sub_f32 v12, v12, v32
v_sub_f32 v13, v13, v32
v_sub_f32 v14, v14, v32
v_sub_f32 v15, v15, v32
v_exp_f32 v8, v8
v_exp_f32 v9, v9
v_exp_f32 v10, v10
v_exp_f32 v11, v11
v_exp_f32 v12, v12
v_exp_f32 v13, v13
v_exp_f32 v14, v14
v_exp_f32 v15, v15
v_cvt_pk_bf16_f32 v24, v8, v9
v_cvt_pk_bf16_f32 v25, v10, v11
v_cvt_pk_bf16_f32 v26, v12, v13
v_cvt_pk_bf16_f32 v27, v14, v15
s_waitcnt lgkmcnt(14)
s_nop 0
v_mfma_f32_16x16x32_bf16 v[64:67], a[160:163], v[24:27], v[64:67]
s_waitcnt lgkmcnt(12)
v_mfma_f32_16x16x32_bf16 v[88:91], a[164:167], v[24:27], v[88:91]
s_waitcnt lgkmcnt(10)
v_mfma_f32_16x16x32_bf16 v[112:115], a[168:171], v[24:27], v[112:115]
s_waitcnt lgkmcnt(8)
v_mfma_f32_16x16x32_bf16 v[136:139], a[172:175], v[24:27], v[136:139]
s_waitcnt lgkmcnt(6)
v_mfma_f32_16x16x32_bf16 v[160:163], a[176:179], v[24:27], v[160:163]
s_waitcnt lgkmcnt(4)
v_mfma_f32_16x16x32_bf16 v[184:187], a[180:183], v[24:27], v[184:187]
s_waitcnt lgkmcnt(2)
v_mfma_f32_16x16x32_bf16 v[208:211], a[184:187], v[24:27], v[208:211]
s_waitcnt lgkmcnt(0)
v_mfma_f32_16x16x32_bf16 v[232:235], a[188:191], v[24:27], v[232:235]
v_mfma_f32_16x16x32_bf16 a[228:231], a[224:227], v[24:27], a[228:231]
v_mfma_f32_16x16x32_bf16 v[8:11], a[96:99], a[16:19], 0
v_mfma_f32_16x16x32_bf16 v[8:11], a[100:103], a[20:23], v[8:11]
v_mfma_f32_16x16x32_bf16 v[8:11], a[104:107], a[24:27], v[8:11]
v_mfma_f32_16x16x32_bf16 v[8:11], a[108:111], a[28:31], v[8:11]
v_mfma_f32_16x16x32_bf16 v[12:15], a[112:115], a[16:19], 0
v_mfma_f32_16x16x32_bf16 v[12:15], a[116:119], a[20:23], v[12:15]
v_mfma_f32_16x16x32_bf16 v[12:15], a[120:123], a[24:27], v[12:15]
v_mfma_f32_16x16x32_bf16 v[12:15], a[124:127], a[28:31], v[12:15]
s_nop 3
v_sub_f32 v8, v8, v33
v_sub_f32 v9, v9, v33
v_sub_f32 v10, v10, v33
v_sub_f32 v11, v11, v33
v_sub_f32 v12, v12, v33
v_sub_f32 v13, v13, v33
v_sub_f32 v14, v14, v33
v_sub_f32 v15, v15, v33
v_exp_f32 v8, v8
v_exp_f32 v9, v9
v_exp_f32 v10, v10
v_exp_f32 v11, v11
v_exp_f32 v12, v12
v_exp_f32 v13, v13
v_exp_f32 v14, v14
v_exp_f32 v15, v15
v_cvt_pk_bf16_f32 v24, v8, v9
v_cvt_pk_bf16_f32 v25, v10, v11
v_cvt_pk_bf16_f32 v26, v12, v13
v_cvt_pk_bf16_f32 v27, v14, v15
s_nop 1
v_mfma_f32_16x16x32_bf16 v[68:71], a[160:163], v[24:27], v[68:71]
v_mfma_f32_16x16x32_bf16 v[92:95], a[164:167], v[24:27], v[92:95]
v_mfma_f32_16x16x32_bf16 v[116:119], a[168:171], v[24:27], v[116:119]
v_mfma_f32_16x16x32_bf16 v[140:143], a[172:175], v[24:27], v[140:143]
v_mfma_f32_16x16x32_bf16 v[164:167], a[176:179], v[24:27], v[164:167]
v_mfma_f32_16x16x32_bf16 v[188:191], a[180:183], v[24:27], v[188:191]
v_mfma_f32_16x16x32_bf16 v[212:215], a[184:187], v[24:27], v[212:215]
v_mfma_f32_16x16x32_bf16 v[236:239], a[188:191], v[24:27], v[236:239]
v_mfma_f32_16x16x32_bf16 a[232:235], a[224:227], v[24:27], a[232:235]
v_mfma_f32_16x16x32_bf16 v[8:11], a[96:99], a[32:35], 0
v_mfma_f32_16x16x32_bf16 v[8:11], a[100:103], a[36:39], v[8:11]
v_mfma_f32_16x16x32_bf16 v[8:11], a[104:107], a[40:43], v[8:11]
v_mfma_f32_16x16x32_bf16 v[8:11], a[108:111], a[44:47], v[8:11]
v_mfma_f32_16x16x32_bf16 v[12:15], a[112:115], a[32:35], 0
v_mfma_f32_16x16x32_bf16 v[12:15], a[116:119], a[36:39], v[12:15]
v_mfma_f32_16x16x32_bf16 v[12:15], a[120:123], a[40:43], v[12:15]
v_mfma_f32_16x16x32_bf16 v[12:15], a[124:127], a[44:47], v[12:15]
s_nop 3
v_sub_f32 v8, v8, v34
v_sub_f32 v9, v9, v34
v_sub_f32 v10, v10, v34
v_sub_f32 v11, v11, v34
v_sub_f32 v12, v12, v34
v_sub_f32 v13, v13, v34
v_sub_f32 v14, v14, v34
v_sub_f32 v15, v15, v34
v_exp_f32 v8, v8
v_exp_f32 v9, v9
v_exp_f32 v10, v10
v_exp_f32 v11, v11
v_exp_f32 v12, v12
v_exp_f32 v13, v13
v_exp_f32 v14, v14
v_exp_f32 v15, v15
v_cvt_pk_bf16_f32 v24, v8, v9
v_cvt_pk_bf16_f32 v25, v10, v11
v_cvt_pk_bf16_f32 v26, v12, v13
v_cvt_pk_bf16_f32 v27, v14, v15
s_nop 1
v_mfma_f32_16x16x32_bf16 v[72:75], a[160:163], v[24:27], v[72:75]
v_mfma_f32_16x16x32_bf16 v[96:99], a[164:167], v[24:27], v[96:99]
v_mfma_f32_16x16x32_bf16 v[120:123], a[168:171], v[24:27], v[120:123]
v_mfma_f32_16x16x32_bf16 v[144:147], a[172:175], v[24:27], v[144:147]
v_mfma_f32_16x16x32_bf16 v[168:171], a[176:179], v[24:27], v[168:171]
v_mfma_f32_16x16x32_bf16 v[192:195], a[180:183], v[24:27], v[192:195]
v_mfma_f32_16x16x32_bf16 v[216:219], a[184:187], v[24:27], v[216:219]
v_mfma_f32_16x16x32_bf16 v[240:243], a[188:191], v[24:27], v[240:243]
v_mfma_f32_16x16x32_bf16 a[236:239], a[224:227], v[24:27], a[236:239]
v_mfma_f32_16x16x32_bf16 v[8:11], a[96:99], a[48:51], 0
v_mfma_f32_16x16x32_bf16 v[8:11], a[100:103], a[52:55], v[8:11]
v_mfma_f32_16x16x32_bf16 v[8:11], a[104:107], a[56:59], v[8:11]
v_mfma_f32_16x16x32_bf16 v[8:11], a[108:111], a[60:63], v[8:11]
v_mfma_f32_16x16x32_bf16 v[12:15], a[112:115], a[48:51], 0
v_mfma_f32_16x16x32_bf16 v[12:15], a[116:119], a[52:55], v[12:15]
v_mfma_f32_16x16x32_bf16 v[12:15], a[120:123], a[56:59], v[12:15]
v_mfma_f32_16x16x32_bf16 v[12:15], a[124:127], a[60:63], v[12:15]
s_nop 3
v_sub_f32 v8, v8, v35
v_sub_f32 v9, v9, v35
v_sub_f32 v10, v10, v35
v_sub_f32 v11, v11, v35
v_sub_f32 v12, v12, v35
v_sub_f32 v13, v13, v35
v_sub_f32 v14, v14, v35
v_sub_f32 v15, v15, v35
v_exp_f32 v8, v8
v_exp_f32 v9, v9
v_exp_f32 v10, v10
v_exp_f32 v11, v11
v_exp_f32 v12, v12
v_exp_f32 v13, v13
v_exp_f32 v14, v14
v_exp_f32 v15, v15
v_cvt_pk_bf16_f32 v24, v8, v9
v_cvt_pk_bf16_f32 v25, v10, v11
v_cvt_pk_bf16_f32 v26, v12, v13
v_cvt_pk_bf16_f32 v27, v14, v15
s_nop 1
v_mfma_f32_16x16x32_bf16 v[76:79], a[160:163], v[24:27], v[76:79]
v_mfma_f32_16x16x32_bf16 v[100:103], a[164:167], v[24:27], v[100:103]
v_mfma_f32_16x16x32_bf16 v[124:127], a[168:171], v[24:27], v[124:127]
v_mfma_f32_16x16x32_bf16 v[148:151], a[172:175], v[24:27], v[148:151]
v_mfma_f32_16x16x32_bf16 v[172:175], a[176:179], v[24:27], v[172:175]
v_mfma_f32_16x16x32_bf16 v[196:199], a[180:183], v[24:27], v[196:199]
v_mfma_f32_16x16x32_bf16 v[220:223], a[184:187], v[24:27], v[220:223]
v_mfma_f32_16x16x32_bf16 v[244:247], a[188:191], v[24:27], v[244:247]
v_mfma_f32_16x16x32_bf16 a[240:243], a[224:227], v[24:27], a[240:243]
v_mfma_f32_16x16x32_bf16 v[8:11], a[96:99], a[64:67], 0
v_mfma_f32_16x16x32_bf16 v[8:11], a[100:103], a[68:71], v[8:11]
v_mfma_f32_16x16x32_bf16 v[8:11], a[104:107], a[72:75], v[8:11]
v_mfma_f32_16x16x32_bf16 v[8:11], a[108:111], a[76:79], v[8:11]
v_mfma_f32_16x16x32_bf16 v[12:15], a[112:115], a[64:67], 0
v_mfma_f32_16x16x32_bf16 v[12:15], a[116:119], a[68:71], v[12:15]
v_mfma_f32_16x16x32_bf16 v[12:15], a[120:123], a[72:75], v[12:15]
v_mfma_f32_16x16x32_bf16 v[12:15], a[124:127], a[76:79], v[12:15]
s_nop 3
v_sub_f32 v8, v8, v36
v_sub_f32 v9, v9, v36
v_sub_f32 v10, v10, v36
v_sub_f32 v11, v11, v36
v_sub_f32 v12, v12, v36
v_sub_f32 v13, v13, v36
v_sub_f32 v14, v14, v36
v_sub_f32 v15, v15, v36
v_exp_f32 v8, v8
v_exp_f32 v9, v9
v_exp_f32 v10, v10
v_exp_f32 v11, v11
v_exp_f32 v12, v12
v_exp_f32 v13, v13
v_exp_f32 v14, v14
v_exp_f32 v15, v15
v_cvt_pk_bf16_f32 v24, v8, v9
v_cvt_pk_bf16_f32 v25, v10, v11
v_cvt_pk_bf16_f32 v26, v12, v13
v_cvt_pk_bf16_f32 v27, v14, v15
s_nop 1
v_mfma_f32_16x16x32_bf16 v[80:83], a[160:163], v[24:27], v[80:83]
v_mfma_f32_16x16x32_bf16 v[104:107], a[164:167], v[24:27], v[104:107]
v_mfma_f32_16x16x32_bf16 v[128:131], a[168:171], v[24:27], v[128:131]
v_mfma_f32_16x16x32_bf16 v[152:155], a[172:175], v[24:27], v[152:155]
v_mfma_f32_16x16x32_bf16 v[176:179], a[176:179], v[24:27], v[176:179]
v_mfma_f32_16x16x32_bf16 v[200:203], a[180:183], v[24:27], v[200:203]
v_mfma_f32_16x16x32_bf16 v[224:227], a[184:187], v[24:27], v[224:227]
v_mfma_f32_16x16x32_bf16 v[248:251], a[188:191], v[24:27], v[248:251]
v_mfma_f32_16x16x32_bf16 a[244:247], a[224:227], v[24:27], a[244:247]
v_mfma_f32_16x16x32_bf16 v[8:11], a[96:99], a[80:83], 0
v_mfma_f32_16x16x32_bf16 v[8:11], a[100:103], a[84:87], v[8:11]
v_mfma_f32_16x16x32_bf16 v[8:11], a[104:107], a[88:91], v[8:11]
v_mfma_f32_16x16x32_bf16 v[8:11], a[108:111], a[92:95], v[8:11]
v_mfma_f32_16x16x32_bf16 v[12:15], a[112:115], a[80:83], 0
v_mfma_f32_16x16x32_bf16 v[12:15], a[116:119], a[84:87], v[12:15]
v_mfma_f32_16x16x32_bf16 v[12:15], a[120:123], a[88:91], v[12:15]
v_mfma_f32_16x16x32_bf16 v[12:15], a[124:127], a[92:95], v[12:15]
s_nop 3
v_sub_f32 v8, v8, v37
v_sub_f32 v9, v9, v37
v_sub_f32 v10, v10, v37
v_sub_f32 v11, v11, v37
v_sub_f32 v12, v12, v37
v_sub_f32 v13, v13, v37
v_sub_f32 v14, v14, v37
v_sub_f32 v15, v15, v37
v_exp_f32 v8, v8
v_exp_f32 v9, v9
v_exp_f32 v10, v10
v_exp_f32 v11, v11
v_exp_f32 v12, v12
v_exp_f32 v13, v13
v_exp_f32 v14, v14
v_exp_f32 v15, v15
v_cvt_pk_bf16_f32 v24, v8, v9
v_cvt_pk_bf16_f32 v25, v10, v11
v_cvt_pk_bf16_f32 v26, v12, v13
v_cvt_pk_bf16_f32 v27, v14, v15
s_nop 1
v_mfma_f32_16x16x32_bf16 v[84:87], a[160:163], v[24:27], v[84:87]
v_mfma_f32_16x16x32_bf16 v[108:111], a[164:167], v[24:27], v[108:111]
v_mfma_f32_16x16x32_bf16 v[132:135], a[168:171], v[24:27], v[132:135]
v_mfma_f32_16x16x32_bf16 v[156:159], a[172:175], v[24:27], v[156:159]
v_mfma_f32_16x16x32_bf16 v[180:183], a[176:179], v[24:27], v[180:183]
v_mfma_f32_16x16x32_bf16 v[204:207], a[180:183], v[24:27], v[204:207]
v_mfma_f32_16x16x32_bf16 v[228:231], a[184:187], v[24:27], v[228:231]
v_mfma_f32_16x16x32_bf16 v[252:255], a[188:191], v[24:27], v[252:255]
v_mfma_f32_16x16x32_bf16 a[248:251], a[224:227], v[24:27], a[248:251]
s_waitcnt lgkmcnt(0)
s_nop 7
s_nop 7
s_barrier
s_sub_u32 s47, s47, 1
s_cmp_lg_u32 s47, 0
s_cbranch_scc1 L_FB2
s_nop 7
s_nop 7
s_cmp_eq_u32 s46, 0
s_cbranch_scc1 L_OE0
s_and_b32 s88, s33, 3
s_lshr_b32 s89, s33, 2
s_lshl_b32 s90, s31, 2
s_add_u32 s90, s90, s88
s_lshl_b32 s90, s90, 7
s_lshl_b32 s91, s28, 5
s_add_u32 s90, s90, s91
s_lshl_b32 s90, s90, 13
s_and_b32 s82, s32, 3
s_add_u32 s82, s82, s28
s_add_u32 s91, s82, 0
s_and_b32 s91, s91, 3
s_lshl_b32 s91, s91, 11
s_add_u32 s74, s90, s91
s_add_u32 s91, s82, 1
s_and_b32 s91, s91, 3
s_lshl_b32 s91, s91, 11
s_add_u32 s75, s90, s91
s_add_u32 s91, s82, 2
s_and_b32 s91, s91, 3
s_lshl_b32 s91, s91, 11
s_add_u32 s76, s90, s91
s_add_u32 s91, s82, 3
s_and_b32 s91, s91, 3
s_lshl_b32 s91, s91, 11
s_add_u32 s77, s90, s91
s_lshr_b32 s91, s88, 1
s_add_u32 s85, s88, s91
s_add_u32 s91, s85, 0
s_cmp_ge_u32 s91, 6
s_cselect_b32 s98, 6, 0
s_sub_u32 s91, s91, s98
s_lshl_b32 s91, s91, 10
v_add_u32 v58, s91, v4
s_add_u32 s91, s85, 1
s_cmp_ge_u32 s91, 6
s_cselect_b32 s98, 6, 0
s_sub_u32 s91, s91, s98
s_lshl_b32 s91, s91, 10
v_add_u32 v59, s91, v4
s_add_u32 s91, s85, 2
s_cmp_ge_u32 s91, 6
s_cselect_b32 s98, 6, 0
s_sub_u32 s91, s91, s98
s_lshl_b32 s91, s91, 10
v_add_u32 v60, s91, v4
s_add_u32 s91, s85, 3
s_cmp_ge_u32 s91, 6
s_cselect_b32 s98, 6, 0
s_sub_u32 s91, s91, s98
s_lshl_b32 s91, s91, 10
v_add_u32 v61, s91, v4
s_add_u32 s91, s85, 4
s_cmp_ge_u32 s91, 6
s_cselect_b32 s98, 6, 0
s_sub_u32 s91, s91, s98
s_lshl_b32 s91, s91, 10
v_add_u32 v62, s91, v4
s_add_u32 s91, s85, 5
s_cmp_ge_u32 s91, 6
s_cselect_b32 s98, 6, 0
s_sub_u32 s91, s91, s98
s_lshl_b32 s91, s91, 10
v_add_u32 v63, s91, v4
s_lshl_b32 s90, s31, 4
s_add_u32 s90, s90, s32
s_lshl_b32 s90, s90, 1
s_add_u32 s90, s90, s89
s_lshl_b32 s90, s90, 7
s_lshl_b32 s91, s28, 5
s_add_u32 s90, s90, s91
s_mul_i32 s78, s90, 6144
s_mul_i32 s90, s32, 192
s_mul_i32 s91, s89, 96
s_add_u32 s90, s90, s91
s_lshl_b32 s90, s90, 11
s_lshl_b32 s91, s31, 10
s_add_u32 s90, s90, s91
s_lshl_b32 s91, s88, 8
s_add_u32 s90, s90, s91
s_and_b32 s91, s82, 3
s_lshl_b32 s91, s91, 6
s_add_u32 s79, s90, s91
s_mov_b32 s4, s68
s_mov_b32 s5, s69
s_mov_b32 s6, 6291456
s_mov_b32 s7, 0x00020000
v_add_u32 v6, 4096, v4
s_lshl_b32 s90, s28, 20
s_lshl_b32 s91, s88, 8
s_add_u32 s74, s90, s91
s_lshl_b32 s75, s28, 15
v_and_b32 v32, 15, v0
v_lshrrev_b32 v33, 4, v0
v_lshlrev_b32 v35, 2, v33
v_xor_b32 v35, v35, v32
v_lshlrev_b32 v35, 4, v35
v_lshl_add_u32 v2, v33, 10, v35
v_add_u32 v3, 3072, v2
v_add_u32 v6, 6144, v2
v_add_u32 v7, 9216, v2
v_lshrrev_b32 v35, 2, v32
v_and_b32 v32, 3, v32
v_lshl_add_u32 v33, v33, 2, v35
v_lshlrev_b32 v33, 8, v33
v_add_u32 v33, s75, v33
v_lshlrev_b32 v35, 2, v35
s_add_u32 s91, s82, 0
s_and_b32 s91, s91, 3
s_lshl_b32 s91, s91, 2
v_add_u32 v54, s91, v32
v_xor_b32 v54, v54, v35
v_lshl_add_u32 v54, v54, 4, v33
s_add_u32 s91, s82, 1
s_and_b32 s91, s91, 3
s_lshl_b32 s91, s91, 2
v_add_u32 v55, s91, v32
v_xor_b32 v55, v55, v35
v_lshl_add_u32 v55, v55, 4, v33
s_add_u32 s91, s82, 2
s_and_b32 s91, s91, 3
s_lshl_b32 s91, s91, 2
v_add_u32 v56, s91, v32
v_xor_b32 v56, v56, v35
v_lshl_add_u32 v56, v56, 4, v33
s_add_u32 s91, s82, 3
s_and_b32 s91, s91, 3
s_lshl_b32 s91, s91, 2
v_add_u32 v57, s91, v32
v_xor_b32 v57, v57, v35
v_lshl_add_u32 v57, v57, 4, v33
s_add_u32 s81, s74, 0
s_add_u32 m0, s75, 0
s_nop 0
buffer_load_dwordx4 v2, s[20:23], s81 offen offset:0 lds
buffer_load_dwordx4 v3, s[20:23], s81 offen offset:1024 lds
buffer_load_dwordx4 v6, s[20:23], s81 offen offset:2048 lds
buffer_load_dwordx4 v7, s[20:23], s81 offen offset:3072 lds
s_add_u32 s81, s74, 16384
s_add_u32 m0, s75, 4096
s_nop 0
buffer_load_dwordx4 v2, s[20:23], s81 offen offset:0 lds
buffer_load_dwordx4 v3, s[20:23], s81 offen offset:1024 lds
buffer_load_dwordx4 v6, s[20:23], s81 offen offset:2048 lds
buffer_load_dwordx4 v7, s[20:23], s81 offen offset:3072 lds
s_add_u32 s81, s74, 32768
s_add_u32 m0, s75, 8192
s_nop 0
buffer_load_dwordx4 v2, s[20:23], s81 offen offset:0 lds
buffer_load_dwordx4 v3, s[20:23], s81 offen offset:1024 lds
buffer_load_dwordx4 v6, s[20:23], s81 offen offset:2048 lds
buffer_load_dwordx4 v7, s[20:23], s81 offen offset:3072 lds
s_add_u32 s81, s74, 49152
s_add_u32 m0, s75, 12288
s_nop 0
buffer_load_dwordx4 v2, s[20:23], s81 offen offset:0 lds
buffer_load_dwordx4 v3, s[20:23], s81 offen offset:1024 lds
buffer_load_dwordx4 v6, s[20:23], s81 offen offset:2048 lds
buffer_load_dwordx4 v7, s[20:23], s81 offen offset:3072 lds
s_add_u32 s81, s74, 65536
s_add_u32 m0, s75, 16384
s_nop 0
buffer_load_dwordx4 v2, s[20:23], s81 offen offset:0 lds
buffer_load_dwordx4 v3, s[20:23], s81 offen offset:1024 lds
buffer_load_dwordx4 v6, s[20:23], s81 offen offset:2048 lds
buffer_load_dwordx4 v7, s[20:23], s81 offen offset:3072 lds
s_add_u32 s81, s74, 81920
s_add_u32 m0, s75, 20480
s_nop 0
buffer_load_dwordx4 v2, s[20:23], s81 offen offset:0 lds
buffer_load_dwordx4 v3, s[20:23], s81 offen offset:1024 lds
buffer_load_dwordx4 v6, s[20:23], s81 offen offset:2048 lds
buffer_load_dwordx4 v7, s[20:23], s81 offen offset:3072 lds
s_branch L_OE1
.section .rodata,"a"
.p2align 6
.amdhsa_kernel concat_heads__mha_block_cached__gqa_block_cached__near_ridge_kernel
  .amdhsa_next_free_vgpr 512
  .amdhsa_next_free_sgpr 102
  .amdhsa_accum_offset 256
  .amdhsa_group_segment_fixed_size 0
  .amdhsa_kernarg_size 104
  .amdhsa_user_sgpr_count 2
  .amdhsa_user_sgpr_kernarg_segment_ptr 1
  .amdhsa_system_sgpr_workgroup_id_x 1
  .amdhsa_float_denorm_mode_32 3
.end_amdhsa_kernel
```
